```python
import torch

def _softmax(x, axis=-1):
    return torch.softmax(x, dim=axis)
def _gelu(x):
    return torch.nn.functional.gelu(x, approximate="tanh")
def _silu(x):
    return torch.nn.functional.silu(x)
def _sigmoid(x):
    return torch.sigmoid(x)
def _layernorm(x, axis=-1, eps=1e-5):
    m = x.mean(dim=axis, keepdim=True)
    v = x.var(dim=axis, keepdim=True, unbiased=False)
    return (x - m) / torch.sqrt(v + eps)
def _scatter_add(tgt, idx, src, axis=0):
    return tgt.clone().index_add_(axis, idx, src)
def _segment_sum(src, seg, n):
    out = torch.zeros((n,) + src.shape[1:], dtype=src.dtype)
    return out.index_add_(0, seg, src)
def _pad(x, pw):
    flat = tuple(v for pair in reversed(pw) for v in pair)
    return torch.nn.functional.pad(x, flat)

kernel_name = 'standalone__modern_conv_block_convnext__vision'

def setup_inputs():

    _w = (lambda a: (lambda t: t.to(torch.bfloat16) if t.is_floating_point() else t)(torch.as_tensor(a)))
    H = W = 224
    C = 192
    K = 3
    return {
        "x": _w((lambda *s: torch.randn(*s, dtype=torch.bfloat16) * 0.05)(1, H, W, C)),
        "dw": _w((lambda *s: torch.randn(*s, dtype=torch.bfloat16) * 0.05)(K, K, C)),
        "w1": _w((lambda *s: torch.randn(*s, dtype=torch.bfloat16) * 0.05)(C, 4 * C)),
        "b1": _w((lambda *s: torch.randn(*s, dtype=torch.bfloat16) * 0.2)(4 * C)),
        "w2": _w((lambda *s: torch.randn(*s, dtype=torch.bfloat16) * 0.05)(4 * C, C)),
        "b2": _w((lambda *s: torch.randn(*s, dtype=torch.bfloat16) * 0.4)(C)),
        "gamma": _w((lambda *s: torch.randn(*s, dtype=torch.bfloat16) * 0.05)(C)),
    }

def reference(x, dw, w1, b1, w2, b2, gamma):
    B, H, W, C = x.shape
    K = dw.shape[0]
    pad = K // 2
    xp = _pad(x, ((0,0),(pad,pad),(pad,pad),(0,0)))
    out = torch.zeros_like(x)
    for i in range(K):
        for j in range(K):
            out = out + xp[:, i:i+H, j:j+W, :] * dw[i, j][None, None, None, :]
    h = _layernorm(out, axis=-1)
    h = torch.einsum('bhwc,ce->bhwe', h, w1) + b1
    h = _gelu(h)
    h = torch.einsum('bhwe,ec->bhwc', h, w2) + b2
    return x + gamma[None, None, None, :] * h
```

```asm
; @launch grid=(256,1,1) block=(256,1,1) lds=163840
.amdgcn_target "amdgcn-amd-amdhsa--gfx950"
.text
.globl standalone__modern_conv_block_convnext__vision_kernel
.p2align 8
.type standalone__modern_conv_block_convnext__vision_kernel,@function
standalone__modern_conv_block_convnext__vision_kernel:
    s_cmp_ge_u32 s2, 256
    s_cbranch_scc1 L_exit
    s_load_dwordx2 s[8:9], s[0:1], 0
    s_load_dwordx2 s[24:25], s[0:1], 8
    s_getpc_b64 s[42:43]
L_pf:
    s_lshl_b32 s38, s2, 3
    s_add_u32 s38, s38, L_wgtab-L_pf
    s_load_dwordx2 s[54:55], s[42:43], s38
    s_lshr_b32 s41, s2, 3
    s_lshl_b32 s41, s41, 12
    v_lshrrev_b32 v104, 3, v0
    v_lshl_add_u32 v104, v104, 7, s41
    v_min_u32 v104, L_exit-L_pf, v104
    global_load_dword v102, v104, s[42:43]
    v_lshrrev_b32 v40, 6, v0
    s_movk_i32 s44, 384
    v_readfirstlane_b32 s28, v40
    v_lshrrev_b32 v116, 3, v0
    v_and_b32 v121, 7, v0
    v_mul_u32_u24 v117, 3641, v116
    v_lshrrev_b32 v117, 16, v117
    v_mul_u32_u24 v118, 18, v117
    v_sub_u32 v118, v116, v118
    v_bfe_u32 v106, v118, 1, 3
    v_xor_b32 v106, v106, v121
    v_mul_u32_u24 v117, 79104, v117
    v_mad_u32_u24 v117, v116, s44, v117
    v_lshl_add_u32 v148, v106, 4, v117
    v_bfrev_b32 v122, 2
    v_lshlrev_b32 v18, 4, v0
    s_mov_b32 s10, 19267584
    s_mov_b32 s11, 0x20000
    s_movk_i32 s26, 3456
    s_mov_b32 s27, s11
    s_lshl_b32 s50, s28, 10
    s_add_u32 s50, s50, 49408
    s_waitcnt lgkmcnt(0)
    buffer_load_dwordx4 v[76:79], v18, s[24:27], 0 offen
    s_load_dwordx2 s[12:13], s[0:1], 16
    s_load_dwordx2 s[16:17], s[0:1], 32
    s_load_dwordx2 s[20:21], s[0:1], 56
    s_load_dwordx2 s[60:61], s[0:1], 24
    s_load_dwordx4 s[64:67], s[0:1], 40
    s_and_b32 s53, s55, 0xff
    s_bfe_u32 s56, s55, 0x80008
    s_bfe_u32 s31, s55, 0x80010
    s_cmp_lt_u32 s31, 13
    s_cbranch_scc1 L_body0
L_body1:
    v_subrev_u32 v118, s53, v118
    v_cmp_gt_u32 vcc, s56, v118
    v_add_u32 v148, s54, v148
    s_nop 0
    v_cndmask_b32 v148, v122, v148, vcc
    s_add_u32 m0, s50, 0
    s_nop 0
    buffer_load_dwordx4 v148, s[8:11], 0 offen lds
    s_mov_b32 s57, 344064
    v_add_u32 v150, s57, v148
    s_add_u32 m0, s50, 9216
    s_nop 0
    buffer_load_dwordx4 v150, s[8:11], 0 offen lds
    v_add_u32 v152, s57, v150
    v_add_u32 v116, 32, v116
    v_mul_u32_u24 v117, 3641, v116
    v_lshrrev_b32 v117, 16, v117
    v_mul_u32_u24 v119, 18, v117
    v_sub_u32 v119, v116, v119
    v_bfe_u32 v106, v119, 1, 3
    v_xor_b32 v106, v106, v121
    v_mul_u32_u24 v117, 79104, v117
    v_mad_u32_u24 v117, v116, s44, v117
    v_lshl_add_u32 v149, v106, 4, v117
    v_and_b32 v1, 63, v0
    s_add_u32 m0, s50, 18432
    s_nop 0
    buffer_load_dwordx4 v152, s[8:11], 0 offen lds
    v_add_u32 v154, s57, v152
    v_subrev_u32 v119, s53, v119
    v_cmp_gt_u32 vcc, s56, v119
    v_add_u32 v149, s54, v149
    s_nop 0
    v_cndmask_b32 v149, v122, v149, vcc
    v_mov_b32 v81, 0
    v_mov_b32 v83, 0
    v_mov_b32 v85, 0
    v_mov_b32 v87, 0
    v_mov_b32 v88, 0
    v_mov_b32 v90, 0
    s_add_u32 m0, s50, 27648
    s_nop 0
    buffer_load_dwordx4 v154, s[8:11], 0 offen lds
    s_add_u32 s30, s50, 31744
    s_mul_i32 s51, s28, 9216
    s_add_u32 s51, s51, 57600
    s_mul_i32 s40, s28, s57
    s_add_u32 s40, s40, s54
    s_cmp_lt_u32 s28, 3
    s_cselect_b32 s30, s30, 158976
    s_cselect_b32 s51, s51, 158976
    s_cselect_b32 s52, 34688, 0
    s_cselect_b32 s40, s40, 0x40000000
    v_mov_b32 v92, 0
    v_mov_b32 v94, 0
    s_add_u32 m0, s50, 4096
    s_nop 0
    buffer_load_dwordx4 v149, s[8:11], 0 offen lds
    v_add_u32 v151, s57, v149
    v_bfe_u32 v116, v0, 3, 3
    v_add_u32 v116, 64, v116
    v_mul_u32_u24 v117, 3641, v116
    v_lshrrev_b32 v117, 16, v117
    v_mul_u32_u24 v120, 18, v117
    v_sub_u32 v120, v116, v120
    v_bfe_u32 v106, v120, 1, 3
    v_xor_b32 v106, v106, v121
    v_mul_u32_u24 v117, 79104, v117
    v_mad_u32_u24 v117, v116, s44, v117
    v_lshl_add_u32 v156, v106, 4, v117
    s_add_u32 m0, s50, 13312
    s_nop 0
    buffer_load_dwordx4 v151, s[8:11], 0 offen lds
    v_add_u32 v153, s57, v151
    v_subrev_u32 v120, s53, v120
    v_cmp_gt_u32 vcc, s56, v120
    v_add_u32 v156, s40, v156
    s_nop 0
    v_cndmask_b32 v156, v122, v156, vcc
    s_mov_b32 s58, 0x98532410
    s_mov_b32 s59, 0x00000f67
    v_mul_u32_u24 v40, 2731, v0
    v_lshrrev_b32 v40, 16, v40
    v_mul_u32_u24 v41, 24, v40
    v_sub_u32 v41, v0, v41
    s_add_u32 m0, s50, 22528
    s_nop 0
    buffer_load_dwordx4 v153, s[8:11], 0 offen lds
    s_cmp_lt_u32 s28, 3
    s_cselect_b32 s41, s57, 0x40000000
    v_add_u32 v155, s41, v153
    v_lshlrev_b32 v40, 2, v40
    v_lshrrev_b64 v[42:43], v40, s[58:59]
    v_and_b32 v40, 1, v42
    v_lshlrev_b32 v40, 3, v40
    v_lshl_add_u32 v40, v41, 4, v40
    v_bfe_u32 v42, v42, 1, 3
    v_mul_u32_u24 v41, 384, v42
    s_mov_b32 m0, s30
    s_add_u32 s30, s30, s52
    buffer_load_dwordx4 v155, s[8:11], 0 offen lds
    s_mov_b32 m0, s51
    s_add_u32 s51, s51, s52
    buffer_load_dwordx4 v156, s[8:11], 0 offen lds
    s_add_u32 s29, s54, 86400
    v_cmp_gt_u32 vcc, 5, v42
    v_add_u32 v40, v40, v41
    v_mov_b32 v41, 262144
    v_cndmask_b32 v123, v41, v40, vcc
    v_and_b32 v44, 15, v1
    v_lshrrev_b32 v45, 4, v1
    s_waitcnt lgkmcnt(0)
    s_cmp_eq_u32 s28, 3
    s_cselect_b64 s[60:61], s[64:65], s[60:61]
    s_movk_i32 s62, 1536
    s_cselect_b32 s62, 384, s62
    s_mov_b32 s63, s11
    s_cselect_b32 s41, 63, -1
    v_and_b32 v103, s41, v0
    v_lshlrev_b32 v103, 3, v103
    buffer_load_dwordx2 v[96:97], v103, s[60:63], 0 offen
    v_and_b32 v46, 1, v45
    v_lshrrev_b32 v47, 1, v45
    v_lshrrev_b32 v40, 3, v44
    v_xor_b32 v40, v40, v46
    v_mul_u32_u24 v40, 262144, v40
    v_lshl_add_u32 v40, v46, 4, v40
    v_and_b32 v41, 7, v44
    v_mul_u32_u24 v41, 1936, v41
    v_add_u32 v40, v40, v41
    v_mul_u32_u24 v41, 384, v47
    s_mov_b64 s[64:65], s[66:67]
    s_movk_i32 s66, 384
    s_mov_b32 s67, s11
    v_lshlrev_b32 v103, 3, v1
    buffer_load_dwordx2 v[98:99], v103, s[64:67], 0 offen
    v_add_u32 v48, v40, v41
    v_xor_b32 v41, 1, v47
    v_mul_u32_u24 v41, 262144, v41
    v_add_u32 v49, v40, v41
    s_lshl_b32 s38, s28, 5
    v_add_u32 v50, s38, v48
    v_add_u32 v51, s38, v49
    v_mov_b32 v52, 0
    v_mov_b32 v53, 0
    v_mov_b32 v54, 0
    s_add_u32 m0, s50, 34688
    s_nop 0
    buffer_load_dwordx4 v148, s[8:11], 0 offen offset:128 lds
    v_mov_b32 v55, 0
    s_waitcnt vmcnt(12)
    v_and_b32 v80, 0xffff, v76
    v_lshrrev_b32 v82, 16, v76
    v_and_b32 v84, 0xffff, v77
    v_lshrrev_b32 v86, 16, v77
    v_and_b32 v89, 0xffff, v78
    v_lshrrev_b32 v91, 16, v78
    v_and_b32 v93, 0xffff, v79
    v_lshrrev_b32 v95, 16, v79
    ds_write_b64 v123, v[80:81] offset:24576
    ds_write_b64 v123, v[82:83] offset:26512
    ds_write_b64 v123, v[84:85] offset:28448
    ds_write_b64 v123, v[86:87] offset:30384
    ds_write_b64 v123, v[88:89] offset:32320
    ds_write_b64 v123, v[90:91] offset:34256
    ds_write_b64 v123, v[92:93] offset:36192
    ds_write_b64 v123, v[94:95] offset:38128
    v_lshrrev_b32 v40, 3, v1
    v_and_b32 v41, 7, v1
    v_and_b32 v42, 6, v40
    v_xor_b32 v41, v41, v42
    v_mul_u32_u24 v40, 1536, v40
    v_lshl_add_u32 v14, v41, 4, v40
    s_mul_i32 s38, s28, 73728
    v_add_u32 v14, s38, v14
    v_bfe_u32 v40, v1, 2, 3
    v_and_b32 v41, 4, v40
    v_mfma_f32_32x32x16_bf16 v[160:175], v[52:55], v[52:55], 0
    v_add_u32 v40, v40, v41
    v_mul_u32_u24 v40, 384, v40
    v_lshl_add_u32 v40, v47, 6, v40
    v_and_b32 v41, 3, v1
    v_lshl_add_u32 v15, v41, 4, v40
    s_add_u32 m0, s50, 38784
    s_nop 0
    buffer_load_dwordx4 v149, s[8:11], 0 offen offset:128 lds
    s_waitcnt lgkmcnt(0)
    s_barrier
    ds_read_b128 a[0:3], v48 offset:24576
    ds_read_b128 a[4:7], v48 offset:25344
    ds_read_b128 a[8:11], v49 offset:26112
    ds_read_b128 a[12:15], v48 offset:24608
    ds_read_b128 a[16:19], v48 offset:25376
    s_add_u32 m0, s50, 43904
    s_nop 0
    buffer_load_dwordx4 v150, s[8:11], 0 offen offset:128 lds
    s_mul_i32 s38, s28, 6144
    v_add_u32 v15, s38, v15
    s_mov_b32 s14, 294912
    s_mov_b32 s15, s11
    s_mov_b64 s[18:19], s[14:15]
    v_mfma_f32_32x32x16_bf16 v[176:191], v[52:55], v[52:55], 0
    s_mov_b64 s[22:23], s[10:11]
    s_mul_i32 s45, s28, 6144
    s_add_u32 s45, s45, 0
    s_mul_i32 s46, s28, 6160
    s_add_u32 s46, s46, 24576
    s_mov_b32 s35, 0
    v_add_u32 v40, 1, v41
    ds_read_b128 a[20:23], v49 offset:26144
    ds_read_b128 a[24:27], v48 offset:24640
    ds_read_b128 a[28:31], v48 offset:25408
    ds_read_b128 a[32:35], v49 offset:26176
    ds_read_b128 a[36:39], v48 offset:24672
    s_add_u32 m0, s50, 48000
    s_nop 0
    buffer_load_dwordx4 v151, s[8:11], 0 offen offset:128 lds
    v_and_b32 v40, 3, v40
    v_lshl_add_u32 v40, v40, 2, v41
    v_mul_u32_u24 v157, 0x1111, v40
    v_mfma_f32_32x32x16_bf16 v[192:207], v[52:55], v[52:55], 0
    s_mul_i32 s38, s28, 6912
    s_add_u32 s38, s38, 49408
    s_lshl_b32 s39, s28, 5
    v_add_u32 v40, v46, v44
    v_bfe_u32 v41, v40, 1, 3
    v_xor_b32 v41, v41, v47
    v_lshlrev_b32 v40, 7, v40
    v_lshl_add_u32 v40, v41, 4, v40
    v_add_u32 v140, s38, v40
    ds_read_b128 a[40:43], v48 offset:25440
    ds_read_b128 a[44:47], v49 offset:26208
    ds_read_b128 a[48:51], v48 offset:24704
    ds_read_b128 a[52:55], v48 offset:25472
    ds_read_b128 a[56:59], v49 offset:26240
    s_add_u32 m0, s50, 53120
    s_nop 0
    buffer_load_dwordx4 v152, s[8:11], 0 offen offset:128 lds
    v_xor_b32 v141, 32, v140
    v_mfma_f32_32x32x16_bf16 v[208:223], v[52:55], v[52:55], 0
    v_xor_b32 v142, 64, v140
    v_xor_b32 v143, 96, v140
    v_xor_b32 v40, s39, v40
    v_add_u32 v34, 77056, v40
    v_add_u32 v40, 2, v44
    v_bfe_u32 v41, v40, 1, 3
    v_xor_b32 v41, v41, v47
    v_lshlrev_b32 v40, 7, v40
    v_lshl_add_u32 v40, v41, 4, v40
    v_mul_u32_u24 v41, 2304, v46
    v_mfma_f32_32x32x16_bf16 v[224:239], v[52:55], v[52:55], 0
    ds_read_b128 a[60:63], v48 offset:24736
    ds_read_b128 a[64:67], v48 offset:25504
    ds_read_b128 a[68:71], v49 offset:26272
    ds_read_b128 a[72:75], v48 offset:24768
    ds_read_b128 a[76:79], v48 offset:25536
    s_add_u32 m0, s50, 57216
    s_nop 0
    buffer_load_dwordx4 v153, s[8:11], 0 offen offset:128 lds
    v_add_u32 v40, v40, v41
    v_add_u32 v144, s38, v40
    v_xor_b32 v145, 32, v144
    v_xor_b32 v146, 64, v144
    v_xor_b32 v147, 96, v144
    v_xor_b32 v40, s39, v40
    v_add_u32 v35, 77056, v40
    v_add_u32 v40, 1, v44
    v_bfe_u32 v41, v40, 1, 3
    v_xor_b32 v41, v41, v45
    v_mfma_f32_32x32x16_bf16 v[240:255], v[52:55], v[52:55], 0
    v_lshlrev_b32 v40, 7, v40
    v_lshl_add_u32 v40, v41, 4, v40
    ds_read_b128 a[80:83], v49 offset:26304
    ds_read_b128 a[84:87], v48 offset:24800
    ds_read_b128 a[88:91], v48 offset:25568
    ds_read_b128 a[92:95], v49 offset:26336
    ds_read_b128 a[96:99], v48 offset:24832
    s_add_u32 m0, s50, 62336
    s_nop 0
    buffer_load_dwordx4 v154, s[8:11], 0 offen offset:128 lds
    v_add_u32 v40, 2304, v40
    v_add_u32 v32, s38, v40
    v_xor_b32 v33, 64, v32
    s_lshr_b32 s38, s28, 1
    s_lshl_b32 s38, s38, 10
    s_and_b32 s39, s28, 1
    s_lshl_b32 s39, s39, 3
    s_add_u32 s38, s38, s39
    v_mfma_f32_16x16x32_bf16 v[20:23], v[52:55], v[52:55], 0
    v_lshl_add_u32 v19, v1, 4, s38
    v_lshlrev_b32 v159, 5, v44
    s_lshl_b32 s38, s28, 2
    v_lshl_add_u32 v158, v47, 4, v159
    ds_read_b128 a[100:103], v48 offset:25600
    ds_read_b128 a[104:107], v49 offset:26368
    ds_read_b128 a[108:111], v48 offset:24864
    ds_read_b128 a[112:115], v48 offset:25632
    ds_read_b128 a[116:119], v49 offset:26400
    s_mov_b32 m0, s30
    s_add_u32 s30, s30, s52
    buffer_load_dwordx4 v155, s[8:11], 0 offen offset:128 lds
    v_add_u32 v158, s38, v158
    v_bfe_u32 v40, v1, 2, 3
    v_and_b32 v42, 3, v1
    v_lshlrev_b32 v43, 7, v40
    v_lshl_add_u32 v43, v47, 10, v43
    v_lshl_add_u32 v43, v42, 3, v43
    v_mfma_f32_16x16x32_bf16 v[24:27], v[52:55], v[52:55], 0
    v_lshrrev_b32 v2, 1, v40
    v_xor_b32 v2, s28, v2
    v_lshl_add_u32 v2, v2, 5, v43
    v_xor_b32 v3, 32, v2
    v_xor_b32 v4, 64, v2
    v_xor_b32 v5, 96, v2
    ds_read_b128 a[120:123], v48 offset:24896
    ds_read_b128 a[124:127], v48 offset:25664
    ds_read_b128 a[128:131], v49 offset:26432
    ds_read_b128 a[132:135], v48 offset:24928
    ds_read_b128 a[136:139], v48 offset:25696
    s_mov_b32 m0, s51
    s_add_u32 s51, s51, s52
    buffer_load_dwordx4 v156, s[8:11], 0 offen offset:128 lds
    v_mul_u32_u24 v43, 3080, v46
    v_lshl_add_u32 v43, v47, 8, v43
    v_lshl_add_u32 v43, v44, 4, v43
    v_lshlrev_b32 v42, 4, v45
    v_mfma_f32_16x16x32_bf16 v[28:31], v[52:55], v[52:55], 0
    s_xor_b32 s38, s28, 0
    s_mul_i32 s39, s38, 6160
    s_add_u32 s39, s39, 73984
    v_add_u32 v6, s39, v43
    s_xor_b32 s38, s28, 1
    s_mul_i32 s39, s38, 6160
    s_add_u32 s39, s39, 73984
    v_add_u32 v7, s39, v43
    ds_read_b128 a[140:143], v49 offset:26464
    ds_read_b128 a[144:147], v50 offset:24576
    ds_read_b128 a[148:151], v50 offset:25344
    ds_read_b128 a[152:155], v51 offset:26112
    ds_read_b128 a[156:159], v50 offset:24704
    s_add_u32 m0, s50, 69376
    s_nop 0
    buffer_load_dwordx4 v148, s[8:11], 0 offen offset:256 lds
    s_xor_b32 s38, s28, 2
    s_mul_i32 s39, s38, 6160
    s_add_u32 s39, s39, 73984
    v_add_u32 v8, s39, v43
    s_xor_b32 s38, s28, 3
    s_mul_i32 s39, s38, 6160
    s_add_u32 s39, s39, 73984
    v_add_u32 v9, s39, v43
    s_lshl_b32 s38, s28, 6
    s_add_u32 s38, s38, 153856
    v_add_u32 v10, s38, v42
    v_xor_b32 v11, 64, v10
    v_xor_b32 v12, 128, v10
    ds_read_b128 a[160:163], v50 offset:25472
    ds_read_b128 a[164:167], v51 offset:26240
    ds_read_b128 a[168:171], v50 offset:24832
    ds_read_b128 a[172:175], v50 offset:25600
    ds_read_b128 a[176:179], v51 offset:26368
    s_add_u32 m0, s50, 73472
    s_nop 0
    buffer_load_dwordx4 v149, s[8:11], 0 offen offset:256 lds
    v_xor_b32 v13, 192, v10
    v_lshlrev_b32 v17, 5, v45
    v_add_u32 v17, 156928, v17
    v_mul_u32_u24 v16, 384, v44
    v_add3_u32 v16, v16, v42, s29
    s_waitcnt vmcnt(11)
    v_mfma_f32_32x32x16_bf16 v[76:91], v[52:55], v[52:55], 0
    s_mov_b32 s38, 0x3eefde6e
    v_lshlrev_b32 v104, 16, v96
    v_and_b32 v105, 0xffff0000, v96
    v_lshlrev_b32 v106, 16, v97
    v_and_b32 v107, 0xffff0000, v97
    v_mul_f32 v104, s38, v104
    v_mul_f32 v105, s38, v105
    v_mul_f32 v106, s38, v106
    v_mul_f32 v107, s38, v107
    s_mov_b32 s38, 0x40089ba4
    v_lshlrev_b32 v108, 16, v98
    v_and_b32 v109, 0xffff0000, v98
    v_lshlrev_b32 v110, 16, v99
    v_and_b32 v111, 0xffff0000, v99
    v_mul_f32 v108, s38, v108
    v_mul_f32 v109, s38, v109
    v_mul_f32 v110, s38, v110
    v_mul_f32 v111, s38, v111
    v_add_u32 v100, 153856, v18
    s_mov_b32 s38, 157952
    v_lshl_add_u32 v101, v1, 4, s38
    ds_write_b128 v100, v[104:107]
    ds_write_b128 v101, v[108:111]
    s_mul_i32 s38, s28, -6912
    s_add_u32 s38, s38, 27648
    s_lshr_b32 s39, s28, 1
    s_mul_i32 s39, s39, 34816
    s_add_u32 s38, s38, s39
    s_and_b32 s39, s28, 1
    s_lshl_b32 s39, s39, 6
    v_xor_b32 v18, s39, v32
    v_add_u32 v18, s38, v18
    s_waitcnt lgkmcnt(0)
    v_mfma_f32_32x32x16_bf16 v[92:107], v[52:55], v[52:55], 0
    v_mfma_f32_32x32x16_bf16 v[108:123], v[52:55], v[52:55], 0
    s_waitcnt vmcnt(13)
    s_barrier
    ds_read_b128 a[180:183], v140 offset:0
    ds_read_b128 a[184:187], v140 offset:2304
    ds_read_b128 a[188:191], v140 offset:4608
    ds_read_b128 a[192:195], v140 offset:6912
    ds_read_b128 a[196:199], v140 offset:9216
    ds_read_b128 a[200:203], v144 offset:0
    ds_read_b128 a[204:207], v144 offset:2304
    ds_read_b128 a[208:211], v144 offset:4608
    ds_read_b128 a[212:215], v144 offset:6912
    ds_read_b128 v[52:55], v141 offset:0
    ds_read_b128 v[56:59], v141 offset:2304
    ds_read_b128 v[60:63], v141 offset:4608
    s_waitcnt lgkmcnt(10)
    v_smfmac_f32_16x16x64_bf16 v[160:163], a[0:3], a[180:187], v157
    s_waitcnt lgkmcnt(9)
    ds_read_b128 v[64:67], v141 offset:6912
    ds_read_b128 v[68:71], v141 offset:9216
    v_smfmac_f32_16x16x64_bf16 v[160:163], a[8:11], a[184:191], v157
    ds_read_b128 v[124:127], v145 offset:0
    s_add_u32 m0, s50, 78592
    s_nop 0
    buffer_load_dwordx4 v150, s[8:11], 0 offen offset:256 lds
    v_smfmac_f32_16x16x64_bf16 v[76:79], a[0:3], a[184:191], v157
    s_waitcnt lgkmcnt(11)
    ds_read_b128 v[128:131], v145 offset:2304
    v_smfmac_f32_16x16x64_bf16 v[76:79], a[8:11], a[188:195], v157
    ds_read_b128 v[132:135], v145 offset:4608
    v_smfmac_f32_16x16x64_bf16 v[208:211], a[0:3], a[188:195], v157
    s_waitcnt lgkmcnt(12)
    ds_read_b128 v[136:139], v145 offset:6912
    v_smfmac_f32_16x16x64_bf16 v[208:211], a[8:11], a[192:199], v157
    s_waitcnt lgkmcnt(11)
    ds_read_b128 a[180:183], v34 offset:0
    s_add_u32 m0, s50, 82688
    s_nop 0
    buffer_load_dwordx4 v151, s[8:11], 0 offen offset:256 lds
    v_smfmac_f32_16x16x64_bf16 v[160:163], a[4:7], a[200:207], v157
    s_waitcnt lgkmcnt(11)
    ds_read_b128 a[184:187], v34 offset:2304
    v_smfmac_f32_16x16x64_bf16 v[76:79], a[4:7], a[204:211], v157
    s_waitcnt lgkmcnt(11)
    ds_read_b128 a[188:191], v34 offset:4608
    v_smfmac_f32_16x16x64_bf16 v[208:211], a[4:7], a[208:215], v157
    s_waitcnt lgkmcnt(10)
    ds_read_b128 a[200:203], v35 offset:0
    v_smfmac_f32_16x16x64_bf16 v[164:167], a[12:15], v[52:59], v157
    s_waitcnt lgkmcnt(10)
    ds_read_b128 a[204:207], v35 offset:2304
    s_add_u32 m0, s50, 87808
    s_nop 0
    buffer_load_dwordx4 v152, s[8:11], 0 offen offset:256 lds
    v_smfmac_f32_16x16x64_bf16 v[164:167], a[20:23], v[56:63], v157
    ds_read_b128 v[52:55], v142 offset:0
    v_smfmac_f32_16x16x64_bf16 v[80:83], a[12:15], v[56:63], v157
    s_waitcnt lgkmcnt(11)
    ds_read_b128 v[56:59], v142 offset:2304
    v_smfmac_f32_16x16x64_bf16 v[80:83], a[20:23], v[60:67], v157
    v_smfmac_f32_16x16x64_bf16 v[212:215], a[12:15], v[60:67], v157
    s_waitcnt lgkmcnt(11)
    ds_read_b128 v[60:63], v142 offset:4608
    s_add_u32 m0, s50, 91904
    s_nop 0
    buffer_load_dwordx4 v153, s[8:11], 0 offen offset:256 lds
    v_smfmac_f32_16x16x64_bf16 v[212:215], a[20:23], v[64:71], v157
    s_waitcnt lgkmcnt(10)
    ds_read_b128 v[64:67], v142 offset:6912
    ds_read_b128 v[68:71], v142 offset:9216
    v_smfmac_f32_16x16x64_bf16 v[164:167], a[16:19], v[124:131], v157
    s_waitcnt lgkmcnt(11)
    ds_read_b128 v[124:127], v146 offset:0
    v_smfmac_f32_16x16x64_bf16 v[80:83], a[16:19], v[128:135], v157
    s_waitcnt lgkmcnt(11)
    ds_read_b128 v[128:131], v146 offset:2304
    v_smfmac_f32_16x16x64_bf16 v[212:215], a[16:19], v[132:139], v157
    s_waitcnt lgkmcnt(10)
    ds_read_b128 v[132:135], v146 offset:4608
    s_add_u32 m0, s50, 97024
    s_nop 0
    buffer_load_dwordx4 v154, s[8:11], 0 offen offset:256 lds
    v_smfmac_f32_16x16x64_bf16 v[20:23], a[144:147], a[180:187], v157
    s_waitcnt lgkmcnt(10)
    ds_read_b128 v[136:139], v146 offset:6912
    v_smfmac_f32_16x16x64_bf16 v[20:23], a[152:155], a[184:191], v157
    s_waitcnt lgkmcnt(9)
    ds_read_b128 a[180:183], v143 offset:0
    ds_read_b128 a[184:187], v143 offset:2304
    v_smfmac_f32_16x16x64_bf16 v[20:23], a[148:151], a[200:207], v157
    s_waitcnt lgkmcnt(9)
    ds_read_b128 a[188:191], v143 offset:4608
    v_smfmac_f32_16x16x64_bf16 v[168:171], a[24:27], v[52:59], v157
    s_waitcnt lgkmcnt(9)
    ds_read_b128 a[192:195], v143 offset:6912
    s_mov_b32 m0, s30
    s_add_u32 s30, s30, s52
    buffer_load_dwordx4 v155, s[8:11], 0 offen offset:256 lds
    v_smfmac_f32_16x16x64_bf16 v[168:171], a[32:35], v[56:63], v157
    ds_read_b128 a[196:199], v143 offset:9216
    v_smfmac_f32_16x16x64_bf16 v[84:87], a[24:27], v[56:63], v157
    s_waitcnt lgkmcnt(10)
    ds_read_b128 a[200:203], v147 offset:0
    v_smfmac_f32_16x16x64_bf16 v[84:87], a[32:35], v[60:67], v157
    ds_read_b128 a[204:207], v147 offset:2304
    v_smfmac_f32_16x16x64_bf16 v[216:219], a[24:27], v[60:67], v157
    s_waitcnt lgkmcnt(11)
    ds_read_b128 a[208:211], v147 offset:4608
    s_mov_b32 m0, s51
    s_add_u32 s51, s51, s52
    buffer_load_dwordx4 v156, s[8:11], 0 offen offset:256 lds
    v_smfmac_f32_16x16x64_bf16 v[216:219], a[32:35], v[64:71], v157
    s_waitcnt lgkmcnt(10)
    ds_read_b128 a[212:215], v147 offset:6912
    v_smfmac_f32_16x16x64_bf16 v[168:171], a[28:31], v[124:131], v157
    s_waitcnt lgkmcnt(10)
    s_waitcnt vmcnt(9)
    s_barrier
    ds_read_b128 v[52:55], v140 offset:34816
    v_smfmac_f32_16x16x64_bf16 v[84:87], a[28:31], v[128:135], v157
    s_waitcnt lgkmcnt(10)
    ds_read_b128 v[56:59], v140 offset:37120
    v_smfmac_f32_16x16x64_bf16 v[216:219], a[28:31], v[132:139], v157
    s_waitcnt lgkmcnt(9)
    ds_read_b128 v[60:63], v140 offset:39424
    s_add_u32 m0, s45, 0
    s_add_u32 s47, s35, 0
    buffer_load_dwordx4 v14, s[12:15], s47 offen lds
    v_smfmac_f32_16x16x64_bf16 v[172:175], a[36:39], a[180:187], v157
    s_waitcnt lgkmcnt(9)
    ds_read_b128 v[64:67], v140 offset:41728
    v_smfmac_f32_16x16x64_bf16 v[172:175], a[44:47], a[184:191], v157
    ds_read_b128 v[68:71], v140 offset:44032
    v_smfmac_f32_16x16x64_bf16 v[88:91], a[36:39], a[184:191], v157
    s_waitcnt lgkmcnt(10)
    ds_read_b128 v[124:127], v144 offset:34816
    v_smfmac_f32_16x16x64_bf16 v[88:91], a[44:47], a[188:195], v157
    ds_read_b128 v[128:131], v144 offset:37120
    s_add_u32 m0, s45, 1024
    s_add_u32 s47, s35, 12288
    buffer_load_dwordx4 v14, s[12:15], s47 offen lds
    v_smfmac_f32_16x16x64_bf16 v[220:223], a[36:39], a[188:195], v157
    s_waitcnt lgkmcnt(11)
    ds_read_b128 v[132:135], v144 offset:39424
    v_smfmac_f32_16x16x64_bf16 v[220:223], a[44:47], a[192:199], v157
    s_waitcnt lgkmcnt(10)
    ds_read_b128 v[136:139], v144 offset:41728
    v_smfmac_f32_16x16x64_bf16 v[172:175], a[40:43], a[200:207], v157
    s_waitcnt lgkmcnt(10)
    ds_read_b128 a[180:183], v141 offset:34816
    v_smfmac_f32_16x16x64_bf16 v[88:91], a[40:43], a[204:211], v157
    s_waitcnt lgkmcnt(10)
    ds_read_b128 a[184:187], v141 offset:37120
    s_add_u32 m0, s45, 2048
    s_add_u32 s47, s35, 24576
    buffer_load_dwordx4 v14, s[12:15], s47 offen lds
    v_smfmac_f32_16x16x64_bf16 v[220:223], a[40:43], a[208:215], v157
    ds_read_b128 a[188:191], v141 offset:39424
    ds_read_b128 a[216:219], v32 offset:0
    ds_read_b128 a[220:223], v33 offset:0
    ds_read_b128 a[224:227], v32 offset:2304
    ds_read_b128 a[228:231], v33 offset:2304
    ds_read_b128 a[240:243], v32 offset:4608
    ds_read_b128 a[244:247], v33 offset:4608
    v_pk_add_f32 v[40:41], v[160:161], 0 op_sel_hi:[1,0]
    v_pk_mul_f32 v[42:43], v[160:161], v[160:161]
    v_pk_add_f32 v[44:45], v[76:77], 0 op_sel_hi:[1,0]
    v_pk_mul_f32 v[46:47], v[76:77], v[76:77]
    v_pk_add_f32 v[48:49], v[208:209], 0 op_sel_hi:[1,0]
    v_pk_mul_f32 v[50:51], v[208:209], v[208:209]
    v_pk_add_f32 v[40:41], v[40:41], v[162:163]
    v_pk_fma_f32 v[42:43], v[162:163], v[162:163], v[42:43]
    v_pk_add_f32 v[44:45], v[44:45], v[78:79]
    v_pk_fma_f32 v[46:47], v[78:79], v[78:79], v[46:47]
    v_pk_add_f32 v[48:49], v[48:49], v[210:211]
    v_pk_fma_f32 v[50:51], v[210:211], v[210:211], v[50:51]
    v_pk_add_f32 v[72:73], v[20:21], 0 op_sel_hi:[1,0]
    v_pk_mul_f32 v[74:75], v[20:21], v[20:21]
    v_pk_add_f32 v[40:41], v[40:41], v[164:165]
    v_pk_fma_f32 v[42:43], v[164:165], v[164:165], v[42:43]
    v_pk_add_f32 v[44:45], v[44:45], v[80:81]
    v_pk_fma_f32 v[46:47], v[80:81], v[80:81], v[46:47]
    v_pk_add_f32 v[48:49], v[48:49], v[212:213]
    v_pk_fma_f32 v[50:51], v[212:213], v[212:213], v[50:51]
    v_pk_add_f32 v[40:41], v[40:41], v[166:167]
    v_pk_fma_f32 v[42:43], v[166:167], v[166:167], v[42:43]
    v_pk_add_f32 v[44:45], v[44:45], v[82:83]
    v_pk_fma_f32 v[46:47], v[82:83], v[82:83], v[46:47]
    v_pk_add_f32 v[48:49], v[48:49], v[214:215]
    v_pk_fma_f32 v[50:51], v[214:215], v[214:215], v[50:51]
    v_pk_add_f32 v[72:73], v[72:73], v[22:23]
    v_pk_fma_f32 v[74:75], v[22:23], v[22:23], v[74:75]
    v_pk_add_f32 v[40:41], v[40:41], v[168:169]
    v_pk_fma_f32 v[42:43], v[168:169], v[168:169], v[42:43]
    v_pk_add_f32 v[44:45], v[44:45], v[84:85]
    v_pk_fma_f32 v[46:47], v[84:85], v[84:85], v[46:47]
    v_pk_add_f32 v[48:49], v[48:49], v[216:217]
    v_pk_fma_f32 v[50:51], v[216:217], v[216:217], v[50:51]
    v_pk_add_f32 v[40:41], v[40:41], v[170:171]
    v_pk_fma_f32 v[42:43], v[170:171], v[170:171], v[42:43]
    v_pk_add_f32 v[44:45], v[44:45], v[86:87]
    v_pk_fma_f32 v[46:47], v[86:87], v[86:87], v[46:47]
    v_pk_add_f32 v[48:49], v[48:49], v[218:219]
    v_pk_fma_f32 v[50:51], v[218:219], v[218:219], v[50:51]
    v_pk_add_f32 v[40:41], v[40:41], v[172:173]
    v_pk_fma_f32 v[42:43], v[172:173], v[172:173], v[42:43]
    v_pk_add_f32 v[44:45], v[44:45], v[88:89]
    v_pk_fma_f32 v[46:47], v[88:89], v[88:89], v[46:47]
    v_pk_add_f32 v[48:49], v[48:49], v[220:221]
    v_pk_fma_f32 v[50:51], v[220:221], v[220:221], v[50:51]
    v_pk_add_f32 v[40:41], v[40:41], v[174:175]
    v_pk_fma_f32 v[42:43], v[174:175], v[174:175], v[42:43]
    v_pk_add_f32 v[44:45], v[44:45], v[90:91]
    v_pk_fma_f32 v[46:47], v[90:91], v[90:91], v[46:47]
    v_pk_add_f32 v[48:49], v[48:49], v[222:223]
    v_pk_fma_f32 v[50:51], v[222:223], v[222:223], v[50:51]
    s_waitcnt lgkmcnt(14)
    v_smfmac_f32_16x16x64_bf16 v[176:179], a[48:51], v[52:59], v157
    s_waitcnt lgkmcnt(14)
    ds_read_b128 a[192:195], v141 offset:41728
    ds_read_b128 a[196:199], v141 offset:44032
    v_smfmac_f32_16x16x64_bf16 v[176:179], a[56:59], v[56:63], v157
    ds_read_b128 a[200:203], v145 offset:34816
    s_add_u32 m0, s45, 3072
    s_add_u32 s47, s35, 36864
    buffer_load_dwordx4 v14, s[12:15], s47 offen lds
    v_smfmac_f32_16x16x64_bf16 v[92:95], a[48:51], v[56:63], v157
    s_waitcnt lgkmcnt(14)
    ds_read_b128 a[204:207], v145 offset:37120
    v_smfmac_f32_16x16x64_bf16 v[92:95], a[56:59], v[60:67], v157
    ds_read_b128 a[208:211], v145 offset:39424
    v_smfmac_f32_16x16x64_bf16 v[224:227], a[48:51], v[60:67], v157
    s_waitcnt lgkmcnt(14)
    ds_read_b128 a[212:215], v145 offset:41728
    v_smfmac_f32_16x16x64_bf16 v[224:227], a[56:59], v[64:71], v157
    s_waitcnt lgkmcnt(14)
    ds_read_b128 v[52:55], v34 offset:34816
    v_smfmac_f32_16x16x64_bf16 v[176:179], a[52:55], v[124:131], v157
    s_waitcnt lgkmcnt(14)
    ds_read_b128 v[56:59], v34 offset:37120
    s_add_u32 m0, s45, 4096
    s_add_u32 s47, s35, 49152
    buffer_load_dwordx4 v14, s[12:15], s47 offen lds
    v_smfmac_f32_16x16x64_bf16 v[92:95], a[52:55], v[128:135], v157
    s_waitcnt lgkmcnt(14)
    ds_read_b128 v[60:63], v34 offset:39424
    v_smfmac_f32_16x16x64_bf16 v[224:227], a[52:55], v[132:139], v157
    s_waitcnt lgkmcnt(14)
    ds_read_b128 v[124:127], v35 offset:34816
    v_smfmac_f32_16x16x64_bf16 v[180:183], a[60:63], a[180:187], v157
    s_waitcnt lgkmcnt(14)
    ds_read_b128 v[128:131], v35 offset:37120
    v_smfmac_f32_16x16x64_bf16 v[180:183], a[68:71], a[184:191], v157
    ds_read_b128 a[180:183], v142 offset:34816
    v_smfmac_f32_16x16x64_bf16 v[96:99], a[60:63], a[184:191], v157
    s_waitcnt lgkmcnt(11)
    ds_read_b128 a[184:187], v142 offset:37120
    s_add_u32 m0, s45, 5120
    s_add_u32 s47, s35, 61440
    buffer_load_dwordx4 v14, s[12:15], s47 offen lds
    v_smfmac_f32_16x16x64_bf16 v[96:99], a[68:71], a[188:195], v157
    v_smfmac_f32_16x16x64_bf16 v[228:231], a[60:63], a[188:195], v157
    s_waitcnt lgkmcnt(11)
    ds_read_b128 a[188:191], v142 offset:39424
    v_smfmac_f32_16x16x64_bf16 v[228:231], a[68:71], a[192:199], v157
    s_waitcnt lgkmcnt(10)
    ds_read_b128 a[192:195], v142 offset:41728
    ds_read_b128 a[196:199], v142 offset:44032
    v_smfmac_f32_16x16x64_bf16 v[180:183], a[64:67], a[200:207], v157
    s_waitcnt lgkmcnt(11)
    ds_read_b128 a[200:203], v146 offset:34816
    v_smfmac_f32_16x16x64_bf16 v[96:99], a[64:67], a[204:211], v157
    s_waitcnt lgkmcnt(11)
    ds_read_b128 a[204:207], v146 offset:37120
    v_smfmac_f32_16x16x64_bf16 v[228:231], a[64:67], a[208:215], v157
    s_waitcnt lgkmcnt(10)
    ds_read_b128 a[208:211], v146 offset:39424
    v_smfmac_f32_16x16x64_bf16 v[24:27], a[156:159], v[52:59], v157
    s_waitcnt lgkmcnt(10)
    ds_read_b128 a[212:215], v146 offset:41728
    v_smfmac_f32_16x16x64_bf16 v[24:27], a[164:167], v[56:63], v157
    s_waitcnt lgkmcnt(9)
    ds_read_b128 v[52:55], v143 offset:34816
    ds_read_b128 v[56:59], v143 offset:37120
    v_smfmac_f32_16x16x64_bf16 v[24:27], a[160:163], v[124:131], v157
    s_waitcnt lgkmcnt(9)
    ds_read_b128 v[60:63], v143 offset:39424
    v_smfmac_f32_16x16x64_bf16 v[184:187], a[72:75], a[180:187], v157
    s_waitcnt lgkmcnt(9)
    ds_read_b128 v[64:67], v143 offset:41728
    v_smfmac_f32_16x16x64_bf16 v[184:187], a[80:83], a[184:191], v157
    ds_read_b128 v[68:71], v143 offset:44032
    v_smfmac_f32_16x16x64_bf16 v[100:103], a[72:75], a[184:191], v157
    s_waitcnt lgkmcnt(10)
    ds_read_b128 v[124:127], v147 offset:34816
    v_smfmac_f32_16x16x64_bf16 v[100:103], a[80:83], a[188:195], v157
    ds_read_b128 v[128:131], v147 offset:37120
    v_smfmac_f32_16x16x64_bf16 v[232:235], a[72:75], a[188:195], v157
    s_waitcnt lgkmcnt(11)
    ds_read_b128 v[132:135], v147 offset:39424
    v_smfmac_f32_16x16x64_bf16 v[232:235], a[80:83], a[192:199], v157
    s_waitcnt lgkmcnt(10)
    ds_read_b128 v[136:139], v147 offset:41728
    v_smfmac_f32_16x16x64_bf16 v[184:187], a[76:79], a[200:207], v157
    s_waitcnt lgkmcnt(10)
    v_add_u32 v140, 69632, v140
    v_add_u32 v141, 69632, v141
    v_add_u32 v142, 69632, v142
    v_add_u32 v143, 69632, v143
    v_add_u32 v144, 69632, v144
    v_add_u32 v145, 69632, v145
    v_add_u32 v146, 69632, v146
    v_add_u32 v147, 69632, v147
    v_add_u32 v34, 69632, v34
    v_add_u32 v35, 69632, v35
    s_waitcnt vmcnt(6)
    s_barrier
    ds_read_b128 a[180:183], v34 offset:0
    v_smfmac_f32_16x16x64_bf16 v[100:103], a[76:79], a[204:211], v157
    s_waitcnt lgkmcnt(10)
    ds_read_b128 a[184:187], v34 offset:2304
    v_smfmac_f32_16x16x64_bf16 v[232:235], a[76:79], a[208:215], v157
    s_waitcnt lgkmcnt(9)
    ds_read_b128 a[188:191], v34 offset:4608
    v_smfmac_f32_16x16x64_bf16 v[188:191], a[84:87], v[52:59], v157
    s_waitcnt lgkmcnt(9)
    ds_read_b128 a[200:203], v35 offset:0
    v_smfmac_f32_16x16x64_bf16 v[188:191], a[92:95], v[56:63], v157
    ds_read_b128 a[204:207], v35 offset:2304
    v_smfmac_f32_16x16x64_bf16 v[104:107], a[84:87], v[56:63], v157
    s_waitcnt lgkmcnt(10)
    ds_read_b128 v[52:55], v140 offset:0
    v_smfmac_f32_16x16x64_bf16 v[104:107], a[92:95], v[60:67], v157
    ds_read_b128 v[56:59], v140 offset:2304
    v_smfmac_f32_16x16x64_bf16 v[236:239], a[84:87], v[60:67], v157
    s_waitcnt lgkmcnt(11)
    ds_read_b128 v[60:63], v140 offset:4608
    v_smfmac_f32_16x16x64_bf16 v[236:239], a[92:95], v[64:71], v157
    s_waitcnt lgkmcnt(10)
    ds_read_b128 v[64:67], v140 offset:6912
    v_smfmac_f32_16x16x64_bf16 v[188:191], a[88:91], v[124:131], v157
    s_waitcnt lgkmcnt(10)
    ds_read_b128 v[68:71], v140 offset:9216
    v_smfmac_f32_16x16x64_bf16 v[104:107], a[88:91], v[128:135], v157
    s_waitcnt lgkmcnt(10)
    ds_read_b128 v[124:127], v144 offset:0
    v_smfmac_f32_16x16x64_bf16 v[236:239], a[88:91], v[132:139], v157
    ds_read_b128 v[128:131], v144 offset:2304
    ds_read_b128 v[148:151], v32 offset:34816
    ds_read_b128 v[152:155], v33 offset:34816
    ds_read_b128 a[232:235], v32 offset:37120
    ds_read_b128 a[236:239], v33 offset:37120
    ds_read_b128 a[248:251], v32 offset:39424
    ds_read_b128 a[252:255], v33 offset:39424
    ds_read_b128 v[36:39], v18
    v_add_u32 v32, 69632, v32
    v_add_u32 v33, 69632, v33
    v_add_u32 v18, 69632, v18
    v_pk_add_f32 v[40:41], v[40:41], v[176:177]
    v_pk_fma_f32 v[42:43], v[176:177], v[176:177], v[42:43]
    v_pk_add_f32 v[44:45], v[44:45], v[92:93]
    v_pk_fma_f32 v[46:47], v[92:93], v[92:93], v[46:47]
    v_pk_add_f32 v[48:49], v[48:49], v[224:225]
    v_pk_fma_f32 v[50:51], v[224:225], v[224:225], v[50:51]
    v_pk_add_f32 v[40:41], v[40:41], v[178:179]
    v_pk_fma_f32 v[42:43], v[178:179], v[178:179], v[42:43]
    v_pk_add_f32 v[44:45], v[44:45], v[94:95]
    v_pk_fma_f32 v[46:47], v[94:95], v[94:95], v[46:47]
    v_pk_add_f32 v[48:49], v[48:49], v[226:227]
    v_pk_fma_f32 v[50:51], v[226:227], v[226:227], v[50:51]
    v_pk_add_f32 v[72:73], v[72:73], v[24:25]
    v_pk_fma_f32 v[74:75], v[24:25], v[24:25], v[74:75]
    v_pk_add_f32 v[40:41], v[40:41], v[180:181]
    v_pk_fma_f32 v[42:43], v[180:181], v[180:181], v[42:43]
    v_pk_add_f32 v[44:45], v[44:45], v[96:97]
    v_pk_fma_f32 v[46:47], v[96:97], v[96:97], v[46:47]
    v_pk_add_f32 v[48:49], v[48:49], v[228:229]
    v_pk_fma_f32 v[50:51], v[228:229], v[228:229], v[50:51]
    v_pk_add_f32 v[40:41], v[40:41], v[182:183]
    v_pk_fma_f32 v[42:43], v[182:183], v[182:183], v[42:43]
    v_pk_add_f32 v[44:45], v[44:45], v[98:99]
    v_pk_fma_f32 v[46:47], v[98:99], v[98:99], v[46:47]
    v_pk_add_f32 v[48:49], v[48:49], v[230:231]
    v_pk_fma_f32 v[50:51], v[230:231], v[230:231], v[50:51]
    v_pk_add_f32 v[72:73], v[72:73], v[26:27]
    v_pk_fma_f32 v[74:75], v[26:27], v[26:27], v[74:75]
    v_pk_add_f32 v[40:41], v[40:41], v[184:185]
    v_pk_fma_f32 v[42:43], v[184:185], v[184:185], v[42:43]
    v_pk_add_f32 v[44:45], v[44:45], v[100:101]
    v_pk_fma_f32 v[46:47], v[100:101], v[100:101], v[46:47]
    v_pk_add_f32 v[48:49], v[48:49], v[232:233]
    v_pk_fma_f32 v[50:51], v[232:233], v[232:233], v[50:51]
    v_pk_add_f32 v[40:41], v[40:41], v[186:187]
    v_pk_fma_f32 v[42:43], v[186:187], v[186:187], v[42:43]
    v_pk_add_f32 v[44:45], v[44:45], v[102:103]
    v_pk_fma_f32 v[46:47], v[102:103], v[102:103], v[46:47]
    v_pk_add_f32 v[48:49], v[48:49], v[234:235]
    v_pk_fma_f32 v[50:51], v[234:235], v[234:235], v[50:51]
    v_pk_add_f32 v[40:41], v[40:41], v[188:189]
    v_pk_fma_f32 v[42:43], v[188:189], v[188:189], v[42:43]
    v_pk_add_f32 v[44:45], v[44:45], v[104:105]
    v_pk_fma_f32 v[46:47], v[104:105], v[104:105], v[46:47]
    v_pk_add_f32 v[48:49], v[48:49], v[236:237]
    v_pk_fma_f32 v[50:51], v[236:237], v[236:237], v[50:51]
    v_pk_add_f32 v[40:41], v[40:41], v[190:191]
    v_pk_fma_f32 v[42:43], v[190:191], v[190:191], v[42:43]
    v_pk_add_f32 v[44:45], v[44:45], v[106:107]
    v_pk_fma_f32 v[46:47], v[106:107], v[106:107], v[46:47]
    v_pk_add_f32 v[48:49], v[48:49], v[238:239]
    v_pk_fma_f32 v[50:51], v[238:239], v[238:239], v[50:51]
    s_waitcnt lgkmcnt(14)
    v_smfmac_f32_16x16x64_bf16 v[28:31], a[168:171], a[180:187], v157
    s_waitcnt lgkmcnt(14)
    ds_read_b128 v[132:135], v144 offset:4608
    ds_read_b128 v[136:139], v144 offset:6912
    v_smfmac_f32_16x16x64_bf16 v[28:31], a[176:179], a[184:191], v157
    s_waitcnt lgkmcnt(14)
    ds_read_b128 a[180:183], v141 offset:0
    v_smfmac_f32_16x16x64_bf16 v[28:31], a[172:175], a[200:207], v157
    s_waitcnt lgkmcnt(14)
    ds_read_b128 a[184:187], v141 offset:2304
    v_smfmac_f32_16x16x64_bf16 v[192:195], a[96:99], v[52:59], v157
    s_waitcnt lgkmcnt(14)
    ds_read_b128 a[188:191], v141 offset:4608
    v_smfmac_f32_16x16x64_bf16 v[192:195], a[104:107], v[56:63], v157
    ds_read_b128 a[192:195], v141 offset:6912
    v_smfmac_f32_16x16x64_bf16 v[108:111], a[96:99], v[56:63], v157
    s_waitcnt lgkmcnt(14)
    ds_read_b128 a[196:199], v141 offset:9216
    v_smfmac_f32_16x16x64_bf16 v[108:111], a[104:107], v[60:67], v157
    ds_read_b128 a[200:203], v145 offset:0
    v_smfmac_f32_16x16x64_bf16 v[240:243], a[96:99], v[60:67], v157
    s_waitcnt lgkmcnt(14)
    ds_read_b128 a[204:207], v145 offset:2304
    v_smfmac_f32_16x16x64_bf16 v[240:243], a[104:107], v[64:71], v157
    s_waitcnt lgkmcnt(14)
    ds_read_b128 a[208:211], v145 offset:4608
    v_add_f32 v72, v72, v28
    v_smfmac_f32_16x16x64_bf16 v[192:195], a[100:103], v[124:131], v157
    s_waitcnt lgkmcnt(9)
    ds_read_b128 a[212:215], v145 offset:6912
    v_fmac_f32 v74, v28, v28
    v_smfmac_f32_16x16x64_bf16 v[108:111], a[100:103], v[128:135], v157
    s_waitcnt lgkmcnt(9)
    ds_read_b128 v[52:55], v142 offset:0
    v_add_f32 v73, v73, v29
    v_smfmac_f32_16x16x64_bf16 v[240:243], a[100:103], v[132:139], v157
    s_waitcnt lgkmcnt(8)
    ds_read_b128 v[56:59], v142 offset:2304
    v_fmac_f32 v75, v29, v29
    v_smfmac_f32_16x16x64_bf16 v[196:199], a[108:111], a[180:187], v157
    s_waitcnt lgkmcnt(8)
    ds_read_b128 v[60:63], v142 offset:4608
    v_add_f32 v72, v72, v30
    v_smfmac_f32_16x16x64_bf16 v[196:199], a[116:119], a[184:191], v157
    ds_read_b128 v[64:67], v142 offset:6912
    v_fmac_f32 v74, v30, v30
    v_smfmac_f32_16x16x64_bf16 v[112:115], a[108:111], a[184:191], v157
    s_waitcnt lgkmcnt(9)
    ds_read_b128 v[68:71], v142 offset:9216
    v_add_f32 v73, v73, v31
    v_smfmac_f32_16x16x64_bf16 v[112:115], a[116:119], a[188:195], v157
    ds_read_b128 v[124:127], v146 offset:0
    v_fmac_f32 v75, v31, v31
    v_smfmac_f32_16x16x64_bf16 v[244:247], a[108:111], a[188:195], v157
    s_waitcnt lgkmcnt(10)
    ds_read_b128 v[128:131], v146 offset:2304
    v_add_f32 v73, v72, v73
    v_smfmac_f32_16x16x64_bf16 v[244:247], a[116:119], a[192:199], v157
    s_waitcnt lgkmcnt(9)
    ds_read_b128 v[132:135], v146 offset:4608
    v_add_f32 v75, v74, v75
    v_smfmac_f32_16x16x64_bf16 v[196:199], a[112:115], a[200:207], v157
    s_waitcnt lgkmcnt(9)
    ds_read_b128 v[136:139], v146 offset:6912
    v_smfmac_f32_16x16x64_bf16 v[112:115], a[112:115], a[204:211], v157
    s_waitcnt lgkmcnt(9)
    ds_read_b128 a[180:183], v143 offset:0
    ds_read_b128 a[184:187], v143 offset:2304
    v_permlane32_swap_b32 v73, v75
    v_smfmac_f32_16x16x64_bf16 v[244:247], a[112:115], a[208:215], v157
    s_waitcnt lgkmcnt(9)
    ds_read_b128 a[188:191], v143 offset:4608
    v_add_f32 v73, v73, v75
    v_smfmac_f32_16x16x64_bf16 v[200:203], a[120:123], v[52:59], v157
    s_waitcnt lgkmcnt(9)
    ds_read_b128 a[192:195], v143 offset:6912
    v_mov_b32 v75, v73
    v_smfmac_f32_16x16x64_bf16 v[200:203], a[128:131], v[56:63], v157
    ds_read_b128 a[196:199], v143 offset:9216
    v_smfmac_f32_16x16x64_bf16 v[116:119], a[120:123], v[56:63], v157
    s_waitcnt lgkmcnt(10)
    ds_read_b128 a[200:203], v147 offset:0
    v_permlane16_swap_b32 v73, v75
    v_smfmac_f32_16x16x64_bf16 v[116:119], a[128:131], v[60:67], v157
    ds_read_b128 a[204:207], v147 offset:2304
    v_add_f32 v73, v73, v75
    v_smfmac_f32_16x16x64_bf16 v[248:251], a[120:123], v[60:67], v157
    s_waitcnt lgkmcnt(11)
    ds_read_b128 a[208:211], v147 offset:4608
    ds_write_b32 v158, v73 offset:47104
    v_smfmac_f32_16x16x64_bf16 v[248:251], a[128:131], v[64:71], v157
    s_waitcnt lgkmcnt(11)
    ds_read_b128 a[212:215], v147 offset:6912
    v_smfmac_f32_16x16x64_bf16 v[200:203], a[124:127], v[124:131], v157
    s_waitcnt lgkmcnt(11)
    v_smfmac_f32_16x16x64_bf16 v[116:119], a[124:127], v[128:135], v157
    s_waitcnt lgkmcnt(10)
    v_smfmac_f32_16x16x64_bf16 v[248:251], a[124:127], v[132:139], v157
    s_waitcnt lgkmcnt(8)
    v_smfmac_f32_16x16x64_bf16 v[204:207], a[132:135], a[180:187], v157
    s_waitcnt lgkmcnt(7)
    v_smfmac_f32_16x16x64_bf16 v[204:207], a[140:143], a[184:191], v157
    v_smfmac_f32_16x16x64_bf16 v[120:123], a[132:135], a[184:191], v157
    s_waitcnt lgkmcnt(6)
    v_smfmac_f32_16x16x64_bf16 v[120:123], a[140:143], a[188:195], v157
    v_smfmac_f32_16x16x64_bf16 v[252:255], a[132:135], a[188:195], v157
    s_waitcnt lgkmcnt(5)
    v_smfmac_f32_16x16x64_bf16 v[252:255], a[140:143], a[192:199], v157
    s_waitcnt lgkmcnt(3)
    v_smfmac_f32_16x16x64_bf16 v[204:207], a[136:139], a[200:207], v157
    s_waitcnt lgkmcnt(2)
    v_smfmac_f32_16x16x64_bf16 v[120:123], a[136:139], a[204:211], v157
    s_waitcnt lgkmcnt(0)
    v_smfmac_f32_16x16x64_bf16 v[252:255], a[136:139], a[208:215], v157
    ds_read_b128 v[124:127], v32 offset:0
    ds_read_b128 v[128:131], v33 offset:0
    ds_read_b128 v[132:135], v32 offset:2304
    ds_read_b128 v[136:139], v33 offset:2304
    ds_read_b128 v[140:143], v32 offset:4608
    ds_read_b128 v[144:147], v33 offset:4608
    v_pk_add_f32 v[40:41], v[40:41], v[192:193]
    v_pk_fma_f32 v[42:43], v[192:193], v[192:193], v[42:43]
    v_pk_add_f32 v[44:45], v[44:45], v[108:109]
    v_pk_fma_f32 v[46:47], v[108:109], v[108:109], v[46:47]
    v_pk_add_f32 v[48:49], v[48:49], v[240:241]
    v_pk_fma_f32 v[50:51], v[240:241], v[240:241], v[50:51]
    v_pk_add_f32 v[40:41], v[40:41], v[194:195]
    v_pk_fma_f32 v[42:43], v[194:195], v[194:195], v[42:43]
    v_pk_add_f32 v[44:45], v[44:45], v[110:111]
    v_pk_fma_f32 v[46:47], v[110:111], v[110:111], v[46:47]
    v_pk_add_f32 v[48:49], v[48:49], v[242:243]
    v_pk_fma_f32 v[50:51], v[242:243], v[242:243], v[50:51]
    v_pk_add_f32 v[40:41], v[40:41], v[196:197]
    v_pk_fma_f32 v[42:43], v[196:197], v[196:197], v[42:43]
    v_pk_add_f32 v[44:45], v[44:45], v[112:113]
    v_pk_fma_f32 v[46:47], v[112:113], v[112:113], v[46:47]
    v_pk_add_f32 v[48:49], v[48:49], v[244:245]
    v_pk_fma_f32 v[50:51], v[244:245], v[244:245], v[50:51]
    v_pk_add_f32 v[40:41], v[40:41], v[198:199]
    v_pk_fma_f32 v[42:43], v[198:199], v[198:199], v[42:43]
    v_pk_add_f32 v[44:45], v[44:45], v[114:115]
    v_pk_fma_f32 v[46:47], v[114:115], v[114:115], v[46:47]
    v_pk_add_f32 v[48:49], v[48:49], v[246:247]
    v_pk_fma_f32 v[50:51], v[246:247], v[246:247], v[50:51]
    v_pk_add_f32 v[40:41], v[40:41], v[200:201]
    v_pk_fma_f32 v[42:43], v[200:201], v[200:201], v[42:43]
    v_pk_add_f32 v[44:45], v[44:45], v[116:117]
    v_pk_fma_f32 v[46:47], v[116:117], v[116:117], v[46:47]
    v_pk_add_f32 v[48:49], v[48:49], v[248:249]
    v_pk_fma_f32 v[50:51], v[248:249], v[248:249], v[50:51]
    v_pk_add_f32 v[40:41], v[40:41], v[202:203]
    v_pk_fma_f32 v[42:43], v[202:203], v[202:203], v[42:43]
    v_pk_add_f32 v[44:45], v[44:45], v[118:119]
    v_pk_fma_f32 v[46:47], v[118:119], v[118:119], v[46:47]
    v_pk_add_f32 v[48:49], v[48:49], v[250:251]
    v_pk_fma_f32 v[50:51], v[250:251], v[250:251], v[50:51]
    s_waitcnt vmcnt(0)
    s_waitcnt lgkmcnt(0)
    s_barrier
    ds_read_b128 v[52:55], v159 offset:47104
    ds_read_b128 v[56:59], v159 offset:47120
    s_mul_i32 s45, s28, 6144
    s_add_u32 s45, s45, 49408
    s_mul_i32 s46, s28, 6160
    s_add_u32 s46, s46, 73984
    s_mov_b32 s35, 128
    s_mov_b32 s36, 0
    s_add_u32 m0, s45, 0
    s_add_u32 s47, s35, 0
    buffer_load_dwordx4 v14, s[12:15], s47 offen lds
    v_pk_add_f32 v[40:41], v[40:41], v[204:205]
    v_pk_fma_f32 v[42:43], v[204:205], v[204:205], v[42:43]
    v_pk_add_f32 v[44:45], v[44:45], v[120:121]
    v_pk_fma_f32 v[46:47], v[120:121], v[120:121], v[46:47]
    v_pk_add_f32 v[48:49], v[48:49], v[252:253]
    v_pk_fma_f32 v[50:51], v[252:253], v[252:253], v[50:51]
    v_pk_add_f32 v[40:41], v[40:41], v[206:207]
    v_pk_fma_f32 v[42:43], v[206:207], v[206:207], v[42:43]
    v_pk_add_f32 v[44:45], v[44:45], v[122:123]
    v_pk_fma_f32 v[46:47], v[122:123], v[122:123], v[46:47]
    v_pk_add_f32 v[48:49], v[48:49], v[254:255]
    v_pk_fma_f32 v[50:51], v[254:255], v[254:255], v[50:51]
    v_add_f32 v41, v40, v41
    v_add_f32 v45, v44, v45
    v_add_f32 v49, v48, v49
    v_add_f32 v43, v42, v43
    v_add_f32 v47, v46, v47
    v_add_f32 v51, v50, v51
    s_add_u32 m0, s45, 1024
    s_add_u32 s47, s35, 12288
    buffer_load_dwordx4 v14, s[12:15], s47 offen lds
    v_permlane32_swap_b32 v41, v43
    v_permlane32_swap_b32 v45, v47
    v_permlane32_swap_b32 v49, v51
    s_waitcnt lgkmcnt(0)
    v_add_f32 v41, v41, v43
    v_add_f32 v45, v45, v47
    v_add_f32 v49, v49, v51
    v_pk_add_f32 v[52:53], v[52:53], v[54:55]
    v_mov_b32 v43, v41
    v_mov_b32 v47, v45
    v_mov_b32 v51, v49
    v_pk_add_f32 v[56:57], v[56:57], v[58:59]
    v_permlane16_swap_b32 v41, v43
    v_permlane16_swap_b32 v45, v47
    v_permlane16_swap_b32 v49, v51
    v_add_f32 v52, v52, v53
    v_add_f32 v41, v41, v43
    v_add_f32 v45, v45, v47
    v_add_f32 v49, v49, v51
    v_add_f32 v53, v56, v57
    s_add_u32 m0, s45, 2048
    s_add_u32 s47, s35, 24576
    buffer_load_dwordx4 v14, s[12:15], s47 offen lds
    v_mul_f32 v41, 0x3baaaaab, v41
    v_mul_f32 v45, 0x3baaaaab, v45
    v_mul_f32 v49, 0x3baaaaab, v49
    v_mul_f32 v52, 0x3baaaaab, v52
    v_mov_b32 v43, v41
    v_mov_b32 v47, v45
    v_mov_b32 v51, v49
    v_mul_f32 v53, 0x3baaaaab, v53
    v_permlane32_swap_b32 v41, v43
    v_permlane32_swap_b32 v45, v47
    v_permlane32_swap_b32 v49, v51
    v_lshlrev_b32 v156, 4, v1
    v_fma_f32 v43, -v41, v41, v43
    v_fma_f32 v47, -v45, v45, v47
    v_fma_f32 v51, -v49, v49, v51
    v_fma_f32 v53, -v52, v52, v53
    v_max_f32 v43, 0, v43
    v_max_f32 v47, 0, v47
    v_max_f32 v51, 0, v51
    v_max_f32 v53, 0, v53
    s_add_u32 m0, s45, 3072
    s_add_u32 s47, s35, 36864
    buffer_load_dwordx4 v14, s[12:15], s47 offen lds
    v_add_f32 v43, 0x3727c5ac, v43
    v_add_f32 v47, 0x3727c5ac, v47
    v_add_f32 v51, 0x3727c5ac, v51
    v_add_f32 v53, 0x3727c5ac, v53
    v_rsq_f32 v43, v43
    v_rsq_f32 v47, v47
    v_rsq_f32 v51, v51
    v_rsq_f32 v53, v53
    v_mul_f32 v40, 0x3eefde6e, v43
    v_mul_f32 v44, 0x3eefde6e, v47
    v_mul_f32 v48, 0x3eefde6e, v51
    v_mul_f32 v54, 0x3eefde6e, v53
    v_mul_f32 v42, v41, v40
    v_mul_f32 v46, v45, v44
    v_mul_f32 v50, v49, v48
    v_mul_f32 v56, v52, v54
    v_pk_fma_f32 v[20:21], v[20:21], v[54:55], v[56:57] op_sel_hi:[1,0,0] neg_lo:[0,0,1] neg_hi:[0,0,1]
    v_pk_fma_f32 v[22:23], v[22:23], v[54:55], v[56:57] op_sel_hi:[1,0,0] neg_lo:[0,0,1] neg_hi:[0,0,1]
    v_pk_fma_f32 v[24:25], v[24:25], v[54:55], v[56:57] op_sel_hi:[1,0,0] neg_lo:[0,0,1] neg_hi:[0,0,1]
    v_pk_fma_f32 v[26:27], v[26:27], v[54:55], v[56:57] op_sel_hi:[1,0,0] neg_lo:[0,0,1] neg_hi:[0,0,1]
    v_pk_fma_f32 v[28:29], v[28:29], v[54:55], v[56:57] op_sel_hi:[1,0,0] neg_lo:[0,0,1] neg_hi:[0,0,1]
    v_pk_fma_f32 v[30:31], v[30:31], v[54:55], v[56:57] op_sel_hi:[1,0,0] neg_lo:[0,0,1] neg_hi:[0,0,1]
    v_cvt_pk_bf16_f32 v20, v20, v21
    v_cvt_pk_bf16_f32 v21, v22, v23
    s_add_u32 m0, s45, 4096
    s_add_u32 s47, s35, 49152
    buffer_load_dwordx4 v14, s[12:15], s47 offen lds
    v_cvt_pk_bf16_f32 v22, v24, v25
    v_cvt_pk_bf16_f32 v23, v26, v27
    v_cvt_pk_bf16_f32 v24, v28, v29
    v_cvt_pk_bf16_f32 v25, v30, v31
    ds_write_b64 v19, v[20:21] offset:40960
    ds_write_b64 v19, v[22:23] offset:43008
    ds_write_b64 v19, v[24:25] offset:45056
    v_pk_fma_f32 v[160:161], v[160:161], v[40:41], v[42:43] op_sel_hi:[1,0,0] neg_lo:[0,0,1] neg_hi:[0,0,1]
    v_pk_fma_f32 v[162:163], v[162:163], v[40:41], v[42:43] op_sel_hi:[1,0,0] neg_lo:[0,0,1] neg_hi:[0,0,1]
    v_pk_fma_f32 v[164:165], v[164:165], v[40:41], v[42:43] op_sel_hi:[1,0,0] neg_lo:[0,0,1] neg_hi:[0,0,1]
    v_pk_fma_f32 v[166:167], v[166:167], v[40:41], v[42:43] op_sel_hi:[1,0,0] neg_lo:[0,0,1] neg_hi:[0,0,1]
    v_pk_fma_f32 v[168:169], v[168:169], v[40:41], v[42:43] op_sel_hi:[1,0,0] neg_lo:[0,0,1] neg_hi:[0,0,1]
    v_pk_fma_f32 v[170:171], v[170:171], v[40:41], v[42:43] op_sel_hi:[1,0,0] neg_lo:[0,0,1] neg_hi:[0,0,1]
    v_pk_fma_f32 v[172:173], v[172:173], v[40:41], v[42:43] op_sel_hi:[1,0,0] neg_lo:[0,0,1] neg_hi:[0,0,1]
    v_cvt_pk_bf16_f32 v160, v160, v161
    v_pk_fma_f32 v[174:175], v[174:175], v[40:41], v[42:43] op_sel_hi:[1,0,0] neg_lo:[0,0,1] neg_hi:[0,0,1]
    v_cvt_pk_bf16_f32 v161, v162, v163
    s_add_u32 m0, s45, 5120
    s_add_u32 s47, s35, 61440
    buffer_load_dwordx4 v14, s[12:15], s47 offen lds
    v_pk_fma_f32 v[176:177], v[176:177], v[40:41], v[42:43] op_sel_hi:[1,0,0] neg_lo:[0,0,1] neg_hi:[0,0,1]
    v_cvt_pk_bf16_f32 v162, v164, v165
    v_pk_fma_f32 v[178:179], v[178:179], v[40:41], v[42:43] op_sel_hi:[1,0,0] neg_lo:[0,0,1] neg_hi:[0,0,1]
    v_cvt_pk_bf16_f32 v163, v166, v167
    v_pk_fma_f32 v[180:181], v[180:181], v[40:41], v[42:43] op_sel_hi:[1,0,0] neg_lo:[0,0,1] neg_hi:[0,0,1]
    v_cvt_pk_bf16_f32 v164, v168, v169
    v_pk_fma_f32 v[182:183], v[182:183], v[40:41], v[42:43] op_sel_hi:[1,0,0] neg_lo:[0,0,1] neg_hi:[0,0,1]
    v_cvt_pk_bf16_f32 v165, v170, v171
    v_pk_fma_f32 v[184:185], v[184:185], v[40:41], v[42:43] op_sel_hi:[1,0,0] neg_lo:[0,0,1] neg_hi:[0,0,1]
    v_cvt_pk_bf16_f32 v166, v172, v173
    v_pk_fma_f32 v[186:187], v[186:187], v[40:41], v[42:43] op_sel_hi:[1,0,0] neg_lo:[0,0,1] neg_hi:[0,0,1]
    v_cvt_pk_bf16_f32 v167, v174, v175
    v_pk_fma_f32 v[188:189], v[188:189], v[40:41], v[42:43] op_sel_hi:[1,0,0] neg_lo:[0,0,1] neg_hi:[0,0,1]
    v_cvt_pk_bf16_f32 v168, v176, v177
    v_pk_fma_f32 v[190:191], v[190:191], v[40:41], v[42:43] op_sel_hi:[1,0,0] neg_lo:[0,0,1] neg_hi:[0,0,1]
    v_cvt_pk_bf16_f32 v169, v178, v179
    s_add_u32 m0, s46, 0
    s_add_u32 s47, s36, 0
    buffer_load_dwordx4 v15, s[16:19], s47 offen lds
    v_pk_fma_f32 v[192:193], v[192:193], v[40:41], v[42:43] op_sel_hi:[1,0,0] neg_lo:[0,0,1] neg_hi:[0,0,1]
    v_cvt_pk_bf16_f32 v170, v180, v181
    v_pk_fma_f32 v[194:195], v[194:195], v[40:41], v[42:43] op_sel_hi:[1,0,0] neg_lo:[0,0,1] neg_hi:[0,0,1]
    v_cvt_pk_bf16_f32 v171, v182, v183
    v_pk_fma_f32 v[196:197], v[196:197], v[40:41], v[42:43] op_sel_hi:[1,0,0] neg_lo:[0,0,1] neg_hi:[0,0,1]
    v_cvt_pk_bf16_f32 v172, v184, v185
    v_pk_fma_f32 v[198:199], v[198:199], v[40:41], v[42:43] op_sel_hi:[1,0,0] neg_lo:[0,0,1] neg_hi:[0,0,1]
    v_cvt_pk_bf16_f32 v173, v186, v187
    v_pk_fma_f32 v[200:201], v[200:201], v[40:41], v[42:43] op_sel_hi:[1,0,0] neg_lo:[0,0,1] neg_hi:[0,0,1]
    v_cvt_pk_bf16_f32 v174, v188, v189
    v_pk_fma_f32 v[202:203], v[202:203], v[40:41], v[42:43] op_sel_hi:[1,0,0] neg_lo:[0,0,1] neg_hi:[0,0,1]
    v_cvt_pk_bf16_f32 v175, v190, v191
    v_pk_fma_f32 v[204:205], v[204:205], v[40:41], v[42:43] op_sel_hi:[1,0,0] neg_lo:[0,0,1] neg_hi:[0,0,1]
    v_cvt_pk_bf16_f32 v176, v192, v193
    v_pk_fma_f32 v[206:207], v[206:207], v[40:41], v[42:43] op_sel_hi:[1,0,0] neg_lo:[0,0,1] neg_hi:[0,0,1]
    v_cvt_pk_bf16_f32 v177, v194, v195
    s_add_u32 m0, s46, 1024
    s_add_u32 s47, s36, 128
    buffer_load_dwordx4 v15, s[16:19], s47 offen lds
    v_cvt_pk_bf16_f32 v178, v196, v197
    v_cvt_pk_bf16_f32 v179, v198, v199
    v_cvt_pk_bf16_f32 v180, v200, v201
    v_cvt_pk_bf16_f32 v181, v202, v203
    v_cvt_pk_bf16_f32 v182, v204, v205
    v_cvt_pk_bf16_f32 v183, v206, v207
    ds_read_b128 v[40:43], v18
    v_pk_fma_f32 v[76:77], v[76:77], v[44:45], v[46:47] op_sel_hi:[1,0,0] neg_lo:[0,0,1] neg_hi:[0,0,1]
    v_pk_fma_f32 v[78:79], v[78:79], v[44:45], v[46:47] op_sel_hi:[1,0,0] neg_lo:[0,0,1] neg_hi:[0,0,1]
    v_pk_fma_f32 v[80:81], v[80:81], v[44:45], v[46:47] op_sel_hi:[1,0,0] neg_lo:[0,0,1] neg_hi:[0,0,1]
    v_pk_fma_f32 v[82:83], v[82:83], v[44:45], v[46:47] op_sel_hi:[1,0,0] neg_lo:[0,0,1] neg_hi:[0,0,1]
    v_pk_fma_f32 v[84:85], v[84:85], v[44:45], v[46:47] op_sel_hi:[1,0,0] neg_lo:[0,0,1] neg_hi:[0,0,1]
    v_pk_fma_f32 v[86:87], v[86:87], v[44:45], v[46:47] op_sel_hi:[1,0,0] neg_lo:[0,0,1] neg_hi:[0,0,1]
    v_pk_fma_f32 v[88:89], v[88:89], v[44:45], v[46:47] op_sel_hi:[1,0,0] neg_lo:[0,0,1] neg_hi:[0,0,1]
    v_cvt_pk_bf16_f32 v184, v76, v77
    v_pk_fma_f32 v[90:91], v[90:91], v[44:45], v[46:47] op_sel_hi:[1,0,0] neg_lo:[0,0,1] neg_hi:[0,0,1]
    v_cvt_pk_bf16_f32 v185, v78, v79
    s_add_u32 m0, s46, 2048
    s_add_u32 s47, s36, 256
    buffer_load_dwordx4 v15, s[16:19], s47 offen lds
    v_pk_fma_f32 v[92:93], v[92:93], v[44:45], v[46:47] op_sel_hi:[1,0,0] neg_lo:[0,0,1] neg_hi:[0,0,1]
    v_cvt_pk_bf16_f32 v186, v80, v81
    v_pk_fma_f32 v[94:95], v[94:95], v[44:45], v[46:47] op_sel_hi:[1,0,0] neg_lo:[0,0,1] neg_hi:[0,0,1]
    v_cvt_pk_bf16_f32 v187, v82, v83
    v_pk_fma_f32 v[96:97], v[96:97], v[44:45], v[46:47] op_sel_hi:[1,0,0] neg_lo:[0,0,1] neg_hi:[0,0,1]
    v_cvt_pk_bf16_f32 v188, v84, v85
    v_pk_fma_f32 v[98:99], v[98:99], v[44:45], v[46:47] op_sel_hi:[1,0,0] neg_lo:[0,0,1] neg_hi:[0,0,1]
    v_cvt_pk_bf16_f32 v189, v86, v87
    v_pk_fma_f32 v[100:101], v[100:101], v[44:45], v[46:47] op_sel_hi:[1,0,0] neg_lo:[0,0,1] neg_hi:[0,0,1]
    v_cvt_pk_bf16_f32 v190, v88, v89
    v_pk_fma_f32 v[102:103], v[102:103], v[44:45], v[46:47] op_sel_hi:[1,0,0] neg_lo:[0,0,1] neg_hi:[0,0,1]
    v_cvt_pk_bf16_f32 v191, v90, v91
    v_pk_fma_f32 v[104:105], v[104:105], v[44:45], v[46:47] op_sel_hi:[1,0,0] neg_lo:[0,0,1] neg_hi:[0,0,1]
    v_cvt_pk_bf16_f32 v192, v92, v93
    v_pk_fma_f32 v[106:107], v[106:107], v[44:45], v[46:47] op_sel_hi:[1,0,0] neg_lo:[0,0,1] neg_hi:[0,0,1]
    v_cvt_pk_bf16_f32 v193, v94, v95
    s_add_u32 m0, s46, 3080
    s_add_u32 s47, s36, 1536
    buffer_load_dwordx4 v15, s[16:19], s47 offen lds
    v_pk_fma_f32 v[108:109], v[108:109], v[44:45], v[46:47] op_sel_hi:[1,0,0] neg_lo:[0,0,1] neg_hi:[0,0,1]
    v_cvt_pk_bf16_f32 v194, v96, v97
    v_pk_fma_f32 v[110:111], v[110:111], v[44:45], v[46:47] op_sel_hi:[1,0,0] neg_lo:[0,0,1] neg_hi:[0,0,1]
    v_cvt_pk_bf16_f32 v195, v98, v99
    v_pk_fma_f32 v[112:113], v[112:113], v[44:45], v[46:47] op_sel_hi:[1,0,0] neg_lo:[0,0,1] neg_hi:[0,0,1]
    v_cvt_pk_bf16_f32 v196, v100, v101
    v_pk_fma_f32 v[114:115], v[114:115], v[44:45], v[46:47] op_sel_hi:[1,0,0] neg_lo:[0,0,1] neg_hi:[0,0,1]
    v_cvt_pk_bf16_f32 v197, v102, v103
    v_pk_fma_f32 v[116:117], v[116:117], v[44:45], v[46:47] op_sel_hi:[1,0,0] neg_lo:[0,0,1] neg_hi:[0,0,1]
    v_cvt_pk_bf16_f32 v198, v104, v105
    v_pk_fma_f32 v[118:119], v[118:119], v[44:45], v[46:47] op_sel_hi:[1,0,0] neg_lo:[0,0,1] neg_hi:[0,0,1]
    v_cvt_pk_bf16_f32 v199, v106, v107
    v_pk_fma_f32 v[120:121], v[120:121], v[44:45], v[46:47] op_sel_hi:[1,0,0] neg_lo:[0,0,1] neg_hi:[0,0,1]
    v_cvt_pk_bf16_f32 v200, v108, v109
    v_pk_fma_f32 v[122:123], v[122:123], v[44:45], v[46:47] op_sel_hi:[1,0,0] neg_lo:[0,0,1] neg_hi:[0,0,1]
    v_cvt_pk_bf16_f32 v201, v110, v111
    s_add_u32 m0, s46, 4104
    s_add_u32 s47, s36, 1664
    buffer_load_dwordx4 v15, s[16:19], s47 offen lds
    v_cvt_pk_bf16_f32 v202, v112, v113
    v_cvt_pk_bf16_f32 v203, v114, v115
    v_cvt_pk_bf16_f32 v204, v116, v117
    v_cvt_pk_bf16_f32 v205, v118, v119
    v_cvt_pk_bf16_f32 v206, v120, v121
    v_cvt_pk_bf16_f32 v207, v122, v123
    v_pk_fma_f32 v[208:209], v[208:209], v[48:49], v[50:51] op_sel_hi:[1,0,0] neg_lo:[0,0,1] neg_hi:[0,0,1]
    v_pk_fma_f32 v[210:211], v[210:211], v[48:49], v[50:51] op_sel_hi:[1,0,0] neg_lo:[0,0,1] neg_hi:[0,0,1]
    v_pk_fma_f32 v[212:213], v[212:213], v[48:49], v[50:51] op_sel_hi:[1,0,0] neg_lo:[0,0,1] neg_hi:[0,0,1]
    v_pk_fma_f32 v[214:215], v[214:215], v[48:49], v[50:51] op_sel_hi:[1,0,0] neg_lo:[0,0,1] neg_hi:[0,0,1]
    v_pk_fma_f32 v[216:217], v[216:217], v[48:49], v[50:51] op_sel_hi:[1,0,0] neg_lo:[0,0,1] neg_hi:[0,0,1]
    v_pk_fma_f32 v[218:219], v[218:219], v[48:49], v[50:51] op_sel_hi:[1,0,0] neg_lo:[0,0,1] neg_hi:[0,0,1]
    v_pk_fma_f32 v[220:221], v[220:221], v[48:49], v[50:51] op_sel_hi:[1,0,0] neg_lo:[0,0,1] neg_hi:[0,0,1]
    v_cvt_pk_bf16_f32 v208, v208, v209
    v_pk_fma_f32 v[222:223], v[222:223], v[48:49], v[50:51] op_sel_hi:[1,0,0] neg_lo:[0,0,1] neg_hi:[0,0,1]
    v_cvt_pk_bf16_f32 v209, v210, v211
    s_add_u32 m0, s46, 5128
    s_add_u32 s47, s36, 1792
    buffer_load_dwordx4 v15, s[16:19], s47 offen lds
    v_pk_fma_f32 v[224:225], v[224:225], v[48:49], v[50:51] op_sel_hi:[1,0,0] neg_lo:[0,0,1] neg_hi:[0,0,1]
    v_cvt_pk_bf16_f32 v210, v212, v213
    v_pk_fma_f32 v[226:227], v[226:227], v[48:49], v[50:51] op_sel_hi:[1,0,0] neg_lo:[0,0,1] neg_hi:[0,0,1]
    v_cvt_pk_bf16_f32 v211, v214, v215
    v_pk_fma_f32 v[228:229], v[228:229], v[48:49], v[50:51] op_sel_hi:[1,0,0] neg_lo:[0,0,1] neg_hi:[0,0,1]
    v_cvt_pk_bf16_f32 v212, v216, v217
    v_pk_fma_f32 v[230:231], v[230:231], v[48:49], v[50:51] op_sel_hi:[1,0,0] neg_lo:[0,0,1] neg_hi:[0,0,1]
    v_cvt_pk_bf16_f32 v213, v218, v219
    v_pk_fma_f32 v[232:233], v[232:233], v[48:49], v[50:51] op_sel_hi:[1,0,0] neg_lo:[0,0,1] neg_hi:[0,0,1]
    v_cvt_pk_bf16_f32 v214, v220, v221
    v_pk_fma_f32 v[234:235], v[234:235], v[48:49], v[50:51] op_sel_hi:[1,0,0] neg_lo:[0,0,1] neg_hi:[0,0,1]
    v_cvt_pk_bf16_f32 v215, v222, v223
    v_pk_fma_f32 v[236:237], v[236:237], v[48:49], v[50:51] op_sel_hi:[1,0,0] neg_lo:[0,0,1] neg_hi:[0,0,1]
    v_cvt_pk_bf16_f32 v216, v224, v225
    v_pk_fma_f32 v[238:239], v[238:239], v[48:49], v[50:51] op_sel_hi:[1,0,0] neg_lo:[0,0,1] neg_hi:[0,0,1]
    v_cvt_pk_bf16_f32 v217, v226, v227
    v_pk_fma_f32 v[240:241], v[240:241], v[48:49], v[50:51] op_sel_hi:[1,0,0] neg_lo:[0,0,1] neg_hi:[0,0,1]
    v_cvt_pk_bf16_f32 v218, v228, v229
    v_pk_fma_f32 v[242:243], v[242:243], v[48:49], v[50:51] op_sel_hi:[1,0,0] neg_lo:[0,0,1] neg_hi:[0,0,1]
    v_cvt_pk_bf16_f32 v219, v230, v231
    v_pk_fma_f32 v[244:245], v[244:245], v[48:49], v[50:51] op_sel_hi:[1,0,0] neg_lo:[0,0,1] neg_hi:[0,0,1]
    v_cvt_pk_bf16_f32 v220, v232, v233
    v_pk_fma_f32 v[246:247], v[246:247], v[48:49], v[50:51] op_sel_hi:[1,0,0] neg_lo:[0,0,1] neg_hi:[0,0,1]
    v_cvt_pk_bf16_f32 v221, v234, v235
    v_pk_fma_f32 v[248:249], v[248:249], v[48:49], v[50:51] op_sel_hi:[1,0,0] neg_lo:[0,0,1] neg_hi:[0,0,1]
    v_cvt_pk_bf16_f32 v222, v236, v237
    v_pk_fma_f32 v[250:251], v[250:251], v[48:49], v[50:51] op_sel_hi:[1,0,0] neg_lo:[0,0,1] neg_hi:[0,0,1]
    v_cvt_pk_bf16_f32 v223, v238, v239
    v_pk_fma_f32 v[252:253], v[252:253], v[48:49], v[50:51] op_sel_hi:[1,0,0] neg_lo:[0,0,1] neg_hi:[0,0,1]
    v_cvt_pk_bf16_f32 v224, v240, v241
    v_pk_fma_f32 v[254:255], v[254:255], v[48:49], v[50:51] op_sel_hi:[1,0,0] neg_lo:[0,0,1] neg_hi:[0,0,1]
    v_cvt_pk_bf16_f32 v225, v242, v243
    v_cvt_pk_bf16_f32 v226, v244, v245
    v_cvt_pk_bf16_f32 v227, v246, v247
    v_cvt_pk_bf16_f32 v228, v248, v249
    v_cvt_pk_bf16_f32 v229, v250, v251
    v_cvt_pk_bf16_f32 v230, v252, v253
    v_cvt_pk_bf16_f32 v231, v254, v255
    s_waitcnt lgkmcnt(0)
    s_barrier
    ds_read_b128 v[232:235], v156 offset:40960
    ds_read_b128 v[236:239], v156 offset:41984
    ds_read_b128 v[240:243], v156 offset:43008
    ds_read_b128 v[244:247], v156 offset:44032
    ds_read_b128 v[248:251], v156 offset:45056
    ds_read_b128 v[252:255], v156 offset:46080
    s_cmp_eq_u32 s28, 0
    s_cselect_b32 s38, 0, 262144
    v_add_u32 v19, s38, v17
    s_mov_b32 s32, 0x44ea44ea
    s_mul_i32 s45, s28, 6144
    s_add_u32 s45, s45, 98816
    s_mul_i32 s46, s28, 6160
    s_add_u32 s46, s46, 123392
    s_mov_b32 s35, 256
    s_mov_b32 s36, 24576
    s_mov_b32 s33, 49408
    s_mov_b32 s48, 49408
    s_mov_b32 s49, -98816
    s_mov_b32 s37, 10
    ds_read_b128 v[20:23], v10
    ds_read_b64_tr_b16 a[192:193], v2 offset:0
    ds_read_b64_tr_b16 a[194:195], v2 offset:2048
    ds_read_b64_tr_b16 a[196:197], v2 offset:4096
    ds_read_b64_tr_b16 a[198:199], v2 offset:6144
    ds_read_b64_tr_b16 a[200:201], v2 offset:8192
    ds_read_b64_tr_b16 a[202:203], v2 offset:10240
    ds_read_b64_tr_b16 a[204:205], v2 offset:12288
    ds_read_b64_tr_b16 a[206:207], v2 offset:14336
    v_add_u32 v10, 0x100, v10
    s_waitcnt lgkmcnt(6)
    v_mfma_f32_16x16x32_bf16 v[76:79], a[192:195], v[160:163], v[20:23]
    s_add_u32 m0, s45, 0
    ds_read_b64_tr_b16 a[208:209], v2 offset:16384
    ds_read_b64_tr_b16 a[210:211], v2 offset:18432
    v_mfma_f32_16x16x32_bf16 v[84:87], a[192:195], v[184:187], v[20:23]
    s_add_u32 s47, s35, 0
    buffer_load_dwordx4 v14, s[12:15], s47 offen lds
    v_mfma_f32_16x16x32_bf16 v[92:95], a[192:195], v[208:211], v[20:23]
    v_mfma_f32_16x16x32_bf16 v[44:47], a[192:195], v[232:235], v[20:23]
    s_waitcnt lgkmcnt(6)
    v_mfma_f32_16x16x32_bf16 v[76:79], a[196:199], v[164:167], v[76:79]
    s_add_u32 m0, s45, 1024
    ds_read_b64_tr_b16 a[212:213], v2 offset:20480
    ds_read_b64_tr_b16 a[214:215], v2 offset:22528
    v_add_u32 v2, s33, v2
    v_mfma_f32_16x16x32_bf16 v[84:87], a[196:199], v[188:191], v[84:87]
    s_add_u32 s47, s35, 12288
    buffer_load_dwordx4 v14, s[12:15], s47 offen lds
    v_mfma_f32_16x16x32_bf16 v[92:95], a[196:199], v[212:215], v[92:95]
    v_mfma_f32_16x16x32_bf16 v[44:47], a[196:199], v[236:239], v[44:47]
    s_waitcnt lgkmcnt(6)
    v_mfma_f32_16x16x32_bf16 v[76:79], a[200:203], v[168:171], v[76:79]
    s_add_u32 m0, s45, 2048
    ds_read_b128 v[24:27], v11
    ds_read_b64_tr_b16 a[192:193], v3 offset:0
    ds_read_b64_tr_b16 a[194:195], v3 offset:2048
    v_add_u32 v11, 0x100, v11
    v_mfma_f32_16x16x32_bf16 v[84:87], a[200:203], v[192:195], v[84:87]
    s_add_u32 s47, s35, 24576
    buffer_load_dwordx4 v14, s[12:15], s47 offen lds
    v_mfma_f32_16x16x32_bf16 v[92:95], a[200:203], v[216:219], v[92:95]
    v_mfma_f32_16x16x32_bf16 v[44:47], a[200:203], v[240:243], v[44:47]
    s_waitcnt lgkmcnt(7)
    v_mfma_f32_16x16x32_bf16 v[76:79], a[204:207], v[172:175], v[76:79]
    s_add_u32 m0, s45, 3072
    ds_read_b64_tr_b16 a[196:197], v3 offset:4096
    ds_read_b64_tr_b16 a[198:199], v3 offset:6144
    v_mfma_f32_16x16x32_bf16 v[84:87], a[204:207], v[196:199], v[84:87]
    s_add_u32 s47, s35, 36864
    buffer_load_dwordx4 v14, s[12:15], s47 offen lds
    v_mfma_f32_16x16x32_bf16 v[92:95], a[204:207], v[220:223], v[92:95]
    v_mfma_f32_16x16x32_bf16 v[44:47], a[204:207], v[244:247], v[44:47]
    s_waitcnt lgkmcnt(7)
    v_mfma_f32_16x16x32_bf16 v[76:79], a[208:211], v[176:179], v[76:79]
    s_add_u32 m0, s45, 4096
    ds_read_b64_tr_b16 a[200:201], v3 offset:8192
    ds_read_b64_tr_b16 a[202:203], v3 offset:10240
    v_mfma_f32_16x16x32_bf16 v[84:87], a[208:211], v[200:203], v[84:87]
    s_add_u32 s47, s35, 49152
    buffer_load_dwordx4 v14, s[12:15], s47 offen lds
    v_mfma_f32_16x16x32_bf16 v[92:95], a[208:211], v[224:227], v[92:95]
    v_mfma_f32_16x16x32_bf16 v[44:47], a[208:211], v[248:251], v[44:47]
    s_waitcnt lgkmcnt(7)
    v_mfma_f32_16x16x32_bf16 v[76:79], a[212:215], v[180:183], v[76:79]
    s_add_u32 m0, s45, 5120
    ds_read_b64_tr_b16 a[204:205], v3 offset:12288
    ds_read_b64_tr_b16 a[206:207], v3 offset:14336
    v_mfma_f32_16x16x32_bf16 v[84:87], a[212:215], v[204:207], v[84:87]
    s_add_u32 s47, s35, 61440
    buffer_load_dwordx4 v14, s[12:15], s47 offen lds
    v_mfma_f32_16x16x32_bf16 v[92:95], a[212:215], v[228:231], v[92:95]
    v_mfma_f32_16x16x32_bf16 v[44:47], a[212:215], v[252:255], v[44:47]
    s_waitcnt lgkmcnt(6)
    v_mfma_f32_16x16x32_bf16 v[80:83], a[192:195], v[160:163], v[24:27]
    s_add_u32 m0, s46, 0
    ds_read_b64_tr_b16 a[208:209], v3 offset:16384
    ds_read_b64_tr_b16 a[210:211], v3 offset:18432
    v_mfma_f32_16x16x32_bf16 v[88:91], a[192:195], v[184:187], v[24:27]
    s_add_u32 s47, s36, 0
    buffer_load_dwordx4 v15, s[16:19], s47 offen lds
    v_mfma_f32_16x16x32_bf16 v[96:99], a[192:195], v[208:211], v[24:27]
    s_waitcnt lgkmcnt(6)
    v_mfma_f32_16x16x32_bf16 v[80:83], a[196:199], v[164:167], v[80:83]
    s_add_u32 m0, s46, 1024
    ds_read_b64_tr_b16 a[212:213], v3 offset:20480
    ds_read_b64_tr_b16 a[214:215], v3 offset:22528
    v_add_u32 v3, s33, v3
    v_mfma_f32_16x16x32_bf16 v[88:91], a[196:199], v[188:191], v[88:91]
    s_add_u32 s47, s36, 128
    buffer_load_dwordx4 v15, s[16:19], s47 offen lds
    v_mfma_f32_16x16x32_bf16 v[96:99], a[196:199], v[212:215], v[96:99]
    s_waitcnt lgkmcnt(6)
    v_mfma_f32_16x16x32_bf16 v[80:83], a[200:203], v[168:171], v[80:83]
    s_add_u32 m0, s46, 2048
    ds_read_b128 v[20:23], v12
    ds_read_b64_tr_b16 a[192:193], v4 offset:0
    ds_read_b64_tr_b16 a[194:195], v4 offset:2048
    v_add_u32 v12, 0x100, v12
    v_mfma_f32_16x16x32_bf16 v[88:91], a[200:203], v[192:195], v[88:91]
    s_add_u32 s47, s36, 256
    buffer_load_dwordx4 v15, s[16:19], s47 offen lds
    v_mfma_f32_16x16x32_bf16 v[96:99], a[200:203], v[216:219], v[96:99]
    s_waitcnt lgkmcnt(7)
    v_mfma_f32_16x16x32_bf16 v[80:83], a[204:207], v[172:175], v[80:83]
    s_add_u32 m0, s46, 3080
    ds_read_b64_tr_b16 a[196:197], v4 offset:4096
    ds_read_b64_tr_b16 a[198:199], v4 offset:6144
    v_mfma_f32_16x16x32_bf16 v[88:91], a[204:207], v[196:199], v[88:91]
    s_add_u32 s47, s36, 1536
    buffer_load_dwordx4 v15, s[16:19], s47 offen lds
    v_mfma_f32_16x16x32_bf16 v[96:99], a[204:207], v[220:223], v[96:99]
    s_waitcnt lgkmcnt(7)
    v_mfma_f32_16x16x32_bf16 v[80:83], a[208:211], v[176:179], v[80:83]
    s_add_u32 m0, s46, 4104
    ds_read_b64_tr_b16 a[200:201], v4 offset:8192
    ds_read_b64_tr_b16 a[202:203], v4 offset:10240
    v_mfma_f32_16x16x32_bf16 v[88:91], a[208:211], v[200:203], v[88:91]
    s_add_u32 s47, s36, 1664
    buffer_load_dwordx4 v15, s[16:19], s47 offen lds
    v_mfma_f32_16x16x32_bf16 v[96:99], a[208:211], v[224:227], v[96:99]
    s_waitcnt lgkmcnt(7)
    v_mfma_f32_16x16x32_bf16 v[80:83], a[212:215], v[180:183], v[80:83]
    s_add_u32 m0, s46, 5128
    ds_read_b64_tr_b16 a[204:205], v4 offset:12288
    ds_read_b64_tr_b16 a[206:207], v4 offset:14336
    v_mfma_f32_16x16x32_bf16 v[88:91], a[212:215], v[204:207], v[88:91]
    s_add_u32 s47, s36, 1792
    buffer_load_dwordx4 v15, s[16:19], s47 offen lds
    v_mfma_f32_16x16x32_bf16 v[96:99], a[212:215], v[228:231], v[96:99]
    s_waitcnt lgkmcnt(6)
    v_mfma_f32_16x16x32_bf16 v[100:103], a[192:195], v[160:163], v[20:23]
    s_add_u32 s45, s45, s49
    ds_read_b64_tr_b16 a[208:209], v4 offset:16384
    ds_read_b64_tr_b16 a[210:211], v4 offset:18432
    v_cvt_pk_f16_f32 v28, v76, v77
    v_cvt_pk_f16_f32 v30, v78, v79
    v_pk_fma_f16 v29, v28, v28, s32
    v_pk_fma_f16 v31, v30, v30, s32
    v_pk_mul_f16 v28, v28, v29 neg_lo:[1,0] neg_hi:[1,0]
    v_mfma_f32_16x16x32_bf16 v[108:111], a[192:195], v[184:187], v[20:23]
    v_pk_mul_f16 v30, v30, v31 neg_lo:[1,0] neg_hi:[1,0]
    v_exp_f16 v29, v28
    v_exp_f16 v31, v30
    v_exp_f16_sdwa v29, v28 dst_sel:WORD_1 dst_unused:UNUSED_PRESERVE src0_sel:WORD_1
    v_mfma_f32_16x16x32_bf16 v[116:119], a[192:195], v[208:211], v[20:23]
    s_waitcnt lgkmcnt(6)
    ds_read_b128 a[0:3], v17 offset:0
    ds_read_b128 a[144:147], v19 offset:0
    v_exp_f16_sdwa v31, v30 dst_sel:WORD_1 dst_unused:UNUSED_PRESERVE src0_sel:WORD_1
    v_pk_add_f16 v28, v29, 1.0 op_sel_hi:[1,0]
    v_pk_add_f16 v30, v31, 1.0 op_sel_hi:[1,0]
    v_rcp_f16 v29, v28
    v_mfma_f32_16x16x32_bf16 v[100:103], a[196:199], v[164:167], v[100:103]
    s_add_u32 s46, s46, s49
    ds_read_b64_tr_b16 a[212:213], v4 offset:20480
    ds_read_b64_tr_b16 a[214:215], v4 offset:22528
    v_add_u32 v4, s33, v4
    v_rcp_f16 v31, v30
    v_rcp_f16_sdwa v29, v28 dst_sel:WORD_1 dst_unused:UNUSED_PRESERVE src0_sel:WORD_1
    v_mfma_f32_16x16x32_bf16 v[108:111], a[196:199], v[188:191], v[108:111]
    v_rcp_f16_sdwa v31, v30 dst_sel:WORD_1 dst_unused:UNUSED_PRESERVE src0_sel:WORD_1
    v_fma_mix_f32 v28, v76, v29, 0 op_sel_hi:[0,1,0]
    v_fma_mix_f32 v30, v78, v31, 0 op_sel_hi:[0,1,0]
    v_fma_mix_f32 v29, v77, v29, 0 op_sel:[0,1,0] op_sel_hi:[0,1,0]
    v_fma_mix_f32 v31, v79, v31, 0 op_sel:[0,1,0] op_sel_hi:[0,1,0]
    v_cvt_pk_bf16_f32 v52, v28, v29
    v_cvt_pk_bf16_f32 v53, v30, v31
    v_mfma_f32_16x16x32_bf16 v[116:119], a[196:199], v[212:215], v[116:119]
    s_waitcnt lgkmcnt(8)
    ds_read_b128 a[4:7], v17 offset:16
    ds_read_b128 a[148:151], v19 offset:16
    v_cvt_pk_f16_f32 v32, v80, v81
    v_cvt_pk_f16_f32 v34, v82, v83
    v_pk_fma_f16 v33, v32, v32, s32
    v_pk_fma_f16 v35, v34, v34, s32
    v_pk_mul_f16 v32, v32, v33 neg_lo:[1,0] neg_hi:[1,0]
    v_mfma_f32_16x16x32_bf16 v[100:103], a[200:203], v[168:171], v[100:103]
    s_add_u32 s35, s35, 128
    ds_read_b128 v[24:27], v13
    ds_read_b64_tr_b16 a[192:193], v5 offset:0
    ds_read_b64_tr_b16 a[194:195], v5 offset:2048
    v_add_u32 v13, 0x100, v13
    v_pk_mul_f16 v34, v34, v35 neg_lo:[1,0] neg_hi:[1,0]
    v_exp_f16 v33, v32
    v_mfma_f32_16x16x32_bf16 v[108:111], a[200:203], v[192:195], v[108:111]
    v_exp_f16 v35, v34
    v_exp_f16_sdwa v33, v32 dst_sel:WORD_1 dst_unused:UNUSED_PRESERVE src0_sel:WORD_1
    v_exp_f16_sdwa v35, v34 dst_sel:WORD_1 dst_unused:UNUSED_PRESERVE src0_sel:WORD_1
    v_pk_add_f16 v32, v33, 1.0 op_sel_hi:[1,0]
    v_pk_add_f16 v34, v35, 1.0 op_sel_hi:[1,0]
    v_mfma_f32_16x16x32_bf16 v[116:119], a[200:203], v[216:219], v[116:119]
    s_waitcnt lgkmcnt(11)
    ds_read_b128 a[8:11], v17 offset:128
    ds_read_b128 a[152:155], v19 offset:128
    v_rcp_f16 v33, v32
    v_rcp_f16 v35, v34
    v_mfma_f32_16x16x32_bf16 v[100:103], a[204:207], v[172:175], v[100:103]
    s_add_u32 s36, s36, 24576
    ds_read_b64_tr_b16 a[196:197], v5 offset:4096
    ds_read_b64_tr_b16 a[198:199], v5 offset:6144
    v_rcp_f16_sdwa v33, v32 dst_sel:WORD_1 dst_unused:UNUSED_PRESERVE src0_sel:WORD_1
    v_rcp_f16_sdwa v35, v34 dst_sel:WORD_1 dst_unused:UNUSED_PRESERVE src0_sel:WORD_1
    v_fma_mix_f32 v32, v80, v33, 0 op_sel_hi:[0,1,0]
    v_fma_mix_f32 v34, v82, v35, 0 op_sel_hi:[0,1,0]
    v_mfma_f32_16x16x32_bf16 v[108:111], a[204:207], v[196:199], v[108:111]
    v_fma_mix_f32 v33, v81, v33, 0 op_sel:[0,1,0] op_sel_hi:[0,1,0]
    v_fma_mix_f32 v35, v83, v35, 0 op_sel:[0,1,0] op_sel_hi:[0,1,0]
    v_cvt_pk_bf16_f32 v54, v32, v33
    v_cvt_pk_bf16_f32 v55, v34, v35
    v_cvt_pk_f16_f32 v28, v84, v85
    v_cvt_pk_f16_f32 v30, v86, v87
    v_pk_fma_f16 v29, v28, v28, s32
    v_pk_fma_f16 v31, v30, v30, s32
    v_mfma_f32_16x16x32_bf16 v[116:119], a[204:207], v[220:223], v[116:119]
    s_waitcnt lgkmcnt(13)
    ds_read_b128 a[12:15], v17 offset:144
    ds_read_b128 a[156:159], v19 offset:144
    v_pk_mul_f16 v28, v28, v29 neg_lo:[1,0] neg_hi:[1,0]
    v_pk_mul_f16 v30, v30, v31 neg_lo:[1,0] neg_hi:[1,0]
    v_exp_f16 v29, v28
    v_mfma_f32_16x16x32_bf16 v[100:103], a[208:211], v[176:179], v[100:103]
    s_mov_b32 s38, s48
    ds_read_b64_tr_b16 a[200:201], v5 offset:8192
    ds_read_b64_tr_b16 a[202:203], v5 offset:10240
    v_exp_f16 v31, v30
    v_exp_f16_sdwa v29, v28 dst_sel:WORD_1 dst_unused:UNUSED_PRESERVE src0_sel:WORD_1
    v_exp_f16_sdwa v31, v30 dst_sel:WORD_1 dst_unused:UNUSED_PRESERVE src0_sel:WORD_1
    v_mfma_f32_16x16x32_bf16 v[108:111], a[208:211], v[200:203], v[108:111]
    v_pk_add_f16 v28, v29, 1.0 op_sel_hi:[1,0]
    v_pk_add_f16 v30, v31, 1.0 op_sel_hi:[1,0]
    v_rcp_f16 v29, v28
    v_rcp_f16 v31, v30
    v_rcp_f16_sdwa v29, v28 dst_sel:WORD_1 dst_unused:UNUSED_PRESERVE src0_sel:WORD_1
    v_mfma_f32_16x16x32_bf16 v[116:119], a[208:211], v[224:227], v[116:119]
    s_waitcnt lgkmcnt(13)
    ds_read_b128 a[16:19], v17 offset:256
    ds_read_b128 a[160:163], v19 offset:256
    v_rcp_f16_sdwa v31, v30 dst_sel:WORD_1 dst_unused:UNUSED_PRESERVE src0_sel:WORD_1
    v_fma_mix_f32 v28, v84, v29, 0 op_sel_hi:[0,1,0]
    v_fma_mix_f32 v30, v86, v31, 0 op_sel_hi:[0,1,0]
    v_fma_mix_f32 v29, v85, v29, 0 op_sel:[0,1,0] op_sel_hi:[0,1,0]
    v_mfma_f32_16x16x32_bf16 v[100:103], a[212:215], v[180:183], v[100:103]
    s_mov_b32 s48, s49
    ds_read_b64_tr_b16 a[204:205], v5 offset:12288
    ds_read_b64_tr_b16 a[206:207], v5 offset:14336
    v_fma_mix_f32 v31, v87, v31, 0 op_sel:[0,1,0] op_sel_hi:[0,1,0]
    v_cvt_pk_bf16_f32 v56, v28, v29
    v_cvt_pk_bf16_f32 v57, v30, v31
    v_cvt_pk_f16_f32 v32, v88, v89
    v_cvt_pk_f16_f32 v34, v90, v91
    v_mfma_f32_16x16x32_bf16 v[108:111], a[212:215], v[204:207], v[108:111]
    v_pk_fma_f16 v33, v32, v32, s32
    v_pk_fma_f16 v35, v34, v34, s32
    v_pk_mul_f16 v32, v32, v33 neg_lo:[1,0] neg_hi:[1,0]
    v_pk_mul_f16 v34, v34, v35 neg_lo:[1,0] neg_hi:[1,0]
    v_exp_f16 v33, v32
    v_exp_f16 v35, v34
    v_mfma_f32_16x16x32_bf16 v[116:119], a[212:215], v[228:231], v[116:119]
    s_waitcnt lgkmcnt(12)
    ds_read_b128 a[20:23], v17 offset:272
    ds_read_b128 a[164:167], v19 offset:272
    v_exp_f16_sdwa v33, v32 dst_sel:WORD_1 dst_unused:UNUSED_PRESERVE src0_sel:WORD_1
    v_exp_f16_sdwa v35, v34 dst_sel:WORD_1 dst_unused:UNUSED_PRESERVE src0_sel:WORD_1
    v_pk_add_f16 v32, v33, 1.0 op_sel_hi:[1,0]
    v_mfma_f32_16x16x32_bf16 v[104:107], a[192:195], v[160:163], v[24:27]
    s_waitcnt vmcnt(12)
    s_barrier
    s_mov_b32 s49, s33
    ds_read_b64_tr_b16 a[208:209], v5 offset:16384
    ds_read_b64_tr_b16 a[210:211], v5 offset:18432
    v_pk_add_f16 v34, v35, 1.0 op_sel_hi:[1,0]
    v_rcp_f16 v33, v32
    v_rcp_f16 v35, v34
    v_mfma_f32_16x16x32_bf16 v[112:115], a[192:195], v[184:187], v[24:27]
    v_rcp_f16_sdwa v33, v32 dst_sel:WORD_1 dst_unused:UNUSED_PRESERVE src0_sel:WORD_1
    v_rcp_f16_sdwa v35, v34 dst_sel:WORD_1 dst_unused:UNUSED_PRESERVE src0_sel:WORD_1
    v_fma_mix_f32 v32, v88, v33, 0 op_sel_hi:[0,1,0]
    v_fma_mix_f32 v34, v90, v35, 0 op_sel_hi:[0,1,0]
    v_fma_mix_f32 v33, v89, v33, 0 op_sel:[0,1,0] op_sel_hi:[0,1,0]
    v_fma_mix_f32 v35, v91, v35, 0 op_sel:[0,1,0] op_sel_hi:[0,1,0]
    v_mfma_f32_16x16x32_bf16 v[120:123], a[192:195], v[208:211], v[24:27]
    s_waitcnt lgkmcnt(12)
    ds_read_b128 a[24:27], v17 offset:384
    ds_read_b128 a[168:171], v19 offset:384
    v_cvt_pk_bf16_f32 v58, v32, v33
    v_cvt_pk_bf16_f32 v59, v34, v35
    v_cvt_pk_f16_f32 v28, v92, v93
    v_cvt_pk_f16_f32 v30, v94, v95
    v_pk_fma_f16 v29, v28, v28, s32
    v_mfma_f32_16x16x32_bf16 v[104:107], a[196:199], v[164:167], v[104:107]
    s_sub_u32 s37, s37, 1
    ds_read_b64_tr_b16 a[212:213], v5 offset:20480
    ds_read_b64_tr_b16 a[214:215], v5 offset:22528
    v_add_u32 v5, s33, v5
    v_pk_fma_f16 v31, v30, v30, s32
    v_pk_mul_f16 v28, v28, v29 neg_lo:[1,0] neg_hi:[1,0]
    v_pk_mul_f16 v30, v30, v31 neg_lo:[1,0] neg_hi:[1,0]
    v_mfma_f32_16x16x32_bf16 v[112:115], a[196:199], v[188:191], v[112:115]
    v_exp_f16 v29, v28
    v_exp_f16 v31, v30
    v_exp_f16_sdwa v29, v28 dst_sel:WORD_1 dst_unused:UNUSED_PRESERVE src0_sel:WORD_1
    v_exp_f16_sdwa v31, v30 dst_sel:WORD_1 dst_unused:UNUSED_PRESERVE src0_sel:WORD_1
    v_pk_add_f16 v28, v29, 1.0 op_sel_hi:[1,0]
    v_mfma_f32_16x16x32_bf16 v[120:123], a[196:199], v[212:215], v[120:123]
    s_waitcnt lgkmcnt(12)
    ds_read_b128 a[28:31], v17 offset:400
    ds_read_b128 a[172:175], v19 offset:400
    v_pk_add_f16 v30, v31, 1.0 op_sel_hi:[1,0]
    v_rcp_f16 v29, v28
    v_rcp_f16 v31, v30
    v_mfma_f32_16x16x32_bf16 v[104:107], a[200:203], v[168:171], v[104:107]
    s_cmp_lg_u32 s37, 0
    ds_read_b128 v[20:23], v10
    ds_read_b64_tr_b16 a[192:193], v2 offset:0
    ds_read_b64_tr_b16 a[194:195], v2 offset:2048
    v_add_u32 v10, 0x100, v10
    v_rcp_f16_sdwa v29, v28 dst_sel:WORD_1 dst_unused:UNUSED_PRESERVE src0_sel:WORD_1
    v_mfma_f32_16x16x32_bf16 v[112:115], a[200:203], v[192:195], v[112:115]
    v_rcp_f16_sdwa v31, v30 dst_sel:WORD_1 dst_unused:UNUSED_PRESERVE src0_sel:WORD_1
    v_fma_mix_f32 v28, v92, v29, 0 op_sel_hi:[0,1,0]
    v_fma_mix_f32 v30, v94, v31, 0 op_sel_hi:[0,1,0]
    v_fma_mix_f32 v29, v93, v29, 0 op_sel:[0,1,0] op_sel_hi:[0,1,0]
    v_fma_mix_f32 v31, v95, v31, 0 op_sel:[0,1,0] op_sel_hi:[0,1,0]
    v_cvt_pk_bf16_f32 v60, v28, v29
    v_cvt_pk_bf16_f32 v61, v30, v31
    v_cvt_pk_f16_f32 v32, v96, v97
    v_mfma_f32_16x16x32_bf16 v[120:123], a[200:203], v[216:219], v[120:123]
    s_waitcnt lgkmcnt(13)
    ds_read_b128 a[32:35], v17 offset:512
    ds_read_b128 a[176:179], v19 offset:512
    v_cvt_pk_f16_f32 v34, v98, v99
    v_pk_fma_f16 v33, v32, v32, s32
    v_pk_fma_f16 v35, v34, v34, s32
    v_pk_mul_f16 v32, v32, v33 neg_lo:[1,0] neg_hi:[1,0]
    v_pk_mul_f16 v34, v34, v35 neg_lo:[1,0] neg_hi:[1,0]
    v_mfma_f32_16x16x32_bf16 v[104:107], a[204:207], v[172:175], v[104:107]
    ds_read_b64_tr_b16 a[196:197], v2 offset:4096
    ds_read_b64_tr_b16 a[198:199], v2 offset:6144
    v_exp_f16 v33, v32
    v_exp_f16 v35, v34
    v_mfma_f32_16x16x32_bf16 v[112:115], a[204:207], v[196:199], v[112:115]
    v_exp_f16_sdwa v33, v32 dst_sel:WORD_1 dst_unused:UNUSED_PRESERVE src0_sel:WORD_1
    v_exp_f16_sdwa v35, v34 dst_sel:WORD_1 dst_unused:UNUSED_PRESERVE src0_sel:WORD_1
    v_pk_add_f16 v32, v33, 1.0 op_sel_hi:[1,0]
    v_pk_add_f16 v34, v35, 1.0 op_sel_hi:[1,0]
    v_rcp_f16 v33, v32
    v_mfma_f32_16x16x32_bf16 v[120:123], a[204:207], v[220:223], v[120:123]
    s_waitcnt lgkmcnt(13)
    ds_read_b128 a[36:39], v17 offset:528
    ds_read_b128 a[180:183], v19 offset:528
    v_rcp_f16 v35, v34
    v_rcp_f16_sdwa v33, v32 dst_sel:WORD_1 dst_unused:UNUSED_PRESERVE src0_sel:WORD_1
    v_rcp_f16_sdwa v35, v34 dst_sel:WORD_1 dst_unused:UNUSED_PRESERVE src0_sel:WORD_1
    v_mfma_f32_16x16x32_bf16 v[104:107], a[208:211], v[176:179], v[104:107]
    ds_read_b64_tr_b16 a[200:201], v2 offset:8192
    ds_read_b64_tr_b16 a[202:203], v2 offset:10240
    v_fma_mix_f32 v32, v96, v33, 0 op_sel_hi:[0,1,0]
    v_fma_mix_f32 v34, v98, v35, 0 op_sel_hi:[0,1,0]
    v_fma_mix_f32 v33, v97, v33, 0 op_sel:[0,1,0] op_sel_hi:[0,1,0]
    v_fma_mix_f32 v35, v99, v35, 0 op_sel:[0,1,0] op_sel_hi:[0,1,0]
    v_cvt_pk_bf16_f32 v62, v32, v33
    v_mfma_f32_16x16x32_bf16 v[112:115], a[208:211], v[200:203], v[112:115]
    v_cvt_pk_bf16_f32 v63, v34, v35
    v_cvt_pk_f16_f32 v28, v44, v45
    v_cvt_pk_f16_f32 v30, v46, v47
    v_pk_fma_f16 v29, v28, v28, s32
    v_pk_fma_f16 v31, v30, v30, s32
    v_pk_mul_f16 v28, v28, v29 neg_lo:[1,0] neg_hi:[1,0]
    v_pk_mul_f16 v30, v30, v31 neg_lo:[1,0] neg_hi:[1,0]
    v_mfma_f32_16x16x32_bf16 v[120:123], a[208:211], v[224:227], v[120:123]
    s_waitcnt lgkmcnt(13)
    ds_read_b128 a[40:43], v17 offset:640
    ds_read_b128 a[184:187], v19 offset:640
    v_exp_f16 v29, v28
    v_exp_f16 v31, v30
    v_exp_f16_sdwa v29, v28 dst_sel:WORD_1 dst_unused:UNUSED_PRESERVE src0_sel:WORD_1
    v_mfma_f32_16x16x32_bf16 v[104:107], a[212:215], v[180:183], v[104:107]
    ds_read_b64_tr_b16 a[204:205], v2 offset:12288
    ds_read_b64_tr_b16 a[206:207], v2 offset:14336
    v_exp_f16_sdwa v31, v30 dst_sel:WORD_1 dst_unused:UNUSED_PRESERVE src0_sel:WORD_1
    v_pk_add_f16 v28, v29, 1.0 op_sel_hi:[1,0]
    v_pk_add_f16 v30, v31, 1.0 op_sel_hi:[1,0]
    v_mfma_f32_16x16x32_bf16 v[112:115], a[212:215], v[204:207], v[112:115]
    s_mov_b32 s33, s38
    v_rcp_f16 v29, v28
    v_rcp_f16 v31, v30
    v_rcp_f16_sdwa v29, v28 dst_sel:WORD_1 dst_unused:UNUSED_PRESERVE src0_sel:WORD_1
    v_rcp_f16_sdwa v31, v30 dst_sel:WORD_1 dst_unused:UNUSED_PRESERVE src0_sel:WORD_1
    v_fma_mix_f32 v28, v44, v29, 0 op_sel_hi:[0,1,0]
    v_mfma_f32_16x16x32_bf16 v[120:123], a[212:215], v[228:231], v[120:123]
    s_waitcnt lgkmcnt(12)
    ds_read_b128 a[44:47], v17 offset:656
    ds_read_b128 a[188:191], v19 offset:656
    v_fma_mix_f32 v30, v46, v31, 0 op_sel_hi:[0,1,0]
    v_fma_mix_f32 v29, v45, v29, 0 op_sel:[0,1,0] op_sel_hi:[0,1,0]
    v_fma_mix_f32 v31, v47, v31, 0 op_sel:[0,1,0] op_sel_hi:[0,1,0]
    v_cvt_pk_bf16_f32 v48, v28, v29
    v_cvt_pk_bf16_f32 v49, v30, v31
    s_waitcnt vmcnt(0)
    s_barrier
    v_mfma_f32_16x16x32_bf16 v[76:79], a[192:195], v[160:163], v[20:23]
    s_add_u32 m0, s45, 0
    ds_read_b64_tr_b16 a[208:209], v2 offset:16384
    ds_read_b64_tr_b16 a[210:211], v2 offset:18432
    v_cvt_pk_f16_f32 v28, v100, v101
    v_mfma_f32_16x16x32_bf16 v[84:87], a[192:195], v[184:187], v[20:23]
    s_add_u32 s47, s35, 0
    buffer_load_dwordx4 v14, s[12:15], s47 offen lds
    v_mfma_f32_16x16x32_bf16 v[92:95], a[192:195], v[208:211], v[20:23]
    v_cvt_pk_f16_f32 v30, v102, v103
    v_pk_fma_f16 v29, v28, v28, s32
    v_pk_fma_f16 v31, v30, v30, s32
    v_mfma_f32_16x16x32_bf16 v[44:47], a[192:195], v[232:235], v[20:23]
    s_waitcnt lgkmcnt(12)
    v_pk_mul_f16 v28, v28, v29 neg_lo:[1,0] neg_hi:[1,0]
    v_pk_mul_f16 v30, v30, v31 neg_lo:[1,0] neg_hi:[1,0]
    v_mfma_f32_16x16x32_bf16 v[76:79], a[196:199], v[164:167], v[76:79]
    s_add_u32 m0, s45, 1024
    ds_read_b64_tr_b16 a[212:213], v2 offset:20480
    ds_read_b64_tr_b16 a[214:215], v2 offset:22528
    v_add_u32 v2, s33, v2
    v_mfma_f32_16x16x32_bf16 v[84:87], a[196:199], v[188:191], v[84:87]
    s_add_u32 s47, s35, 12288
    buffer_load_dwordx4 v14, s[12:15], s47 offen lds
    v_mfma_f32_16x16x32_bf16 v[92:95], a[196:199], v[212:215], v[92:95]
    v_exp_f16 v29, v28
    v_mfma_f32_16x16x32_bf16 v[44:47], a[196:199], v[236:239], v[44:47]
    s_waitcnt lgkmcnt(10)
    v_exp_f16 v31, v30
    v_exp_f16_sdwa v29, v28 dst_sel:WORD_1 dst_unused:UNUSED_PRESERVE src0_sel:WORD_1
    v_mfma_f32_16x16x32_bf16 v[76:79], a[200:203], v[168:171], v[76:79]
    s_add_u32 m0, s45, 2048
    ds_read_b128 v[24:27], v11
    ds_read_b64_tr_b16 a[192:193], v3 offset:0
    ds_read_b64_tr_b16 a[194:195], v3 offset:2048
    v_add_u32 v11, 0x100, v11
    v_mfma_f32_16x16x32_bf16 v[84:87], a[200:203], v[192:195], v[84:87]
    s_add_u32 s47, s35, 24576
    buffer_load_dwordx4 v14, s[12:15], s47 offen lds
    v_mfma_f32_16x16x32_bf16 v[92:95], a[200:203], v[216:219], v[92:95]
    v_exp_f16_sdwa v31, v30 dst_sel:WORD_1 dst_unused:UNUSED_PRESERVE src0_sel:WORD_1
    v_mfma_f32_16x16x32_bf16 v[44:47], a[200:203], v[240:243], v[44:47]
    s_waitcnt lgkmcnt(9)
    v_pk_add_f16 v28, v29, 1.0 op_sel_hi:[1,0]
    v_pk_add_f16 v30, v31, 1.0 op_sel_hi:[1,0]
    v_mfma_f32_16x16x32_bf16 v[76:79], a[204:207], v[172:175], v[76:79]
    s_add_u32 m0, s45, 3072
    ds_read_b64_tr_b16 a[196:197], v3 offset:4096
    ds_read_b64_tr_b16 a[198:199], v3 offset:6144
    v_rcp_f16 v29, v28
    v_mfma_f32_16x16x32_bf16 v[84:87], a[204:207], v[196:199], v[84:87]
    s_add_u32 s47, s35, 36864
    buffer_load_dwordx4 v14, s[12:15], s47 offen lds
    v_mfma_f32_16x16x32_bf16 v[92:95], a[204:207], v[220:223], v[92:95]
    v_rcp_f16 v31, v30
    v_mfma_f32_16x16x32_bf16 v[44:47], a[204:207], v[244:247], v[44:47]
    s_waitcnt lgkmcnt(7)
    v_rcp_f16_sdwa v29, v28 dst_sel:WORD_1 dst_unused:UNUSED_PRESERVE src0_sel:WORD_1
    v_mfma_f32_16x16x32_bf16 v[76:79], a[208:211], v[176:179], v[76:79]
    s_add_u32 m0, s45, 4096
    ds_read_b64_tr_b16 a[200:201], v3 offset:8192
    ds_read_b64_tr_b16 a[202:203], v3 offset:10240
    v_rcp_f16_sdwa v31, v30 dst_sel:WORD_1 dst_unused:UNUSED_PRESERVE src0_sel:WORD_1
    v_mfma_f32_16x16x32_bf16 v[84:87], a[208:211], v[200:203], v[84:87]
    s_add_u32 s47, s35, 49152
    buffer_load_dwordx4 v14, s[12:15], s47 offen lds
    v_mfma_f32_16x16x32_bf16 v[92:95], a[208:211], v[224:227], v[92:95]
    v_fma_mix_f32 v28, v100, v29, 0 op_sel_hi:[0,1,0]
    v_fma_mix_f32 v30, v102, v31, 0 op_sel_hi:[0,1,0]
    v_fma_mix_f32 v29, v101, v29, 0 op_sel:[0,1,0] op_sel_hi:[0,1,0]
    v_mfma_f32_16x16x32_bf16 v[44:47], a[208:211], v[248:251], v[44:47]
    s_waitcnt lgkmcnt(7)
    v_fma_mix_f32 v31, v103, v31, 0 op_sel:[0,1,0] op_sel_hi:[0,1,0]
    v_cvt_pk_bf16_f32 v64, v28, v29
    v_cvt_pk_bf16_f32 v65, v30, v31
    v_mfma_f32_16x16x32_bf16 v[76:79], a[212:215], v[180:183], v[76:79]
    s_add_u32 m0, s45, 5120
    ds_read_b64_tr_b16 a[204:205], v3 offset:12288
    ds_read_b64_tr_b16 a[206:207], v3 offset:14336
    v_cvt_pk_f16_f32 v32, v104, v105
    v_mfma_f32_16x16x32_bf16 v[84:87], a[212:215], v[204:207], v[84:87]
    s_add_u32 s47, s35, 61440
    buffer_load_dwordx4 v14, s[12:15], s47 offen lds
    v_mfma_f32_16x16x32_bf16 v[92:95], a[212:215], v[228:231], v[92:95]
    v_cvt_pk_f16_f32 v34, v106, v107
    v_pk_fma_f16 v33, v32, v32, s32
    v_mfma_f32_16x16x32_bf16 v[44:47], a[212:215], v[252:255], v[44:47]
    s_waitcnt lgkmcnt(6)
    v_pk_fma_f16 v35, v34, v34, s32
    v_pk_mul_f16 v32, v32, v33 neg_lo:[1,0] neg_hi:[1,0]
    v_pk_mul_f16 v34, v34, v35 neg_lo:[1,0] neg_hi:[1,0]
    v_mfma_f32_16x16x32_bf16 v[80:83], a[192:195], v[160:163], v[24:27]
    s_add_u32 m0, s46, 0
    ds_read_b64_tr_b16 a[208:209], v3 offset:16384
    ds_read_b64_tr_b16 a[210:211], v3 offset:18432
    v_mfma_f32_16x16x32_bf16 v[88:91], a[192:195], v[184:187], v[24:27]
    s_add_u32 s47, s36, 0
    buffer_load_dwordx4 v15, s[16:19], s47 offen lds
    v_mfma_f32_16x16x32_bf16 v[96:99], a[192:195], v[208:211], v[24:27]
    s_waitcnt lgkmcnt(6)
    v_exp_f16 v33, v32
    v_exp_f16 v35, v34
    v_mfma_f32_16x16x32_bf16 v[80:83], a[196:199], v[164:167], v[80:83]
    s_add_u32 m0, s46, 1024
    ds_read_b64_tr_b16 a[212:213], v3 offset:20480
    ds_read_b64_tr_b16 a[214:215], v3 offset:22528
    v_add_u32 v3, s33, v3
    v_mfma_f32_16x16x32_bf16 v[88:91], a[196:199], v[188:191], v[88:91]
    s_add_u32 s47, s36, 128
    buffer_load_dwordx4 v15, s[16:19], s47 offen lds
    v_mfma_f32_16x16x32_bf16 v[96:99], a[196:199], v[212:215], v[96:99]
    s_waitcnt lgkmcnt(6)
    v_exp_f16_sdwa v33, v32 dst_sel:WORD_1 dst_unused:UNUSED_PRESERVE src0_sel:WORD_1
    v_mfma_f32_16x16x32_bf16 v[80:83], a[200:203], v[168:171], v[80:83]
    s_add_u32 m0, s46, 2048
    ds_read_b64_tr_b16 a[192:193], v6 offset:0
    ds_read_b64_tr_b16 a[194:195], v7 offset:0
    v_exp_f16_sdwa v35, v34 dst_sel:WORD_1 dst_unused:UNUSED_PRESERVE src0_sel:WORD_1
    v_mfma_f32_16x16x32_bf16 v[88:91], a[200:203], v[192:195], v[88:91]
    s_add_u32 s47, s36, 256
    buffer_load_dwordx4 v15, s[16:19], s47 offen lds
    v_mfma_f32_16x16x32_bf16 v[96:99], a[200:203], v[216:219], v[96:99]
    s_waitcnt lgkmcnt(6)
    v_pk_add_f16 v32, v33, 1.0 op_sel_hi:[1,0]
    v_pk_add_f16 v34, v35, 1.0 op_sel_hi:[1,0]
    v_mfma_f32_16x16x32_bf16 v[80:83], a[204:207], v[172:175], v[80:83]
    s_add_u32 m0, s46, 3080
    ds_read_b64_tr_b16 a[196:197], v6 offset:8
    ds_read_b64_tr_b16 a[198:199], v7 offset:8
    v_mfma_f32_16x16x32_bf16 v[88:91], a[204:207], v[196:199], v[88:91]
    s_add_u32 s47, s36, 1536
    buffer_load_dwordx4 v15, s[16:19], s47 offen lds
    v_mfma_f32_16x16x32_bf16 v[96:99], a[204:207], v[220:223], v[96:99]
    s_waitcnt lgkmcnt(6)
    v_rcp_f16 v33, v32
    v_rcp_f16 v35, v34
    v_mfma_f32_16x16x32_bf16 v[80:83], a[208:211], v[176:179], v[80:83]
    s_add_u32 m0, s46, 4104
    ds_read_b64_tr_b16 a[200:201], v6 offset:512
    ds_read_b64_tr_b16 a[202:203], v7 offset:512
    v_mfma_f32_16x16x32_bf16 v[88:91], a[208:211], v[200:203], v[88:91]
    s_add_u32 s47, s36, 1664
    buffer_load_dwordx4 v15, s[16:19], s47 offen lds
    v_mfma_f32_16x16x32_bf16 v[96:99], a[208:211], v[224:227], v[96:99]
    s_waitcnt lgkmcnt(6)
    v_rcp_f16_sdwa v33, v32 dst_sel:WORD_1 dst_unused:UNUSED_PRESERVE src0_sel:WORD_1
    v_rcp_f16_sdwa v35, v34 dst_sel:WORD_1 dst_unused:UNUSED_PRESERVE src0_sel:WORD_1
    v_mfma_f32_16x16x32_bf16 v[80:83], a[212:215], v[180:183], v[80:83]
    s_add_u32 m0, s46, 5128
    ds_read_b64_tr_b16 a[204:205], v6 offset:520
    ds_read_b64_tr_b16 a[206:207], v7 offset:520
    v_fma_mix_f32 v32, v104, v33, 0 op_sel_hi:[0,1,0]
    v_mfma_f32_16x16x32_bf16 v[88:91], a[212:215], v[204:207], v[88:91]
    s_add_u32 s47, s36, 1792
    buffer_load_dwordx4 v15, s[16:19], s47 offen lds
    v_mfma_f32_16x16x32_bf16 v[96:99], a[212:215], v[228:231], v[96:99]
    s_waitcnt lgkmcnt(6)
    v_fma_mix_f32 v34, v106, v35, 0 op_sel_hi:[0,1,0]
    v_fma_mix_f32 v33, v105, v33, 0 op_sel:[0,1,0] op_sel_hi:[0,1,0]
    v_mfma_f32_16x16x32_bf16 a[48:51], a[192:195], v[56:59], a[0:3]
    ds_read_b64_tr_b16 a[208:209], v6 offset:1024
    ds_read_b64_tr_b16 a[210:211], v7 offset:1024
    v_fma_mix_f32 v35, v107, v35, 0 op_sel:[0,1,0] op_sel_hi:[0,1,0]
    v_mfma_f32_16x16x32_bf16 a[96:99], a[192:195], v[60:63], a[0:3]
    v_cvt_pk_bf16_f32 v66, v32, v33
    v_cvt_pk_bf16_f32 v67, v34, v35
    v_cvt_pk_f16_f32 v28, v108, v109
    v_mfma_f32_16x16x16_bf16 a[144:147], a[192:193], v[48:49], a[144:147]
    v_cvt_pk_f16_f32 v30, v110, v111
    v_pk_fma_f16 v29, v28, v28, s32
    v_pk_fma_f16 v31, v30, v30, s32
    v_pk_mul_f16 v28, v28, v29 neg_lo:[1,0] neg_hi:[1,0]
    v_mfma_f32_16x16x32_bf16 a[0:3], a[192:195], v[52:55], a[0:3]
    s_waitcnt lgkmcnt(6)
    v_pk_mul_f16 v30, v30, v31 neg_lo:[1,0] neg_hi:[1,0]
    v_exp_f16 v29, v28
    v_mfma_f32_16x16x32_bf16 a[52:55], a[196:199], v[56:59], a[4:7]
    ds_read_b64_tr_b16 a[212:213], v6 offset:1032
    ds_read_b64_tr_b16 a[214:215], v7 offset:1032
    v_mfma_f32_16x16x32_bf16 a[100:103], a[196:199], v[60:63], a[4:7]
    v_exp_f16 v31, v30
    v_exp_f16_sdwa v29, v28 dst_sel:WORD_1 dst_unused:UNUSED_PRESERVE src0_sel:WORD_1
    v_mfma_f32_16x16x16_bf16 a[148:151], a[196:197], v[48:49], a[148:151]
    v_exp_f16_sdwa v31, v30 dst_sel:WORD_1 dst_unused:UNUSED_PRESERVE src0_sel:WORD_1
    v_pk_add_f16 v28, v29, 1.0 op_sel_hi:[1,0]
    v_pk_add_f16 v30, v31, 1.0 op_sel_hi:[1,0]
    v_mfma_f32_16x16x32_bf16 a[4:7], a[196:199], v[52:55], a[4:7]
    s_waitcnt lgkmcnt(6)
    v_rcp_f16 v29, v28
    v_mfma_f32_16x16x32_bf16 a[56:59], a[200:203], v[56:59], a[8:11]
    ds_read_b64_tr_b16 a[192:193], v6 offset:1536
    ds_read_b64_tr_b16 a[194:195], v7 offset:1536
    v_mfma_f32_16x16x32_bf16 a[104:107], a[200:203], v[60:63], a[8:11]
    v_rcp_f16 v31, v30
    v_rcp_f16_sdwa v29, v28 dst_sel:WORD_1 dst_unused:UNUSED_PRESERVE src0_sel:WORD_1
    v_mfma_f32_16x16x16_bf16 a[152:155], a[200:201], v[48:49], a[152:155]
    v_rcp_f16_sdwa v31, v30 dst_sel:WORD_1 dst_unused:UNUSED_PRESERVE src0_sel:WORD_1
    v_fma_mix_f32 v28, v108, v29, 0 op_sel_hi:[0,1,0]
    v_fma_mix_f32 v30, v110, v31, 0 op_sel_hi:[0,1,0]
    v_mfma_f32_16x16x32_bf16 a[8:11], a[200:203], v[52:55], a[8:11]
    s_waitcnt lgkmcnt(6)
    v_fma_mix_f32 v29, v109, v29, 0 op_sel:[0,1,0] op_sel_hi:[0,1,0]
    v_fma_mix_f32 v31, v111, v31, 0 op_sel:[0,1,0] op_sel_hi:[0,1,0]
    v_cvt_pk_bf16_f32 v68, v28, v29
    v_mfma_f32_16x16x32_bf16 a[60:63], a[204:207], v[56:59], a[12:15]
    ds_read_b64_tr_b16 a[196:197], v6 offset:1544
    ds_read_b64_tr_b16 a[198:199], v7 offset:1544
    v_cvt_pk_bf16_f32 v69, v30, v31
    v_mfma_f32_16x16x32_bf16 a[108:111], a[204:207], v[60:63], a[12:15]
    v_cvt_pk_f16_f32 v32, v112, v113
    v_cvt_pk_f16_f32 v34, v114, v115
    v_pk_fma_f16 v33, v32, v32, s32
    v_mfma_f32_16x16x16_bf16 a[156:159], a[204:205], v[48:49], a[156:159]
    v_pk_fma_f16 v35, v34, v34, s32
    v_pk_mul_f16 v32, v32, v33 neg_lo:[1,0] neg_hi:[1,0]
    v_pk_mul_f16 v34, v34, v35 neg_lo:[1,0] neg_hi:[1,0]
    v_exp_f16 v33, v32
    v_mfma_f32_16x16x32_bf16 a[12:15], a[204:207], v[52:55], a[12:15]
    s_waitcnt lgkmcnt(6)
    v_exp_f16 v35, v34
    v_mfma_f32_16x16x32_bf16 a[64:67], a[208:211], v[56:59], a[16:19]
    ds_read_b64_tr_b16 a[200:201], v6 offset:2048
    ds_read_b64_tr_b16 a[202:203], v7 offset:2048
    v_mfma_f32_16x16x32_bf16 a[112:115], a[208:211], v[60:63], a[16:19]
    v_exp_f16_sdwa v33, v32 dst_sel:WORD_1 dst_unused:UNUSED_PRESERVE src0_sel:WORD_1
    v_exp_f16_sdwa v35, v34 dst_sel:WORD_1 dst_unused:UNUSED_PRESERVE src0_sel:WORD_1
    v_mfma_f32_16x16x16_bf16 a[160:163], a[208:209], v[48:49], a[160:163]
    v_pk_add_f16 v32, v33, 1.0 op_sel_hi:[1,0]
    v_pk_add_f16 v34, v35, 1.0 op_sel_hi:[1,0]
    v_rcp_f16 v33, v32
    v_mfma_f32_16x16x32_bf16 a[16:19], a[208:211], v[52:55], a[16:19]
    s_waitcnt lgkmcnt(6)
    v_rcp_f16 v35, v34
    v_mfma_f32_16x16x32_bf16 a[68:71], a[212:215], v[56:59], a[20:23]
    ds_read_b64_tr_b16 a[204:205], v6 offset:2056
    ds_read_b64_tr_b16 a[206:207], v7 offset:2056
    v_mfma_f32_16x16x32_bf16 a[116:119], a[212:215], v[60:63], a[20:23]
    v_rcp_f16_sdwa v33, v32 dst_sel:WORD_1 dst_unused:UNUSED_PRESERVE src0_sel:WORD_1
    v_rcp_f16_sdwa v35, v34 dst_sel:WORD_1 dst_unused:UNUSED_PRESERVE src0_sel:WORD_1
    v_mfma_f32_16x16x16_bf16 a[164:167], a[212:213], v[48:49], a[164:167]
    v_fma_mix_f32 v32, v112, v33, 0 op_sel_hi:[0,1,0]
    v_fma_mix_f32 v34, v114, v35, 0 op_sel_hi:[0,1,0]
    v_fma_mix_f32 v33, v113, v33, 0 op_sel:[0,1,0] op_sel_hi:[0,1,0]
    v_fma_mix_f32 v35, v115, v35, 0 op_sel:[0,1,0] op_sel_hi:[0,1,0]
    v_mfma_f32_16x16x32_bf16 a[20:23], a[212:215], v[52:55], a[20:23]
    s_waitcnt lgkmcnt(6)
    v_cvt_pk_bf16_f32 v70, v32, v33
    v_cvt_pk_bf16_f32 v71, v34, v35
    v_cvt_pk_f16_f32 v28, v116, v117
    v_mfma_f32_16x16x32_bf16 a[72:75], a[192:195], v[56:59], a[24:27]
    ds_read_b64_tr_b16 a[208:209], v6 offset:2560
    ds_read_b64_tr_b16 a[210:211], v7 offset:2560
    v_cvt_pk_f16_f32 v30, v118, v119
    v_mfma_f32_16x16x32_bf16 a[120:123], a[192:195], v[60:63], a[24:27]
    v_pk_fma_f16 v29, v28, v28, s32
    v_pk_fma_f16 v31, v30, v30, s32
    v_pk_mul_f16 v28, v28, v29 neg_lo:[1,0] neg_hi:[1,0]
    v_mfma_f32_16x16x16_bf16 a[168:171], a[192:193], v[48:49], a[168:171]
    v_pk_mul_f16 v30, v30, v31 neg_lo:[1,0] neg_hi:[1,0]
    v_exp_f16 v29, v28
    v_exp_f16 v31, v30
    v_mfma_f32_16x16x32_bf16 a[24:27], a[192:195], v[52:55], a[24:27]
    s_waitcnt lgkmcnt(6)
    v_exp_f16_sdwa v29, v28 dst_sel:WORD_1 dst_unused:UNUSED_PRESERVE src0_sel:WORD_1
    v_mfma_f32_16x16x32_bf16 a[76:79], a[196:199], v[56:59], a[28:31]
    ds_read_b64_tr_b16 a[212:213], v6 offset:2568
    ds_read_b64_tr_b16 a[214:215], v7 offset:2568
    v_add_u32 v6, s33, v6
    v_add_u32 v7, s33, v7
    v_mfma_f32_16x16x32_bf16 a[124:127], a[196:199], v[60:63], a[28:31]
    v_exp_f16_sdwa v31, v30 dst_sel:WORD_1 dst_unused:UNUSED_PRESERVE src0_sel:WORD_1
    v_pk_add_f16 v28, v29, 1.0 op_sel_hi:[1,0]
    v_mfma_f32_16x16x16_bf16 a[172:175], a[196:197], v[48:49], a[172:175]
    v_pk_add_f16 v30, v31, 1.0 op_sel_hi:[1,0]
    v_rcp_f16 v29, v28
    v_rcp_f16 v31, v30
    v_mfma_f32_16x16x32_bf16 a[28:31], a[196:199], v[52:55], a[28:31]
    s_waitcnt lgkmcnt(6)
    v_rcp_f16_sdwa v29, v28 dst_sel:WORD_1 dst_unused:UNUSED_PRESERVE src0_sel:WORD_1
    v_mfma_f32_16x16x32_bf16 a[80:83], a[200:203], v[56:59], a[32:35]
    ds_read_b128 v[20:23], v12
    ds_read_b64_tr_b16 a[192:193], v4 offset:0
    ds_read_b64_tr_b16 a[194:195], v4 offset:2048
    v_add_u32 v12, 0x100, v12
    v_mfma_f32_16x16x32_bf16 a[128:131], a[200:203], v[60:63], a[32:35]
    v_rcp_f16_sdwa v31, v30 dst_sel:WORD_1 dst_unused:UNUSED_PRESERVE src0_sel:WORD_1
    v_fma_mix_f32 v28, v116, v29, 0 op_sel_hi:[0,1,0]
    v_mfma_f32_16x16x16_bf16 a[176:179], a[200:201], v[48:49], a[176:179]
    v_fma_mix_f32 v30, v118, v31, 0 op_sel_hi:[0,1,0]
    v_fma_mix_f32 v29, v117, v29, 0 op_sel:[0,1,0] op_sel_hi:[0,1,0]
    v_fma_mix_f32 v31, v119, v31, 0 op_sel:[0,1,0] op_sel_hi:[0,1,0]
    v_cvt_pk_bf16_f32 v72, v28, v29
    v_mfma_f32_16x16x32_bf16 a[32:35], a[200:203], v[52:55], a[32:35]
    s_waitcnt lgkmcnt(7)
    v_cvt_pk_bf16_f32 v73, v30, v31
    v_cvt_pk_f16_f32 v32, v120, v121
    v_mfma_f32_16x16x32_bf16 a[84:87], a[204:207], v[56:59], a[36:39]
    ds_read_b64_tr_b16 a[196:197], v4 offset:4096
    ds_read_b64_tr_b16 a[198:199], v4 offset:6144
    v_mfma_f32_16x16x32_bf16 a[132:135], a[204:207], v[60:63], a[36:39]
    v_cvt_pk_f16_f32 v34, v122, v123
    v_pk_fma_f16 v33, v32, v32, s32
    v_pk_fma_f16 v35, v34, v34, s32
    v_mfma_f32_16x16x16_bf16 a[180:183], a[204:205], v[48:49], a[180:183]
    v_pk_mul_f16 v32, v32, v33 neg_lo:[1,0] neg_hi:[1,0]
    v_pk_mul_f16 v34, v34, v35 neg_lo:[1,0] neg_hi:[1,0]
    v_exp_f16 v33, v32
    v_mfma_f32_16x16x32_bf16 a[36:39], a[204:207], v[52:55], a[36:39]
    s_waitcnt lgkmcnt(7)
    v_exp_f16 v35, v34
    v_mfma_f32_16x16x32_bf16 a[88:91], a[208:211], v[56:59], a[40:43]
    ds_read_b64_tr_b16 a[200:201], v4 offset:8192
    ds_read_b64_tr_b16 a[202:203], v4 offset:10240
    v_mfma_f32_16x16x32_bf16 a[136:139], a[208:211], v[60:63], a[40:43]
    v_exp_f16_sdwa v33, v32 dst_sel:WORD_1 dst_unused:UNUSED_PRESERVE src0_sel:WORD_1
    v_exp_f16_sdwa v35, v34 dst_sel:WORD_1 dst_unused:UNUSED_PRESERVE src0_sel:WORD_1
    v_mfma_f32_16x16x16_bf16 a[184:187], a[208:209], v[48:49], a[184:187]
    v_pk_add_f16 v32, v33, 1.0 op_sel_hi:[1,0]
    v_pk_add_f16 v34, v35, 1.0 op_sel_hi:[1,0]
    v_rcp_f16 v33, v32
    v_mfma_f32_16x16x32_bf16 a[40:43], a[208:211], v[52:55], a[40:43]
    s_waitcnt lgkmcnt(7)
    v_rcp_f16 v35, v34
    v_mfma_f32_16x16x32_bf16 a[92:95], a[212:215], v[56:59], a[44:47]
    ds_read_b64_tr_b16 a[204:205], v4 offset:12288
    ds_read_b64_tr_b16 a[206:207], v4 offset:14336
    v_mfma_f32_16x16x32_bf16 a[140:143], a[212:215], v[60:63], a[44:47]
    v_rcp_f16_sdwa v33, v32 dst_sel:WORD_1 dst_unused:UNUSED_PRESERVE src0_sel:WORD_1
    v_rcp_f16_sdwa v35, v34 dst_sel:WORD_1 dst_unused:UNUSED_PRESERVE src0_sel:WORD_1
    v_mfma_f32_16x16x16_bf16 a[188:191], a[212:213], v[48:49], a[188:191]
    v_fma_mix_f32 v32, v120, v33, 0 op_sel_hi:[0,1,0]
    v_fma_mix_f32 v34, v122, v35, 0 op_sel_hi:[0,1,0]
    v_fma_mix_f32 v33, v121, v33, 0 op_sel:[0,1,0] op_sel_hi:[0,1,0]
    v_fma_mix_f32 v35, v123, v35, 0 op_sel:[0,1,0] op_sel_hi:[0,1,0]
    v_mfma_f32_16x16x32_bf16 a[44:47], a[212:215], v[52:55], a[44:47]
    s_waitcnt lgkmcnt(6)
    v_cvt_pk_bf16_f32 v74, v32, v33
    v_cvt_pk_bf16_f32 v75, v34, v35
    v_mfma_f32_16x16x32_bf16 v[100:103], a[192:195], v[160:163], v[20:23]
    s_add_u32 s45, s45, s49
    ds_read_b64_tr_b16 a[208:209], v4 offset:16384
    ds_read_b64_tr_b16 a[210:211], v4 offset:18432
    v_cvt_pk_f16_f32 v28, v76, v77
    v_cvt_pk_f16_f32 v30, v78, v79
    v_mfma_f32_16x16x32_bf16 v[108:111], a[192:195], v[184:187], v[20:23]
    v_pk_fma_f16 v29, v28, v28, s32
    v_pk_fma_f16 v31, v30, v30, s32
    v_pk_mul_f16 v28, v28, v29 neg_lo:[1,0] neg_hi:[1,0]
    v_mfma_f32_16x16x32_bf16 v[116:119], a[192:195], v[208:211], v[20:23]
    s_waitcnt lgkmcnt(6)
    v_pk_mul_f16 v30, v30, v31 neg_lo:[1,0] neg_hi:[1,0]
    v_exp_f16 v29, v28
    v_mfma_f32_16x16x32_bf16 v[100:103], a[196:199], v[164:167], v[100:103]
    s_add_u32 s46, s46, s49
    ds_read_b64_tr_b16 a[212:213], v4 offset:20480
    ds_read_b64_tr_b16 a[214:215], v4 offset:22528
    v_add_u32 v4, s33, v4
    v_exp_f16 v31, v30
    v_mfma_f32_16x16x32_bf16 v[108:111], a[196:199], v[188:191], v[108:111]
    v_exp_f16_sdwa v29, v28 dst_sel:WORD_1 dst_unused:UNUSED_PRESERVE src0_sel:WORD_1
    v_mfma_f32_16x16x32_bf16 v[116:119], a[196:199], v[212:215], v[116:119]
    s_waitcnt lgkmcnt(6)
    v_exp_f16_sdwa v31, v30 dst_sel:WORD_1 dst_unused:UNUSED_PRESERVE src0_sel:WORD_1
    v_pk_add_f16 v28, v29, 1.0 op_sel_hi:[1,0]
    v_pk_add_f16 v30, v31, 1.0 op_sel_hi:[1,0]
    v_mfma_f32_16x16x32_bf16 v[100:103], a[200:203], v[168:171], v[100:103]
    s_add_u32 s35, s35, 128
    ds_read_b128 v[24:27], v13
    ds_read_b64_tr_b16 a[192:193], v5 offset:0
    ds_read_b64_tr_b16 a[194:195], v5 offset:2048
    v_add_u32 v13, 0x100, v13
    v_mfma_f32_16x16x32_bf16 v[108:111], a[200:203], v[192:195], v[108:111]
    v_rcp_f16 v29, v28
    v_rcp_f16 v31, v30
    v_mfma_f32_16x16x32_bf16 v[116:119], a[200:203], v[216:219], v[116:119]
    s_waitcnt lgkmcnt(7)
    v_rcp_f16_sdwa v29, v28 dst_sel:WORD_1 dst_unused:UNUSED_PRESERVE src0_sel:WORD_1
    v_rcp_f16_sdwa v31, v30 dst_sel:WORD_1 dst_unused:UNUSED_PRESERVE src0_sel:WORD_1
    v_mfma_f32_16x16x32_bf16 v[100:103], a[204:207], v[172:175], v[100:103]
    s_add_u32 s36, s36, 24576
    ds_read_b64_tr_b16 a[196:197], v5 offset:4096
    ds_read_b64_tr_b16 a[198:199], v5 offset:6144
    v_fma_mix_f32 v28, v76, v29, 0 op_sel_hi:[0,1,0]
    v_fma_mix_f32 v30, v78, v31, 0 op_sel_hi:[0,1,0]
    v_mfma_f32_16x16x32_bf16 v[108:111], a[204:207], v[196:199], v[108:111]
    v_fma_mix_f32 v29, v77, v29, 0 op_sel:[0,1,0] op_sel_hi:[0,1,0]
    v_fma_mix_f32 v31, v79, v31, 0 op_sel:[0,1,0] op_sel_hi:[0,1,0]
    v_cvt_pk_bf16_f32 v52, v28, v29
    v_cvt_pk_bf16_f32 v53, v30, v31
    v_mfma_f32_16x16x32_bf16 v[116:119], a[204:207], v[220:223], v[116:119]
    s_waitcnt lgkmcnt(7)
    v_cvt_pk_f16_f32 v32, v80, v81
    v_cvt_pk_f16_f32 v34, v82, v83
    v_pk_fma_f16 v33, v32, v32, s32
    v_mfma_f32_16x16x32_bf16 v[100:103], a[208:211], v[176:179], v[100:103]
    s_mov_b32 s38, s48
    ds_read_b64_tr_b16 a[200:201], v5 offset:8192
    ds_read_b64_tr_b16 a[202:203], v5 offset:10240
    v_pk_fma_f16 v35, v34, v34, s32
    v_pk_mul_f16 v32, v32, v33 neg_lo:[1,0] neg_hi:[1,0]
    v_mfma_f32_16x16x32_bf16 v[108:111], a[208:211], v[200:203], v[108:111]
    v_pk_mul_f16 v34, v34, v35 neg_lo:[1,0] neg_hi:[1,0]
    v_exp_f16 v33, v32
    v_mfma_f32_16x16x32_bf16 v[116:119], a[208:211], v[224:227], v[116:119]
    s_waitcnt lgkmcnt(7)
    v_exp_f16 v35, v34
    v_exp_f16_sdwa v33, v32 dst_sel:WORD_1 dst_unused:UNUSED_PRESERVE src0_sel:WORD_1
    v_mfma_f32_16x16x32_bf16 v[100:103], a[212:215], v[180:183], v[100:103]
    s_mov_b32 s48, s49
    ds_read_b64_tr_b16 a[204:205], v5 offset:12288
    ds_read_b64_tr_b16 a[206:207], v5 offset:14336
    v_exp_f16_sdwa v35, v34 dst_sel:WORD_1 dst_unused:UNUSED_PRESERVE src0_sel:WORD_1
    v_mfma_f32_16x16x32_bf16 v[108:111], a[212:215], v[204:207], v[108:111]
    v_pk_add_f16 v32, v33, 1.0 op_sel_hi:[1,0]
    v_pk_add_f16 v34, v35, 1.0 op_sel_hi:[1,0]
    v_rcp_f16 v33, v32
    v_mfma_f32_16x16x32_bf16 v[116:119], a[212:215], v[228:231], v[116:119]
    s_waitcnt lgkmcnt(6)
    v_rcp_f16 v35, v34
    v_rcp_f16_sdwa v33, v32 dst_sel:WORD_1 dst_unused:UNUSED_PRESERVE src0_sel:WORD_1
    v_mfma_f32_16x16x32_bf16 v[104:107], a[192:195], v[160:163], v[24:27]
    s_mov_b32 s49, s33
    ds_read_b64_tr_b16 a[208:209], v5 offset:16384
    ds_read_b64_tr_b16 a[210:211], v5 offset:18432
    v_mfma_f32_16x16x32_bf16 v[112:115], a[192:195], v[184:187], v[24:27]
    v_rcp_f16_sdwa v35, v34 dst_sel:WORD_1 dst_unused:UNUSED_PRESERVE src0_sel:WORD_1
    v_fma_mix_f32 v32, v80, v33, 0 op_sel_hi:[0,1,0]
    v_fma_mix_f32 v34, v82, v35, 0 op_sel_hi:[0,1,0]
    v_fma_mix_f32 v33, v81, v33, 0 op_sel:[0,1,0] op_sel_hi:[0,1,0]
    v_mfma_f32_16x16x32_bf16 v[120:123], a[192:195], v[208:211], v[24:27]
    s_waitcnt lgkmcnt(6)
    v_fma_mix_f32 v35, v83, v35, 0 op_sel:[0,1,0] op_sel_hi:[0,1,0]
    v_cvt_pk_bf16_f32 v54, v32, v33
    v_cvt_pk_bf16_f32 v55, v34, v35
    v_cvt_pk_f16_f32 v28, v84, v85
    v_mfma_f32_16x16x32_bf16 v[104:107], a[196:199], v[164:167], v[104:107]
    s_sub_u32 s37, s37, 1
    ds_read_b64_tr_b16 a[212:213], v5 offset:20480
    ds_read_b64_tr_b16 a[214:215], v5 offset:22528
    v_add_u32 v5, s33, v5
    v_mfma_f32_16x16x32_bf16 v[112:115], a[196:199], v[188:191], v[112:115]
    v_cvt_pk_f16_f32 v30, v86, v87
    v_pk_fma_f16 v29, v28, v28, s32
    v_pk_fma_f16 v31, v30, v30, s32
    v_pk_mul_f16 v28, v28, v29 neg_lo:[1,0] neg_hi:[1,0]
    v_mfma_f32_16x16x32_bf16 v[120:123], a[196:199], v[212:215], v[120:123]
    s_waitcnt lgkmcnt(6)
    v_pk_mul_f16 v30, v30, v31 neg_lo:[1,0] neg_hi:[1,0]
    v_exp_f16 v29, v28
    v_mfma_f32_16x16x32_bf16 v[104:107], a[200:203], v[168:171], v[104:107]
    s_cmp_lg_u32 s37, 0
    ds_read_b64_tr_b16 a[192:193], v8 offset:0
    ds_read_b64_tr_b16 a[194:195], v9 offset:0
    v_exp_f16 v31, v30
    v_mfma_f32_16x16x32_bf16 v[112:115], a[200:203], v[192:195], v[112:115]
    v_exp_f16_sdwa v29, v28 dst_sel:WORD_1 dst_unused:UNUSED_PRESERVE src0_sel:WORD_1
    v_exp_f16_sdwa v31, v30 dst_sel:WORD_1 dst_unused:UNUSED_PRESERVE src0_sel:WORD_1
    v_mfma_f32_16x16x32_bf16 v[120:123], a[200:203], v[216:219], v[120:123]
    s_waitcnt lgkmcnt(6)
    v_pk_add_f16 v28, v29, 1.0 op_sel_hi:[1,0]
    v_pk_add_f16 v30, v31, 1.0 op_sel_hi:[1,0]
    v_rcp_f16 v29, v28
    v_mfma_f32_16x16x32_bf16 v[104:107], a[204:207], v[172:175], v[104:107]
    ds_read_b64_tr_b16 a[196:197], v8 offset:8
    ds_read_b64_tr_b16 a[198:199], v9 offset:8
    v_mfma_f32_16x16x32_bf16 v[112:115], a[204:207], v[196:199], v[112:115]
    v_rcp_f16 v31, v30
    v_rcp_f16_sdwa v29, v28 dst_sel:WORD_1 dst_unused:UNUSED_PRESERVE src0_sel:WORD_1
    v_mfma_f32_16x16x32_bf16 v[120:123], a[204:207], v[220:223], v[120:123]
    s_waitcnt lgkmcnt(6)
    v_rcp_f16_sdwa v31, v30 dst_sel:WORD_1 dst_unused:UNUSED_PRESERVE src0_sel:WORD_1
    v_fma_mix_f32 v28, v84, v29, 0 op_sel_hi:[0,1,0]
    v_fma_mix_f32 v30, v86, v31, 0 op_sel_hi:[0,1,0]
    v_fma_mix_f32 v29, v85, v29, 0 op_sel:[0,1,0] op_sel_hi:[0,1,0]
    v_mfma_f32_16x16x32_bf16 v[104:107], a[208:211], v[176:179], v[104:107]
    ds_read_b64_tr_b16 a[200:201], v8 offset:512
    ds_read_b64_tr_b16 a[202:203], v9 offset:512
    v_fma_mix_f32 v31, v87, v31, 0 op_sel:[0,1,0] op_sel_hi:[0,1,0]
    v_cvt_pk_bf16_f32 v56, v28, v29
    v_mfma_f32_16x16x32_bf16 v[112:115], a[208:211], v[200:203], v[112:115]
    v_cvt_pk_bf16_f32 v57, v30, v31
    v_cvt_pk_f16_f32 v32, v88, v89
    v_cvt_pk_f16_f32 v34, v90, v91
    v_mfma_f32_16x16x32_bf16 v[120:123], a[208:211], v[224:227], v[120:123]
    s_waitcnt lgkmcnt(6)
    v_pk_fma_f16 v33, v32, v32, s32
    v_pk_fma_f16 v35, v34, v34, s32
    v_pk_mul_f16 v32, v32, v33 neg_lo:[1,0] neg_hi:[1,0]
    v_pk_mul_f16 v34, v34, v35 neg_lo:[1,0] neg_hi:[1,0]
    v_mfma_f32_16x16x32_bf16 v[104:107], a[212:215], v[180:183], v[104:107]
    ds_read_b64_tr_b16 a[204:205], v8 offset:520
    ds_read_b64_tr_b16 a[206:207], v9 offset:520
    v_exp_f16 v33, v32
    v_mfma_f32_16x16x32_bf16 v[112:115], a[212:215], v[204:207], v[112:115]
    v_exp_f16 v35, v34
    v_mfma_f32_16x16x32_bf16 v[120:123], a[212:215], v[228:231], v[120:123]
    s_waitcnt lgkmcnt(6)
    v_exp_f16_sdwa v33, v32 dst_sel:WORD_1 dst_unused:UNUSED_PRESERVE src0_sel:WORD_1
    v_exp_f16_sdwa v35, v34 dst_sel:WORD_1 dst_unused:UNUSED_PRESERVE src0_sel:WORD_1
    v_pk_add_f16 v32, v33, 1.0 op_sel_hi:[1,0]
    v_mfma_f32_16x16x32_bf16 a[0:3], a[192:195], v[64:67], a[0:3]
    ds_read_b64_tr_b16 a[208:209], v8 offset:1024
    ds_read_b64_tr_b16 a[210:211], v9 offset:1024
    v_pk_add_f16 v34, v35, 1.0 op_sel_hi:[1,0]
    v_mfma_f32_16x16x32_bf16 a[48:51], a[192:195], v[68:71], a[48:51]
    v_rcp_f16 v33, v32
    v_rcp_f16 v35, v34
    v_mfma_f32_16x16x32_bf16 a[96:99], a[192:195], v[72:75], a[96:99]
    s_waitcnt lgkmcnt(6)
    v_rcp_f16_sdwa v33, v32 dst_sel:WORD_1 dst_unused:UNUSED_PRESERVE src0_sel:WORD_1
    v_rcp_f16_sdwa v35, v34 dst_sel:WORD_1 dst_unused:UNUSED_PRESERVE src0_sel:WORD_1
    v_mfma_f32_16x16x32_bf16 a[4:7], a[196:199], v[64:67], a[4:7]
    ds_read_b64_tr_b16 a[212:213], v8 offset:1032
    ds_read_b64_tr_b16 a[214:215], v9 offset:1032
    v_fma_mix_f32 v32, v88, v33, 0 op_sel_hi:[0,1,0]
    v_fma_mix_f32 v34, v90, v35, 0 op_sel_hi:[0,1,0]
    v_mfma_f32_16x16x32_bf16 a[52:55], a[196:199], v[68:71], a[52:55]
    v_fma_mix_f32 v33, v89, v33, 0 op_sel:[0,1,0] op_sel_hi:[0,1,0]
    v_fma_mix_f32 v35, v91, v35, 0 op_sel:[0,1,0] op_sel_hi:[0,1,0]
    v_cvt_pk_bf16_f32 v58, v32, v33
    v_mfma_f32_16x16x32_bf16 a[100:103], a[196:199], v[72:75], a[100:103]
    s_waitcnt lgkmcnt(6)
    v_cvt_pk_bf16_f32 v59, v34, v35
    v_cvt_pk_f16_f32 v28, v92, v93
    v_cvt_pk_f16_f32 v30, v94, v95
    v_pk_fma_f16 v29, v28, v28, s32
    v_mfma_f32_16x16x32_bf16 a[8:11], a[200:203], v[64:67], a[8:11]
    ds_read_b64_tr_b16 a[192:193], v8 offset:1536
    ds_read_b64_tr_b16 a[194:195], v9 offset:1536
    v_pk_fma_f16 v31, v30, v30, s32
    v_pk_mul_f16 v28, v28, v29 neg_lo:[1,0] neg_hi:[1,0]
    v_mfma_f32_16x16x32_bf16 a[56:59], a[200:203], v[68:71], a[56:59]
    v_pk_mul_f16 v30, v30, v31 neg_lo:[1,0] neg_hi:[1,0]
    v_exp_f16 v29, v28
    v_mfma_f32_16x16x32_bf16 a[104:107], a[200:203], v[72:75], a[104:107]
    s_waitcnt lgkmcnt(6)
    v_exp_f16 v31, v30
    v_exp_f16_sdwa v29, v28 dst_sel:WORD_1 dst_unused:UNUSED_PRESERVE src0_sel:WORD_1
    v_mfma_f32_16x16x32_bf16 a[12:15], a[204:207], v[64:67], a[12:15]
    ds_read_b64_tr_b16 a[196:197], v8 offset:1544
    ds_read_b64_tr_b16 a[198:199], v9 offset:1544
    v_exp_f16_sdwa v31, v30 dst_sel:WORD_1 dst_unused:UNUSED_PRESERVE src0_sel:WORD_1
    v_mfma_f32_16x16x32_bf16 a[60:63], a[204:207], v[68:71], a[60:63]
    v_pk_add_f16 v28, v29, 1.0 op_sel_hi:[1,0]
    v_pk_add_f16 v30, v31, 1.0 op_sel_hi:[1,0]
    v_rcp_f16 v29, v28
    v_mfma_f32_16x16x32_bf16 a[108:111], a[204:207], v[72:75], a[108:111]
    s_waitcnt lgkmcnt(6)
    v_rcp_f16 v31, v30
    v_mfma_f32_16x16x32_bf16 a[16:19], a[208:211], v[64:67], a[16:19]
    ds_read_b64_tr_b16 a[200:201], v8 offset:2048
    ds_read_b64_tr_b16 a[202:203], v9 offset:2048
    v_rcp_f16_sdwa v29, v28 dst_sel:WORD_1 dst_unused:UNUSED_PRESERVE src0_sel:WORD_1
    v_mfma_f32_16x16x32_bf16 a[64:67], a[208:211], v[68:71], a[64:67]
    v_rcp_f16_sdwa v31, v30 dst_sel:WORD_1 dst_unused:UNUSED_PRESERVE src0_sel:WORD_1
    v_fma_mix_f32 v28, v92, v29, 0 op_sel_hi:[0,1,0]
    v_fma_mix_f32 v30, v94, v31, 0 op_sel_hi:[0,1,0]
    v_fma_mix_f32 v29, v93, v29, 0 op_sel:[0,1,0] op_sel_hi:[0,1,0]
    v_mfma_f32_16x16x32_bf16 a[112:115], a[208:211], v[72:75], a[112:115]
    s_waitcnt lgkmcnt(6)
    v_fma_mix_f32 v31, v95, v31, 0 op_sel:[0,1,0] op_sel_hi:[0,1,0]
    v_cvt_pk_bf16_f32 v60, v28, v29
    v_cvt_pk_bf16_f32 v61, v30, v31
    v_mfma_f32_16x16x32_bf16 a[20:23], a[212:215], v[64:67], a[20:23]
    ds_read_b64_tr_b16 a[204:205], v8 offset:2056
    ds_read_b64_tr_b16 a[206:207], v9 offset:2056
    v_cvt_pk_f16_f32 v32, v96, v97
    v_cvt_pk_f16_f32 v34, v98, v99
    v_mfma_f32_16x16x32_bf16 a[68:71], a[212:215], v[68:71], a[68:71]
    v_pk_fma_f16 v33, v32, v32, s32
    v_pk_fma_f16 v35, v34, v34, s32
    v_pk_mul_f16 v32, v32, v33 neg_lo:[1,0] neg_hi:[1,0]
    v_pk_mul_f16 v34, v34, v35 neg_lo:[1,0] neg_hi:[1,0]
    v_mfma_f32_16x16x32_bf16 a[116:119], a[212:215], v[72:75], a[116:119]
    s_waitcnt lgkmcnt(6)
    v_exp_f16 v33, v32
    v_exp_f16 v35, v34
    v_mfma_f32_16x16x32_bf16 a[24:27], a[192:195], v[64:67], a[24:27]
    ds_read_b64_tr_b16 a[208:209], v8 offset:2560
    ds_read_b64_tr_b16 a[210:211], v9 offset:2560
    v_mfma_f32_16x16x32_bf16 a[72:75], a[192:195], v[68:71], a[72:75]
    v_exp_f16_sdwa v33, v32 dst_sel:WORD_1 dst_unused:UNUSED_PRESERVE src0_sel:WORD_1
    v_exp_f16_sdwa v35, v34 dst_sel:WORD_1 dst_unused:UNUSED_PRESERVE src0_sel:WORD_1
    v_pk_add_f16 v32, v33, 1.0 op_sel_hi:[1,0]
    v_mfma_f32_16x16x32_bf16 a[120:123], a[192:195], v[72:75], a[120:123]
    s_waitcnt lgkmcnt(6)
    v_pk_add_f16 v34, v35, 1.0 op_sel_hi:[1,0]
    v_rcp_f16 v33, v32
    v_mfma_f32_16x16x32_bf16 a[28:31], a[196:199], v[64:67], a[28:31]
    ds_read_b64_tr_b16 a[212:213], v8 offset:2568
    ds_read_b64_tr_b16 a[214:215], v9 offset:2568
    v_add_u32 v8, s33, v8
    v_add_u32 v9, s33, v9
    v_mfma_f32_16x16x32_bf16 a[76:79], a[196:199], v[68:71], a[76:79]
    v_rcp_f16 v35, v34
    v_rcp_f16_sdwa v33, v32 dst_sel:WORD_1 dst_unused:UNUSED_PRESERVE src0_sel:WORD_1
    v_mfma_f32_16x16x32_bf16 a[124:127], a[196:199], v[72:75], a[124:127]
    s_waitcnt lgkmcnt(6)
    v_rcp_f16_sdwa v35, v34 dst_sel:WORD_1 dst_unused:UNUSED_PRESERVE src0_sel:WORD_1
    v_fma_mix_f32 v32, v96, v33, 0 op_sel_hi:[0,1,0]
    v_fma_mix_f32 v34, v98, v35, 0 op_sel_hi:[0,1,0]
    v_mfma_f32_16x16x32_bf16 a[32:35], a[200:203], v[64:67], a[32:35]
    ds_read_b128 v[20:23], v10
    ds_read_b64_tr_b16 a[192:193], v2 offset:0
    ds_read_b64_tr_b16 a[194:195], v2 offset:2048
    v_add_u32 v10, 0x100, v10
    v_mfma_f32_16x16x32_bf16 a[80:83], a[200:203], v[68:71], a[80:83]
    v_fma_mix_f32 v33, v97, v33, 0 op_sel:[0,1,0] op_sel_hi:[0,1,0]
    v_fma_mix_f32 v35, v99, v35, 0 op_sel:[0,1,0] op_sel_hi:[0,1,0]
    v_cvt_pk_bf16_f32 v62, v32, v33
    v_mfma_f32_16x16x32_bf16 a[128:131], a[200:203], v[72:75], a[128:131]
    s_waitcnt lgkmcnt(7)
    v_cvt_pk_bf16_f32 v63, v34, v35
    v_cvt_pk_f16_f32 v28, v44, v45
    v_cvt_pk_f16_f32 v30, v46, v47
    v_pk_fma_f16 v29, v28, v28, s32
    v_mfma_f32_16x16x32_bf16 a[36:39], a[204:207], v[64:67], a[36:39]
    ds_read_b64_tr_b16 a[196:197], v2 offset:4096
    ds_read_b64_tr_b16 a[198:199], v2 offset:6144
    v_pk_fma_f16 v31, v30, v30, s32
    v_mfma_f32_16x16x32_bf16 a[84:87], a[204:207], v[68:71], a[84:87]
    v_pk_mul_f16 v28, v28, v29 neg_lo:[1,0] neg_hi:[1,0]
    v_pk_mul_f16 v30, v30, v31 neg_lo:[1,0] neg_hi:[1,0]
    v_exp_f16 v29, v28
    v_mfma_f32_16x16x32_bf16 a[132:135], a[204:207], v[72:75], a[132:135]
    s_waitcnt lgkmcnt(7)
    v_exp_f16 v31, v30
    v_exp_f16_sdwa v29, v28 dst_sel:WORD_1 dst_unused:UNUSED_PRESERVE src0_sel:WORD_1
    v_mfma_f32_16x16x32_bf16 a[40:43], a[208:211], v[64:67], a[40:43]
    ds_read_b64_tr_b16 a[200:201], v2 offset:8192
    ds_read_b64_tr_b16 a[202:203], v2 offset:10240
    v_exp_f16_sdwa v31, v30 dst_sel:WORD_1 dst_unused:UNUSED_PRESERVE src0_sel:WORD_1
    v_mfma_f32_16x16x32_bf16 a[88:91], a[208:211], v[68:71], a[88:91]
    v_pk_add_f16 v28, v29, 1.0 op_sel_hi:[1,0]
    v_pk_add_f16 v30, v31, 1.0 op_sel_hi:[1,0]
    v_mfma_f32_16x16x32_bf16 a[136:139], a[208:211], v[72:75], a[136:139]
    s_waitcnt lgkmcnt(7)
    v_rcp_f16 v29, v28
    v_rcp_f16 v31, v30
    v_mfma_f32_16x16x32_bf16 a[44:47], a[212:215], v[64:67], a[44:47]
    ds_read_b64_tr_b16 a[204:205], v2 offset:12288
    ds_read_b64_tr_b16 a[206:207], v2 offset:14336
    v_rcp_f16_sdwa v29, v28 dst_sel:WORD_1 dst_unused:UNUSED_PRESERVE src0_sel:WORD_1
    v_mfma_f32_16x16x32_bf16 a[92:95], a[212:215], v[68:71], a[92:95]
    s_mov_b32 s33, s38
    v_rcp_f16_sdwa v31, v30 dst_sel:WORD_1 dst_unused:UNUSED_PRESERVE src0_sel:WORD_1
    v_fma_mix_f32 v28, v44, v29, 0 op_sel_hi:[0,1,0]
    v_fma_mix_f32 v30, v46, v31, 0 op_sel_hi:[0,1,0]
    v_mfma_f32_16x16x32_bf16 a[140:143], a[212:215], v[72:75], a[140:143]
    s_waitcnt lgkmcnt(6)
    v_fma_mix_f32 v29, v45, v29, 0 op_sel:[0,1,0] op_sel_hi:[0,1,0]
    v_fma_mix_f32 v31, v47, v31, 0 op_sel:[0,1,0] op_sel_hi:[0,1,0]
    v_cvt_pk_bf16_f32 v48, v28, v29
    v_cvt_pk_bf16_f32 v49, v30, v31
    s_waitcnt vmcnt(0)
    s_barrier
.p2align 6
L_loop_b1:
    v_mfma_f32_16x16x32_bf16 v[76:79], a[192:195], v[160:163], v[20:23]
    s_add_u32 m0, s45, 0
    ds_read_b64_tr_b16 a[208:209], v2 offset:16384
    ds_read_b64_tr_b16 a[210:211], v2 offset:18432
    v_cvt_pk_f16_f32 v28, v100, v101
    v_mfma_f32_16x16x32_bf16 v[84:87], a[192:195], v[184:187], v[20:23]
    s_add_u32 s47, s35, 0
    buffer_load_dwordx4 v14, s[12:15], s47 offen lds
    v_mfma_f32_16x16x32_bf16 v[92:95], a[192:195], v[208:211], v[20:23]
    v_cvt_pk_f16_f32 v30, v102, v103
    v_pk_fma_f16 v29, v28, v28, s32
    v_pk_fma_f16 v31, v30, v30, s32
    v_mfma_f32_16x16x32_bf16 v[44:47], a[192:195], v[232:235], v[20:23]
    s_waitcnt lgkmcnt(6)
    v_pk_mul_f16 v28, v28, v29 neg_lo:[1,0] neg_hi:[1,0]
    v_pk_mul_f16 v30, v30, v31 neg_lo:[1,0] neg_hi:[1,0]
    v_mfma_f32_16x16x32_bf16 v[76:79], a[196:199], v[164:167], v[76:79]
    s_add_u32 m0, s45, 1024
    ds_read_b64_tr_b16 a[212:213], v2 offset:20480
    ds_read_b64_tr_b16 a[214:215], v2 offset:22528
    v_add_u32 v2, s33, v2
    v_mfma_f32_16x16x32_bf16 v[84:87], a[196:199], v[188:191], v[84:87]
    s_add_u32 s47, s35, 12288
    buffer_load_dwordx4 v14, s[12:15], s47 offen lds
    v_mfma_f32_16x16x32_bf16 v[92:95], a[196:199], v[212:215], v[92:95]
    v_exp_f16 v29, v28
    v_mfma_f32_16x16x32_bf16 v[44:47], a[196:199], v[236:239], v[44:47]
    s_waitcnt lgkmcnt(6)
    v_exp_f16 v31, v30
    v_exp_f16_sdwa v29, v28 dst_sel:WORD_1 dst_unused:UNUSED_PRESERVE src0_sel:WORD_1
    v_mfma_f32_16x16x32_bf16 v[76:79], a[200:203], v[168:171], v[76:79]
    s_add_u32 m0, s45, 2048
    ds_read_b128 v[24:27], v11
    ds_read_b64_tr_b16 a[192:193], v3 offset:0
    ds_read_b64_tr_b16 a[194:195], v3 offset:2048
    v_add_u32 v11, 0x100, v11
    v_mfma_f32_16x16x32_bf16 v[84:87], a[200:203], v[192:195], v[84:87]
    s_add_u32 s47, s35, 24576
    buffer_load_dwordx4 v14, s[12:15], s47 offen lds
    v_mfma_f32_16x16x32_bf16 v[92:95], a[200:203], v[216:219], v[92:95]
    v_exp_f16_sdwa v31, v30 dst_sel:WORD_1 dst_unused:UNUSED_PRESERVE src0_sel:WORD_1
    v_mfma_f32_16x16x32_bf16 v[44:47], a[200:203], v[240:243], v[44:47]
    s_waitcnt lgkmcnt(7)
    v_pk_add_f16 v28, v29, 1.0 op_sel_hi:[1,0]
    v_pk_add_f16 v30, v31, 1.0 op_sel_hi:[1,0]
    v_mfma_f32_16x16x32_bf16 v[76:79], a[204:207], v[172:175], v[76:79]
    s_add_u32 m0, s45, 3072
    ds_read_b64_tr_b16 a[196:197], v3 offset:4096
    ds_read_b64_tr_b16 a[198:199], v3 offset:6144
    v_rcp_f16 v29, v28
    v_mfma_f32_16x16x32_bf16 v[84:87], a[204:207], v[196:199], v[84:87]
    s_add_u32 s47, s35, 36864
    buffer_load_dwordx4 v14, s[12:15], s47 offen lds
    v_mfma_f32_16x16x32_bf16 v[92:95], a[204:207], v[220:223], v[92:95]
    v_rcp_f16 v31, v30
    v_mfma_f32_16x16x32_bf16 v[44:47], a[204:207], v[244:247], v[44:47]
    s_waitcnt lgkmcnt(7)
    v_rcp_f16_sdwa v29, v28 dst_sel:WORD_1 dst_unused:UNUSED_PRESERVE src0_sel:WORD_1
    v_mfma_f32_16x16x32_bf16 v[76:79], a[208:211], v[176:179], v[76:79]
    s_add_u32 m0, s45, 4096
    ds_read_b64_tr_b16 a[200:201], v3 offset:8192
    ds_read_b64_tr_b16 a[202:203], v3 offset:10240
    v_rcp_f16_sdwa v31, v30 dst_sel:WORD_1 dst_unused:UNUSED_PRESERVE src0_sel:WORD_1
    v_mfma_f32_16x16x32_bf16 v[84:87], a[208:211], v[200:203], v[84:87]
    s_add_u32 s47, s35, 49152
    buffer_load_dwordx4 v14, s[12:15], s47 offen lds
    v_mfma_f32_16x16x32_bf16 v[92:95], a[208:211], v[224:227], v[92:95]
    v_fma_mix_f32 v28, v100, v29, 0 op_sel_hi:[0,1,0]
    v_fma_mix_f32 v30, v102, v31, 0 op_sel_hi:[0,1,0]
    v_fma_mix_f32 v29, v101, v29, 0 op_sel:[0,1,0] op_sel_hi:[0,1,0]
    v_mfma_f32_16x16x32_bf16 v[44:47], a[208:211], v[248:251], v[44:47]
    s_waitcnt lgkmcnt(7)
    v_fma_mix_f32 v31, v103, v31, 0 op_sel:[0,1,0] op_sel_hi:[0,1,0]
    v_cvt_pk_bf16_f32 v64, v28, v29
    v_cvt_pk_bf16_f32 v65, v30, v31
    v_mfma_f32_16x16x32_bf16 v[76:79], a[212:215], v[180:183], v[76:79]
    s_add_u32 m0, s45, 5120
    ds_read_b64_tr_b16 a[204:205], v3 offset:12288
    ds_read_b64_tr_b16 a[206:207], v3 offset:14336
    v_cvt_pk_f16_f32 v32, v104, v105
    v_mfma_f32_16x16x32_bf16 v[84:87], a[212:215], v[204:207], v[84:87]
    s_add_u32 s47, s35, 61440
    buffer_load_dwordx4 v14, s[12:15], s47 offen lds
    v_mfma_f32_16x16x32_bf16 v[92:95], a[212:215], v[228:231], v[92:95]
    v_cvt_pk_f16_f32 v34, v106, v107
    v_pk_fma_f16 v33, v32, v32, s32
    v_mfma_f32_16x16x32_bf16 v[44:47], a[212:215], v[252:255], v[44:47]
    s_waitcnt lgkmcnt(6)
    v_pk_fma_f16 v35, v34, v34, s32
    v_pk_mul_f16 v32, v32, v33 neg_lo:[1,0] neg_hi:[1,0]
    v_pk_mul_f16 v34, v34, v35 neg_lo:[1,0] neg_hi:[1,0]
    v_mfma_f32_16x16x32_bf16 v[80:83], a[192:195], v[160:163], v[24:27]
    s_add_u32 m0, s46, 0
    ds_read_b64_tr_b16 a[208:209], v3 offset:16384
    ds_read_b64_tr_b16 a[210:211], v3 offset:18432
    v_mfma_f32_16x16x32_bf16 v[88:91], a[192:195], v[184:187], v[24:27]
    s_add_u32 s47, s36, 0
    buffer_load_dwordx4 v15, s[16:19], s47 offen lds
    v_mfma_f32_16x16x32_bf16 v[96:99], a[192:195], v[208:211], v[24:27]
    s_waitcnt lgkmcnt(6)
    v_exp_f16 v33, v32
    v_exp_f16 v35, v34
    v_mfma_f32_16x16x32_bf16 v[80:83], a[196:199], v[164:167], v[80:83]
    s_add_u32 m0, s46, 1024
    ds_read_b64_tr_b16 a[212:213], v3 offset:20480
    ds_read_b64_tr_b16 a[214:215], v3 offset:22528
    v_add_u32 v3, s33, v3
    v_mfma_f32_16x16x32_bf16 v[88:91], a[196:199], v[188:191], v[88:91]
    s_add_u32 s47, s36, 128
    buffer_load_dwordx4 v15, s[16:19], s47 offen lds
    v_mfma_f32_16x16x32_bf16 v[96:99], a[196:199], v[212:215], v[96:99]
    s_waitcnt lgkmcnt(6)
    v_exp_f16_sdwa v33, v32 dst_sel:WORD_1 dst_unused:UNUSED_PRESERVE src0_sel:WORD_1
    v_mfma_f32_16x16x32_bf16 v[80:83], a[200:203], v[168:171], v[80:83]
    s_add_u32 m0, s46, 2048
    ds_read_b64_tr_b16 a[192:193], v6 offset:0
    ds_read_b64_tr_b16 a[194:195], v7 offset:0
    v_exp_f16_sdwa v35, v34 dst_sel:WORD_1 dst_unused:UNUSED_PRESERVE src0_sel:WORD_1
    v_mfma_f32_16x16x32_bf16 v[88:91], a[200:203], v[192:195], v[88:91]
    s_add_u32 s47, s36, 256
    buffer_load_dwordx4 v15, s[16:19], s47 offen lds
    v_mfma_f32_16x16x32_bf16 v[96:99], a[200:203], v[216:219], v[96:99]
    s_waitcnt lgkmcnt(6)
    v_pk_add_f16 v32, v33, 1.0 op_sel_hi:[1,0]
    v_pk_add_f16 v34, v35, 1.0 op_sel_hi:[1,0]
    v_mfma_f32_16x16x32_bf16 v[80:83], a[204:207], v[172:175], v[80:83]
    s_add_u32 m0, s46, 3080
    ds_read_b64_tr_b16 a[196:197], v6 offset:8
    ds_read_b64_tr_b16 a[198:199], v7 offset:8
    v_mfma_f32_16x16x32_bf16 v[88:91], a[204:207], v[196:199], v[88:91]
    s_add_u32 s47, s36, 1536
    buffer_load_dwordx4 v15, s[16:19], s47 offen lds
    v_mfma_f32_16x16x32_bf16 v[96:99], a[204:207], v[220:223], v[96:99]
    s_waitcnt lgkmcnt(6)
    v_rcp_f16 v33, v32
    v_rcp_f16 v35, v34
    v_mfma_f32_16x16x32_bf16 v[80:83], a[208:211], v[176:179], v[80:83]
    s_add_u32 m0, s46, 4104
    ds_read_b64_tr_b16 a[200:201], v6 offset:512
    ds_read_b64_tr_b16 a[202:203], v7 offset:512
    v_mfma_f32_16x16x32_bf16 v[88:91], a[208:211], v[200:203], v[88:91]
    s_add_u32 s47, s36, 1664
    buffer_load_dwordx4 v15, s[16:19], s47 offen lds
    v_mfma_f32_16x16x32_bf16 v[96:99], a[208:211], v[224:227], v[96:99]
    s_waitcnt lgkmcnt(6)
    v_rcp_f16_sdwa v33, v32 dst_sel:WORD_1 dst_unused:UNUSED_PRESERVE src0_sel:WORD_1
    v_rcp_f16_sdwa v35, v34 dst_sel:WORD_1 dst_unused:UNUSED_PRESERVE src0_sel:WORD_1
    v_mfma_f32_16x16x32_bf16 v[80:83], a[212:215], v[180:183], v[80:83]
    s_add_u32 m0, s46, 5128
    ds_read_b64_tr_b16 a[204:205], v6 offset:520
    ds_read_b64_tr_b16 a[206:207], v7 offset:520
    v_fma_mix_f32 v32, v104, v33, 0 op_sel_hi:[0,1,0]
    v_mfma_f32_16x16x32_bf16 v[88:91], a[212:215], v[204:207], v[88:91]
    s_add_u32 s47, s36, 1792
    buffer_load_dwordx4 v15, s[16:19], s47 offen lds
    v_mfma_f32_16x16x32_bf16 v[96:99], a[212:215], v[228:231], v[96:99]
    s_waitcnt lgkmcnt(6)
    v_fma_mix_f32 v34, v106, v35, 0 op_sel_hi:[0,1,0]
    v_fma_mix_f32 v33, v105, v33, 0 op_sel:[0,1,0] op_sel_hi:[0,1,0]
    v_mfma_f32_16x16x32_bf16 a[0:3], a[192:195], v[52:55], a[0:3]
    ds_read_b64_tr_b16 a[208:209], v6 offset:1024
    ds_read_b64_tr_b16 a[210:211], v7 offset:1024
    v_fma_mix_f32 v35, v107, v35, 0 op_sel:[0,1,0] op_sel_hi:[0,1,0]
    v_mfma_f32_16x16x32_bf16 a[48:51], a[192:195], v[56:59], a[48:51]
    v_cvt_pk_bf16_f32 v66, v32, v33
    v_cvt_pk_bf16_f32 v67, v34, v35
    v_cvt_pk_f16_f32 v28, v108, v109
    v_mfma_f32_16x16x16_bf16 a[144:147], a[192:193], v[48:49], a[144:147]
    v_cvt_pk_f16_f32 v30, v110, v111
    v_pk_fma_f16 v29, v28, v28, s32
    v_pk_fma_f16 v31, v30, v30, s32
    v_pk_mul_f16 v28, v28, v29 neg_lo:[1,0] neg_hi:[1,0]
    v_mfma_f32_16x16x32_bf16 a[96:99], a[192:195], v[60:63], a[96:99]
    s_waitcnt lgkmcnt(6)
    v_pk_mul_f16 v30, v30, v31 neg_lo:[1,0] neg_hi:[1,0]
    v_exp_f16 v29, v28
    v_mfma_f32_16x16x32_bf16 a[4:7], a[196:199], v[52:55], a[4:7]
    ds_read_b64_tr_b16 a[212:213], v6 offset:1032
    ds_read_b64_tr_b16 a[214:215], v7 offset:1032
    v_mfma_f32_16x16x32_bf16 a[52:55], a[196:199], v[56:59], a[52:55]
    v_exp_f16 v31, v30
    v_exp_f16_sdwa v29, v28 dst_sel:WORD_1 dst_unused:UNUSED_PRESERVE src0_sel:WORD_1
    v_mfma_f32_16x16x16_bf16 a[148:151], a[196:197], v[48:49], a[148:151]
    v_exp_f16_sdwa v31, v30 dst_sel:WORD_1 dst_unused:UNUSED_PRESERVE src0_sel:WORD_1
    v_pk_add_f16 v28, v29, 1.0 op_sel_hi:[1,0]
    v_pk_add_f16 v30, v31, 1.0 op_sel_hi:[1,0]
    v_mfma_f32_16x16x32_bf16 a[100:103], a[196:199], v[60:63], a[100:103]
    s_waitcnt lgkmcnt(6)
    v_rcp_f16 v29, v28
    v_mfma_f32_16x16x32_bf16 a[8:11], a[200:203], v[52:55], a[8:11]
    ds_read_b64_tr_b16 a[192:193], v6 offset:1536
    ds_read_b64_tr_b16 a[194:195], v7 offset:1536
    v_mfma_f32_16x16x32_bf16 a[56:59], a[200:203], v[56:59], a[56:59]
    v_rcp_f16 v31, v30
    v_rcp_f16_sdwa v29, v28 dst_sel:WORD_1 dst_unused:UNUSED_PRESERVE src0_sel:WORD_1
    v_mfma_f32_16x16x16_bf16 a[152:155], a[200:201], v[48:49], a[152:155]
    v_rcp_f16_sdwa v31, v30 dst_sel:WORD_1 dst_unused:UNUSED_PRESERVE src0_sel:WORD_1
    v_fma_mix_f32 v28, v108, v29, 0 op_sel_hi:[0,1,0]
    v_fma_mix_f32 v30, v110, v31, 0 op_sel_hi:[0,1,0]
    v_mfma_f32_16x16x32_bf16 a[104:107], a[200:203], v[60:63], a[104:107]
    s_waitcnt lgkmcnt(6)
    v_fma_mix_f32 v29, v109, v29, 0 op_sel:[0,1,0] op_sel_hi:[0,1,0]
    v_fma_mix_f32 v31, v111, v31, 0 op_sel:[0,1,0] op_sel_hi:[0,1,0]
    v_cvt_pk_bf16_f32 v68, v28, v29
    v_mfma_f32_16x16x32_bf16 a[12:15], a[204:207], v[52:55], a[12:15]
    ds_read_b64_tr_b16 a[196:197], v6 offset:1544
    ds_read_b64_tr_b16 a[198:199], v7 offset:1544
    v_cvt_pk_bf16_f32 v69, v30, v31
    v_mfma_f32_16x16x32_bf16 a[60:63], a[204:207], v[56:59], a[60:63]
    v_cvt_pk_f16_f32 v32, v112, v113
    v_cvt_pk_f16_f32 v34, v114, v115
    v_pk_fma_f16 v33, v32, v32, s32
    v_mfma_f32_16x16x16_bf16 a[156:159], a[204:205], v[48:49], a[156:159]
    v_pk_fma_f16 v35, v34, v34, s32
    v_pk_mul_f16 v32, v32, v33 neg_lo:[1,0] neg_hi:[1,0]
    v_pk_mul_f16 v34, v34, v35 neg_lo:[1,0] neg_hi:[1,0]
    v_exp_f16 v33, v32
    v_mfma_f32_16x16x32_bf16 a[108:111], a[204:207], v[60:63], a[108:111]
    s_waitcnt lgkmcnt(6)
    v_exp_f16 v35, v34
    v_mfma_f32_16x16x32_bf16 a[16:19], a[208:211], v[52:55], a[16:19]
    ds_read_b64_tr_b16 a[200:201], v6 offset:2048
    ds_read_b64_tr_b16 a[202:203], v7 offset:2048
    v_mfma_f32_16x16x32_bf16 a[64:67], a[208:211], v[56:59], a[64:67]
    v_exp_f16_sdwa v33, v32 dst_sel:WORD_1 dst_unused:UNUSED_PRESERVE src0_sel:WORD_1
    v_exp_f16_sdwa v35, v34 dst_sel:WORD_1 dst_unused:UNUSED_PRESERVE src0_sel:WORD_1
    v_mfma_f32_16x16x16_bf16 a[160:163], a[208:209], v[48:49], a[160:163]
    v_pk_add_f16 v32, v33, 1.0 op_sel_hi:[1,0]
    v_pk_add_f16 v34, v35, 1.0 op_sel_hi:[1,0]
    v_rcp_f16 v33, v32
    v_mfma_f32_16x16x32_bf16 a[112:115], a[208:211], v[60:63], a[112:115]
    s_waitcnt lgkmcnt(6)
    v_rcp_f16 v35, v34
    v_mfma_f32_16x16x32_bf16 a[20:23], a[212:215], v[52:55], a[20:23]
    ds_read_b64_tr_b16 a[204:205], v6 offset:2056
    ds_read_b64_tr_b16 a[206:207], v7 offset:2056
    v_mfma_f32_16x16x32_bf16 a[68:71], a[212:215], v[56:59], a[68:71]
    v_rcp_f16_sdwa v33, v32 dst_sel:WORD_1 dst_unused:UNUSED_PRESERVE src0_sel:WORD_1
    v_rcp_f16_sdwa v35, v34 dst_sel:WORD_1 dst_unused:UNUSED_PRESERVE src0_sel:WORD_1
    v_mfma_f32_16x16x16_bf16 a[164:167], a[212:213], v[48:49], a[164:167]
    v_fma_mix_f32 v32, v112, v33, 0 op_sel_hi:[0,1,0]
    v_fma_mix_f32 v34, v114, v35, 0 op_sel_hi:[0,1,0]
    v_fma_mix_f32 v33, v113, v33, 0 op_sel:[0,1,0] op_sel_hi:[0,1,0]
    v_fma_mix_f32 v35, v115, v35, 0 op_sel:[0,1,0] op_sel_hi:[0,1,0]
    v_mfma_f32_16x16x32_bf16 a[116:119], a[212:215], v[60:63], a[116:119]
    s_waitcnt lgkmcnt(6)
    v_cvt_pk_bf16_f32 v70, v32, v33
    v_cvt_pk_bf16_f32 v71, v34, v35
    v_cvt_pk_f16_f32 v28, v116, v117
    v_mfma_f32_16x16x32_bf16 a[24:27], a[192:195], v[52:55], a[24:27]
    ds_read_b64_tr_b16 a[208:209], v6 offset:2560
    ds_read_b64_tr_b16 a[210:211], v7 offset:2560
    v_cvt_pk_f16_f32 v30, v118, v119
    v_mfma_f32_16x16x32_bf16 a[72:75], a[192:195], v[56:59], a[72:75]
    v_pk_fma_f16 v29, v28, v28, s32
    v_pk_fma_f16 v31, v30, v30, s32
    v_pk_mul_f16 v28, v28, v29 neg_lo:[1,0] neg_hi:[1,0]
    v_mfma_f32_16x16x16_bf16 a[168:171], a[192:193], v[48:49], a[168:171]
    v_pk_mul_f16 v30, v30, v31 neg_lo:[1,0] neg_hi:[1,0]
    v_exp_f16 v29, v28
    v_exp_f16 v31, v30
    v_mfma_f32_16x16x32_bf16 a[120:123], a[192:195], v[60:63], a[120:123]
    s_waitcnt lgkmcnt(6)
    v_exp_f16_sdwa v29, v28 dst_sel:WORD_1 dst_unused:UNUSED_PRESERVE src0_sel:WORD_1
    v_mfma_f32_16x16x32_bf16 a[28:31], a[196:199], v[52:55], a[28:31]
    ds_read_b64_tr_b16 a[212:213], v6 offset:2568
    ds_read_b64_tr_b16 a[214:215], v7 offset:2568
    v_add_u32 v6, s33, v6
    v_add_u32 v7, s33, v7
    v_mfma_f32_16x16x32_bf16 a[76:79], a[196:199], v[56:59], a[76:79]
    v_exp_f16_sdwa v31, v30 dst_sel:WORD_1 dst_unused:UNUSED_PRESERVE src0_sel:WORD_1
    v_pk_add_f16 v28, v29, 1.0 op_sel_hi:[1,0]
    v_mfma_f32_16x16x16_bf16 a[172:175], a[196:197], v[48:49], a[172:175]
    v_pk_add_f16 v30, v31, 1.0 op_sel_hi:[1,0]
    v_rcp_f16 v29, v28
    v_rcp_f16 v31, v30
    v_mfma_f32_16x16x32_bf16 a[124:127], a[196:199], v[60:63], a[124:127]
    s_waitcnt lgkmcnt(6)
    v_rcp_f16_sdwa v29, v28 dst_sel:WORD_1 dst_unused:UNUSED_PRESERVE src0_sel:WORD_1
    v_mfma_f32_16x16x32_bf16 a[32:35], a[200:203], v[52:55], a[32:35]
    ds_read_b128 v[20:23], v12
    ds_read_b64_tr_b16 a[192:193], v4 offset:0
    ds_read_b64_tr_b16 a[194:195], v4 offset:2048
    v_add_u32 v12, 0x100, v12
    v_mfma_f32_16x16x32_bf16 a[80:83], a[200:203], v[56:59], a[80:83]
    v_rcp_f16_sdwa v31, v30 dst_sel:WORD_1 dst_unused:UNUSED_PRESERVE src0_sel:WORD_1
    v_fma_mix_f32 v28, v116, v29, 0 op_sel_hi:[0,1,0]
    v_mfma_f32_16x16x16_bf16 a[176:179], a[200:201], v[48:49], a[176:179]
    v_fma_mix_f32 v30, v118, v31, 0 op_sel_hi:[0,1,0]
    v_fma_mix_f32 v29, v117, v29, 0 op_sel:[0,1,0] op_sel_hi:[0,1,0]
    v_fma_mix_f32 v31, v119, v31, 0 op_sel:[0,1,0] op_sel_hi:[0,1,0]
    v_cvt_pk_bf16_f32 v72, v28, v29
    v_mfma_f32_16x16x32_bf16 a[128:131], a[200:203], v[60:63], a[128:131]
    s_waitcnt lgkmcnt(7)
    v_cvt_pk_bf16_f32 v73, v30, v31
    v_cvt_pk_f16_f32 v32, v120, v121
    v_mfma_f32_16x16x32_bf16 a[36:39], a[204:207], v[52:55], a[36:39]
    ds_read_b64_tr_b16 a[196:197], v4 offset:4096
    ds_read_b64_tr_b16 a[198:199], v4 offset:6144
    v_mfma_f32_16x16x32_bf16 a[84:87], a[204:207], v[56:59], a[84:87]
    v_cvt_pk_f16_f32 v34, v122, v123
    v_pk_fma_f16 v33, v32, v32, s32
    v_pk_fma_f16 v35, v34, v34, s32
    v_mfma_f32_16x16x16_bf16 a[180:183], a[204:205], v[48:49], a[180:183]
    v_pk_mul_f16 v32, v32, v33 neg_lo:[1,0] neg_hi:[1,0]
    v_pk_mul_f16 v34, v34, v35 neg_lo:[1,0] neg_hi:[1,0]
    v_exp_f16 v33, v32
    v_mfma_f32_16x16x32_bf16 a[132:135], a[204:207], v[60:63], a[132:135]
    s_waitcnt lgkmcnt(7)
    v_exp_f16 v35, v34
    v_mfma_f32_16x16x32_bf16 a[40:43], a[208:211], v[52:55], a[40:43]
    ds_read_b64_tr_b16 a[200:201], v4 offset:8192
    ds_read_b64_tr_b16 a[202:203], v4 offset:10240
    v_mfma_f32_16x16x32_bf16 a[88:91], a[208:211], v[56:59], a[88:91]
    v_exp_f16_sdwa v33, v32 dst_sel:WORD_1 dst_unused:UNUSED_PRESERVE src0_sel:WORD_1
    v_exp_f16_sdwa v35, v34 dst_sel:WORD_1 dst_unused:UNUSED_PRESERVE src0_sel:WORD_1
    v_mfma_f32_16x16x16_bf16 a[184:187], a[208:209], v[48:49], a[184:187]
    v_pk_add_f16 v32, v33, 1.0 op_sel_hi:[1,0]
    v_pk_add_f16 v34, v35, 1.0 op_sel_hi:[1,0]
    v_rcp_f16 v33, v32
    v_mfma_f32_16x16x32_bf16 a[136:139], a[208:211], v[60:63], a[136:139]
    s_waitcnt lgkmcnt(7)
    v_rcp_f16 v35, v34
    v_mfma_f32_16x16x32_bf16 a[44:47], a[212:215], v[52:55], a[44:47]
    ds_read_b64_tr_b16 a[204:205], v4 offset:12288
    ds_read_b64_tr_b16 a[206:207], v4 offset:14336
    v_mfma_f32_16x16x32_bf16 a[92:95], a[212:215], v[56:59], a[92:95]
    v_rcp_f16_sdwa v33, v32 dst_sel:WORD_1 dst_unused:UNUSED_PRESERVE src0_sel:WORD_1
    v_rcp_f16_sdwa v35, v34 dst_sel:WORD_1 dst_unused:UNUSED_PRESERVE src0_sel:WORD_1
    v_mfma_f32_16x16x16_bf16 a[188:191], a[212:213], v[48:49], a[188:191]
    v_fma_mix_f32 v32, v120, v33, 0 op_sel_hi:[0,1,0]
    v_fma_mix_f32 v34, v122, v35, 0 op_sel_hi:[0,1,0]
    v_fma_mix_f32 v33, v121, v33, 0 op_sel:[0,1,0] op_sel_hi:[0,1,0]
    v_fma_mix_f32 v35, v123, v35, 0 op_sel:[0,1,0] op_sel_hi:[0,1,0]
    v_mfma_f32_16x16x32_bf16 a[140:143], a[212:215], v[60:63], a[140:143]
    s_waitcnt lgkmcnt(6)
    v_cvt_pk_bf16_f32 v74, v32, v33
    v_cvt_pk_bf16_f32 v75, v34, v35
    v_mfma_f32_16x16x32_bf16 v[100:103], a[192:195], v[160:163], v[20:23]
    s_add_u32 s45, s45, s49
    ds_read_b64_tr_b16 a[208:209], v4 offset:16384
    ds_read_b64_tr_b16 a[210:211], v4 offset:18432
    v_cvt_pk_f16_f32 v28, v76, v77
    v_cvt_pk_f16_f32 v30, v78, v79
    v_mfma_f32_16x16x32_bf16 v[108:111], a[192:195], v[184:187], v[20:23]
    v_pk_fma_f16 v29, v28, v28, s32
    v_pk_fma_f16 v31, v30, v30, s32
    v_pk_mul_f16 v28, v28, v29 neg_lo:[1,0] neg_hi:[1,0]
    v_mfma_f32_16x16x32_bf16 v[116:119], a[192:195], v[208:211], v[20:23]
    s_waitcnt lgkmcnt(6)
    v_pk_mul_f16 v30, v30, v31 neg_lo:[1,0] neg_hi:[1,0]
    v_exp_f16 v29, v28
    v_mfma_f32_16x16x32_bf16 v[100:103], a[196:199], v[164:167], v[100:103]
    s_add_u32 s46, s46, s49
    ds_read_b64_tr_b16 a[212:213], v4 offset:20480
    ds_read_b64_tr_b16 a[214:215], v4 offset:22528
    v_add_u32 v4, s33, v4
    v_exp_f16 v31, v30
    v_mfma_f32_16x16x32_bf16 v[108:111], a[196:199], v[188:191], v[108:111]
    v_exp_f16_sdwa v29, v28 dst_sel:WORD_1 dst_unused:UNUSED_PRESERVE src0_sel:WORD_1
    v_mfma_f32_16x16x32_bf16 v[116:119], a[196:199], v[212:215], v[116:119]
    s_waitcnt lgkmcnt(6)
    v_exp_f16_sdwa v31, v30 dst_sel:WORD_1 dst_unused:UNUSED_PRESERVE src0_sel:WORD_1
    v_pk_add_f16 v28, v29, 1.0 op_sel_hi:[1,0]
    v_pk_add_f16 v30, v31, 1.0 op_sel_hi:[1,0]
    v_mfma_f32_16x16x32_bf16 v[100:103], a[200:203], v[168:171], v[100:103]
    s_add_u32 s35, s35, 128
    ds_read_b128 v[24:27], v13
    ds_read_b64_tr_b16 a[192:193], v5 offset:0
    ds_read_b64_tr_b16 a[194:195], v5 offset:2048
    v_add_u32 v13, 0x100, v13
    v_mfma_f32_16x16x32_bf16 v[108:111], a[200:203], v[192:195], v[108:111]
    v_rcp_f16 v29, v28
    v_rcp_f16 v31, v30
    v_mfma_f32_16x16x32_bf16 v[116:119], a[200:203], v[216:219], v[116:119]
    s_waitcnt lgkmcnt(7)
    v_rcp_f16_sdwa v29, v28 dst_sel:WORD_1 dst_unused:UNUSED_PRESERVE src0_sel:WORD_1
    v_rcp_f16_sdwa v31, v30 dst_sel:WORD_1 dst_unused:UNUSED_PRESERVE src0_sel:WORD_1
    v_mfma_f32_16x16x32_bf16 v[100:103], a[204:207], v[172:175], v[100:103]
    s_add_u32 s36, s36, 24576
    ds_read_b64_tr_b16 a[196:197], v5 offset:4096
    ds_read_b64_tr_b16 a[198:199], v5 offset:6144
    v_fma_mix_f32 v28, v76, v29, 0 op_sel_hi:[0,1,0]
    v_fma_mix_f32 v30, v78, v31, 0 op_sel_hi:[0,1,0]
    v_mfma_f32_16x16x32_bf16 v[108:111], a[204:207], v[196:199], v[108:111]
    v_fma_mix_f32 v29, v77, v29, 0 op_sel:[0,1,0] op_sel_hi:[0,1,0]
    v_fma_mix_f32 v31, v79, v31, 0 op_sel:[0,1,0] op_sel_hi:[0,1,0]
    v_cvt_pk_bf16_f32 v52, v28, v29
    v_cvt_pk_bf16_f32 v53, v30, v31
    v_mfma_f32_16x16x32_bf16 v[116:119], a[204:207], v[220:223], v[116:119]
    s_waitcnt lgkmcnt(7)
    v_cvt_pk_f16_f32 v32, v80, v81
    v_cvt_pk_f16_f32 v34, v82, v83
    v_pk_fma_f16 v33, v32, v32, s32
    v_mfma_f32_16x16x32_bf16 v[100:103], a[208:211], v[176:179], v[100:103]
    s_mov_b32 s38, s48
    ds_read_b64_tr_b16 a[200:201], v5 offset:8192
    ds_read_b64_tr_b16 a[202:203], v5 offset:10240
    v_pk_fma_f16 v35, v34, v34, s32
    v_pk_mul_f16 v32, v32, v33 neg_lo:[1,0] neg_hi:[1,0]
    v_mfma_f32_16x16x32_bf16 v[108:111], a[208:211], v[200:203], v[108:111]
    v_pk_mul_f16 v34, v34, v35 neg_lo:[1,0] neg_hi:[1,0]
    v_exp_f16 v33, v32
    v_mfma_f32_16x16x32_bf16 v[116:119], a[208:211], v[224:227], v[116:119]
    s_waitcnt lgkmcnt(7)
    v_exp_f16 v35, v34
    v_exp_f16_sdwa v33, v32 dst_sel:WORD_1 dst_unused:UNUSED_PRESERVE src0_sel:WORD_1
    v_mfma_f32_16x16x32_bf16 v[100:103], a[212:215], v[180:183], v[100:103]
    s_mov_b32 s48, s49
    ds_read_b64_tr_b16 a[204:205], v5 offset:12288
    ds_read_b64_tr_b16 a[206:207], v5 offset:14336
    v_exp_f16_sdwa v35, v34 dst_sel:WORD_1 dst_unused:UNUSED_PRESERVE src0_sel:WORD_1
    v_mfma_f32_16x16x32_bf16 v[108:111], a[212:215], v[204:207], v[108:111]
    v_pk_add_f16 v32, v33, 1.0 op_sel_hi:[1,0]
    v_pk_add_f16 v34, v35, 1.0 op_sel_hi:[1,0]
    v_rcp_f16 v33, v32
    v_mfma_f32_16x16x32_bf16 v[116:119], a[212:215], v[228:231], v[116:119]
    s_waitcnt lgkmcnt(6)
    v_rcp_f16 v35, v34
    v_rcp_f16_sdwa v33, v32 dst_sel:WORD_1 dst_unused:UNUSED_PRESERVE src0_sel:WORD_1
    v_mfma_f32_16x16x32_bf16 v[104:107], a[192:195], v[160:163], v[24:27]
    s_mov_b32 s49, s33
    ds_read_b64_tr_b16 a[208:209], v5 offset:16384
    ds_read_b64_tr_b16 a[210:211], v5 offset:18432
    v_mfma_f32_16x16x32_bf16 v[112:115], a[192:195], v[184:187], v[24:27]
    v_rcp_f16_sdwa v35, v34 dst_sel:WORD_1 dst_unused:UNUSED_PRESERVE src0_sel:WORD_1
    v_fma_mix_f32 v32, v80, v33, 0 op_sel_hi:[0,1,0]
    v_fma_mix_f32 v34, v82, v35, 0 op_sel_hi:[0,1,0]
    v_fma_mix_f32 v33, v81, v33, 0 op_sel:[0,1,0] op_sel_hi:[0,1,0]
    v_mfma_f32_16x16x32_bf16 v[120:123], a[192:195], v[208:211], v[24:27]
    s_waitcnt lgkmcnt(6)
    v_fma_mix_f32 v35, v83, v35, 0 op_sel:[0,1,0] op_sel_hi:[0,1,0]
    v_cvt_pk_bf16_f32 v54, v32, v33
    v_cvt_pk_bf16_f32 v55, v34, v35
    v_cvt_pk_f16_f32 v28, v84, v85
    v_mfma_f32_16x16x32_bf16 v[104:107], a[196:199], v[164:167], v[104:107]
    s_sub_u32 s37, s37, 1
    ds_read_b64_tr_b16 a[212:213], v5 offset:20480
    ds_read_b64_tr_b16 a[214:215], v5 offset:22528
    v_add_u32 v5, s33, v5
    v_mfma_f32_16x16x32_bf16 v[112:115], a[196:199], v[188:191], v[112:115]
    v_cvt_pk_f16_f32 v30, v86, v87
    v_pk_fma_f16 v29, v28, v28, s32
    v_pk_fma_f16 v31, v30, v30, s32
    v_pk_mul_f16 v28, v28, v29 neg_lo:[1,0] neg_hi:[1,0]
    v_mfma_f32_16x16x32_bf16 v[120:123], a[196:199], v[212:215], v[120:123]
    s_waitcnt lgkmcnt(6)
    v_pk_mul_f16 v30, v30, v31 neg_lo:[1,0] neg_hi:[1,0]
    v_exp_f16 v29, v28
    v_mfma_f32_16x16x32_bf16 v[104:107], a[200:203], v[168:171], v[104:107]
    s_cmp_lg_u32 s37, 0
    ds_read_b64_tr_b16 a[192:193], v8 offset:0
    ds_read_b64_tr_b16 a[194:195], v9 offset:0
    v_exp_f16 v31, v30
    v_mfma_f32_16x16x32_bf16 v[112:115], a[200:203], v[192:195], v[112:115]
    v_exp_f16_sdwa v29, v28 dst_sel:WORD_1 dst_unused:UNUSED_PRESERVE src0_sel:WORD_1
    v_exp_f16_sdwa v31, v30 dst_sel:WORD_1 dst_unused:UNUSED_PRESERVE src0_sel:WORD_1
    v_mfma_f32_16x16x32_bf16 v[120:123], a[200:203], v[216:219], v[120:123]
    s_waitcnt lgkmcnt(6)
    v_pk_add_f16 v28, v29, 1.0 op_sel_hi:[1,0]
    v_pk_add_f16 v30, v31, 1.0 op_sel_hi:[1,0]
    v_rcp_f16 v29, v28
    v_mfma_f32_16x16x32_bf16 v[104:107], a[204:207], v[172:175], v[104:107]
    ds_read_b64_tr_b16 a[196:197], v8 offset:8
    ds_read_b64_tr_b16 a[198:199], v9 offset:8
    v_mfma_f32_16x16x32_bf16 v[112:115], a[204:207], v[196:199], v[112:115]
    v_rcp_f16 v31, v30
    v_rcp_f16_sdwa v29, v28 dst_sel:WORD_1 dst_unused:UNUSED_PRESERVE src0_sel:WORD_1
    v_mfma_f32_16x16x32_bf16 v[120:123], a[204:207], v[220:223], v[120:123]
    s_waitcnt lgkmcnt(6)
    v_rcp_f16_sdwa v31, v30 dst_sel:WORD_1 dst_unused:UNUSED_PRESERVE src0_sel:WORD_1
    v_fma_mix_f32 v28, v84, v29, 0 op_sel_hi:[0,1,0]
    v_fma_mix_f32 v30, v86, v31, 0 op_sel_hi:[0,1,0]
    v_fma_mix_f32 v29, v85, v29, 0 op_sel:[0,1,0] op_sel_hi:[0,1,0]
    v_mfma_f32_16x16x32_bf16 v[104:107], a[208:211], v[176:179], v[104:107]
    ds_read_b64_tr_b16 a[200:201], v8 offset:512
    ds_read_b64_tr_b16 a[202:203], v9 offset:512
    v_fma_mix_f32 v31, v87, v31, 0 op_sel:[0,1,0] op_sel_hi:[0,1,0]
    v_cvt_pk_bf16_f32 v56, v28, v29
    v_mfma_f32_16x16x32_bf16 v[112:115], a[208:211], v[200:203], v[112:115]
    v_cvt_pk_bf16_f32 v57, v30, v31
    v_cvt_pk_f16_f32 v32, v88, v89
    v_cvt_pk_f16_f32 v34, v90, v91
    v_mfma_f32_16x16x32_bf16 v[120:123], a[208:211], v[224:227], v[120:123]
    s_waitcnt lgkmcnt(6)
    v_pk_fma_f16 v33, v32, v32, s32
    v_pk_fma_f16 v35, v34, v34, s32
    v_pk_mul_f16 v32, v32, v33 neg_lo:[1,0] neg_hi:[1,0]
    v_pk_mul_f16 v34, v34, v35 neg_lo:[1,0] neg_hi:[1,0]
    v_mfma_f32_16x16x32_bf16 v[104:107], a[212:215], v[180:183], v[104:107]
    ds_read_b64_tr_b16 a[204:205], v8 offset:520
    ds_read_b64_tr_b16 a[206:207], v9 offset:520
    v_exp_f16 v33, v32
    v_mfma_f32_16x16x32_bf16 v[112:115], a[212:215], v[204:207], v[112:115]
    v_exp_f16 v35, v34
    v_mfma_f32_16x16x32_bf16 v[120:123], a[212:215], v[228:231], v[120:123]
    s_waitcnt lgkmcnt(6)
    v_exp_f16_sdwa v33, v32 dst_sel:WORD_1 dst_unused:UNUSED_PRESERVE src0_sel:WORD_1
    v_exp_f16_sdwa v35, v34 dst_sel:WORD_1 dst_unused:UNUSED_PRESERVE src0_sel:WORD_1
    v_pk_add_f16 v32, v33, 1.0 op_sel_hi:[1,0]
    v_mfma_f32_16x16x32_bf16 a[0:3], a[192:195], v[64:67], a[0:3]
    ds_read_b64_tr_b16 a[208:209], v8 offset:1024
    ds_read_b64_tr_b16 a[210:211], v9 offset:1024
    v_pk_add_f16 v34, v35, 1.0 op_sel_hi:[1,0]
    v_mfma_f32_16x16x32_bf16 a[48:51], a[192:195], v[68:71], a[48:51]
    v_rcp_f16 v33, v32
    v_rcp_f16 v35, v34
    v_mfma_f32_16x16x32_bf16 a[96:99], a[192:195], v[72:75], a[96:99]
    s_waitcnt lgkmcnt(6)
    v_rcp_f16_sdwa v33, v32 dst_sel:WORD_1 dst_unused:UNUSED_PRESERVE src0_sel:WORD_1
    v_rcp_f16_sdwa v35, v34 dst_sel:WORD_1 dst_unused:UNUSED_PRESERVE src0_sel:WORD_1
    v_mfma_f32_16x16x32_bf16 a[4:7], a[196:199], v[64:67], a[4:7]
    ds_read_b64_tr_b16 a[212:213], v8 offset:1032
    ds_read_b64_tr_b16 a[214:215], v9 offset:1032
    v_fma_mix_f32 v32, v88, v33, 0 op_sel_hi:[0,1,0]
    v_fma_mix_f32 v34, v90, v35, 0 op_sel_hi:[0,1,0]
    v_mfma_f32_16x16x32_bf16 a[52:55], a[196:199], v[68:71], a[52:55]
    v_fma_mix_f32 v33, v89, v33, 0 op_sel:[0,1,0] op_sel_hi:[0,1,0]
    v_fma_mix_f32 v35, v91, v35, 0 op_sel:[0,1,0] op_sel_hi:[0,1,0]
    v_cvt_pk_bf16_f32 v58, v32, v33
    v_mfma_f32_16x16x32_bf16 a[100:103], a[196:199], v[72:75], a[100:103]
    s_waitcnt lgkmcnt(6)
    v_cvt_pk_bf16_f32 v59, v34, v35
    v_cvt_pk_f16_f32 v28, v92, v93
    v_cvt_pk_f16_f32 v30, v94, v95
    v_pk_fma_f16 v29, v28, v28, s32
    v_mfma_f32_16x16x32_bf16 a[8:11], a[200:203], v[64:67], a[8:11]
    ds_read_b64_tr_b16 a[192:193], v8 offset:1536
    ds_read_b64_tr_b16 a[194:195], v9 offset:1536
    v_pk_fma_f16 v31, v30, v30, s32
    v_pk_mul_f16 v28, v28, v29 neg_lo:[1,0] neg_hi:[1,0]
    v_mfma_f32_16x16x32_bf16 a[56:59], a[200:203], v[68:71], a[56:59]
    v_pk_mul_f16 v30, v30, v31 neg_lo:[1,0] neg_hi:[1,0]
    v_exp_f16 v29, v28
    v_mfma_f32_16x16x32_bf16 a[104:107], a[200:203], v[72:75], a[104:107]
    s_waitcnt lgkmcnt(6)
    v_exp_f16 v31, v30
    v_exp_f16_sdwa v29, v28 dst_sel:WORD_1 dst_unused:UNUSED_PRESERVE src0_sel:WORD_1
    v_mfma_f32_16x16x32_bf16 a[12:15], a[204:207], v[64:67], a[12:15]
    ds_read_b64_tr_b16 a[196:197], v8 offset:1544
    ds_read_b64_tr_b16 a[198:199], v9 offset:1544
    v_exp_f16_sdwa v31, v30 dst_sel:WORD_1 dst_unused:UNUSED_PRESERVE src0_sel:WORD_1
    v_mfma_f32_16x16x32_bf16 a[60:63], a[204:207], v[68:71], a[60:63]
    v_pk_add_f16 v28, v29, 1.0 op_sel_hi:[1,0]
    v_pk_add_f16 v30, v31, 1.0 op_sel_hi:[1,0]
    v_rcp_f16 v29, v28
    v_mfma_f32_16x16x32_bf16 a[108:111], a[204:207], v[72:75], a[108:111]
    s_waitcnt lgkmcnt(6)
    v_rcp_f16 v31, v30
    v_mfma_f32_16x16x32_bf16 a[16:19], a[208:211], v[64:67], a[16:19]
    ds_read_b64_tr_b16 a[200:201], v8 offset:2048
    ds_read_b64_tr_b16 a[202:203], v9 offset:2048
    v_rcp_f16_sdwa v29, v28 dst_sel:WORD_1 dst_unused:UNUSED_PRESERVE src0_sel:WORD_1
    v_mfma_f32_16x16x32_bf16 a[64:67], a[208:211], v[68:71], a[64:67]
    v_rcp_f16_sdwa v31, v30 dst_sel:WORD_1 dst_unused:UNUSED_PRESERVE src0_sel:WORD_1
    v_fma_mix_f32 v28, v92, v29, 0 op_sel_hi:[0,1,0]
    v_fma_mix_f32 v30, v94, v31, 0 op_sel_hi:[0,1,0]
    v_fma_mix_f32 v29, v93, v29, 0 op_sel:[0,1,0] op_sel_hi:[0,1,0]
    v_mfma_f32_16x16x32_bf16 a[112:115], a[208:211], v[72:75], a[112:115]
    s_waitcnt lgkmcnt(6)
    v_fma_mix_f32 v31, v95, v31, 0 op_sel:[0,1,0] op_sel_hi:[0,1,0]
    v_cvt_pk_bf16_f32 v60, v28, v29
    v_cvt_pk_bf16_f32 v61, v30, v31
    v_mfma_f32_16x16x32_bf16 a[20:23], a[212:215], v[64:67], a[20:23]
    ds_read_b64_tr_b16 a[204:205], v8 offset:2056
    ds_read_b64_tr_b16 a[206:207], v9 offset:2056
    v_cvt_pk_f16_f32 v32, v96, v97
    v_cvt_pk_f16_f32 v34, v98, v99
    v_mfma_f32_16x16x32_bf16 a[68:71], a[212:215], v[68:71], a[68:71]
    v_pk_fma_f16 v33, v32, v32, s32
    v_pk_fma_f16 v35, v34, v34, s32
    v_pk_mul_f16 v32, v32, v33 neg_lo:[1,0] neg_hi:[1,0]
    v_pk_mul_f16 v34, v34, v35 neg_lo:[1,0] neg_hi:[1,0]
    v_mfma_f32_16x16x32_bf16 a[116:119], a[212:215], v[72:75], a[116:119]
    s_waitcnt lgkmcnt(6)
    v_exp_f16 v33, v32
    v_exp_f16 v35, v34
    v_mfma_f32_16x16x32_bf16 a[24:27], a[192:195], v[64:67], a[24:27]
    ds_read_b64_tr_b16 a[208:209], v8 offset:2560
    ds_read_b64_tr_b16 a[210:211], v9 offset:2560
    v_mfma_f32_16x16x32_bf16 a[72:75], a[192:195], v[68:71], a[72:75]
    v_exp_f16_sdwa v33, v32 dst_sel:WORD_1 dst_unused:UNUSED_PRESERVE src0_sel:WORD_1
    v_exp_f16_sdwa v35, v34 dst_sel:WORD_1 dst_unused:UNUSED_PRESERVE src0_sel:WORD_1
    v_pk_add_f16 v32, v33, 1.0 op_sel_hi:[1,0]
    v_mfma_f32_16x16x32_bf16 a[120:123], a[192:195], v[72:75], a[120:123]
    s_waitcnt lgkmcnt(6)
    v_pk_add_f16 v34, v35, 1.0 op_sel_hi:[1,0]
    v_rcp_f16 v33, v32
    v_mfma_f32_16x16x32_bf16 a[28:31], a[196:199], v[64:67], a[28:31]
    ds_read_b64_tr_b16 a[212:213], v8 offset:2568
    ds_read_b64_tr_b16 a[214:215], v9 offset:2568
    v_add_u32 v8, s33, v8
    v_add_u32 v9, s33, v9
    v_mfma_f32_16x16x32_bf16 a[76:79], a[196:199], v[68:71], a[76:79]
    v_rcp_f16 v35, v34
    v_rcp_f16_sdwa v33, v32 dst_sel:WORD_1 dst_unused:UNUSED_PRESERVE src0_sel:WORD_1
    v_mfma_f32_16x16x32_bf16 a[124:127], a[196:199], v[72:75], a[124:127]
    s_waitcnt lgkmcnt(6)
    v_rcp_f16_sdwa v35, v34 dst_sel:WORD_1 dst_unused:UNUSED_PRESERVE src0_sel:WORD_1
    v_fma_mix_f32 v32, v96, v33, 0 op_sel_hi:[0,1,0]
    v_fma_mix_f32 v34, v98, v35, 0 op_sel_hi:[0,1,0]
    v_mfma_f32_16x16x32_bf16 a[32:35], a[200:203], v[64:67], a[32:35]
    ds_read_b128 v[20:23], v10
    ds_read_b64_tr_b16 a[192:193], v2 offset:0
    ds_read_b64_tr_b16 a[194:195], v2 offset:2048
    v_add_u32 v10, 0x100, v10
    v_mfma_f32_16x16x32_bf16 a[80:83], a[200:203], v[68:71], a[80:83]
    v_fma_mix_f32 v33, v97, v33, 0 op_sel:[0,1,0] op_sel_hi:[0,1,0]
    v_fma_mix_f32 v35, v99, v35, 0 op_sel:[0,1,0] op_sel_hi:[0,1,0]
    v_cvt_pk_bf16_f32 v62, v32, v33
    v_mfma_f32_16x16x32_bf16 a[128:131], a[200:203], v[72:75], a[128:131]
    s_waitcnt lgkmcnt(7)
    v_cvt_pk_bf16_f32 v63, v34, v35
    v_cvt_pk_f16_f32 v28, v44, v45
    v_cvt_pk_f16_f32 v30, v46, v47
    v_pk_fma_f16 v29, v28, v28, s32
    v_mfma_f32_16x16x32_bf16 a[36:39], a[204:207], v[64:67], a[36:39]
    ds_read_b64_tr_b16 a[196:197], v2 offset:4096
    ds_read_b64_tr_b16 a[198:199], v2 offset:6144
    v_pk_fma_f16 v31, v30, v30, s32
    v_mfma_f32_16x16x32_bf16 a[84:87], a[204:207], v[68:71], a[84:87]
    v_pk_mul_f16 v28, v28, v29 neg_lo:[1,0] neg_hi:[1,0]
    v_pk_mul_f16 v30, v30, v31 neg_lo:[1,0] neg_hi:[1,0]
    v_exp_f16 v29, v28
    v_mfma_f32_16x16x32_bf16 a[132:135], a[204:207], v[72:75], a[132:135]
    s_waitcnt lgkmcnt(7)
    v_exp_f16 v31, v30
    v_exp_f16_sdwa v29, v28 dst_sel:WORD_1 dst_unused:UNUSED_PRESERVE src0_sel:WORD_1
    v_mfma_f32_16x16x32_bf16 a[40:43], a[208:211], v[64:67], a[40:43]
    ds_read_b64_tr_b16 a[200:201], v2 offset:8192
    ds_read_b64_tr_b16 a[202:203], v2 offset:10240
    v_exp_f16_sdwa v31, v30 dst_sel:WORD_1 dst_unused:UNUSED_PRESERVE src0_sel:WORD_1
    v_mfma_f32_16x16x32_bf16 a[88:91], a[208:211], v[68:71], a[88:91]
    v_pk_add_f16 v28, v29, 1.0 op_sel_hi:[1,0]
    v_pk_add_f16 v30, v31, 1.0 op_sel_hi:[1,0]
    v_mfma_f32_16x16x32_bf16 a[136:139], a[208:211], v[72:75], a[136:139]
    s_waitcnt lgkmcnt(7)
    v_rcp_f16 v29, v28
    v_rcp_f16 v31, v30
    v_mfma_f32_16x16x32_bf16 a[44:47], a[212:215], v[64:67], a[44:47]
    ds_read_b64_tr_b16 a[204:205], v2 offset:12288
    ds_read_b64_tr_b16 a[206:207], v2 offset:14336
    v_rcp_f16_sdwa v29, v28 dst_sel:WORD_1 dst_unused:UNUSED_PRESERVE src0_sel:WORD_1
    v_mfma_f32_16x16x32_bf16 a[92:95], a[212:215], v[68:71], a[92:95]
    s_mov_b32 s33, s38
    v_rcp_f16_sdwa v31, v30 dst_sel:WORD_1 dst_unused:UNUSED_PRESERVE src0_sel:WORD_1
    v_fma_mix_f32 v28, v44, v29, 0 op_sel_hi:[0,1,0]
    v_fma_mix_f32 v30, v46, v31, 0 op_sel_hi:[0,1,0]
    v_mfma_f32_16x16x32_bf16 a[140:143], a[212:215], v[72:75], a[140:143]
    s_waitcnt lgkmcnt(6)
    v_fma_mix_f32 v29, v45, v29, 0 op_sel:[0,1,0] op_sel_hi:[0,1,0]
    v_fma_mix_f32 v31, v47, v31, 0 op_sel:[0,1,0] op_sel_hi:[0,1,0]
    v_cvt_pk_bf16_f32 v48, v28, v29
    v_cvt_pk_bf16_f32 v49, v30, v31
    s_waitcnt vmcnt(0)
    s_barrier
    v_mfma_f32_16x16x32_bf16 v[76:79], a[192:195], v[160:163], v[20:23]
    s_add_u32 m0, s45, 0
    ds_read_b64_tr_b16 a[208:209], v2 offset:16384
    ds_read_b64_tr_b16 a[210:211], v2 offset:18432
    v_cvt_pk_f16_f32 v28, v100, v101
    v_mfma_f32_16x16x32_bf16 v[84:87], a[192:195], v[184:187], v[20:23]
    s_add_u32 s47, s35, 0
    buffer_load_dwordx4 v14, s[12:15], s47 offen lds
    v_mfma_f32_16x16x32_bf16 v[92:95], a[192:195], v[208:211], v[20:23]
    v_cvt_pk_f16_f32 v30, v102, v103
    v_pk_fma_f16 v29, v28, v28, s32
    v_pk_fma_f16 v31, v30, v30, s32
    v_mfma_f32_16x16x32_bf16 v[44:47], a[192:195], v[232:235], v[20:23]
    s_waitcnt lgkmcnt(6)
    v_pk_mul_f16 v28, v28, v29 neg_lo:[1,0] neg_hi:[1,0]
    v_pk_mul_f16 v30, v30, v31 neg_lo:[1,0] neg_hi:[1,0]
    v_mfma_f32_16x16x32_bf16 v[76:79], a[196:199], v[164:167], v[76:79]
    s_add_u32 m0, s45, 1024
    ds_read_b64_tr_b16 a[212:213], v2 offset:20480
    ds_read_b64_tr_b16 a[214:215], v2 offset:22528
    v_add_u32 v2, s33, v2
    v_mfma_f32_16x16x32_bf16 v[84:87], a[196:199], v[188:191], v[84:87]
    s_add_u32 s47, s35, 12288
    buffer_load_dwordx4 v14, s[12:15], s47 offen lds
    v_mfma_f32_16x16x32_bf16 v[92:95], a[196:199], v[212:215], v[92:95]
    v_exp_f16 v29, v28
    v_mfma_f32_16x16x32_bf16 v[44:47], a[196:199], v[236:239], v[44:47]
    s_waitcnt lgkmcnt(6)
    v_exp_f16 v31, v30
    v_exp_f16_sdwa v29, v28 dst_sel:WORD_1 dst_unused:UNUSED_PRESERVE src0_sel:WORD_1
    v_mfma_f32_16x16x32_bf16 v[76:79], a[200:203], v[168:171], v[76:79]
    s_add_u32 m0, s45, 2048
    ds_read_b128 v[24:27], v11
    ds_read_b64_tr_b16 a[192:193], v3 offset:0
    ds_read_b64_tr_b16 a[194:195], v3 offset:2048
    v_add_u32 v11, 0x100, v11
    v_mfma_f32_16x16x32_bf16 v[84:87], a[200:203], v[192:195], v[84:87]
    s_add_u32 s47, s35, 24576
    buffer_load_dwordx4 v14, s[12:15], s47 offen lds
    v_mfma_f32_16x16x32_bf16 v[92:95], a[200:203], v[216:219], v[92:95]
    v_exp_f16_sdwa v31, v30 dst_sel:WORD_1 dst_unused:UNUSED_PRESERVE src0_sel:WORD_1
    v_mfma_f32_16x16x32_bf16 v[44:47], a[200:203], v[240:243], v[44:47]
    s_waitcnt lgkmcnt(7)
    v_pk_add_f16 v28, v29, 1.0 op_sel_hi:[1,0]
    v_pk_add_f16 v30, v31, 1.0 op_sel_hi:[1,0]
    v_mfma_f32_16x16x32_bf16 v[76:79], a[204:207], v[172:175], v[76:79]
    s_add_u32 m0, s45, 3072
    ds_read_b64_tr_b16 a[196:197], v3 offset:4096
    ds_read_b64_tr_b16 a[198:199], v3 offset:6144
    v_rcp_f16 v29, v28
    v_mfma_f32_16x16x32_bf16 v[84:87], a[204:207], v[196:199], v[84:87]
    s_add_u32 s47, s35, 36864
    buffer_load_dwordx4 v14, s[12:15], s47 offen lds
    v_mfma_f32_16x16x32_bf16 v[92:95], a[204:207], v[220:223], v[92:95]
    v_rcp_f16 v31, v30
    v_mfma_f32_16x16x32_bf16 v[44:47], a[204:207], v[244:247], v[44:47]
    s_waitcnt lgkmcnt(7)
    v_rcp_f16_sdwa v29, v28 dst_sel:WORD_1 dst_unused:UNUSED_PRESERVE src0_sel:WORD_1
    v_mfma_f32_16x16x32_bf16 v[76:79], a[208:211], v[176:179], v[76:79]
    s_add_u32 m0, s45, 4096
    ds_read_b64_tr_b16 a[200:201], v3 offset:8192
    ds_read_b64_tr_b16 a[202:203], v3 offset:10240
    v_rcp_f16_sdwa v31, v30 dst_sel:WORD_1 dst_unused:UNUSED_PRESERVE src0_sel:WORD_1
    v_mfma_f32_16x16x32_bf16 v[84:87], a[208:211], v[200:203], v[84:87]
    s_add_u32 s47, s35, 49152
    buffer_load_dwordx4 v14, s[12:15], s47 offen lds
    v_mfma_f32_16x16x32_bf16 v[92:95], a[208:211], v[224:227], v[92:95]
    v_fma_mix_f32 v28, v100, v29, 0 op_sel_hi:[0,1,0]
    v_fma_mix_f32 v30, v102, v31, 0 op_sel_hi:[0,1,0]
    v_fma_mix_f32 v29, v101, v29, 0 op_sel:[0,1,0] op_sel_hi:[0,1,0]
    v_mfma_f32_16x16x32_bf16 v[44:47], a[208:211], v[248:251], v[44:47]
    s_waitcnt lgkmcnt(7)
    v_fma_mix_f32 v31, v103, v31, 0 op_sel:[0,1,0] op_sel_hi:[0,1,0]
    v_cvt_pk_bf16_f32 v64, v28, v29
    v_cvt_pk_bf16_f32 v65, v30, v31
    v_mfma_f32_16x16x32_bf16 v[76:79], a[212:215], v[180:183], v[76:79]
    s_add_u32 m0, s45, 5120
    ds_read_b64_tr_b16 a[204:205], v3 offset:12288
    ds_read_b64_tr_b16 a[206:207], v3 offset:14336
    v_cvt_pk_f16_f32 v32, v104, v105
    v_mfma_f32_16x16x32_bf16 v[84:87], a[212:215], v[204:207], v[84:87]
    s_add_u32 s47, s35, 61440
    buffer_load_dwordx4 v14, s[12:15], s47 offen lds
    v_mfma_f32_16x16x32_bf16 v[92:95], a[212:215], v[228:231], v[92:95]
    v_cvt_pk_f16_f32 v34, v106, v107
    v_pk_fma_f16 v33, v32, v32, s32
    v_mfma_f32_16x16x32_bf16 v[44:47], a[212:215], v[252:255], v[44:47]
    s_waitcnt lgkmcnt(6)
    v_pk_fma_f16 v35, v34, v34, s32
    v_pk_mul_f16 v32, v32, v33 neg_lo:[1,0] neg_hi:[1,0]
    v_pk_mul_f16 v34, v34, v35 neg_lo:[1,0] neg_hi:[1,0]
    v_mfma_f32_16x16x32_bf16 v[80:83], a[192:195], v[160:163], v[24:27]
    s_add_u32 m0, s46, 0
    ds_read_b64_tr_b16 a[208:209], v3 offset:16384
    ds_read_b64_tr_b16 a[210:211], v3 offset:18432
    v_mfma_f32_16x16x32_bf16 v[88:91], a[192:195], v[184:187], v[24:27]
    s_add_u32 s47, s36, 0
    buffer_load_dwordx4 v15, s[16:19], s47 offen lds
    v_mfma_f32_16x16x32_bf16 v[96:99], a[192:195], v[208:211], v[24:27]
    s_waitcnt lgkmcnt(6)
    v_exp_f16 v33, v32
    v_exp_f16 v35, v34
    v_mfma_f32_16x16x32_bf16 v[80:83], a[196:199], v[164:167], v[80:83]
    s_add_u32 m0, s46, 1024
    ds_read_b64_tr_b16 a[212:213], v3 offset:20480
    ds_read_b64_tr_b16 a[214:215], v3 offset:22528
    v_add_u32 v3, s33, v3
    v_mfma_f32_16x16x32_bf16 v[88:91], a[196:199], v[188:191], v[88:91]
    s_add_u32 s47, s36, 128
    buffer_load_dwordx4 v15, s[16:19], s47 offen lds
    v_mfma_f32_16x16x32_bf16 v[96:99], a[196:199], v[212:215], v[96:99]
    s_waitcnt lgkmcnt(6)
    v_exp_f16_sdwa v33, v32 dst_sel:WORD_1 dst_unused:UNUSED_PRESERVE src0_sel:WORD_1
    v_mfma_f32_16x16x32_bf16 v[80:83], a[200:203], v[168:171], v[80:83]
    s_add_u32 m0, s46, 2048
    ds_read_b64_tr_b16 a[192:193], v6 offset:0
    ds_read_b64_tr_b16 a[194:195], v7 offset:0
    v_exp_f16_sdwa v35, v34 dst_sel:WORD_1 dst_unused:UNUSED_PRESERVE src0_sel:WORD_1
    v_mfma_f32_16x16x32_bf16 v[88:91], a[200:203], v[192:195], v[88:91]
    s_add_u32 s47, s36, 256
    buffer_load_dwordx4 v15, s[16:19], s47 offen lds
    v_mfma_f32_16x16x32_bf16 v[96:99], a[200:203], v[216:219], v[96:99]
    s_waitcnt lgkmcnt(6)
    v_pk_add_f16 v32, v33, 1.0 op_sel_hi:[1,0]
    v_pk_add_f16 v34, v35, 1.0 op_sel_hi:[1,0]
    v_mfma_f32_16x16x32_bf16 v[80:83], a[204:207], v[172:175], v[80:83]
    s_add_u32 m0, s46, 3080
    ds_read_b64_tr_b16 a[196:197], v6 offset:8
    ds_read_b64_tr_b16 a[198:199], v7 offset:8
    v_mfma_f32_16x16x32_bf16 v[88:91], a[204:207], v[196:199], v[88:91]
    s_add_u32 s47, s36, 1536
    buffer_load_dwordx4 v15, s[16:19], s47 offen lds
    v_mfma_f32_16x16x32_bf16 v[96:99], a[204:207], v[220:223], v[96:99]
    s_waitcnt lgkmcnt(6)
    v_rcp_f16 v33, v32
    v_rcp_f16 v35, v34
    v_mfma_f32_16x16x32_bf16 v[80:83], a[208:211], v[176:179], v[80:83]
    s_add_u32 m0, s46, 4104
    ds_read_b64_tr_b16 a[200:201], v6 offset:512
    ds_read_b64_tr_b16 a[202:203], v7 offset:512
    v_mfma_f32_16x16x32_bf16 v[88:91], a[208:211], v[200:203], v[88:91]
    s_add_u32 s47, s36, 1664
    buffer_load_dwordx4 v15, s[16:19], s47 offen lds
    v_mfma_f32_16x16x32_bf16 v[96:99], a[208:211], v[224:227], v[96:99]
    s_waitcnt lgkmcnt(6)
    v_rcp_f16_sdwa v33, v32 dst_sel:WORD_1 dst_unused:UNUSED_PRESERVE src0_sel:WORD_1
    v_rcp_f16_sdwa v35, v34 dst_sel:WORD_1 dst_unused:UNUSED_PRESERVE src0_sel:WORD_1
    v_mfma_f32_16x16x32_bf16 v[80:83], a[212:215], v[180:183], v[80:83]
    s_add_u32 m0, s46, 5128
    ds_read_b64_tr_b16 a[204:205], v6 offset:520
    ds_read_b64_tr_b16 a[206:207], v7 offset:520
    v_fma_mix_f32 v32, v104, v33, 0 op_sel_hi:[0,1,0]
    v_mfma_f32_16x16x32_bf16 v[88:91], a[212:215], v[204:207], v[88:91]
    s_add_u32 s47, s36, 1792
    buffer_load_dwordx4 v15, s[16:19], s47 offen lds
    v_mfma_f32_16x16x32_bf16 v[96:99], a[212:215], v[228:231], v[96:99]
    s_waitcnt lgkmcnt(6)
    v_fma_mix_f32 v34, v106, v35, 0 op_sel_hi:[0,1,0]
    v_fma_mix_f32 v33, v105, v33, 0 op_sel:[0,1,0] op_sel_hi:[0,1,0]
    v_mfma_f32_16x16x32_bf16 a[0:3], a[192:195], v[52:55], a[0:3]
    ds_read_b64_tr_b16 a[208:209], v6 offset:1024
    ds_read_b64_tr_b16 a[210:211], v7 offset:1024
    v_fma_mix_f32 v35, v107, v35, 0 op_sel:[0,1,0] op_sel_hi:[0,1,0]
    v_mfma_f32_16x16x32_bf16 a[48:51], a[192:195], v[56:59], a[48:51]
    v_cvt_pk_bf16_f32 v66, v32, v33
    v_cvt_pk_bf16_f32 v67, v34, v35
    v_cvt_pk_f16_f32 v28, v108, v109
    v_mfma_f32_16x16x16_bf16 a[144:147], a[192:193], v[48:49], a[144:147]
    v_cvt_pk_f16_f32 v30, v110, v111
    v_pk_fma_f16 v29, v28, v28, s32
    v_pk_fma_f16 v31, v30, v30, s32
    v_pk_mul_f16 v28, v28, v29 neg_lo:[1,0] neg_hi:[1,0]
    v_mfma_f32_16x16x32_bf16 a[96:99], a[192:195], v[60:63], a[96:99]
    s_waitcnt lgkmcnt(6)
    v_pk_mul_f16 v30, v30, v31 neg_lo:[1,0] neg_hi:[1,0]
    v_exp_f16 v29, v28
    v_mfma_f32_16x16x32_bf16 a[4:7], a[196:199], v[52:55], a[4:7]
    ds_read_b64_tr_b16 a[212:213], v6 offset:1032
    ds_read_b64_tr_b16 a[214:215], v7 offset:1032
    v_mfma_f32_16x16x32_bf16 a[52:55], a[196:199], v[56:59], a[52:55]
    v_exp_f16 v31, v30
    v_exp_f16_sdwa v29, v28 dst_sel:WORD_1 dst_unused:UNUSED_PRESERVE src0_sel:WORD_1
    v_mfma_f32_16x16x16_bf16 a[148:151], a[196:197], v[48:49], a[148:151]
    v_exp_f16_sdwa v31, v30 dst_sel:WORD_1 dst_unused:UNUSED_PRESERVE src0_sel:WORD_1
    v_pk_add_f16 v28, v29, 1.0 op_sel_hi:[1,0]
    v_pk_add_f16 v30, v31, 1.0 op_sel_hi:[1,0]
    v_mfma_f32_16x16x32_bf16 a[100:103], a[196:199], v[60:63], a[100:103]
    s_waitcnt lgkmcnt(6)
    v_rcp_f16 v29, v28
    v_mfma_f32_16x16x32_bf16 a[8:11], a[200:203], v[52:55], a[8:11]
    ds_read_b64_tr_b16 a[192:193], v6 offset:1536
    ds_read_b64_tr_b16 a[194:195], v7 offset:1536
    v_mfma_f32_16x16x32_bf16 a[56:59], a[200:203], v[56:59], a[56:59]
    v_rcp_f16 v31, v30
    v_rcp_f16_sdwa v29, v28 dst_sel:WORD_1 dst_unused:UNUSED_PRESERVE src0_sel:WORD_1
    v_mfma_f32_16x16x16_bf16 a[152:155], a[200:201], v[48:49], a[152:155]
    v_rcp_f16_sdwa v31, v30 dst_sel:WORD_1 dst_unused:UNUSED_PRESERVE src0_sel:WORD_1
    v_fma_mix_f32 v28, v108, v29, 0 op_sel_hi:[0,1,0]
    v_fma_mix_f32 v30, v110, v31, 0 op_sel_hi:[0,1,0]
    v_mfma_f32_16x16x32_bf16 a[104:107], a[200:203], v[60:63], a[104:107]
    s_waitcnt lgkmcnt(6)
    v_fma_mix_f32 v29, v109, v29, 0 op_sel:[0,1,0] op_sel_hi:[0,1,0]
    v_fma_mix_f32 v31, v111, v31, 0 op_sel:[0,1,0] op_sel_hi:[0,1,0]
    v_cvt_pk_bf16_f32 v68, v28, v29
    v_mfma_f32_16x16x32_bf16 a[12:15], a[204:207], v[52:55], a[12:15]
    ds_read_b64_tr_b16 a[196:197], v6 offset:1544
    ds_read_b64_tr_b16 a[198:199], v7 offset:1544
    v_cvt_pk_bf16_f32 v69, v30, v31
    v_mfma_f32_16x16x32_bf16 a[60:63], a[204:207], v[56:59], a[60:63]
    v_cvt_pk_f16_f32 v32, v112, v113
    v_cvt_pk_f16_f32 v34, v114, v115
    v_pk_fma_f16 v33, v32, v32, s32
    v_mfma_f32_16x16x16_bf16 a[156:159], a[204:205], v[48:49], a[156:159]
    v_pk_fma_f16 v35, v34, v34, s32
    v_pk_mul_f16 v32, v32, v33 neg_lo:[1,0] neg_hi:[1,0]
    v_pk_mul_f16 v34, v34, v35 neg_lo:[1,0] neg_hi:[1,0]
    v_exp_f16 v33, v32
    v_mfma_f32_16x16x32_bf16 a[108:111], a[204:207], v[60:63], a[108:111]
    s_waitcnt lgkmcnt(6)
    v_exp_f16 v35, v34
    v_mfma_f32_16x16x32_bf16 a[16:19], a[208:211], v[52:55], a[16:19]
    ds_read_b64_tr_b16 a[200:201], v6 offset:2048
    ds_read_b64_tr_b16 a[202:203], v7 offset:2048
    v_mfma_f32_16x16x32_bf16 a[64:67], a[208:211], v[56:59], a[64:67]
    v_exp_f16_sdwa v33, v32 dst_sel:WORD_1 dst_unused:UNUSED_PRESERVE src0_sel:WORD_1
    v_exp_f16_sdwa v35, v34 dst_sel:WORD_1 dst_unused:UNUSED_PRESERVE src0_sel:WORD_1
    v_mfma_f32_16x16x16_bf16 a[160:163], a[208:209], v[48:49], a[160:163]
    v_pk_add_f16 v32, v33, 1.0 op_sel_hi:[1,0]
    v_pk_add_f16 v34, v35, 1.0 op_sel_hi:[1,0]
    v_rcp_f16 v33, v32
    v_mfma_f32_16x16x32_bf16 a[112:115], a[208:211], v[60:63], a[112:115]
    s_waitcnt lgkmcnt(6)
    v_rcp_f16 v35, v34
    v_mfma_f32_16x16x32_bf16 a[20:23], a[212:215], v[52:55], a[20:23]
    ds_read_b64_tr_b16 a[204:205], v6 offset:2056
    ds_read_b64_tr_b16 a[206:207], v7 offset:2056
    v_mfma_f32_16x16x32_bf16 a[68:71], a[212:215], v[56:59], a[68:71]
    v_rcp_f16_sdwa v33, v32 dst_sel:WORD_1 dst_unused:UNUSED_PRESERVE src0_sel:WORD_1
    v_rcp_f16_sdwa v35, v34 dst_sel:WORD_1 dst_unused:UNUSED_PRESERVE src0_sel:WORD_1
    v_mfma_f32_16x16x16_bf16 a[164:167], a[212:213], v[48:49], a[164:167]
    v_fma_mix_f32 v32, v112, v33, 0 op_sel_hi:[0,1,0]
    v_fma_mix_f32 v34, v114, v35, 0 op_sel_hi:[0,1,0]
    v_fma_mix_f32 v33, v113, v33, 0 op_sel:[0,1,0] op_sel_hi:[0,1,0]
    v_fma_mix_f32 v35, v115, v35, 0 op_sel:[0,1,0] op_sel_hi:[0,1,0]
    v_mfma_f32_16x16x32_bf16 a[116:119], a[212:215], v[60:63], a[116:119]
    s_waitcnt lgkmcnt(6)
    v_cvt_pk_bf16_f32 v70, v32, v33
    v_cvt_pk_bf16_f32 v71, v34, v35
    v_cvt_pk_f16_f32 v28, v116, v117
    v_mfma_f32_16x16x32_bf16 a[24:27], a[192:195], v[52:55], a[24:27]
    ds_read_b64_tr_b16 a[208:209], v6 offset:2560
    ds_read_b64_tr_b16 a[210:211], v7 offset:2560
    v_cvt_pk_f16_f32 v30, v118, v119
    v_mfma_f32_16x16x32_bf16 a[72:75], a[192:195], v[56:59], a[72:75]
    v_pk_fma_f16 v29, v28, v28, s32
    v_pk_fma_f16 v31, v30, v30, s32
    v_pk_mul_f16 v28, v28, v29 neg_lo:[1,0] neg_hi:[1,0]
    v_mfma_f32_16x16x16_bf16 a[168:171], a[192:193], v[48:49], a[168:171]
    v_pk_mul_f16 v30, v30, v31 neg_lo:[1,0] neg_hi:[1,0]
    v_exp_f16 v29, v28
    v_exp_f16 v31, v30
    v_mfma_f32_16x16x32_bf16 a[120:123], a[192:195], v[60:63], a[120:123]
    s_waitcnt lgkmcnt(6)
    v_exp_f16_sdwa v29, v28 dst_sel:WORD_1 dst_unused:UNUSED_PRESERVE src0_sel:WORD_1
    v_mfma_f32_16x16x32_bf16 a[28:31], a[196:199], v[52:55], a[28:31]
    ds_read_b64_tr_b16 a[212:213], v6 offset:2568
    ds_read_b64_tr_b16 a[214:215], v7 offset:2568
    v_add_u32 v6, s33, v6
    v_add_u32 v7, s33, v7
    v_mfma_f32_16x16x32_bf16 a[76:79], a[196:199], v[56:59], a[76:79]
    v_exp_f16_sdwa v31, v30 dst_sel:WORD_1 dst_unused:UNUSED_PRESERVE src0_sel:WORD_1
    v_pk_add_f16 v28, v29, 1.0 op_sel_hi:[1,0]
    v_mfma_f32_16x16x16_bf16 a[172:175], a[196:197], v[48:49], a[172:175]
    v_pk_add_f16 v30, v31, 1.0 op_sel_hi:[1,0]
    v_rcp_f16 v29, v28
    v_rcp_f16 v31, v30
    v_mfma_f32_16x16x32_bf16 a[124:127], a[196:199], v[60:63], a[124:127]
    s_waitcnt lgkmcnt(6)
    v_rcp_f16_sdwa v29, v28 dst_sel:WORD_1 dst_unused:UNUSED_PRESERVE src0_sel:WORD_1
    v_mfma_f32_16x16x32_bf16 a[32:35], a[200:203], v[52:55], a[32:35]
    ds_read_b128 v[20:23], v12
    ds_read_b64_tr_b16 a[192:193], v4 offset:0
    ds_read_b64_tr_b16 a[194:195], v4 offset:2048
    v_add_u32 v12, 0x100, v12
    v_mfma_f32_16x16x32_bf16 a[80:83], a[200:203], v[56:59], a[80:83]
    v_rcp_f16_sdwa v31, v30 dst_sel:WORD_1 dst_unused:UNUSED_PRESERVE src0_sel:WORD_1
    v_fma_mix_f32 v28, v116, v29, 0 op_sel_hi:[0,1,0]
    v_mfma_f32_16x16x16_bf16 a[176:179], a[200:201], v[48:49], a[176:179]
    v_fma_mix_f32 v30, v118, v31, 0 op_sel_hi:[0,1,0]
    v_fma_mix_f32 v29, v117, v29, 0 op_sel:[0,1,0] op_sel_hi:[0,1,0]
    v_fma_mix_f32 v31, v119, v31, 0 op_sel:[0,1,0] op_sel_hi:[0,1,0]
    v_cvt_pk_bf16_f32 v72, v28, v29
    v_mfma_f32_16x16x32_bf16 a[128:131], a[200:203], v[60:63], a[128:131]
    s_waitcnt lgkmcnt(7)
    v_cvt_pk_bf16_f32 v73, v30, v31
    v_cvt_pk_f16_f32 v32, v120, v121
    v_mfma_f32_16x16x32_bf16 a[36:39], a[204:207], v[52:55], a[36:39]
    ds_read_b64_tr_b16 a[196:197], v4 offset:4096
    ds_read_b64_tr_b16 a[198:199], v4 offset:6144
    v_mfma_f32_16x16x32_bf16 a[84:87], a[204:207], v[56:59], a[84:87]
    v_cvt_pk_f16_f32 v34, v122, v123
    v_pk_fma_f16 v33, v32, v32, s32
    v_pk_fma_f16 v35, v34, v34, s32
    v_mfma_f32_16x16x16_bf16 a[180:183], a[204:205], v[48:49], a[180:183]
    v_pk_mul_f16 v32, v32, v33 neg_lo:[1,0] neg_hi:[1,0]
    v_pk_mul_f16 v34, v34, v35 neg_lo:[1,0] neg_hi:[1,0]
    v_exp_f16 v33, v32
    v_mfma_f32_16x16x32_bf16 a[132:135], a[204:207], v[60:63], a[132:135]
    s_waitcnt lgkmcnt(7)
    v_exp_f16 v35, v34
    v_mfma_f32_16x16x32_bf16 a[40:43], a[208:211], v[52:55], a[40:43]
    ds_read_b64_tr_b16 a[200:201], v4 offset:8192
    ds_read_b64_tr_b16 a[202:203], v4 offset:10240
    v_mfma_f32_16x16x32_bf16 a[88:91], a[208:211], v[56:59], a[88:91]
    v_exp_f16_sdwa v33, v32 dst_sel:WORD_1 dst_unused:UNUSED_PRESERVE src0_sel:WORD_1
    v_exp_f16_sdwa v35, v34 dst_sel:WORD_1 dst_unused:UNUSED_PRESERVE src0_sel:WORD_1
    v_mfma_f32_16x16x16_bf16 a[184:187], a[208:209], v[48:49], a[184:187]
    v_pk_add_f16 v32, v33, 1.0 op_sel_hi:[1,0]
    v_pk_add_f16 v34, v35, 1.0 op_sel_hi:[1,0]
    v_rcp_f16 v33, v32
    v_mfma_f32_16x16x32_bf16 a[136:139], a[208:211], v[60:63], a[136:139]
    s_waitcnt lgkmcnt(7)
    v_rcp_f16 v35, v34
    v_mfma_f32_16x16x32_bf16 a[44:47], a[212:215], v[52:55], a[44:47]
    ds_read_b64_tr_b16 a[204:205], v4 offset:12288
    ds_read_b64_tr_b16 a[206:207], v4 offset:14336
    v_mfma_f32_16x16x32_bf16 a[92:95], a[212:215], v[56:59], a[92:95]
    v_rcp_f16_sdwa v33, v32 dst_sel:WORD_1 dst_unused:UNUSED_PRESERVE src0_sel:WORD_1
    v_rcp_f16_sdwa v35, v34 dst_sel:WORD_1 dst_unused:UNUSED_PRESERVE src0_sel:WORD_1
    v_mfma_f32_16x16x16_bf16 a[188:191], a[212:213], v[48:49], a[188:191]
    v_fma_mix_f32 v32, v120, v33, 0 op_sel_hi:[0,1,0]
    v_fma_mix_f32 v34, v122, v35, 0 op_sel_hi:[0,1,0]
    v_fma_mix_f32 v33, v121, v33, 0 op_sel:[0,1,0] op_sel_hi:[0,1,0]
    v_fma_mix_f32 v35, v123, v35, 0 op_sel:[0,1,0] op_sel_hi:[0,1,0]
    v_mfma_f32_16x16x32_bf16 a[140:143], a[212:215], v[60:63], a[140:143]
    s_waitcnt lgkmcnt(6)
    v_cvt_pk_bf16_f32 v74, v32, v33
    v_cvt_pk_bf16_f32 v75, v34, v35
    v_mfma_f32_16x16x32_bf16 v[100:103], a[192:195], v[160:163], v[20:23]
    s_add_u32 s45, s45, s49
    ds_read_b64_tr_b16 a[208:209], v4 offset:16384
    ds_read_b64_tr_b16 a[210:211], v4 offset:18432
    v_cvt_pk_f16_f32 v28, v76, v77
    v_cvt_pk_f16_f32 v30, v78, v79
    v_mfma_f32_16x16x32_bf16 v[108:111], a[192:195], v[184:187], v[20:23]
    v_pk_fma_f16 v29, v28, v28, s32
    v_pk_fma_f16 v31, v30, v30, s32
    v_pk_mul_f16 v28, v28, v29 neg_lo:[1,0] neg_hi:[1,0]
    v_mfma_f32_16x16x32_bf16 v[116:119], a[192:195], v[208:211], v[20:23]
    s_waitcnt lgkmcnt(6)
    v_pk_mul_f16 v30, v30, v31 neg_lo:[1,0] neg_hi:[1,0]
    v_exp_f16 v29, v28
    v_mfma_f32_16x16x32_bf16 v[100:103], a[196:199], v[164:167], v[100:103]
    s_add_u32 s46, s46, s49
    ds_read_b64_tr_b16 a[212:213], v4 offset:20480
    ds_read_b64_tr_b16 a[214:215], v4 offset:22528
    v_add_u32 v4, s33, v4
    v_exp_f16 v31, v30
    v_mfma_f32_16x16x32_bf16 v[108:111], a[196:199], v[188:191], v[108:111]
    v_exp_f16_sdwa v29, v28 dst_sel:WORD_1 dst_unused:UNUSED_PRESERVE src0_sel:WORD_1
    v_mfma_f32_16x16x32_bf16 v[116:119], a[196:199], v[212:215], v[116:119]
    s_waitcnt lgkmcnt(6)
    v_exp_f16_sdwa v31, v30 dst_sel:WORD_1 dst_unused:UNUSED_PRESERVE src0_sel:WORD_1
    v_pk_add_f16 v28, v29, 1.0 op_sel_hi:[1,0]
    v_pk_add_f16 v30, v31, 1.0 op_sel_hi:[1,0]
    v_mfma_f32_16x16x32_bf16 v[100:103], a[200:203], v[168:171], v[100:103]
    s_add_u32 s35, s35, 128
    ds_read_b128 v[24:27], v13
    ds_read_b64_tr_b16 a[192:193], v5 offset:0
    ds_read_b64_tr_b16 a[194:195], v5 offset:2048
    v_add_u32 v13, 0x100, v13
    v_mfma_f32_16x16x32_bf16 v[108:111], a[200:203], v[192:195], v[108:111]
    v_rcp_f16 v29, v28
    v_rcp_f16 v31, v30
    v_mfma_f32_16x16x32_bf16 v[116:119], a[200:203], v[216:219], v[116:119]
    s_waitcnt lgkmcnt(7)
    v_rcp_f16_sdwa v29, v28 dst_sel:WORD_1 dst_unused:UNUSED_PRESERVE src0_sel:WORD_1
    v_rcp_f16_sdwa v31, v30 dst_sel:WORD_1 dst_unused:UNUSED_PRESERVE src0_sel:WORD_1
    v_mfma_f32_16x16x32_bf16 v[100:103], a[204:207], v[172:175], v[100:103]
    s_add_u32 s36, s36, 24576
    ds_read_b64_tr_b16 a[196:197], v5 offset:4096
    ds_read_b64_tr_b16 a[198:199], v5 offset:6144
    v_fma_mix_f32 v28, v76, v29, 0 op_sel_hi:[0,1,0]
    v_fma_mix_f32 v30, v78, v31, 0 op_sel_hi:[0,1,0]
    v_mfma_f32_16x16x32_bf16 v[108:111], a[204:207], v[196:199], v[108:111]
    v_fma_mix_f32 v29, v77, v29, 0 op_sel:[0,1,0] op_sel_hi:[0,1,0]
    v_fma_mix_f32 v31, v79, v31, 0 op_sel:[0,1,0] op_sel_hi:[0,1,0]
    v_cvt_pk_bf16_f32 v52, v28, v29
    v_cvt_pk_bf16_f32 v53, v30, v31
    v_mfma_f32_16x16x32_bf16 v[116:119], a[204:207], v[220:223], v[116:119]
    s_waitcnt lgkmcnt(7)
    v_cvt_pk_f16_f32 v32, v80, v81
    v_cvt_pk_f16_f32 v34, v82, v83
    v_pk_fma_f16 v33, v32, v32, s32
    v_mfma_f32_16x16x32_bf16 v[100:103], a[208:211], v[176:179], v[100:103]
    s_mov_b32 s38, s48
    ds_read_b64_tr_b16 a[200:201], v5 offset:8192
    ds_read_b64_tr_b16 a[202:203], v5 offset:10240
    v_pk_fma_f16 v35, v34, v34, s32
    v_pk_mul_f16 v32, v32, v33 neg_lo:[1,0] neg_hi:[1,0]
    v_mfma_f32_16x16x32_bf16 v[108:111], a[208:211], v[200:203], v[108:111]
    v_pk_mul_f16 v34, v34, v35 neg_lo:[1,0] neg_hi:[1,0]
    v_exp_f16 v33, v32
    v_mfma_f32_16x16x32_bf16 v[116:119], a[208:211], v[224:227], v[116:119]
    s_waitcnt lgkmcnt(7)
    v_exp_f16 v35, v34
    v_exp_f16_sdwa v33, v32 dst_sel:WORD_1 dst_unused:UNUSED_PRESERVE src0_sel:WORD_1
    v_mfma_f32_16x16x32_bf16 v[100:103], a[212:215], v[180:183], v[100:103]
    s_mov_b32 s48, s49
    ds_read_b64_tr_b16 a[204:205], v5 offset:12288
    ds_read_b64_tr_b16 a[206:207], v5 offset:14336
    v_exp_f16_sdwa v35, v34 dst_sel:WORD_1 dst_unused:UNUSED_PRESERVE src0_sel:WORD_1
    v_mfma_f32_16x16x32_bf16 v[108:111], a[212:215], v[204:207], v[108:111]
    v_pk_add_f16 v32, v33, 1.0 op_sel_hi:[1,0]
    v_pk_add_f16 v34, v35, 1.0 op_sel_hi:[1,0]
    v_rcp_f16 v33, v32
    v_mfma_f32_16x16x32_bf16 v[116:119], a[212:215], v[228:231], v[116:119]
    s_waitcnt lgkmcnt(6)
    v_rcp_f16 v35, v34
    v_rcp_f16_sdwa v33, v32 dst_sel:WORD_1 dst_unused:UNUSED_PRESERVE src0_sel:WORD_1
    v_mfma_f32_16x16x32_bf16 v[104:107], a[192:195], v[160:163], v[24:27]
    s_mov_b32 s49, s33
    ds_read_b64_tr_b16 a[208:209], v5 offset:16384
    ds_read_b64_tr_b16 a[210:211], v5 offset:18432
    v_mfma_f32_16x16x32_bf16 v[112:115], a[192:195], v[184:187], v[24:27]
    v_rcp_f16_sdwa v35, v34 dst_sel:WORD_1 dst_unused:UNUSED_PRESERVE src0_sel:WORD_1
    v_fma_mix_f32 v32, v80, v33, 0 op_sel_hi:[0,1,0]
    v_fma_mix_f32 v34, v82, v35, 0 op_sel_hi:[0,1,0]
    v_fma_mix_f32 v33, v81, v33, 0 op_sel:[0,1,0] op_sel_hi:[0,1,0]
    v_mfma_f32_16x16x32_bf16 v[120:123], a[192:195], v[208:211], v[24:27]
    s_waitcnt lgkmcnt(6)
    v_fma_mix_f32 v35, v83, v35, 0 op_sel:[0,1,0] op_sel_hi:[0,1,0]
    v_cvt_pk_bf16_f32 v54, v32, v33
    v_cvt_pk_bf16_f32 v55, v34, v35
    v_cvt_pk_f16_f32 v28, v84, v85
    v_mfma_f32_16x16x32_bf16 v[104:107], a[196:199], v[164:167], v[104:107]
    s_sub_u32 s37, s37, 1
    ds_read_b64_tr_b16 a[212:213], v5 offset:20480
    ds_read_b64_tr_b16 a[214:215], v5 offset:22528
    v_add_u32 v5, s33, v5
    v_mfma_f32_16x16x32_bf16 v[112:115], a[196:199], v[188:191], v[112:115]
    v_cvt_pk_f16_f32 v30, v86, v87
    v_pk_fma_f16 v29, v28, v28, s32
    v_pk_fma_f16 v31, v30, v30, s32
    v_pk_mul_f16 v28, v28, v29 neg_lo:[1,0] neg_hi:[1,0]
    v_mfma_f32_16x16x32_bf16 v[120:123], a[196:199], v[212:215], v[120:123]
    s_waitcnt lgkmcnt(6)
    v_pk_mul_f16 v30, v30, v31 neg_lo:[1,0] neg_hi:[1,0]
    v_exp_f16 v29, v28
    v_mfma_f32_16x16x32_bf16 v[104:107], a[200:203], v[168:171], v[104:107]
    s_cmp_lg_u32 s37, 0
    ds_read_b64_tr_b16 a[192:193], v8 offset:0
    ds_read_b64_tr_b16 a[194:195], v9 offset:0
    v_exp_f16 v31, v30
    v_mfma_f32_16x16x32_bf16 v[112:115], a[200:203], v[192:195], v[112:115]
    v_exp_f16_sdwa v29, v28 dst_sel:WORD_1 dst_unused:UNUSED_PRESERVE src0_sel:WORD_1
    v_exp_f16_sdwa v31, v30 dst_sel:WORD_1 dst_unused:UNUSED_PRESERVE src0_sel:WORD_1
    v_mfma_f32_16x16x32_bf16 v[120:123], a[200:203], v[216:219], v[120:123]
    s_waitcnt lgkmcnt(6)
    v_pk_add_f16 v28, v29, 1.0 op_sel_hi:[1,0]
    v_pk_add_f16 v30, v31, 1.0 op_sel_hi:[1,0]
    v_rcp_f16 v29, v28
    v_mfma_f32_16x16x32_bf16 v[104:107], a[204:207], v[172:175], v[104:107]
    ds_read_b64_tr_b16 a[196:197], v8 offset:8
    ds_read_b64_tr_b16 a[198:199], v9 offset:8
    v_mfma_f32_16x16x32_bf16 v[112:115], a[204:207], v[196:199], v[112:115]
    v_rcp_f16 v31, v30
    v_rcp_f16_sdwa v29, v28 dst_sel:WORD_1 dst_unused:UNUSED_PRESERVE src0_sel:WORD_1
    v_mfma_f32_16x16x32_bf16 v[120:123], a[204:207], v[220:223], v[120:123]
    s_waitcnt lgkmcnt(6)
    v_rcp_f16_sdwa v31, v30 dst_sel:WORD_1 dst_unused:UNUSED_PRESERVE src0_sel:WORD_1
    v_fma_mix_f32 v28, v84, v29, 0 op_sel_hi:[0,1,0]
    v_fma_mix_f32 v30, v86, v31, 0 op_sel_hi:[0,1,0]
    v_fma_mix_f32 v29, v85, v29, 0 op_sel:[0,1,0] op_sel_hi:[0,1,0]
    v_mfma_f32_16x16x32_bf16 v[104:107], a[208:211], v[176:179], v[104:107]
    ds_read_b64_tr_b16 a[200:201], v8 offset:512
    ds_read_b64_tr_b16 a[202:203], v9 offset:512
    v_fma_mix_f32 v31, v87, v31, 0 op_sel:[0,1,0] op_sel_hi:[0,1,0]
    v_cvt_pk_bf16_f32 v56, v28, v29
    v_mfma_f32_16x16x32_bf16 v[112:115], a[208:211], v[200:203], v[112:115]
    v_cvt_pk_bf16_f32 v57, v30, v31
    v_cvt_pk_f16_f32 v32, v88, v89
    v_cvt_pk_f16_f32 v34, v90, v91
    v_mfma_f32_16x16x32_bf16 v[120:123], a[208:211], v[224:227], v[120:123]
    s_waitcnt lgkmcnt(6)
    v_pk_fma_f16 v33, v32, v32, s32
    v_pk_fma_f16 v35, v34, v34, s32
    v_pk_mul_f16 v32, v32, v33 neg_lo:[1,0] neg_hi:[1,0]
    v_pk_mul_f16 v34, v34, v35 neg_lo:[1,0] neg_hi:[1,0]
    v_mfma_f32_16x16x32_bf16 v[104:107], a[212:215], v[180:183], v[104:107]
    ds_read_b64_tr_b16 a[204:205], v8 offset:520
    ds_read_b64_tr_b16 a[206:207], v9 offset:520
    v_exp_f16 v33, v32
    v_mfma_f32_16x16x32_bf16 v[112:115], a[212:215], v[204:207], v[112:115]
    v_exp_f16 v35, v34
    v_mfma_f32_16x16x32_bf16 v[120:123], a[212:215], v[228:231], v[120:123]
    s_waitcnt lgkmcnt(6)
    v_exp_f16_sdwa v33, v32 dst_sel:WORD_1 dst_unused:UNUSED_PRESERVE src0_sel:WORD_1
    v_exp_f16_sdwa v35, v34 dst_sel:WORD_1 dst_unused:UNUSED_PRESERVE src0_sel:WORD_1
    v_pk_add_f16 v32, v33, 1.0 op_sel_hi:[1,0]
    v_mfma_f32_16x16x32_bf16 a[0:3], a[192:195], v[64:67], a[0:3]
    ds_read_b64_tr_b16 a[208:209], v8 offset:1024
    ds_read_b64_tr_b16 a[210:211], v9 offset:1024
    v_pk_add_f16 v34, v35, 1.0 op_sel_hi:[1,0]
    v_mfma_f32_16x16x32_bf16 a[48:51], a[192:195], v[68:71], a[48:51]
    v_rcp_f16 v33, v32
    v_rcp_f16 v35, v34
    v_mfma_f32_16x16x32_bf16 a[96:99], a[192:195], v[72:75], a[96:99]
    s_waitcnt lgkmcnt(6)
    v_rcp_f16_sdwa v33, v32 dst_sel:WORD_1 dst_unused:UNUSED_PRESERVE src0_sel:WORD_1
    v_rcp_f16_sdwa v35, v34 dst_sel:WORD_1 dst_unused:UNUSED_PRESERVE src0_sel:WORD_1
    v_mfma_f32_16x16x32_bf16 a[4:7], a[196:199], v[64:67], a[4:7]
    ds_read_b64_tr_b16 a[212:213], v8 offset:1032
    ds_read_b64_tr_b16 a[214:215], v9 offset:1032
    v_fma_mix_f32 v32, v88, v33, 0 op_sel_hi:[0,1,0]
    v_fma_mix_f32 v34, v90, v35, 0 op_sel_hi:[0,1,0]
    v_mfma_f32_16x16x32_bf16 a[52:55], a[196:199], v[68:71], a[52:55]
    v_fma_mix_f32 v33, v89, v33, 0 op_sel:[0,1,0] op_sel_hi:[0,1,0]
    v_fma_mix_f32 v35, v91, v35, 0 op_sel:[0,1,0] op_sel_hi:[0,1,0]
    v_cvt_pk_bf16_f32 v58, v32, v33
    v_mfma_f32_16x16x32_bf16 a[100:103], a[196:199], v[72:75], a[100:103]
    s_waitcnt lgkmcnt(6)
    v_cvt_pk_bf16_f32 v59, v34, v35
    v_cvt_pk_f16_f32 v28, v92, v93
    v_cvt_pk_f16_f32 v30, v94, v95
    v_pk_fma_f16 v29, v28, v28, s32
    v_mfma_f32_16x16x32_bf16 a[8:11], a[200:203], v[64:67], a[8:11]
    ds_read_b64_tr_b16 a[192:193], v8 offset:1536
    ds_read_b64_tr_b16 a[194:195], v9 offset:1536
    v_pk_fma_f16 v31, v30, v30, s32
    v_pk_mul_f16 v28, v28, v29 neg_lo:[1,0] neg_hi:[1,0]
    v_mfma_f32_16x16x32_bf16 a[56:59], a[200:203], v[68:71], a[56:59]
    v_pk_mul_f16 v30, v30, v31 neg_lo:[1,0] neg_hi:[1,0]
    v_exp_f16 v29, v28
    v_mfma_f32_16x16x32_bf16 a[104:107], a[200:203], v[72:75], a[104:107]
    s_waitcnt lgkmcnt(6)
    v_exp_f16 v31, v30
    v_exp_f16_sdwa v29, v28 dst_sel:WORD_1 dst_unused:UNUSED_PRESERVE src0_sel:WORD_1
    v_mfma_f32_16x16x32_bf16 a[12:15], a[204:207], v[64:67], a[12:15]
    ds_read_b64_tr_b16 a[196:197], v8 offset:1544
    ds_read_b64_tr_b16 a[198:199], v9 offset:1544
    v_exp_f16_sdwa v31, v30 dst_sel:WORD_1 dst_unused:UNUSED_PRESERVE src0_sel:WORD_1
    v_mfma_f32_16x16x32_bf16 a[60:63], a[204:207], v[68:71], a[60:63]
    v_pk_add_f16 v28, v29, 1.0 op_sel_hi:[1,0]
    v_pk_add_f16 v30, v31, 1.0 op_sel_hi:[1,0]
    v_rcp_f16 v29, v28
    v_mfma_f32_16x16x32_bf16 a[108:111], a[204:207], v[72:75], a[108:111]
    s_waitcnt lgkmcnt(6)
    v_rcp_f16 v31, v30
    v_mfma_f32_16x16x32_bf16 a[16:19], a[208:211], v[64:67], a[16:19]
    ds_read_b64_tr_b16 a[200:201], v8 offset:2048
    ds_read_b64_tr_b16 a[202:203], v9 offset:2048
    v_rcp_f16_sdwa v29, v28 dst_sel:WORD_1 dst_unused:UNUSED_PRESERVE src0_sel:WORD_1
    v_mfma_f32_16x16x32_bf16 a[64:67], a[208:211], v[68:71], a[64:67]
    v_rcp_f16_sdwa v31, v30 dst_sel:WORD_1 dst_unused:UNUSED_PRESERVE src0_sel:WORD_1
    v_fma_mix_f32 v28, v92, v29, 0 op_sel_hi:[0,1,0]
    v_fma_mix_f32 v30, v94, v31, 0 op_sel_hi:[0,1,0]
    v_fma_mix_f32 v29, v93, v29, 0 op_sel:[0,1,0] op_sel_hi:[0,1,0]
    v_mfma_f32_16x16x32_bf16 a[112:115], a[208:211], v[72:75], a[112:115]
    s_waitcnt lgkmcnt(6)
    v_fma_mix_f32 v31, v95, v31, 0 op_sel:[0,1,0] op_sel_hi:[0,1,0]
    v_cvt_pk_bf16_f32 v60, v28, v29
    v_cvt_pk_bf16_f32 v61, v30, v31
    v_mfma_f32_16x16x32_bf16 a[20:23], a[212:215], v[64:67], a[20:23]
    ds_read_b64_tr_b16 a[204:205], v8 offset:2056
    ds_read_b64_tr_b16 a[206:207], v9 offset:2056
    v_cvt_pk_f16_f32 v32, v96, v97
    v_cvt_pk_f16_f32 v34, v98, v99
    v_mfma_f32_16x16x32_bf16 a[68:71], a[212:215], v[68:71], a[68:71]
    v_pk_fma_f16 v33, v32, v32, s32
    v_pk_fma_f16 v35, v34, v34, s32
    v_pk_mul_f16 v32, v32, v33 neg_lo:[1,0] neg_hi:[1,0]
    v_pk_mul_f16 v34, v34, v35 neg_lo:[1,0] neg_hi:[1,0]
    v_mfma_f32_16x16x32_bf16 a[116:119], a[212:215], v[72:75], a[116:119]
    s_waitcnt lgkmcnt(6)
    v_exp_f16 v33, v32
    v_exp_f16 v35, v34
    v_mfma_f32_16x16x32_bf16 a[24:27], a[192:195], v[64:67], a[24:27]
    ds_read_b64_tr_b16 a[208:209], v8 offset:2560
    ds_read_b64_tr_b16 a[210:211], v9 offset:2560
    v_mfma_f32_16x16x32_bf16 a[72:75], a[192:195], v[68:71], a[72:75]
    v_exp_f16_sdwa v33, v32 dst_sel:WORD_1 dst_unused:UNUSED_PRESERVE src0_sel:WORD_1
    v_exp_f16_sdwa v35, v34 dst_sel:WORD_1 dst_unused:UNUSED_PRESERVE src0_sel:WORD_1
    v_pk_add_f16 v32, v33, 1.0 op_sel_hi:[1,0]
    v_mfma_f32_16x16x32_bf16 a[120:123], a[192:195], v[72:75], a[120:123]
    s_waitcnt lgkmcnt(6)
    v_pk_add_f16 v34, v35, 1.0 op_sel_hi:[1,0]
    v_rcp_f16 v33, v32
    v_mfma_f32_16x16x32_bf16 a[28:31], a[196:199], v[64:67], a[28:31]
    ds_read_b64_tr_b16 a[212:213], v8 offset:2568
    ds_read_b64_tr_b16 a[214:215], v9 offset:2568
    v_add_u32 v8, s33, v8
    v_add_u32 v9, s33, v9
    v_mfma_f32_16x16x32_bf16 a[76:79], a[196:199], v[68:71], a[76:79]
    v_rcp_f16 v35, v34
    v_rcp_f16_sdwa v33, v32 dst_sel:WORD_1 dst_unused:UNUSED_PRESERVE src0_sel:WORD_1
    v_mfma_f32_16x16x32_bf16 a[124:127], a[196:199], v[72:75], a[124:127]
    s_waitcnt lgkmcnt(6)
    v_rcp_f16_sdwa v35, v34 dst_sel:WORD_1 dst_unused:UNUSED_PRESERVE src0_sel:WORD_1
    v_fma_mix_f32 v32, v96, v33, 0 op_sel_hi:[0,1,0]
    v_fma_mix_f32 v34, v98, v35, 0 op_sel_hi:[0,1,0]
    v_mfma_f32_16x16x32_bf16 a[32:35], a[200:203], v[64:67], a[32:35]
    ds_read_b128 v[20:23], v10
    ds_read_b64_tr_b16 a[192:193], v2 offset:0
    ds_read_b64_tr_b16 a[194:195], v2 offset:2048
    v_add_u32 v10, 0x100, v10
    v_mfma_f32_16x16x32_bf16 a[80:83], a[200:203], v[68:71], a[80:83]
    v_fma_mix_f32 v33, v97, v33, 0 op_sel:[0,1,0] op_sel_hi:[0,1,0]
    v_fma_mix_f32 v35, v99, v35, 0 op_sel:[0,1,0] op_sel_hi:[0,1,0]
    v_cvt_pk_bf16_f32 v62, v32, v33
    v_mfma_f32_16x16x32_bf16 a[128:131], a[200:203], v[72:75], a[128:131]
    s_waitcnt lgkmcnt(7)
    v_cvt_pk_bf16_f32 v63, v34, v35
    v_cvt_pk_f16_f32 v28, v44, v45
    v_cvt_pk_f16_f32 v30, v46, v47
    v_pk_fma_f16 v29, v28, v28, s32
    v_mfma_f32_16x16x32_bf16 a[36:39], a[204:207], v[64:67], a[36:39]
    ds_read_b64_tr_b16 a[196:197], v2 offset:4096
    ds_read_b64_tr_b16 a[198:199], v2 offset:6144
    v_pk_fma_f16 v31, v30, v30, s32
    v_mfma_f32_16x16x32_bf16 a[84:87], a[204:207], v[68:71], a[84:87]
    v_pk_mul_f16 v28, v28, v29 neg_lo:[1,0] neg_hi:[1,0]
    v_pk_mul_f16 v30, v30, v31 neg_lo:[1,0] neg_hi:[1,0]
    v_exp_f16 v29, v28
    v_mfma_f32_16x16x32_bf16 a[132:135], a[204:207], v[72:75], a[132:135]
    s_waitcnt lgkmcnt(7)
    v_exp_f16 v31, v30
    v_exp_f16_sdwa v29, v28 dst_sel:WORD_1 dst_unused:UNUSED_PRESERVE src0_sel:WORD_1
    v_mfma_f32_16x16x32_bf16 a[40:43], a[208:211], v[64:67], a[40:43]
    ds_read_b64_tr_b16 a[200:201], v2 offset:8192
    ds_read_b64_tr_b16 a[202:203], v2 offset:10240
    v_exp_f16_sdwa v31, v30 dst_sel:WORD_1 dst_unused:UNUSED_PRESERVE src0_sel:WORD_1
    v_mfma_f32_16x16x32_bf16 a[88:91], a[208:211], v[68:71], a[88:91]
    v_pk_add_f16 v28, v29, 1.0 op_sel_hi:[1,0]
    v_pk_add_f16 v30, v31, 1.0 op_sel_hi:[1,0]
    v_mfma_f32_16x16x32_bf16 a[136:139], a[208:211], v[72:75], a[136:139]
    s_waitcnt lgkmcnt(7)
    v_rcp_f16 v29, v28
    v_rcp_f16 v31, v30
    v_mfma_f32_16x16x32_bf16 a[44:47], a[212:215], v[64:67], a[44:47]
    ds_read_b64_tr_b16 a[204:205], v2 offset:12288
    ds_read_b64_tr_b16 a[206:207], v2 offset:14336
    v_rcp_f16_sdwa v29, v28 dst_sel:WORD_1 dst_unused:UNUSED_PRESERVE src0_sel:WORD_1
    v_mfma_f32_16x16x32_bf16 a[92:95], a[212:215], v[68:71], a[92:95]
    s_mov_b32 s33, s38
    v_rcp_f16_sdwa v31, v30 dst_sel:WORD_1 dst_unused:UNUSED_PRESERVE src0_sel:WORD_1
    v_fma_mix_f32 v28, v44, v29, 0 op_sel_hi:[0,1,0]
    v_fma_mix_f32 v30, v46, v31, 0 op_sel_hi:[0,1,0]
    v_mfma_f32_16x16x32_bf16 a[140:143], a[212:215], v[72:75], a[140:143]
    s_waitcnt lgkmcnt(6)
    v_fma_mix_f32 v29, v45, v29, 0 op_sel:[0,1,0] op_sel_hi:[0,1,0]
    v_fma_mix_f32 v31, v47, v31, 0 op_sel:[0,1,0] op_sel_hi:[0,1,0]
    v_cvt_pk_bf16_f32 v48, v28, v29
    v_cvt_pk_bf16_f32 v49, v30, v31
    s_waitcnt vmcnt(0)
    s_barrier
    s_cbranch_scc1 L_loop_b1
    v_mfma_f32_16x16x32_bf16 v[76:79], a[192:195], v[160:163], v[20:23]
    s_add_u32 m0, s46, 0
    ds_read_b64_tr_b16 a[208:209], v2 offset:16384
    ds_read_b64_tr_b16 a[210:211], v2 offset:18432
    v_cvt_pk_f16_f32 v28, v100, v101
    v_mfma_f32_16x16x32_bf16 v[84:87], a[192:195], v[184:187], v[20:23]
    s_add_u32 s47, s36, 0
    buffer_load_dwordx4 v15, s[16:19], s47 offen lds
    v_mfma_f32_16x16x32_bf16 v[92:95], a[192:195], v[208:211], v[20:23]
    v_cvt_pk_f16_f32 v30, v102, v103
    v_pk_fma_f16 v29, v28, v28, s32
    v_mfma_f32_16x16x32_bf16 v[44:47], a[192:195], v[232:235], v[20:23]
    s_waitcnt lgkmcnt(6)
    v_pk_fma_f16 v31, v30, v30, s32
    v_pk_mul_f16 v28, v28, v29 neg_lo:[1,0] neg_hi:[1,0]
    v_pk_mul_f16 v30, v30, v31 neg_lo:[1,0] neg_hi:[1,0]
    v_mfma_f32_16x16x32_bf16 v[76:79], a[196:199], v[164:167], v[76:79]
    s_add_u32 m0, s46, 1024
    ds_read_b64_tr_b16 a[212:213], v2 offset:20480
    ds_read_b64_tr_b16 a[214:215], v2 offset:22528
    v_add_u32 v2, s33, v2
    v_mfma_f32_16x16x32_bf16 v[84:87], a[196:199], v[188:191], v[84:87]
    s_add_u32 s47, s36, 128
    buffer_load_dwordx4 v15, s[16:19], s47 offen lds
    v_mfma_f32_16x16x32_bf16 v[92:95], a[196:199], v[212:215], v[92:95]
    v_exp_f16 v29, v28
    v_mfma_f32_16x16x32_bf16 v[44:47], a[196:199], v[236:239], v[44:47]
    s_waitcnt lgkmcnt(6)
    v_exp_f16 v31, v30
    v_mfma_f32_16x16x32_bf16 v[76:79], a[200:203], v[168:171], v[76:79]
    s_add_u32 m0, s46, 2048
    ds_read_b128 v[24:27], v11
    ds_read_b64_tr_b16 a[192:193], v3 offset:0
    ds_read_b64_tr_b16 a[194:195], v3 offset:2048
    v_add_u32 v11, 0x100, v11
    v_mfma_f32_16x16x32_bf16 v[84:87], a[200:203], v[192:195], v[84:87]
    s_add_u32 s47, s36, 256
    buffer_load_dwordx4 v15, s[16:19], s47 offen lds
    v_mfma_f32_16x16x32_bf16 v[92:95], a[200:203], v[216:219], v[92:95]
    v_exp_f16_sdwa v29, v28 dst_sel:WORD_1 dst_unused:UNUSED_PRESERVE src0_sel:WORD_1
    v_mfma_f32_16x16x32_bf16 v[44:47], a[200:203], v[240:243], v[44:47]
    s_waitcnt lgkmcnt(7)
    v_exp_f16_sdwa v31, v30 dst_sel:WORD_1 dst_unused:UNUSED_PRESERVE src0_sel:WORD_1
    v_mfma_f32_16x16x32_bf16 v[76:79], a[204:207], v[172:175], v[76:79]
    s_add_u32 m0, s46, 3080
    ds_read_b64_tr_b16 a[196:197], v3 offset:4096
    ds_read_b64_tr_b16 a[198:199], v3 offset:6144
    v_pk_add_f16 v28, v29, 1.0 op_sel_hi:[1,0]
    v_mfma_f32_16x16x32_bf16 v[84:87], a[204:207], v[196:199], v[84:87]
    s_add_u32 s47, s36, 1536
    buffer_load_dwordx4 v15, s[16:19], s47 offen lds
    v_mfma_f32_16x16x32_bf16 v[92:95], a[204:207], v[220:223], v[92:95]
    v_pk_add_f16 v30, v31, 1.0 op_sel_hi:[1,0]
    v_rcp_f16 v29, v28
    v_mfma_f32_16x16x32_bf16 v[44:47], a[204:207], v[244:247], v[44:47]
    s_waitcnt lgkmcnt(7)
    v_rcp_f16 v31, v30
    v_mfma_f32_16x16x32_bf16 v[76:79], a[208:211], v[176:179], v[76:79]
    s_add_u32 m0, s46, 4104
    ds_read_b64_tr_b16 a[200:201], v3 offset:8192
    ds_read_b64_tr_b16 a[202:203], v3 offset:10240
    v_mfma_f32_16x16x32_bf16 v[84:87], a[208:211], v[200:203], v[84:87]
    s_add_u32 s47, s36, 1664
    buffer_load_dwordx4 v15, s[16:19], s47 offen lds
    v_mfma_f32_16x16x32_bf16 v[92:95], a[208:211], v[224:227], v[92:95]
    v_rcp_f16_sdwa v29, v28 dst_sel:WORD_1 dst_unused:UNUSED_PRESERVE src0_sel:WORD_1
    v_mfma_f32_16x16x32_bf16 v[44:47], a[208:211], v[248:251], v[44:47]
    s_waitcnt lgkmcnt(7)
    v_rcp_f16_sdwa v31, v30 dst_sel:WORD_1 dst_unused:UNUSED_PRESERVE src0_sel:WORD_1
    v_fma_mix_f32 v28, v100, v29, 0 op_sel_hi:[0,1,0]
    v_fma_mix_f32 v30, v102, v31, 0 op_sel_hi:[0,1,0]
    v_mfma_f32_16x16x32_bf16 v[76:79], a[212:215], v[180:183], v[76:79]
    s_add_u32 m0, s46, 5128
    ds_read_b64_tr_b16 a[204:205], v3 offset:12288
    ds_read_b64_tr_b16 a[206:207], v3 offset:14336
    v_mfma_f32_16x16x32_bf16 v[84:87], a[212:215], v[204:207], v[84:87]
    s_add_u32 s47, s36, 1792
    buffer_load_dwordx4 v15, s[16:19], s47 offen lds
    v_mfma_f32_16x16x32_bf16 v[92:95], a[212:215], v[228:231], v[92:95]
    v_fma_mix_f32 v29, v101, v29, 0 op_sel:[0,1,0] op_sel_hi:[0,1,0]
    v_fma_mix_f32 v31, v103, v31, 0 op_sel:[0,1,0] op_sel_hi:[0,1,0]
    v_cvt_pk_bf16_f32 v64, v28, v29
    v_mfma_f32_16x16x32_bf16 v[44:47], a[212:215], v[252:255], v[44:47]
    s_waitcnt lgkmcnt(6)
    v_cvt_pk_bf16_f32 v65, v30, v31
    v_cvt_pk_f16_f32 v32, v104, v105
    v_cvt_pk_f16_f32 v34, v106, v107
    v_mfma_f32_16x16x32_bf16 v[80:83], a[192:195], v[160:163], v[24:27]
    ds_read_b64_tr_b16 a[208:209], v3 offset:16384
    ds_read_b64_tr_b16 a[210:211], v3 offset:18432
    v_mfma_f32_16x16x32_bf16 v[88:91], a[192:195], v[184:187], v[24:27]
    v_pk_fma_f16 v33, v32, v32, s32
    v_pk_fma_f16 v35, v34, v34, s32
    v_pk_mul_f16 v32, v32, v33 neg_lo:[1,0] neg_hi:[1,0]
    v_mfma_f32_16x16x32_bf16 v[96:99], a[192:195], v[208:211], v[24:27]
    s_waitcnt lgkmcnt(6)
    v_pk_mul_f16 v34, v34, v35 neg_lo:[1,0] neg_hi:[1,0]
    v_exp_f16 v33, v32
    v_mfma_f32_16x16x32_bf16 v[80:83], a[196:199], v[164:167], v[80:83]
    ds_read_b64_tr_b16 a[212:213], v3 offset:20480
    ds_read_b64_tr_b16 a[214:215], v3 offset:22528
    v_add_u32 v3, s33, v3
    v_mfma_f32_16x16x32_bf16 v[88:91], a[196:199], v[188:191], v[88:91]
    v_exp_f16 v35, v34
    v_mfma_f32_16x16x32_bf16 v[96:99], a[196:199], v[212:215], v[96:99]
    s_waitcnt lgkmcnt(6)
    v_exp_f16_sdwa v33, v32 dst_sel:WORD_1 dst_unused:UNUSED_PRESERVE src0_sel:WORD_1
    v_mfma_f32_16x16x32_bf16 v[80:83], a[200:203], v[168:171], v[80:83]
    ds_read_b64_tr_b16 a[192:193], v6 offset:0
    ds_read_b64_tr_b16 a[194:195], v7 offset:0
    v_mfma_f32_16x16x32_bf16 v[88:91], a[200:203], v[192:195], v[88:91]
    v_exp_f16_sdwa v35, v34 dst_sel:WORD_1 dst_unused:UNUSED_PRESERVE src0_sel:WORD_1
    v_pk_add_f16 v32, v33, 1.0 op_sel_hi:[1,0]
    v_pk_add_f16 v34, v35, 1.0 op_sel_hi:[1,0]
    v_mfma_f32_16x16x32_bf16 v[96:99], a[200:203], v[216:219], v[96:99]
    s_waitcnt lgkmcnt(6)
    v_rcp_f16 v33, v32
    v_mfma_f32_16x16x32_bf16 v[80:83], a[204:207], v[172:175], v[80:83]
    ds_read_b64_tr_b16 a[196:197], v6 offset:8
    ds_read_b64_tr_b16 a[198:199], v7 offset:8
    v_mfma_f32_16x16x32_bf16 v[88:91], a[204:207], v[196:199], v[88:91]
    v_rcp_f16 v35, v34
    v_rcp_f16_sdwa v33, v32 dst_sel:WORD_1 dst_unused:UNUSED_PRESERVE src0_sel:WORD_1
    v_mfma_f32_16x16x32_bf16 v[96:99], a[204:207], v[220:223], v[96:99]
    s_waitcnt lgkmcnt(6)
    v_rcp_f16_sdwa v35, v34 dst_sel:WORD_1 dst_unused:UNUSED_PRESERVE src0_sel:WORD_1
    v_fma_mix_f32 v32, v104, v33, 0 op_sel_hi:[0,1,0]
    v_mfma_f32_16x16x32_bf16 v[80:83], a[208:211], v[176:179], v[80:83]
    ds_read_b64_tr_b16 a[200:201], v6 offset:512
    ds_read_b64_tr_b16 a[202:203], v7 offset:512
    v_mfma_f32_16x16x32_bf16 v[88:91], a[208:211], v[200:203], v[88:91]
    v_fma_mix_f32 v34, v106, v35, 0 op_sel_hi:[0,1,0]
    v_fma_mix_f32 v33, v105, v33, 0 op_sel:[0,1,0] op_sel_hi:[0,1,0]
    v_fma_mix_f32 v35, v107, v35, 0 op_sel:[0,1,0] op_sel_hi:[0,1,0]
    v_mfma_f32_16x16x32_bf16 v[96:99], a[208:211], v[224:227], v[96:99]
    s_waitcnt lgkmcnt(6)
    v_cvt_pk_bf16_f32 v66, v32, v33
    v_cvt_pk_bf16_f32 v67, v34, v35
    v_cvt_pk_f16_f32 v28, v108, v109
    v_mfma_f32_16x16x32_bf16 v[80:83], a[212:215], v[180:183], v[80:83]
    ds_read_b64_tr_b16 a[204:205], v6 offset:520
    ds_read_b64_tr_b16 a[206:207], v7 offset:520
    v_cvt_pk_f16_f32 v30, v110, v111
    v_mfma_f32_16x16x32_bf16 v[88:91], a[212:215], v[204:207], v[88:91]
    v_pk_fma_f16 v29, v28, v28, s32
    v_pk_fma_f16 v31, v30, v30, s32
    v_mfma_f32_16x16x32_bf16 v[96:99], a[212:215], v[228:231], v[96:99]
    s_waitcnt lgkmcnt(6)
    v_pk_mul_f16 v28, v28, v29 neg_lo:[1,0] neg_hi:[1,0]
    v_pk_mul_f16 v30, v30, v31 neg_lo:[1,0] neg_hi:[1,0]
    v_mfma_f32_16x16x32_bf16 a[0:3], a[192:195], v[52:55], a[0:3]
    ds_read_b64_tr_b16 a[208:209], v6 offset:1024
    ds_read_b64_tr_b16 a[210:211], v7 offset:1024
    v_exp_f16 v29, v28
    v_mfma_f32_16x16x32_bf16 a[48:51], a[192:195], v[56:59], a[48:51]
    v_exp_f16 v31, v30
    v_exp_f16_sdwa v29, v28 dst_sel:WORD_1 dst_unused:UNUSED_PRESERVE src0_sel:WORD_1
    v_mfma_f32_16x16x16_bf16 a[144:147], a[192:193], v[48:49], a[144:147]
    v_exp_f16_sdwa v31, v30 dst_sel:WORD_1 dst_unused:UNUSED_PRESERVE src0_sel:WORD_1
    v_pk_add_f16 v28, v29, 1.0 op_sel_hi:[1,0]
    v_pk_add_f16 v30, v31, 1.0 op_sel_hi:[1,0]
    v_mfma_f32_16x16x32_bf16 a[96:99], a[192:195], v[60:63], a[96:99]
    s_waitcnt lgkmcnt(6)
    v_rcp_f16 v29, v28
    v_mfma_f32_16x16x32_bf16 a[4:7], a[196:199], v[52:55], a[4:7]
    ds_read_b64_tr_b16 a[212:213], v6 offset:1032
    ds_read_b64_tr_b16 a[214:215], v7 offset:1032
    v_mfma_f32_16x16x32_bf16 a[52:55], a[196:199], v[56:59], a[52:55]
    v_rcp_f16 v31, v30
    v_rcp_f16_sdwa v29, v28 dst_sel:WORD_1 dst_unused:UNUSED_PRESERVE src0_sel:WORD_1
    v_mfma_f32_16x16x16_bf16 a[148:151], a[196:197], v[48:49], a[148:151]
    v_rcp_f16_sdwa v31, v30 dst_sel:WORD_1 dst_unused:UNUSED_PRESERVE src0_sel:WORD_1
    v_fma_mix_f32 v28, v108, v29, 0 op_sel_hi:[0,1,0]
    v_fma_mix_f32 v30, v110, v31, 0 op_sel_hi:[0,1,0]
    v_mfma_f32_16x16x32_bf16 a[100:103], a[196:199], v[60:63], a[100:103]
    s_waitcnt lgkmcnt(6)
    v_fma_mix_f32 v29, v109, v29, 0 op_sel:[0,1,0] op_sel_hi:[0,1,0]
    v_fma_mix_f32 v31, v111, v31, 0 op_sel:[0,1,0] op_sel_hi:[0,1,0]
    v_mfma_f32_16x16x32_bf16 a[8:11], a[200:203], v[52:55], a[8:11]
    ds_read_b64_tr_b16 a[192:193], v6 offset:1536
    ds_read_b64_tr_b16 a[194:195], v7 offset:1536
    v_mfma_f32_16x16x32_bf16 a[56:59], a[200:203], v[56:59], a[56:59]
    v_cvt_pk_bf16_f32 v68, v28, v29
    v_cvt_pk_bf16_f32 v69, v30, v31
    v_cvt_pk_f16_f32 v32, v112, v113
    v_mfma_f32_16x16x16_bf16 a[152:155], a[200:201], v[48:49], a[152:155]
    v_cvt_pk_f16_f32 v34, v114, v115
    v_pk_fma_f16 v33, v32, v32, s32
    v_pk_fma_f16 v35, v34, v34, s32
    v_pk_mul_f16 v32, v32, v33 neg_lo:[1,0] neg_hi:[1,0]
    v_mfma_f32_16x16x32_bf16 a[104:107], a[200:203], v[60:63], a[104:107]
    s_waitcnt lgkmcnt(6)
    v_pk_mul_f16 v34, v34, v35 neg_lo:[1,0] neg_hi:[1,0]
    v_exp_f16 v33, v32
    v_mfma_f32_16x16x32_bf16 a[12:15], a[204:207], v[52:55], a[12:15]
    ds_read_b64_tr_b16 a[196:197], v6 offset:1544
    ds_read_b64_tr_b16 a[198:199], v7 offset:1544
    v_mfma_f32_16x16x32_bf16 a[60:63], a[204:207], v[56:59], a[60:63]
    v_exp_f16 v35, v34
    v_exp_f16_sdwa v33, v32 dst_sel:WORD_1 dst_unused:UNUSED_PRESERVE src0_sel:WORD_1
    v_mfma_f32_16x16x16_bf16 a[156:159], a[204:205], v[48:49], a[156:159]
    v_exp_f16_sdwa v35, v34 dst_sel:WORD_1 dst_unused:UNUSED_PRESERVE src0_sel:WORD_1
    v_pk_add_f16 v32, v33, 1.0 op_sel_hi:[1,0]
    v_pk_add_f16 v34, v35, 1.0 op_sel_hi:[1,0]
    v_mfma_f32_16x16x32_bf16 a[108:111], a[204:207], v[60:63], a[108:111]
    s_waitcnt lgkmcnt(6)
    v_rcp_f16 v33, v32
    v_mfma_f32_16x16x32_bf16 a[16:19], a[208:211], v[52:55], a[16:19]
    ds_read_b64_tr_b16 a[200:201], v6 offset:2048
    ds_read_b64_tr_b16 a[202:203], v7 offset:2048
    v_mfma_f32_16x16x32_bf16 a[64:67], a[208:211], v[56:59], a[64:67]
    v_rcp_f16 v35, v34
    v_rcp_f16_sdwa v33, v32 dst_sel:WORD_1 dst_unused:UNUSED_PRESERVE src0_sel:WORD_1
    v_mfma_f32_16x16x16_bf16 a[160:163], a[208:209], v[48:49], a[160:163]
    v_rcp_f16_sdwa v35, v34 dst_sel:WORD_1 dst_unused:UNUSED_PRESERVE src0_sel:WORD_1
    v_fma_mix_f32 v32, v112, v33, 0 op_sel_hi:[0,1,0]
    v_fma_mix_f32 v34, v114, v35, 0 op_sel_hi:[0,1,0]
    v_mfma_f32_16x16x32_bf16 a[112:115], a[208:211], v[60:63], a[112:115]
    s_waitcnt lgkmcnt(6)
    v_fma_mix_f32 v33, v113, v33, 0 op_sel:[0,1,0] op_sel_hi:[0,1,0]
    v_fma_mix_f32 v35, v115, v35, 0 op_sel:[0,1,0] op_sel_hi:[0,1,0]
    v_mfma_f32_16x16x32_bf16 a[20:23], a[212:215], v[52:55], a[20:23]
    ds_read_b64_tr_b16 a[204:205], v6 offset:2056
    ds_read_b64_tr_b16 a[206:207], v7 offset:2056
    v_mfma_f32_16x16x32_bf16 a[68:71], a[212:215], v[56:59], a[68:71]
    v_cvt_pk_bf16_f32 v70, v32, v33
    v_cvt_pk_bf16_f32 v71, v34, v35
    v_cvt_pk_f16_f32 v28, v116, v117
    v_mfma_f32_16x16x16_bf16 a[164:167], a[212:213], v[48:49], a[164:167]
    v_cvt_pk_f16_f32 v30, v118, v119
    v_pk_fma_f16 v29, v28, v28, s32
    v_pk_fma_f16 v31, v30, v30, s32
    v_pk_mul_f16 v28, v28, v29 neg_lo:[1,0] neg_hi:[1,0]
    v_mfma_f32_16x16x32_bf16 a[116:119], a[212:215], v[60:63], a[116:119]
    s_waitcnt lgkmcnt(6)
    v_pk_mul_f16 v30, v30, v31 neg_lo:[1,0] neg_hi:[1,0]
    v_exp_f16 v29, v28
    v_mfma_f32_16x16x32_bf16 a[24:27], a[192:195], v[52:55], a[24:27]
    ds_read_b64_tr_b16 a[208:209], v6 offset:2560
    ds_read_b64_tr_b16 a[210:211], v7 offset:2560
    v_mfma_f32_16x16x32_bf16 a[72:75], a[192:195], v[56:59], a[72:75]
    v_exp_f16 v31, v30
    v_exp_f16_sdwa v29, v28 dst_sel:WORD_1 dst_unused:UNUSED_PRESERVE src0_sel:WORD_1
    v_mfma_f32_16x16x16_bf16 a[168:171], a[192:193], v[48:49], a[168:171]
    v_exp_f16_sdwa v31, v30 dst_sel:WORD_1 dst_unused:UNUSED_PRESERVE src0_sel:WORD_1
    v_pk_add_f16 v28, v29, 1.0 op_sel_hi:[1,0]
    v_pk_add_f16 v30, v31, 1.0 op_sel_hi:[1,0]
    v_mfma_f32_16x16x32_bf16 a[120:123], a[192:195], v[60:63], a[120:123]
    s_waitcnt lgkmcnt(6)
    v_rcp_f16 v29, v28
    v_mfma_f32_16x16x32_bf16 a[28:31], a[196:199], v[52:55], a[28:31]
    ds_read_b64_tr_b16 a[212:213], v6 offset:2568
    ds_read_b64_tr_b16 a[214:215], v7 offset:2568
    v_add_u32 v6, s33, v6
    v_add_u32 v7, s33, v7
    v_mfma_f32_16x16x32_bf16 a[76:79], a[196:199], v[56:59], a[76:79]
    v_rcp_f16 v31, v30
    v_rcp_f16_sdwa v29, v28 dst_sel:WORD_1 dst_unused:UNUSED_PRESERVE src0_sel:WORD_1
    v_mfma_f32_16x16x16_bf16 a[172:175], a[196:197], v[48:49], a[172:175]
    v_rcp_f16_sdwa v31, v30 dst_sel:WORD_1 dst_unused:UNUSED_PRESERVE src0_sel:WORD_1
    v_fma_mix_f32 v28, v116, v29, 0 op_sel_hi:[0,1,0]
    v_fma_mix_f32 v30, v118, v31, 0 op_sel_hi:[0,1,0]
    v_mfma_f32_16x16x32_bf16 a[124:127], a[196:199], v[60:63], a[124:127]
    s_waitcnt lgkmcnt(6)
    v_fma_mix_f32 v29, v117, v29, 0 op_sel:[0,1,0] op_sel_hi:[0,1,0]
    v_fma_mix_f32 v31, v119, v31, 0 op_sel:[0,1,0] op_sel_hi:[0,1,0]
    v_mfma_f32_16x16x32_bf16 a[32:35], a[200:203], v[52:55], a[32:35]
    ds_read_b128 v[20:23], v12
    ds_read_b64_tr_b16 a[192:193], v4 offset:0
    ds_read_b64_tr_b16 a[194:195], v4 offset:2048
    v_add_u32 v12, 0x100, v12
    v_mfma_f32_16x16x32_bf16 a[80:83], a[200:203], v[56:59], a[80:83]
    v_cvt_pk_bf16_f32 v72, v28, v29
    v_cvt_pk_bf16_f32 v73, v30, v31
    v_cvt_pk_f16_f32 v32, v120, v121
    v_mfma_f32_16x16x16_bf16 a[176:179], a[200:201], v[48:49], a[176:179]
    v_cvt_pk_f16_f32 v34, v122, v123
    v_pk_fma_f16 v33, v32, v32, s32
    v_pk_fma_f16 v35, v34, v34, s32
    v_pk_mul_f16 v32, v32, v33 neg_lo:[1,0] neg_hi:[1,0]
    v_mfma_f32_16x16x32_bf16 a[128:131], a[200:203], v[60:63], a[128:131]
    s_waitcnt lgkmcnt(7)
    v_pk_mul_f16 v34, v34, v35 neg_lo:[1,0] neg_hi:[1,0]
    v_exp_f16 v33, v32
    v_mfma_f32_16x16x32_bf16 a[36:39], a[204:207], v[52:55], a[36:39]
    ds_read_b64_tr_b16 a[196:197], v4 offset:4096
    ds_read_b64_tr_b16 a[198:199], v4 offset:6144
    v_mfma_f32_16x16x32_bf16 a[84:87], a[204:207], v[56:59], a[84:87]
    v_exp_f16 v35, v34
    v_exp_f16_sdwa v33, v32 dst_sel:WORD_1 dst_unused:UNUSED_PRESERVE src0_sel:WORD_1
    v_mfma_f32_16x16x16_bf16 a[180:183], a[204:205], v[48:49], a[180:183]
    v_exp_f16_sdwa v35, v34 dst_sel:WORD_1 dst_unused:UNUSED_PRESERVE src0_sel:WORD_1
    v_pk_add_f16 v32, v33, 1.0 op_sel_hi:[1,0]
    v_pk_add_f16 v34, v35, 1.0 op_sel_hi:[1,0]
    v_mfma_f32_16x16x32_bf16 a[132:135], a[204:207], v[60:63], a[132:135]
    s_waitcnt lgkmcnt(7)
    v_rcp_f16 v33, v32
    v_mfma_f32_16x16x32_bf16 a[40:43], a[208:211], v[52:55], a[40:43]
    ds_read_b64_tr_b16 a[200:201], v4 offset:8192
    ds_read_b64_tr_b16 a[202:203], v4 offset:10240
    v_mfma_f32_16x16x32_bf16 a[88:91], a[208:211], v[56:59], a[88:91]
    v_rcp_f16 v35, v34
    v_rcp_f16_sdwa v33, v32 dst_sel:WORD_1 dst_unused:UNUSED_PRESERVE src0_sel:WORD_1
    v_mfma_f32_16x16x16_bf16 a[184:187], a[208:209], v[48:49], a[184:187]
    v_rcp_f16_sdwa v35, v34 dst_sel:WORD_1 dst_unused:UNUSED_PRESERVE src0_sel:WORD_1
    v_fma_mix_f32 v32, v120, v33, 0 op_sel_hi:[0,1,0]
    v_fma_mix_f32 v34, v122, v35, 0 op_sel_hi:[0,1,0]
    v_mfma_f32_16x16x32_bf16 a[136:139], a[208:211], v[60:63], a[136:139]
    s_waitcnt lgkmcnt(7)
    v_fma_mix_f32 v33, v121, v33, 0 op_sel:[0,1,0] op_sel_hi:[0,1,0]
    v_fma_mix_f32 v35, v123, v35, 0 op_sel:[0,1,0] op_sel_hi:[0,1,0]
    v_mfma_f32_16x16x32_bf16 a[44:47], a[212:215], v[52:55], a[44:47]
    ds_read_b64_tr_b16 a[204:205], v4 offset:12288
    ds_read_b64_tr_b16 a[206:207], v4 offset:14336
    v_mfma_f32_16x16x32_bf16 a[92:95], a[212:215], v[56:59], a[92:95]
    v_cvt_pk_bf16_f32 v74, v32, v33
    v_cvt_pk_bf16_f32 v75, v34, v35
    v_mfma_f32_16x16x16_bf16 a[188:191], a[212:213], v[48:49], a[188:191]
    v_mfma_f32_16x16x32_bf16 a[140:143], a[212:215], v[60:63], a[140:143]
    s_waitcnt lgkmcnt(6)
    v_mfma_f32_16x16x32_bf16 v[100:103], a[192:195], v[160:163], v[20:23]
    s_add_u32 s45, s45, s49
    ds_read_b64_tr_b16 a[208:209], v4 offset:16384
    ds_read_b64_tr_b16 a[210:211], v4 offset:18432
    v_cvt_pk_f16_f32 v28, v76, v77
    v_cvt_pk_f16_f32 v30, v78, v79
    v_mfma_f32_16x16x32_bf16 v[108:111], a[192:195], v[184:187], v[20:23]
    v_pk_fma_f16 v29, v28, v28, s32
    v_pk_fma_f16 v31, v30, v30, s32
    v_pk_mul_f16 v28, v28, v29 neg_lo:[1,0] neg_hi:[1,0]
    v_mfma_f32_16x16x32_bf16 v[116:119], a[192:195], v[208:211], v[20:23]
    s_waitcnt lgkmcnt(6)
    v_pk_mul_f16 v30, v30, v31 neg_lo:[1,0] neg_hi:[1,0]
    v_exp_f16 v29, v28
    v_mfma_f32_16x16x32_bf16 v[100:103], a[196:199], v[164:167], v[100:103]
    s_add_u32 s46, s46, s49
    ds_read_b64_tr_b16 a[212:213], v4 offset:20480
    ds_read_b64_tr_b16 a[214:215], v4 offset:22528
    v_add_u32 v4, s33, v4
    v_exp_f16 v31, v30
    v_mfma_f32_16x16x32_bf16 v[108:111], a[196:199], v[188:191], v[108:111]
    v_exp_f16_sdwa v29, v28 dst_sel:WORD_1 dst_unused:UNUSED_PRESERVE src0_sel:WORD_1
    v_mfma_f32_16x16x32_bf16 v[116:119], a[196:199], v[212:215], v[116:119]
    s_waitcnt lgkmcnt(6)
    v_exp_f16_sdwa v31, v30 dst_sel:WORD_1 dst_unused:UNUSED_PRESERVE src0_sel:WORD_1
    v_pk_add_f16 v28, v29, 1.0 op_sel_hi:[1,0]
    v_pk_add_f16 v30, v31, 1.0 op_sel_hi:[1,0]
    v_mfma_f32_16x16x32_bf16 v[100:103], a[200:203], v[168:171], v[100:103]
    s_add_u32 s35, s35, 128
    ds_read_b128 v[24:27], v13
    ds_read_b64_tr_b16 a[192:193], v5 offset:0
    ds_read_b64_tr_b16 a[194:195], v5 offset:2048
    v_add_u32 v13, 0x100, v13
    v_mfma_f32_16x16x32_bf16 v[108:111], a[200:203], v[192:195], v[108:111]
    v_rcp_f16 v29, v28
    v_rcp_f16 v31, v30
    v_mfma_f32_16x16x32_bf16 v[116:119], a[200:203], v[216:219], v[116:119]
    s_waitcnt lgkmcnt(7)
    v_rcp_f16_sdwa v29, v28 dst_sel:WORD_1 dst_unused:UNUSED_PRESERVE src0_sel:WORD_1
    v_rcp_f16_sdwa v31, v30 dst_sel:WORD_1 dst_unused:UNUSED_PRESERVE src0_sel:WORD_1
    v_mfma_f32_16x16x32_bf16 v[100:103], a[204:207], v[172:175], v[100:103]
    s_add_u32 s36, s36, 24576
    ds_read_b64_tr_b16 a[196:197], v5 offset:4096
    ds_read_b64_tr_b16 a[198:199], v5 offset:6144
    v_fma_mix_f32 v28, v76, v29, 0 op_sel_hi:[0,1,0]
    v_fma_mix_f32 v30, v78, v31, 0 op_sel_hi:[0,1,0]
    v_mfma_f32_16x16x32_bf16 v[108:111], a[204:207], v[196:199], v[108:111]
    v_fma_mix_f32 v29, v77, v29, 0 op_sel:[0,1,0] op_sel_hi:[0,1,0]
    v_fma_mix_f32 v31, v79, v31, 0 op_sel:[0,1,0] op_sel_hi:[0,1,0]
    v_cvt_pk_bf16_f32 v52, v28, v29
    v_mfma_f32_16x16x32_bf16 v[116:119], a[204:207], v[220:223], v[116:119]
    s_waitcnt lgkmcnt(7)
    v_cvt_pk_bf16_f32 v53, v30, v31
    v_cvt_pk_f16_f32 v32, v80, v81
    v_cvt_pk_f16_f32 v34, v82, v83
    v_pk_fma_f16 v33, v32, v32, s32
    v_mfma_f32_16x16x32_bf16 v[100:103], a[208:211], v[176:179], v[100:103]
    s_mov_b32 s38, s48
    ds_read_b64_tr_b16 a[200:201], v5 offset:8192
    ds_read_b64_tr_b16 a[202:203], v5 offset:10240
    v_pk_fma_f16 v35, v34, v34, s32
    v_pk_mul_f16 v32, v32, v33 neg_lo:[1,0] neg_hi:[1,0]
    v_mfma_f32_16x16x32_bf16 v[108:111], a[208:211], v[200:203], v[108:111]
    v_pk_mul_f16 v34, v34, v35 neg_lo:[1,0] neg_hi:[1,0]
    v_exp_f16 v33, v32
    v_mfma_f32_16x16x32_bf16 v[116:119], a[208:211], v[224:227], v[116:119]
    s_waitcnt lgkmcnt(7)
    v_exp_f16 v35, v34
    v_exp_f16_sdwa v33, v32 dst_sel:WORD_1 dst_unused:UNUSED_PRESERVE src0_sel:WORD_1
    v_mfma_f32_16x16x32_bf16 v[100:103], a[212:215], v[180:183], v[100:103]
    s_mov_b32 s48, s49
    ds_read_b64_tr_b16 a[204:205], v5 offset:12288
    ds_read_b64_tr_b16 a[206:207], v5 offset:14336
    v_exp_f16_sdwa v35, v34 dst_sel:WORD_1 dst_unused:UNUSED_PRESERVE src0_sel:WORD_1
    v_mfma_f32_16x16x32_bf16 v[108:111], a[212:215], v[204:207], v[108:111]
    v_pk_add_f16 v32, v33, 1.0 op_sel_hi:[1,0]
    v_pk_add_f16 v34, v35, 1.0 op_sel_hi:[1,0]
    v_rcp_f16 v33, v32
    v_mfma_f32_16x16x32_bf16 v[116:119], a[212:215], v[228:231], v[116:119]
    s_waitcnt lgkmcnt(6)
    v_rcp_f16 v35, v34
    v_mfma_f32_16x16x32_bf16 v[104:107], a[192:195], v[160:163], v[24:27]
    s_mov_b32 s49, s33
    ds_read_b64_tr_b16 a[208:209], v5 offset:16384
    ds_read_b64_tr_b16 a[210:211], v5 offset:18432
    v_rcp_f16_sdwa v33, v32 dst_sel:WORD_1 dst_unused:UNUSED_PRESERVE src0_sel:WORD_1
    v_mfma_f32_16x16x32_bf16 v[112:115], a[192:195], v[184:187], v[24:27]
    v_rcp_f16_sdwa v35, v34 dst_sel:WORD_1 dst_unused:UNUSED_PRESERVE src0_sel:WORD_1
    v_fma_mix_f32 v32, v80, v33, 0 op_sel_hi:[0,1,0]
    v_fma_mix_f32 v34, v82, v35, 0 op_sel_hi:[0,1,0]
    v_fma_mix_f32 v33, v81, v33, 0 op_sel:[0,1,0] op_sel_hi:[0,1,0]
    v_mfma_f32_16x16x32_bf16 v[120:123], a[192:195], v[208:211], v[24:27]
    s_waitcnt lgkmcnt(6)
    v_fma_mix_f32 v35, v83, v35, 0 op_sel:[0,1,0] op_sel_hi:[0,1,0]
    v_cvt_pk_bf16_f32 v54, v32, v33
    v_cvt_pk_bf16_f32 v55, v34, v35
    v_mfma_f32_16x16x32_bf16 v[104:107], a[196:199], v[164:167], v[104:107]
    s_sub_u32 s37, s37, 1
    ds_read_b64_tr_b16 a[212:213], v5 offset:20480
    ds_read_b64_tr_b16 a[214:215], v5 offset:22528
    v_add_u32 v5, s33, v5
    v_cvt_pk_f16_f32 v28, v84, v85
    v_mfma_f32_16x16x32_bf16 v[112:115], a[196:199], v[188:191], v[112:115]
    v_cvt_pk_f16_f32 v30, v86, v87
    v_pk_fma_f16 v29, v28, v28, s32
    v_pk_fma_f16 v31, v30, v30, s32
    v_pk_mul_f16 v28, v28, v29 neg_lo:[1,0] neg_hi:[1,0]
    v_mfma_f32_16x16x32_bf16 v[120:123], a[196:199], v[212:215], v[120:123]
    s_waitcnt lgkmcnt(6)
    v_pk_mul_f16 v30, v30, v31 neg_lo:[1,0] neg_hi:[1,0]
    v_exp_f16 v29, v28
    v_mfma_f32_16x16x32_bf16 v[104:107], a[200:203], v[168:171], v[104:107]
    s_cmp_lg_u32 s37, 0
    ds_read_b64_tr_b16 a[192:193], v8 offset:0
    ds_read_b64_tr_b16 a[194:195], v9 offset:0
    v_exp_f16 v31, v30
    v_mfma_f32_16x16x32_bf16 v[112:115], a[200:203], v[192:195], v[112:115]
    v_exp_f16_sdwa v29, v28 dst_sel:WORD_1 dst_unused:UNUSED_PRESERVE src0_sel:WORD_1
    v_exp_f16_sdwa v31, v30 dst_sel:WORD_1 dst_unused:UNUSED_PRESERVE src0_sel:WORD_1
    v_mfma_f32_16x16x32_bf16 v[120:123], a[200:203], v[216:219], v[120:123]
    s_waitcnt lgkmcnt(6)
    v_pk_add_f16 v28, v29, 1.0 op_sel_hi:[1,0]
    v_pk_add_f16 v30, v31, 1.0 op_sel_hi:[1,0]
    v_mfma_f32_16x16x32_bf16 v[104:107], a[204:207], v[172:175], v[104:107]
    ds_read_b64_tr_b16 a[196:197], v8 offset:8
    ds_read_b64_tr_b16 a[198:199], v9 offset:8
    v_rcp_f16 v29, v28
    v_mfma_f32_16x16x32_bf16 v[112:115], a[204:207], v[196:199], v[112:115]
    v_rcp_f16 v31, v30
    v_rcp_f16_sdwa v29, v28 dst_sel:WORD_1 dst_unused:UNUSED_PRESERVE src0_sel:WORD_1
    v_mfma_f32_16x16x32_bf16 v[120:123], a[204:207], v[220:223], v[120:123]
    s_waitcnt lgkmcnt(6)
    v_rcp_f16_sdwa v31, v30 dst_sel:WORD_1 dst_unused:UNUSED_PRESERVE src0_sel:WORD_1
    v_fma_mix_f32 v28, v84, v29, 0 op_sel_hi:[0,1,0]
    v_fma_mix_f32 v30, v86, v31, 0 op_sel_hi:[0,1,0]
    v_mfma_f32_16x16x32_bf16 v[104:107], a[208:211], v[176:179], v[104:107]
    ds_read_b64_tr_b16 a[200:201], v8 offset:512
    ds_read_b64_tr_b16 a[202:203], v9 offset:512
    v_fma_mix_f32 v29, v85, v29, 0 op_sel:[0,1,0] op_sel_hi:[0,1,0]
    v_fma_mix_f32 v31, v87, v31, 0 op_sel:[0,1,0] op_sel_hi:[0,1,0]
    v_mfma_f32_16x16x32_bf16 v[112:115], a[208:211], v[200:203], v[112:115]
    v_cvt_pk_bf16_f32 v56, v28, v29
    v_cvt_pk_bf16_f32 v57, v30, v31
    v_cvt_pk_f16_f32 v32, v88, v89
    v_cvt_pk_f16_f32 v34, v90, v91
    v_mfma_f32_16x16x32_bf16 v[120:123], a[208:211], v[224:227], v[120:123]
    s_waitcnt lgkmcnt(6)
    v_pk_fma_f16 v33, v32, v32, s32
    v_pk_fma_f16 v35, v34, v34, s32
    v_pk_mul_f16 v32, v32, v33 neg_lo:[1,0] neg_hi:[1,0]
    v_mfma_f32_16x16x32_bf16 v[104:107], a[212:215], v[180:183], v[104:107]
    ds_read_b64_tr_b16 a[204:205], v8 offset:520
    ds_read_b64_tr_b16 a[206:207], v9 offset:520
    v_pk_mul_f16 v34, v34, v35 neg_lo:[1,0] neg_hi:[1,0]
    v_mfma_f32_16x16x32_bf16 v[112:115], a[212:215], v[204:207], v[112:115]
    v_exp_f16 v33, v32
    v_exp_f16 v35, v34
    v_mfma_f32_16x16x32_bf16 v[120:123], a[212:215], v[228:231], v[120:123]
    s_waitcnt lgkmcnt(6)
    v_exp_f16_sdwa v33, v32 dst_sel:WORD_1 dst_unused:UNUSED_PRESERVE src0_sel:WORD_1
    v_exp_f16_sdwa v35, v34 dst_sel:WORD_1 dst_unused:UNUSED_PRESERVE src0_sel:WORD_1
    v_pk_add_f16 v32, v33, 1.0 op_sel_hi:[1,0]
    v_mfma_f32_16x16x32_bf16 a[0:3], a[192:195], v[64:67], a[0:3]
    ds_read_b64_tr_b16 a[208:209], v8 offset:1024
    ds_read_b64_tr_b16 a[210:211], v9 offset:1024
    v_pk_add_f16 v34, v35, 1.0 op_sel_hi:[1,0]
    v_mfma_f32_16x16x32_bf16 a[48:51], a[192:195], v[68:71], a[48:51]
    v_rcp_f16 v33, v32
    v_rcp_f16 v35, v34
    v_mfma_f32_16x16x32_bf16 a[96:99], a[192:195], v[72:75], a[96:99]
    s_waitcnt lgkmcnt(6)
    v_rcp_f16_sdwa v33, v32 dst_sel:WORD_1 dst_unused:UNUSED_PRESERVE src0_sel:WORD_1
    v_rcp_f16_sdwa v35, v34 dst_sel:WORD_1 dst_unused:UNUSED_PRESERVE src0_sel:WORD_1
    v_mfma_f32_16x16x32_bf16 a[4:7], a[196:199], v[64:67], a[4:7]
    ds_read_b64_tr_b16 a[212:213], v8 offset:1032
    ds_read_b64_tr_b16 a[214:215], v9 offset:1032
    v_fma_mix_f32 v32, v88, v33, 0 op_sel_hi:[0,1,0]
    v_mfma_f32_16x16x32_bf16 a[52:55], a[196:199], v[68:71], a[52:55]
    v_fma_mix_f32 v34, v90, v35, 0 op_sel_hi:[0,1,0]
    v_fma_mix_f32 v33, v89, v33, 0 op_sel:[0,1,0] op_sel_hi:[0,1,0]
    v_fma_mix_f32 v35, v91, v35, 0 op_sel:[0,1,0] op_sel_hi:[0,1,0]
    v_cvt_pk_bf16_f32 v58, v32, v33
    v_mfma_f32_16x16x32_bf16 a[100:103], a[196:199], v[72:75], a[100:103]
    s_waitcnt lgkmcnt(6)
    v_cvt_pk_bf16_f32 v59, v34, v35
    v_cvt_pk_f16_f32 v28, v92, v93
    v_cvt_pk_f16_f32 v30, v94, v95
    v_pk_fma_f16 v29, v28, v28, s32
    v_mfma_f32_16x16x32_bf16 a[8:11], a[200:203], v[64:67], a[8:11]
    ds_read_b64_tr_b16 a[192:193], v8 offset:1536
    ds_read_b64_tr_b16 a[194:195], v9 offset:1536
    v_pk_fma_f16 v31, v30, v30, s32
    v_mfma_f32_16x16x32_bf16 a[56:59], a[200:203], v[68:71], a[56:59]
    v_pk_mul_f16 v28, v28, v29 neg_lo:[1,0] neg_hi:[1,0]
    v_pk_mul_f16 v30, v30, v31 neg_lo:[1,0] neg_hi:[1,0]
    v_exp_f16 v29, v28
    v_mfma_f32_16x16x32_bf16 a[104:107], a[200:203], v[72:75], a[104:107]
    s_waitcnt lgkmcnt(6)
    v_exp_f16 v31, v30
    v_exp_f16_sdwa v29, v28 dst_sel:WORD_1 dst_unused:UNUSED_PRESERVE src0_sel:WORD_1
    v_mfma_f32_16x16x32_bf16 a[12:15], a[204:207], v[64:67], a[12:15]
    ds_read_b64_tr_b16 a[196:197], v8 offset:1544
    ds_read_b64_tr_b16 a[198:199], v9 offset:1544
    v_mfma_f32_16x16x32_bf16 a[60:63], a[204:207], v[68:71], a[60:63]
    v_exp_f16_sdwa v31, v30 dst_sel:WORD_1 dst_unused:UNUSED_PRESERVE src0_sel:WORD_1
    v_pk_add_f16 v28, v29, 1.0 op_sel_hi:[1,0]
    v_pk_add_f16 v30, v31, 1.0 op_sel_hi:[1,0]
    v_mfma_f32_16x16x32_bf16 a[108:111], a[204:207], v[72:75], a[108:111]
    s_waitcnt lgkmcnt(6)
    v_rcp_f16 v29, v28
    v_rcp_f16 v31, v30
    v_mfma_f32_16x16x32_bf16 a[16:19], a[208:211], v[64:67], a[16:19]
    ds_read_b64_tr_b16 a[200:201], v8 offset:2048
    ds_read_b64_tr_b16 a[202:203], v9 offset:2048
    v_rcp_f16_sdwa v29, v28 dst_sel:WORD_1 dst_unused:UNUSED_PRESERVE src0_sel:WORD_1
    v_mfma_f32_16x16x32_bf16 a[64:67], a[208:211], v[68:71], a[64:67]
    v_rcp_f16_sdwa v31, v30 dst_sel:WORD_1 dst_unused:UNUSED_PRESERVE src0_sel:WORD_1
    v_fma_mix_f32 v28, v92, v29, 0 op_sel_hi:[0,1,0]
    v_fma_mix_f32 v30, v94, v31, 0 op_sel_hi:[0,1,0]
    v_mfma_f32_16x16x32_bf16 a[112:115], a[208:211], v[72:75], a[112:115]
    s_waitcnt lgkmcnt(6)
    v_fma_mix_f32 v29, v93, v29, 0 op_sel:[0,1,0] op_sel_hi:[0,1,0]
    v_fma_mix_f32 v31, v95, v31, 0 op_sel:[0,1,0] op_sel_hi:[0,1,0]
    v_cvt_pk_bf16_f32 v60, v28, v29
    v_cvt_pk_bf16_f32 v61, v30, v31
    v_mfma_f32_16x16x32_bf16 a[20:23], a[212:215], v[64:67], a[20:23]
    ds_read_b64_tr_b16 a[204:205], v8 offset:2056
    ds_read_b64_tr_b16 a[206:207], v9 offset:2056
    v_cvt_pk_f16_f32 v32, v96, v97
    v_mfma_f32_16x16x32_bf16 a[68:71], a[212:215], v[68:71], a[68:71]
    v_cvt_pk_f16_f32 v34, v98, v99
    v_pk_fma_f16 v33, v32, v32, s32
    v_pk_fma_f16 v35, v34, v34, s32
    v_pk_mul_f16 v32, v32, v33 neg_lo:[1,0] neg_hi:[1,0]
    v_mfma_f32_16x16x32_bf16 a[116:119], a[212:215], v[72:75], a[116:119]
    s_waitcnt lgkmcnt(6)
    v_pk_mul_f16 v34, v34, v35 neg_lo:[1,0] neg_hi:[1,0]
    v_exp_f16 v33, v32
    v_mfma_f32_16x16x32_bf16 a[24:27], a[192:195], v[64:67], a[24:27]
    ds_read_b64_tr_b16 a[208:209], v8 offset:2560
    ds_read_b64_tr_b16 a[210:211], v9 offset:2560
    v_exp_f16 v35, v34
    v_mfma_f32_16x16x32_bf16 a[72:75], a[192:195], v[68:71], a[72:75]
    v_exp_f16_sdwa v33, v32 dst_sel:WORD_1 dst_unused:UNUSED_PRESERVE src0_sel:WORD_1
    v_exp_f16_sdwa v35, v34 dst_sel:WORD_1 dst_unused:UNUSED_PRESERVE src0_sel:WORD_1
    v_mfma_f32_16x16x32_bf16 a[120:123], a[192:195], v[72:75], a[120:123]
    s_waitcnt lgkmcnt(6)
    v_pk_add_f16 v32, v33, 1.0 op_sel_hi:[1,0]
    v_pk_add_f16 v34, v35, 1.0 op_sel_hi:[1,0]
    v_rcp_f16 v33, v32
    v_mfma_f32_16x16x32_bf16 a[28:31], a[196:199], v[64:67], a[28:31]
    ds_read_b64_tr_b16 a[212:213], v8 offset:2568
    ds_read_b64_tr_b16 a[214:215], v9 offset:2568
    v_add_u32 v8, s33, v8
    v_add_u32 v9, s33, v9
    v_mfma_f32_16x16x32_bf16 a[76:79], a[196:199], v[68:71], a[76:79]
    v_rcp_f16 v35, v34
    v_mfma_f32_16x16x32_bf16 a[124:127], a[196:199], v[72:75], a[124:127]
    s_waitcnt lgkmcnt(6)
    v_rcp_f16_sdwa v33, v32 dst_sel:WORD_1 dst_unused:UNUSED_PRESERVE src0_sel:WORD_1
    v_rcp_f16_sdwa v35, v34 dst_sel:WORD_1 dst_unused:UNUSED_PRESERVE src0_sel:WORD_1
    v_fma_mix_f32 v32, v96, v33, 0 op_sel_hi:[0,1,0]
    v_mfma_f32_16x16x32_bf16 a[32:35], a[200:203], v[64:67], a[32:35]
    ds_read_b128 v[20:23], v10
    ds_read_b64_tr_b16 a[192:193], v2 offset:0
    ds_read_b64_tr_b16 a[194:195], v2 offset:2048
    v_fma_mix_f32 v34, v98, v35, 0 op_sel_hi:[0,1,0]
    v_mfma_f32_16x16x32_bf16 a[80:83], a[200:203], v[68:71], a[80:83]
    v_fma_mix_f32 v33, v97, v33, 0 op_sel:[0,1,0] op_sel_hi:[0,1,0]
    v_fma_mix_f32 v35, v99, v35, 0 op_sel:[0,1,0] op_sel_hi:[0,1,0]
    v_cvt_pk_bf16_f32 v62, v32, v33
    v_mfma_f32_16x16x32_bf16 a[128:131], a[200:203], v[72:75], a[128:131]
    s_waitcnt lgkmcnt(7)
    v_cvt_pk_bf16_f32 v63, v34, v35
    v_cvt_pk_f16_f32 v28, v44, v45
    v_cvt_pk_f16_f32 v30, v46, v47
    v_pk_fma_f16 v29, v28, v28, s32
    v_mfma_f32_16x16x32_bf16 a[36:39], a[204:207], v[64:67], a[36:39]
    ds_read_b64_tr_b16 a[196:197], v2 offset:4096
    ds_read_b64_tr_b16 a[198:199], v2 offset:6144
    v_pk_fma_f16 v31, v30, v30, s32
    v_pk_mul_f16 v28, v28, v29 neg_lo:[1,0] neg_hi:[1,0]
    v_mfma_f32_16x16x32_bf16 a[84:87], a[204:207], v[68:71], a[84:87]
    v_pk_mul_f16 v30, v30, v31 neg_lo:[1,0] neg_hi:[1,0]
    v_exp_f16 v29, v28
    v_mfma_f32_16x16x32_bf16 a[132:135], a[204:207], v[72:75], a[132:135]
    s_waitcnt lgkmcnt(7)
    v_exp_f16 v31, v30
    v_exp_f16_sdwa v29, v28 dst_sel:WORD_1 dst_unused:UNUSED_PRESERVE src0_sel:WORD_1
    v_mfma_f32_16x16x32_bf16 a[40:43], a[208:211], v[64:67], a[40:43]
    ds_read_b64_tr_b16 a[200:201], v2 offset:8192
    ds_read_b64_tr_b16 a[202:203], v2 offset:10240
    v_exp_f16_sdwa v31, v30 dst_sel:WORD_1 dst_unused:UNUSED_PRESERVE src0_sel:WORD_1
    v_mfma_f32_16x16x32_bf16 a[88:91], a[208:211], v[68:71], a[88:91]
    v_pk_add_f16 v28, v29, 1.0 op_sel_hi:[1,0]
    v_pk_add_f16 v30, v31, 1.0 op_sel_hi:[1,0]
    v_mfma_f32_16x16x32_bf16 a[136:139], a[208:211], v[72:75], a[136:139]
    s_waitcnt lgkmcnt(7)
    v_rcp_f16 v29, v28
    v_rcp_f16 v31, v30
    v_mfma_f32_16x16x32_bf16 a[44:47], a[212:215], v[64:67], a[44:47]
    ds_read_b64_tr_b16 a[204:205], v2 offset:12288
    ds_read_b64_tr_b16 a[206:207], v2 offset:14336
    v_rcp_f16_sdwa v29, v28 dst_sel:WORD_1 dst_unused:UNUSED_PRESERVE src0_sel:WORD_1
    v_mfma_f32_16x16x32_bf16 a[92:95], a[212:215], v[68:71], a[92:95]
    s_mov_b32 s33, s38
    v_rcp_f16_sdwa v31, v30 dst_sel:WORD_1 dst_unused:UNUSED_PRESERVE src0_sel:WORD_1
    v_fma_mix_f32 v28, v44, v29, 0 op_sel_hi:[0,1,0]
    v_fma_mix_f32 v30, v46, v31, 0 op_sel_hi:[0,1,0]
    v_mfma_f32_16x16x32_bf16 a[140:143], a[212:215], v[72:75], a[140:143]
    s_waitcnt lgkmcnt(6)
    v_fma_mix_f32 v29, v45, v29, 0 op_sel:[0,1,0] op_sel_hi:[0,1,0]
    v_fma_mix_f32 v31, v47, v31, 0 op_sel:[0,1,0] op_sel_hi:[0,1,0]
    v_cvt_pk_bf16_f32 v48, v28, v29
    v_cvt_pk_bf16_f32 v49, v30, v31
    s_waitcnt vmcnt(0)
    s_barrier
    v_mfma_f32_16x16x32_bf16 v[76:79], a[192:195], v[160:163], v[20:23]
    ds_read_b64_tr_b16 a[208:209], v2 offset:16384
    ds_read_b64_tr_b16 a[210:211], v2 offset:18432
    v_mfma_f32_16x16x32_bf16 v[84:87], a[192:195], v[184:187], v[20:23]
    v_cvt_pk_f16_f32 v28, v100, v101
    v_cvt_pk_f16_f32 v30, v102, v103
    v_pk_fma_f16 v29, v28, v28, s32
    v_mfma_f32_16x16x32_bf16 v[92:95], a[192:195], v[208:211], v[20:23]
    v_pk_fma_f16 v31, v30, v30, s32
    v_pk_mul_f16 v28, v28, v29 neg_lo:[1,0] neg_hi:[1,0]
    v_mfma_f32_16x16x32_bf16 v[44:47], a[192:195], v[232:235], v[20:23]
    s_waitcnt lgkmcnt(6)
    v_pk_mul_f16 v30, v30, v31 neg_lo:[1,0] neg_hi:[1,0]
    v_exp_f16 v29, v28
    v_mfma_f32_16x16x32_bf16 v[76:79], a[196:199], v[164:167], v[76:79]
    ds_read_b64_tr_b16 a[212:213], v2 offset:20480
    ds_read_b64_tr_b16 a[214:215], v2 offset:22528
    v_mfma_f32_16x16x32_bf16 v[84:87], a[196:199], v[188:191], v[84:87]
    v_exp_f16 v31, v30
    v_mfma_f32_16x16x32_bf16 v[92:95], a[196:199], v[212:215], v[92:95]
    v_exp_f16_sdwa v29, v28 dst_sel:WORD_1 dst_unused:UNUSED_PRESERVE src0_sel:WORD_1
    v_mfma_f32_16x16x32_bf16 v[44:47], a[196:199], v[236:239], v[44:47]
    s_waitcnt lgkmcnt(6)
    v_exp_f16_sdwa v31, v30 dst_sel:WORD_1 dst_unused:UNUSED_PRESERVE src0_sel:WORD_1
    v_pk_add_f16 v28, v29, 1.0 op_sel_hi:[1,0]
    v_pk_add_f16 v30, v31, 1.0 op_sel_hi:[1,0]
    v_mfma_f32_16x16x32_bf16 v[76:79], a[200:203], v[168:171], v[76:79]
    ds_read_b128 v[24:27], v11
    ds_read_b64_tr_b16 a[192:193], v3 offset:0
    ds_read_b64_tr_b16 a[194:195], v3 offset:2048
    v_mfma_f32_16x16x32_bf16 v[84:87], a[200:203], v[192:195], v[84:87]
    v_rcp_f16 v29, v28
    v_mfma_f32_16x16x32_bf16 v[92:95], a[200:203], v[216:219], v[92:95]
    v_rcp_f16 v31, v30
    v_mfma_f32_16x16x32_bf16 v[44:47], a[200:203], v[240:243], v[44:47]
    s_waitcnt lgkmcnt(7)
    v_rcp_f16_sdwa v29, v28 dst_sel:WORD_1 dst_unused:UNUSED_PRESERVE src0_sel:WORD_1
    v_mfma_f32_16x16x32_bf16 v[76:79], a[204:207], v[172:175], v[76:79]
    ds_read_b64_tr_b16 a[196:197], v3 offset:4096
    ds_read_b64_tr_b16 a[198:199], v3 offset:6144
    v_mfma_f32_16x16x32_bf16 v[84:87], a[204:207], v[196:199], v[84:87]
    v_rcp_f16_sdwa v31, v30 dst_sel:WORD_1 dst_unused:UNUSED_PRESERVE src0_sel:WORD_1
    v_fma_mix_f32 v28, v100, v29, 0 op_sel_hi:[0,1,0]
    v_mfma_f32_16x16x32_bf16 v[92:95], a[204:207], v[220:223], v[92:95]
    v_fma_mix_f32 v30, v102, v31, 0 op_sel_hi:[0,1,0]
    v_fma_mix_f32 v29, v101, v29, 0 op_sel:[0,1,0] op_sel_hi:[0,1,0]
    v_fma_mix_f32 v31, v103, v31, 0 op_sel:[0,1,0] op_sel_hi:[0,1,0]
    v_mfma_f32_16x16x32_bf16 v[44:47], a[204:207], v[244:247], v[44:47]
    s_waitcnt lgkmcnt(7)
    v_cvt_pk_bf16_f32 v64, v28, v29
    v_cvt_pk_bf16_f32 v65, v30, v31
    v_mfma_f32_16x16x32_bf16 v[76:79], a[208:211], v[176:179], v[76:79]
    ds_read_b64_tr_b16 a[200:201], v3 offset:8192
    ds_read_b64_tr_b16 a[202:203], v3 offset:10240
    v_cvt_pk_f16_f32 v32, v104, v105
    v_mfma_f32_16x16x32_bf16 v[84:87], a[208:211], v[200:203], v[84:87]
    v_cvt_pk_f16_f32 v34, v106, v107
    v_pk_fma_f16 v33, v32, v32, s32
    v_mfma_f32_16x16x32_bf16 v[92:95], a[208:211], v[224:227], v[92:95]
    v_pk_fma_f16 v35, v34, v34, s32
    v_pk_mul_f16 v32, v32, v33 neg_lo:[1,0] neg_hi:[1,0]
    v_mfma_f32_16x16x32_bf16 v[44:47], a[208:211], v[248:251], v[44:47]
    s_waitcnt lgkmcnt(7)
    v_pk_mul_f16 v34, v34, v35 neg_lo:[1,0] neg_hi:[1,0]
    v_exp_f16 v33, v32
    v_mfma_f32_16x16x32_bf16 v[76:79], a[212:215], v[180:183], v[76:79]
    ds_read_b64_tr_b16 a[204:205], v3 offset:12288
    ds_read_b64_tr_b16 a[206:207], v3 offset:14336
    v_mfma_f32_16x16x32_bf16 v[84:87], a[212:215], v[204:207], v[84:87]
    v_exp_f16 v35, v34
    v_mfma_f32_16x16x32_bf16 v[92:95], a[212:215], v[228:231], v[92:95]
    v_exp_f16_sdwa v33, v32 dst_sel:WORD_1 dst_unused:UNUSED_PRESERVE src0_sel:WORD_1
    v_mfma_f32_16x16x32_bf16 v[44:47], a[212:215], v[252:255], v[44:47]
    s_waitcnt lgkmcnt(6)
    v_exp_f16_sdwa v35, v34 dst_sel:WORD_1 dst_unused:UNUSED_PRESERVE src0_sel:WORD_1
    v_pk_add_f16 v32, v33, 1.0 op_sel_hi:[1,0]
    v_pk_add_f16 v34, v35, 1.0 op_sel_hi:[1,0]
    v_mfma_f32_16x16x32_bf16 v[80:83], a[192:195], v[160:163], v[24:27]
    ds_read_b64_tr_b16 a[208:209], v3 offset:16384
    ds_read_b64_tr_b16 a[210:211], v3 offset:18432
    v_mfma_f32_16x16x32_bf16 v[88:91], a[192:195], v[184:187], v[24:27]
    v_rcp_f16 v33, v32
    v_mfma_f32_16x16x32_bf16 v[96:99], a[192:195], v[208:211], v[24:27]
    s_waitcnt lgkmcnt(6)
    v_rcp_f16 v35, v34
    v_mfma_f32_16x16x32_bf16 v[80:83], a[196:199], v[164:167], v[80:83]
    ds_read_b64_tr_b16 a[212:213], v3 offset:20480
    ds_read_b64_tr_b16 a[214:215], v3 offset:22528
    v_mfma_f32_16x16x32_bf16 v[88:91], a[196:199], v[188:191], v[88:91]
    v_rcp_f16_sdwa v33, v32 dst_sel:WORD_1 dst_unused:UNUSED_PRESERVE src0_sel:WORD_1
    v_rcp_f16_sdwa v35, v34 dst_sel:WORD_1 dst_unused:UNUSED_PRESERVE src0_sel:WORD_1
    v_mfma_f32_16x16x32_bf16 v[96:99], a[196:199], v[212:215], v[96:99]
    s_waitcnt lgkmcnt(6)
    v_fma_mix_f32 v32, v104, v33, 0 op_sel_hi:[0,1,0]
    v_fma_mix_f32 v34, v106, v35, 0 op_sel_hi:[0,1,0]
    v_mfma_f32_16x16x32_bf16 v[80:83], a[200:203], v[168:171], v[80:83]
    ds_read_b64_tr_b16 a[192:193], v6 offset:0
    ds_read_b64_tr_b16 a[194:195], v7 offset:0
    v_fma_mix_f32 v33, v105, v33, 0 op_sel:[0,1,0] op_sel_hi:[0,1,0]
    v_mfma_f32_16x16x32_bf16 v[88:91], a[200:203], v[192:195], v[88:91]
    v_fma_mix_f32 v35, v107, v35, 0 op_sel:[0,1,0] op_sel_hi:[0,1,0]
    v_cvt_pk_bf16_f32 v66, v32, v33
    v_mfma_f32_16x16x32_bf16 v[96:99], a[200:203], v[216:219], v[96:99]
    s_waitcnt lgkmcnt(6)
    v_cvt_pk_bf16_f32 v67, v34, v35
    v_cvt_pk_f16_f32 v28, v108, v109
    v_cvt_pk_f16_f32 v30, v110, v111
    v_mfma_f32_16x16x32_bf16 v[80:83], a[204:207], v[172:175], v[80:83]
    ds_read_b64_tr_b16 a[196:197], v6 offset:8
    ds_read_b64_tr_b16 a[198:199], v7 offset:8
    v_mfma_f32_16x16x32_bf16 v[88:91], a[204:207], v[196:199], v[88:91]
    v_pk_fma_f16 v29, v28, v28, s32
    v_pk_fma_f16 v31, v30, v30, s32
    v_pk_mul_f16 v28, v28, v29 neg_lo:[1,0] neg_hi:[1,0]
    v_mfma_f32_16x16x32_bf16 v[96:99], a[204:207], v[220:223], v[96:99]
    s_waitcnt lgkmcnt(6)
    v_pk_mul_f16 v30, v30, v31 neg_lo:[1,0] neg_hi:[1,0]
    v_exp_f16 v29, v28
    v_mfma_f32_16x16x32_bf16 v[80:83], a[208:211], v[176:179], v[80:83]
    ds_read_b64_tr_b16 a[200:201], v6 offset:512
    ds_read_b64_tr_b16 a[202:203], v7 offset:512
    v_mfma_f32_16x16x32_bf16 v[88:91], a[208:211], v[200:203], v[88:91]
    v_exp_f16 v31, v30
    v_mfma_f32_16x16x32_bf16 v[96:99], a[208:211], v[224:227], v[96:99]
    s_waitcnt lgkmcnt(6)
    v_exp_f16_sdwa v29, v28 dst_sel:WORD_1 dst_unused:UNUSED_PRESERVE src0_sel:WORD_1
    v_mfma_f32_16x16x32_bf16 v[80:83], a[212:215], v[180:183], v[80:83]
    ds_read_b64_tr_b16 a[204:205], v6 offset:520
    ds_read_b64_tr_b16 a[206:207], v7 offset:520
    v_mfma_f32_16x16x32_bf16 v[88:91], a[212:215], v[204:207], v[88:91]
    v_exp_f16_sdwa v31, v30 dst_sel:WORD_1 dst_unused:UNUSED_PRESERVE src0_sel:WORD_1
    v_pk_add_f16 v28, v29, 1.0 op_sel_hi:[1,0]
    v_mfma_f32_16x16x32_bf16 v[96:99], a[212:215], v[228:231], v[96:99]
    s_waitcnt lgkmcnt(6)
    v_pk_add_f16 v30, v31, 1.0 op_sel_hi:[1,0]
    v_rcp_f16 v29, v28
    v_mfma_f32_16x16x32_bf16 a[0:3], a[192:195], v[52:55], a[0:3]
    ds_read_b64_tr_b16 a[208:209], v6 offset:1024
    ds_read_b64_tr_b16 a[210:211], v7 offset:1024
    v_mfma_f32_16x16x32_bf16 a[48:51], a[192:195], v[56:59], a[48:51]
    v_rcp_f16 v31, v30
    v_rcp_f16_sdwa v29, v28 dst_sel:WORD_1 dst_unused:UNUSED_PRESERVE src0_sel:WORD_1
    v_mfma_f32_16x16x16_bf16 a[144:147], a[192:193], v[48:49], a[144:147]
    v_rcp_f16_sdwa v31, v30 dst_sel:WORD_1 dst_unused:UNUSED_PRESERVE src0_sel:WORD_1
    v_fma_mix_f32 v28, v108, v29, 0 op_sel_hi:[0,1,0]
    v_fma_mix_f32 v30, v110, v31, 0 op_sel_hi:[0,1,0]
    v_mfma_f32_16x16x32_bf16 a[96:99], a[192:195], v[60:63], a[96:99]
    s_waitcnt lgkmcnt(6)
    v_fma_mix_f32 v29, v109, v29, 0 op_sel:[0,1,0] op_sel_hi:[0,1,0]
    v_fma_mix_f32 v31, v111, v31, 0 op_sel:[0,1,0] op_sel_hi:[0,1,0]
    v_mfma_f32_16x16x32_bf16 a[4:7], a[196:199], v[52:55], a[4:7]
    ds_read_b64_tr_b16 a[212:213], v6 offset:1032
    ds_read_b64_tr_b16 a[214:215], v7 offset:1032
    v_mfma_f32_16x16x32_bf16 a[52:55], a[196:199], v[56:59], a[52:55]
    v_cvt_pk_bf16_f32 v68, v28, v29
    v_cvt_pk_bf16_f32 v69, v30, v31
    v_cvt_pk_f16_f32 v32, v112, v113
    v_mfma_f32_16x16x16_bf16 a[148:151], a[196:197], v[48:49], a[148:151]
    v_cvt_pk_f16_f32 v34, v114, v115
    v_pk_fma_f16 v33, v32, v32, s32
    v_pk_fma_f16 v35, v34, v34, s32
    v_pk_mul_f16 v32, v32, v33 neg_lo:[1,0] neg_hi:[1,0]
    v_mfma_f32_16x16x32_bf16 a[100:103], a[196:199], v[60:63], a[100:103]
    s_waitcnt lgkmcnt(6)
    v_pk_mul_f16 v34, v34, v35 neg_lo:[1,0] neg_hi:[1,0]
    v_exp_f16 v33, v32
    v_mfma_f32_16x16x32_bf16 a[8:11], a[200:203], v[52:55], a[8:11]
    ds_read_b64_tr_b16 a[192:193], v6 offset:1536
    ds_read_b64_tr_b16 a[194:195], v7 offset:1536
    v_mfma_f32_16x16x32_bf16 a[56:59], a[200:203], v[56:59], a[56:59]
    v_exp_f16 v35, v34
    v_exp_f16_sdwa v33, v32 dst_sel:WORD_1 dst_unused:UNUSED_PRESERVE src0_sel:WORD_1
    v_mfma_f32_16x16x16_bf16 a[152:155], a[200:201], v[48:49], a[152:155]
    v_exp_f16_sdwa v35, v34 dst_sel:WORD_1 dst_unused:UNUSED_PRESERVE src0_sel:WORD_1
    v_pk_add_f16 v32, v33, 1.0 op_sel_hi:[1,0]
    v_pk_add_f16 v34, v35, 1.0 op_sel_hi:[1,0]
    v_mfma_f32_16x16x32_bf16 a[104:107], a[200:203], v[60:63], a[104:107]
    s_waitcnt lgkmcnt(6)
    v_rcp_f16 v33, v32
    v_mfma_f32_16x16x32_bf16 a[12:15], a[204:207], v[52:55], a[12:15]
    ds_read_b64_tr_b16 a[196:197], v6 offset:1544
    ds_read_b64_tr_b16 a[198:199], v7 offset:1544
    v_mfma_f32_16x16x32_bf16 a[60:63], a[204:207], v[56:59], a[60:63]
    v_rcp_f16 v35, v34
    v_rcp_f16_sdwa v33, v32 dst_sel:WORD_1 dst_unused:UNUSED_PRESERVE src0_sel:WORD_1
    v_mfma_f32_16x16x16_bf16 a[156:159], a[204:205], v[48:49], a[156:159]
    v_rcp_f16_sdwa v35, v34 dst_sel:WORD_1 dst_unused:UNUSED_PRESERVE src0_sel:WORD_1
    v_fma_mix_f32 v32, v112, v33, 0 op_sel_hi:[0,1,0]
    v_fma_mix_f32 v34, v114, v35, 0 op_sel_hi:[0,1,0]
    v_mfma_f32_16x16x32_bf16 a[108:111], a[204:207], v[60:63], a[108:111]
    s_waitcnt lgkmcnt(6)
    v_fma_mix_f32 v33, v113, v33, 0 op_sel:[0,1,0] op_sel_hi:[0,1,0]
    v_fma_mix_f32 v35, v115, v35, 0 op_sel:[0,1,0] op_sel_hi:[0,1,0]
    v_mfma_f32_16x16x32_bf16 a[16:19], a[208:211], v[52:55], a[16:19]
    ds_read_b64_tr_b16 a[200:201], v6 offset:2048
    ds_read_b64_tr_b16 a[202:203], v7 offset:2048
    v_mfma_f32_16x16x32_bf16 a[64:67], a[208:211], v[56:59], a[64:67]
    v_cvt_pk_bf16_f32 v70, v32, v33
    v_cvt_pk_bf16_f32 v71, v34, v35
    v_cvt_pk_f16_f32 v28, v116, v117
    v_mfma_f32_16x16x16_bf16 a[160:163], a[208:209], v[48:49], a[160:163]
    v_cvt_pk_f16_f32 v30, v118, v119
    v_pk_fma_f16 v29, v28, v28, s32
    v_pk_fma_f16 v31, v30, v30, s32
    v_pk_mul_f16 v28, v28, v29 neg_lo:[1,0] neg_hi:[1,0]
    v_mfma_f32_16x16x32_bf16 a[112:115], a[208:211], v[60:63], a[112:115]
    s_waitcnt lgkmcnt(6)
    v_pk_mul_f16 v30, v30, v31 neg_lo:[1,0] neg_hi:[1,0]
    v_exp_f16 v29, v28
    v_mfma_f32_16x16x32_bf16 a[20:23], a[212:215], v[52:55], a[20:23]
    ds_read_b64_tr_b16 a[204:205], v6 offset:2056
    ds_read_b64_tr_b16 a[206:207], v7 offset:2056
    v_mfma_f32_16x16x32_bf16 a[68:71], a[212:215], v[56:59], a[68:71]
    v_exp_f16 v31, v30
    v_exp_f16_sdwa v29, v28 dst_sel:WORD_1 dst_unused:UNUSED_PRESERVE src0_sel:WORD_1
    v_mfma_f32_16x16x16_bf16 a[164:167], a[212:213], v[48:49], a[164:167]
    v_exp_f16_sdwa v31, v30 dst_sel:WORD_1 dst_unused:UNUSED_PRESERVE src0_sel:WORD_1
    v_pk_add_f16 v28, v29, 1.0 op_sel_hi:[1,0]
    v_pk_add_f16 v30, v31, 1.0 op_sel_hi:[1,0]
    v_mfma_f32_16x16x32_bf16 a[116:119], a[212:215], v[60:63], a[116:119]
    s_waitcnt lgkmcnt(6)
    v_rcp_f16 v29, v28
    v_mfma_f32_16x16x32_bf16 a[24:27], a[192:195], v[52:55], a[24:27]
    ds_read_b64_tr_b16 a[208:209], v6 offset:2560
    ds_read_b64_tr_b16 a[210:211], v7 offset:2560
    v_mfma_f32_16x16x32_bf16 a[72:75], a[192:195], v[56:59], a[72:75]
    v_rcp_f16 v31, v30
    v_rcp_f16_sdwa v29, v28 dst_sel:WORD_1 dst_unused:UNUSED_PRESERVE src0_sel:WORD_1
    v_mfma_f32_16x16x16_bf16 a[168:171], a[192:193], v[48:49], a[168:171]
    v_rcp_f16_sdwa v31, v30 dst_sel:WORD_1 dst_unused:UNUSED_PRESERVE src0_sel:WORD_1
    v_fma_mix_f32 v28, v116, v29, 0 op_sel_hi:[0,1,0]
    v_fma_mix_f32 v30, v118, v31, 0 op_sel_hi:[0,1,0]
    v_mfma_f32_16x16x32_bf16 a[120:123], a[192:195], v[60:63], a[120:123]
    s_waitcnt lgkmcnt(6)
    v_fma_mix_f32 v29, v117, v29, 0 op_sel:[0,1,0] op_sel_hi:[0,1,0]
    v_fma_mix_f32 v31, v119, v31, 0 op_sel:[0,1,0] op_sel_hi:[0,1,0]
    v_mfma_f32_16x16x32_bf16 a[28:31], a[196:199], v[52:55], a[28:31]
    ds_read_b64_tr_b16 a[212:213], v6 offset:2568
    ds_read_b64_tr_b16 a[214:215], v7 offset:2568
    v_add_u32 v6, s33, v6
    v_add_u32 v7, s33, v7
    v_mfma_f32_16x16x32_bf16 a[76:79], a[196:199], v[56:59], a[76:79]
    v_cvt_pk_bf16_f32 v72, v28, v29
    v_cvt_pk_bf16_f32 v73, v30, v31
    v_cvt_pk_f16_f32 v32, v120, v121
    v_mfma_f32_16x16x16_bf16 a[172:175], a[196:197], v[48:49], a[172:175]
    v_cvt_pk_f16_f32 v34, v122, v123
    v_pk_fma_f16 v33, v32, v32, s32
    v_pk_fma_f16 v35, v34, v34, s32
    v_pk_mul_f16 v32, v32, v33 neg_lo:[1,0] neg_hi:[1,0]
    v_mfma_f32_16x16x32_bf16 a[124:127], a[196:199], v[60:63], a[124:127]
    s_waitcnt lgkmcnt(6)
    v_pk_mul_f16 v34, v34, v35 neg_lo:[1,0] neg_hi:[1,0]
    v_exp_f16 v33, v32
    v_mfma_f32_16x16x32_bf16 a[32:35], a[200:203], v[52:55], a[32:35]
    ds_read_b128 v[20:23], v12
    ds_read_b64_tr_b16 a[192:193], v4 offset:0
    ds_read_b64_tr_b16 a[194:195], v4 offset:2048
    v_mfma_f32_16x16x32_bf16 a[80:83], a[200:203], v[56:59], a[80:83]
    v_exp_f16 v35, v34
    v_exp_f16_sdwa v33, v32 dst_sel:WORD_1 dst_unused:UNUSED_PRESERVE src0_sel:WORD_1
    v_mfma_f32_16x16x16_bf16 a[176:179], a[200:201], v[48:49], a[176:179]
    v_exp_f16_sdwa v35, v34 dst_sel:WORD_1 dst_unused:UNUSED_PRESERVE src0_sel:WORD_1
    v_pk_add_f16 v32, v33, 1.0 op_sel_hi:[1,0]
    v_pk_add_f16 v34, v35, 1.0 op_sel_hi:[1,0]
    v_mfma_f32_16x16x32_bf16 a[128:131], a[200:203], v[60:63], a[128:131]
    s_waitcnt lgkmcnt(7)
    v_rcp_f16 v33, v32
    v_mfma_f32_16x16x32_bf16 a[36:39], a[204:207], v[52:55], a[36:39]
    ds_read_b64_tr_b16 a[196:197], v4 offset:4096
    ds_read_b64_tr_b16 a[198:199], v4 offset:6144
    v_mfma_f32_16x16x32_bf16 a[84:87], a[204:207], v[56:59], a[84:87]
    v_rcp_f16 v35, v34
    v_rcp_f16_sdwa v33, v32 dst_sel:WORD_1 dst_unused:UNUSED_PRESERVE src0_sel:WORD_1
    v_mfma_f32_16x16x16_bf16 a[180:183], a[204:205], v[48:49], a[180:183]
    v_rcp_f16_sdwa v35, v34 dst_sel:WORD_1 dst_unused:UNUSED_PRESERVE src0_sel:WORD_1
    v_fma_mix_f32 v32, v120, v33, 0 op_sel_hi:[0,1,0]
    v_fma_mix_f32 v34, v122, v35, 0 op_sel_hi:[0,1,0]
    v_mfma_f32_16x16x32_bf16 a[132:135], a[204:207], v[60:63], a[132:135]
    s_waitcnt lgkmcnt(7)
    v_fma_mix_f32 v33, v121, v33, 0 op_sel:[0,1,0] op_sel_hi:[0,1,0]
    v_fma_mix_f32 v35, v123, v35, 0 op_sel:[0,1,0] op_sel_hi:[0,1,0]
    v_mfma_f32_16x16x32_bf16 a[40:43], a[208:211], v[52:55], a[40:43]
    ds_read_b64_tr_b16 a[200:201], v4 offset:8192
    ds_read_b64_tr_b16 a[202:203], v4 offset:10240
    v_mfma_f32_16x16x32_bf16 a[88:91], a[208:211], v[56:59], a[88:91]
    v_cvt_pk_bf16_f32 v74, v32, v33
    v_cvt_pk_bf16_f32 v75, v34, v35
    v_mfma_f32_16x16x16_bf16 a[184:187], a[208:209], v[48:49], a[184:187]
    v_mfma_f32_16x16x32_bf16 a[136:139], a[208:211], v[60:63], a[136:139]
    s_waitcnt lgkmcnt(7)
    v_mfma_f32_16x16x32_bf16 a[44:47], a[212:215], v[52:55], a[44:47]
    ds_read_b64_tr_b16 a[204:205], v4 offset:12288
    ds_read_b64_tr_b16 a[206:207], v4 offset:14336
    v_mfma_f32_16x16x32_bf16 a[92:95], a[212:215], v[56:59], a[92:95]
    v_mfma_f32_16x16x16_bf16 a[188:191], a[212:213], v[48:49], a[188:191]
    v_mfma_f32_16x16x32_bf16 a[140:143], a[212:215], v[60:63], a[140:143]
    s_waitcnt lgkmcnt(6)
    v_mfma_f32_16x16x32_bf16 v[100:103], a[192:195], v[160:163], v[20:23]
    s_add_u32 s45, s45, s49
    ds_read_b64_tr_b16 a[208:209], v4 offset:16384
    ds_read_b64_tr_b16 a[210:211], v4 offset:18432
    v_cvt_pk_f16_f32 v28, v76, v77
    v_cvt_pk_f16_f32 v30, v78, v79
    v_mfma_f32_16x16x32_bf16 v[108:111], a[192:195], v[184:187], v[20:23]
    v_pk_fma_f16 v29, v28, v28, s32
    v_pk_fma_f16 v31, v30, v30, s32
    v_pk_mul_f16 v28, v28, v29 neg_lo:[1,0] neg_hi:[1,0]
    v_mfma_f32_16x16x32_bf16 v[116:119], a[192:195], v[208:211], v[20:23]
    s_waitcnt lgkmcnt(6)
    v_pk_mul_f16 v30, v30, v31 neg_lo:[1,0] neg_hi:[1,0]
    v_exp_f16 v29, v28
    v_mfma_f32_16x16x32_bf16 v[100:103], a[196:199], v[164:167], v[100:103]
    s_add_u32 s46, s46, s49
    ds_read_b64_tr_b16 a[212:213], v4 offset:20480
    ds_read_b64_tr_b16 a[214:215], v4 offset:22528
    v_exp_f16 v31, v30
    v_mfma_f32_16x16x32_bf16 v[108:111], a[196:199], v[188:191], v[108:111]
    v_exp_f16_sdwa v29, v28 dst_sel:WORD_1 dst_unused:UNUSED_PRESERVE src0_sel:WORD_1
    v_exp_f16_sdwa v31, v30 dst_sel:WORD_1 dst_unused:UNUSED_PRESERVE src0_sel:WORD_1
    v_mfma_f32_16x16x32_bf16 v[116:119], a[196:199], v[212:215], v[116:119]
    s_waitcnt lgkmcnt(6)
    v_pk_add_f16 v28, v29, 1.0 op_sel_hi:[1,0]
    v_pk_add_f16 v30, v31, 1.0 op_sel_hi:[1,0]
    v_rcp_f16 v29, v28
    v_mfma_f32_16x16x32_bf16 v[100:103], a[200:203], v[168:171], v[100:103]
    s_add_u32 s35, s35, 128
    ds_read_b128 v[24:27], v13
    ds_read_b64_tr_b16 a[192:193], v5 offset:0
    ds_read_b64_tr_b16 a[194:195], v5 offset:2048
    v_mfma_f32_16x16x32_bf16 v[108:111], a[200:203], v[192:195], v[108:111]
    v_rcp_f16 v31, v30
    v_rcp_f16_sdwa v29, v28 dst_sel:WORD_1 dst_unused:UNUSED_PRESERVE src0_sel:WORD_1
    v_mfma_f32_16x16x32_bf16 v[116:119], a[200:203], v[216:219], v[116:119]
    s_waitcnt lgkmcnt(7)
    v_rcp_f16_sdwa v31, v30 dst_sel:WORD_1 dst_unused:UNUSED_PRESERVE src0_sel:WORD_1
    v_fma_mix_f32 v28, v76, v29, 0 op_sel_hi:[0,1,0]
    v_fma_mix_f32 v30, v78, v31, 0 op_sel_hi:[0,1,0]
    v_mfma_f32_16x16x32_bf16 v[100:103], a[204:207], v[172:175], v[100:103]
    s_add_u32 s36, s36, 24576
    ds_read_b64_tr_b16 a[196:197], v5 offset:4096
    ds_read_b64_tr_b16 a[198:199], v5 offset:6144
    v_fma_mix_f32 v29, v77, v29, 0 op_sel:[0,1,0] op_sel_hi:[0,1,0]
    v_mfma_f32_16x16x32_bf16 v[108:111], a[204:207], v[196:199], v[108:111]
    v_fma_mix_f32 v31, v79, v31, 0 op_sel:[0,1,0] op_sel_hi:[0,1,0]
    v_cvt_pk_bf16_f32 v52, v28, v29
    v_cvt_pk_bf16_f32 v53, v30, v31
    v_cvt_pk_f16_f32 v32, v80, v81
    v_mfma_f32_16x16x32_bf16 v[116:119], a[204:207], v[220:223], v[116:119]
    s_waitcnt lgkmcnt(7)
    v_cvt_pk_f16_f32 v34, v82, v83
    v_pk_fma_f16 v33, v32, v32, s32
    v_pk_fma_f16 v35, v34, v34, s32
    v_pk_mul_f16 v32, v32, v33 neg_lo:[1,0] neg_hi:[1,0]
    v_mfma_f32_16x16x32_bf16 v[100:103], a[208:211], v[176:179], v[100:103]
    s_mov_b32 s38, s48
    ds_read_b64_tr_b16 a[200:201], v5 offset:8192
    ds_read_b64_tr_b16 a[202:203], v5 offset:10240
    v_pk_mul_f16 v34, v34, v35 neg_lo:[1,0] neg_hi:[1,0]
    v_mfma_f32_16x16x32_bf16 v[108:111], a[208:211], v[200:203], v[108:111]
    v_exp_f16 v33, v32
    v_exp_f16 v35, v34
    v_mfma_f32_16x16x32_bf16 v[116:119], a[208:211], v[224:227], v[116:119]
    s_waitcnt lgkmcnt(7)
    v_exp_f16_sdwa v33, v32 dst_sel:WORD_1 dst_unused:UNUSED_PRESERVE src0_sel:WORD_1
    v_mfma_f32_16x16x32_bf16 v[100:103], a[212:215], v[180:183], v[100:103]
    s_mov_b32 s48, s49
    ds_read_b64_tr_b16 a[204:205], v5 offset:12288
    ds_read_b64_tr_b16 a[206:207], v5 offset:14336
    v_exp_f16_sdwa v35, v34 dst_sel:WORD_1 dst_unused:UNUSED_PRESERVE src0_sel:WORD_1
    v_pk_add_f16 v32, v33, 1.0 op_sel_hi:[1,0]
    v_mfma_f32_16x16x32_bf16 v[108:111], a[212:215], v[204:207], v[108:111]
    v_pk_add_f16 v34, v35, 1.0 op_sel_hi:[1,0]
    v_rcp_f16 v33, v32
    v_mfma_f32_16x16x32_bf16 v[116:119], a[212:215], v[228:231], v[116:119]
    s_waitcnt lgkmcnt(6)
    v_rcp_f16 v35, v34
    v_rcp_f16_sdwa v33, v32 dst_sel:WORD_1 dst_unused:UNUSED_PRESERVE src0_sel:WORD_1
    v_mfma_f32_16x16x32_bf16 v[104:107], a[192:195], v[160:163], v[24:27]
    s_mov_b32 s49, s33
    ds_read_b64_tr_b16 a[208:209], v5 offset:16384
    ds_read_b64_tr_b16 a[210:211], v5 offset:18432
    v_rcp_f16_sdwa v35, v34 dst_sel:WORD_1 dst_unused:UNUSED_PRESERVE src0_sel:WORD_1
    v_mfma_f32_16x16x32_bf16 v[112:115], a[192:195], v[184:187], v[24:27]
    v_fma_mix_f32 v32, v80, v33, 0 op_sel_hi:[0,1,0]
    v_fma_mix_f32 v34, v82, v35, 0 op_sel_hi:[0,1,0]
    v_fma_mix_f32 v33, v81, v33, 0 op_sel:[0,1,0] op_sel_hi:[0,1,0]
    v_fma_mix_f32 v35, v83, v35, 0 op_sel:[0,1,0] op_sel_hi:[0,1,0]
    v_mfma_f32_16x16x32_bf16 v[120:123], a[192:195], v[208:211], v[24:27]
    s_waitcnt lgkmcnt(6)
    v_cvt_pk_bf16_f32 v54, v32, v33
    v_cvt_pk_bf16_f32 v55, v34, v35
    v_cvt_pk_f16_f32 v28, v84, v85
    v_mfma_f32_16x16x32_bf16 v[104:107], a[196:199], v[164:167], v[104:107]
    s_sub_u32 s37, s37, 1
    ds_read_b64_tr_b16 a[212:213], v5 offset:20480
    ds_read_b64_tr_b16 a[214:215], v5 offset:22528
    v_cvt_pk_f16_f32 v30, v86, v87
    v_pk_fma_f16 v29, v28, v28, s32
    v_mfma_f32_16x16x32_bf16 v[112:115], a[196:199], v[188:191], v[112:115]
    v_pk_fma_f16 v31, v30, v30, s32
    v_pk_mul_f16 v28, v28, v29 neg_lo:[1,0] neg_hi:[1,0]
    v_pk_mul_f16 v30, v30, v31 neg_lo:[1,0] neg_hi:[1,0]
    v_mfma_f32_16x16x32_bf16 v[120:123], a[196:199], v[212:215], v[120:123]
    s_waitcnt lgkmcnt(6)
    v_exp_f16 v29, v28
    v_exp_f16 v31, v30
    v_mfma_f32_16x16x32_bf16 v[104:107], a[200:203], v[168:171], v[104:107]
    s_cmp_lg_u32 s37, 0
    ds_read_b64_tr_b16 a[192:193], v8 offset:0
    ds_read_b64_tr_b16 a[194:195], v9 offset:0
    v_exp_f16_sdwa v29, v28 dst_sel:WORD_1 dst_unused:UNUSED_PRESERVE src0_sel:WORD_1
    v_mfma_f32_16x16x32_bf16 v[112:115], a[200:203], v[192:195], v[112:115]
    v_exp_f16_sdwa v31, v30 dst_sel:WORD_1 dst_unused:UNUSED_PRESERVE src0_sel:WORD_1
    v_pk_add_f16 v28, v29, 1.0 op_sel_hi:[1,0]
    v_mfma_f32_16x16x32_bf16 v[120:123], a[200:203], v[216:219], v[120:123]
    s_waitcnt lgkmcnt(6)
    v_pk_add_f16 v30, v31, 1.0 op_sel_hi:[1,0]
    v_rcp_f16 v29, v28
    v_mfma_f32_16x16x32_bf16 v[104:107], a[204:207], v[172:175], v[104:107]
    ds_read_b64_tr_b16 a[196:197], v8 offset:8
    ds_read_b64_tr_b16 a[198:199], v9 offset:8
    v_rcp_f16 v31, v30
    v_mfma_f32_16x16x32_bf16 v[112:115], a[204:207], v[196:199], v[112:115]
    v_rcp_f16_sdwa v29, v28 dst_sel:WORD_1 dst_unused:UNUSED_PRESERVE src0_sel:WORD_1
    v_rcp_f16_sdwa v31, v30 dst_sel:WORD_1 dst_unused:UNUSED_PRESERVE src0_sel:WORD_1
    v_mfma_f32_16x16x32_bf16 v[120:123], a[204:207], v[220:223], v[120:123]
    s_waitcnt lgkmcnt(6)
    v_fma_mix_f32 v28, v84, v29, 0 op_sel_hi:[0,1,0]
    v_fma_mix_f32 v30, v86, v31, 0 op_sel_hi:[0,1,0]
    v_fma_mix_f32 v29, v85, v29, 0 op_sel:[0,1,0] op_sel_hi:[0,1,0]
    v_fma_mix_f32 v31, v87, v31, 0 op_sel:[0,1,0] op_sel_hi:[0,1,0]
    v_mfma_f32_16x16x32_bf16 v[104:107], a[208:211], v[176:179], v[104:107]
    ds_read_b64_tr_b16 a[200:201], v8 offset:512
    ds_read_b64_tr_b16 a[202:203], v9 offset:512
    v_cvt_pk_bf16_f32 v56, v28, v29
    v_mfma_f32_16x16x32_bf16 v[112:115], a[208:211], v[200:203], v[112:115]
    v_cvt_pk_bf16_f32 v57, v30, v31
    v_cvt_pk_f16_f32 v32, v88, v89
    v_cvt_pk_f16_f32 v34, v90, v91
    v_pk_fma_f16 v33, v32, v32, s32
    v_mfma_f32_16x16x32_bf16 v[120:123], a[208:211], v[224:227], v[120:123]
    s_waitcnt lgkmcnt(6)
    v_pk_fma_f16 v35, v34, v34, s32
    v_pk_mul_f16 v32, v32, v33 neg_lo:[1,0] neg_hi:[1,0]
    v_pk_mul_f16 v34, v34, v35 neg_lo:[1,0] neg_hi:[1,0]
    v_mfma_f32_16x16x32_bf16 v[104:107], a[212:215], v[180:183], v[104:107]
    ds_read_b64_tr_b16 a[204:205], v8 offset:520
    ds_read_b64_tr_b16 a[206:207], v9 offset:520
    v_exp_f16 v33, v32
    v_mfma_f32_16x16x32_bf16 v[112:115], a[212:215], v[204:207], v[112:115]
    v_exp_f16 v35, v34
    v_exp_f16_sdwa v33, v32 dst_sel:WORD_1 dst_unused:UNUSED_PRESERVE src0_sel:WORD_1
    v_mfma_f32_16x16x32_bf16 v[120:123], a[212:215], v[228:231], v[120:123]
    s_waitcnt lgkmcnt(6)
    v_exp_f16_sdwa v35, v34 dst_sel:WORD_1 dst_unused:UNUSED_PRESERVE src0_sel:WORD_1
    v_pk_add_f16 v32, v33, 1.0 op_sel_hi:[1,0]
    v_pk_add_f16 v34, v35, 1.0 op_sel_hi:[1,0]
    v_mfma_f32_16x16x32_bf16 a[0:3], a[192:195], v[64:67], a[0:3]
    ds_read_b64_tr_b16 a[208:209], v8 offset:1024
    ds_read_b64_tr_b16 a[210:211], v9 offset:1024
    v_mfma_f32_16x16x32_bf16 a[48:51], a[192:195], v[68:71], a[48:51]
    v_rcp_f16 v33, v32
    v_rcp_f16 v35, v34
    v_mfma_f32_16x16x32_bf16 a[96:99], a[192:195], v[72:75], a[96:99]
    s_waitcnt lgkmcnt(6)
    v_rcp_f16_sdwa v33, v32 dst_sel:WORD_1 dst_unused:UNUSED_PRESERVE src0_sel:WORD_1
    v_rcp_f16_sdwa v35, v34 dst_sel:WORD_1 dst_unused:UNUSED_PRESERVE src0_sel:WORD_1
    v_mfma_f32_16x16x32_bf16 a[4:7], a[196:199], v[64:67], a[4:7]
    ds_read_b64_tr_b16 a[212:213], v8 offset:1032
    ds_read_b64_tr_b16 a[214:215], v9 offset:1032
    v_fma_mix_f32 v32, v88, v33, 0 op_sel_hi:[0,1,0]
    v_fma_mix_f32 v34, v90, v35, 0 op_sel_hi:[0,1,0]
    v_mfma_f32_16x16x32_bf16 a[52:55], a[196:199], v[68:71], a[52:55]
    v_fma_mix_f32 v33, v89, v33, 0 op_sel:[0,1,0] op_sel_hi:[0,1,0]
    v_fma_mix_f32 v35, v91, v35, 0 op_sel:[0,1,0] op_sel_hi:[0,1,0]
    v_cvt_pk_bf16_f32 v58, v32, v33
    v_cvt_pk_bf16_f32 v59, v34, v35
    v_mfma_f32_16x16x32_bf16 a[100:103], a[196:199], v[72:75], a[100:103]
    s_waitcnt lgkmcnt(6)
    v_cvt_pk_f16_f32 v28, v92, v93
    v_cvt_pk_f16_f32 v30, v94, v95
    v_pk_fma_f16 v29, v28, v28, s32
    v_mfma_f32_16x16x32_bf16 a[8:11], a[200:203], v[64:67], a[8:11]
    ds_read_b64_tr_b16 a[192:193], v8 offset:1536
    ds_read_b64_tr_b16 a[194:195], v9 offset:1536
    v_pk_fma_f16 v31, v30, v30, s32
    v_pk_mul_f16 v28, v28, v29 neg_lo:[1,0] neg_hi:[1,0]
    v_mfma_f32_16x16x32_bf16 a[56:59], a[200:203], v[68:71], a[56:59]
    v_pk_mul_f16 v30, v30, v31 neg_lo:[1,0] neg_hi:[1,0]
    v_exp_f16 v29, v28
    v_mfma_f32_16x16x32_bf16 a[104:107], a[200:203], v[72:75], a[104:107]
    s_waitcnt lgkmcnt(6)
    v_exp_f16 v31, v30
    v_exp_f16_sdwa v29, v28 dst_sel:WORD_1 dst_unused:UNUSED_PRESERVE src0_sel:WORD_1
    v_mfma_f32_16x16x32_bf16 a[12:15], a[204:207], v[64:67], a[12:15]
    ds_read_b64_tr_b16 a[196:197], v8 offset:1544
    ds_read_b64_tr_b16 a[198:199], v9 offset:1544
    v_exp_f16_sdwa v31, v30 dst_sel:WORD_1 dst_unused:UNUSED_PRESERVE src0_sel:WORD_1
    v_mfma_f32_16x16x32_bf16 a[60:63], a[204:207], v[68:71], a[60:63]
    v_pk_add_f16 v28, v29, 1.0 op_sel_hi:[1,0]
    v_pk_add_f16 v30, v31, 1.0 op_sel_hi:[1,0]
    v_mfma_f32_16x16x32_bf16 a[108:111], a[204:207], v[72:75], a[108:111]
    s_waitcnt lgkmcnt(6)
    v_rcp_f16 v29, v28
    v_rcp_f16 v31, v30
    v_mfma_f32_16x16x32_bf16 a[16:19], a[208:211], v[64:67], a[16:19]
    ds_read_b64_tr_b16 a[200:201], v8 offset:2048
    ds_read_b64_tr_b16 a[202:203], v9 offset:2048
    v_rcp_f16_sdwa v29, v28 dst_sel:WORD_1 dst_unused:UNUSED_PRESERVE src0_sel:WORD_1
    v_mfma_f32_16x16x32_bf16 a[64:67], a[208:211], v[68:71], a[64:67]
    v_rcp_f16_sdwa v31, v30 dst_sel:WORD_1 dst_unused:UNUSED_PRESERVE src0_sel:WORD_1
    v_fma_mix_f32 v28, v92, v29, 0 op_sel_hi:[0,1,0]
    v_fma_mix_f32 v30, v94, v31, 0 op_sel_hi:[0,1,0]
    v_mfma_f32_16x16x32_bf16 a[112:115], a[208:211], v[72:75], a[112:115]
    s_waitcnt lgkmcnt(6)
    v_fma_mix_f32 v29, v93, v29, 0 op_sel:[0,1,0] op_sel_hi:[0,1,0]
    v_fma_mix_f32 v31, v95, v31, 0 op_sel:[0,1,0] op_sel_hi:[0,1,0]
    v_cvt_pk_bf16_f32 v60, v28, v29
    v_cvt_pk_bf16_f32 v61, v30, v31
    v_mfma_f32_16x16x32_bf16 a[20:23], a[212:215], v[64:67], a[20:23]
    ds_read_b64_tr_b16 a[204:205], v8 offset:2056
    ds_read_b64_tr_b16 a[206:207], v9 offset:2056
    v_cvt_pk_f16_f32 v32, v96, v97
    v_cvt_pk_f16_f32 v34, v98, v99
    v_mfma_f32_16x16x32_bf16 a[68:71], a[212:215], v[68:71], a[68:71]
    v_pk_fma_f16 v33, v32, v32, s32
    v_pk_fma_f16 v35, v34, v34, s32
    v_pk_mul_f16 v32, v32, v33 neg_lo:[1,0] neg_hi:[1,0]
    v_mfma_f32_16x16x32_bf16 a[116:119], a[212:215], v[72:75], a[116:119]
    s_waitcnt lgkmcnt(6)
    v_pk_mul_f16 v34, v34, v35 neg_lo:[1,0] neg_hi:[1,0]
    v_exp_f16 v33, v32
    v_mfma_f32_16x16x32_bf16 a[24:27], a[192:195], v[64:67], a[24:27]
    ds_read_b64_tr_b16 a[208:209], v8 offset:2560
    ds_read_b64_tr_b16 a[210:211], v9 offset:2560
    v_exp_f16 v35, v34
    v_mfma_f32_16x16x32_bf16 a[72:75], a[192:195], v[68:71], a[72:75]
    v_exp_f16_sdwa v33, v32 dst_sel:WORD_1 dst_unused:UNUSED_PRESERVE src0_sel:WORD_1
    v_exp_f16_sdwa v35, v34 dst_sel:WORD_1 dst_unused:UNUSED_PRESERVE src0_sel:WORD_1
    v_mfma_f32_16x16x32_bf16 a[120:123], a[192:195], v[72:75], a[120:123]
    s_waitcnt lgkmcnt(6)
    v_pk_add_f16 v32, v33, 1.0 op_sel_hi:[1,0]
    v_pk_add_f16 v34, v35, 1.0 op_sel_hi:[1,0]
    v_rcp_f16 v33, v32
    v_mfma_f32_16x16x32_bf16 a[28:31], a[196:199], v[64:67], a[28:31]
    ds_read_b64_tr_b16 a[212:213], v8 offset:2568
    ds_read_b64_tr_b16 a[214:215], v9 offset:2568
    v_add_u32 v8, s33, v8
    v_add_u32 v9, s33, v9
    v_mfma_f32_16x16x32_bf16 a[76:79], a[196:199], v[68:71], a[76:79]
    v_rcp_f16 v35, v34
    v_mfma_f32_16x16x32_bf16 a[124:127], a[196:199], v[72:75], a[124:127]
    s_waitcnt lgkmcnt(6)
    v_rcp_f16_sdwa v33, v32 dst_sel:WORD_1 dst_unused:UNUSED_PRESERVE src0_sel:WORD_1
    v_rcp_f16_sdwa v35, v34 dst_sel:WORD_1 dst_unused:UNUSED_PRESERVE src0_sel:WORD_1
    v_fma_mix_f32 v32, v96, v33, 0 op_sel_hi:[0,1,0]
    v_mfma_f32_16x16x32_bf16 a[32:35], a[200:203], v[64:67], a[32:35]
    ds_read_b64_tr_b16 a[192:193], v6 offset:0
    ds_read_b64_tr_b16 a[194:195], v7 offset:0
    v_fma_mix_f32 v34, v98, v35, 0 op_sel_hi:[0,1,0]
    v_mfma_f32_16x16x32_bf16 a[80:83], a[200:203], v[68:71], a[80:83]
    v_fma_mix_f32 v33, v97, v33, 0 op_sel:[0,1,0] op_sel_hi:[0,1,0]
    v_fma_mix_f32 v35, v99, v35, 0 op_sel:[0,1,0] op_sel_hi:[0,1,0]
    v_cvt_pk_bf16_f32 v62, v32, v33
    v_cvt_pk_bf16_f32 v63, v34, v35
    v_mfma_f32_16x16x32_bf16 a[128:131], a[200:203], v[72:75], a[128:131]
    s_waitcnt lgkmcnt(6)
    v_cvt_pk_f16_f32 v28, v44, v45
    v_cvt_pk_f16_f32 v30, v46, v47
    v_pk_fma_f16 v29, v28, v28, s32
    v_mfma_f32_16x16x32_bf16 a[36:39], a[204:207], v[64:67], a[36:39]
    ds_read_b64_tr_b16 a[196:197], v6 offset:8
    ds_read_b64_tr_b16 a[198:199], v7 offset:8
    v_pk_fma_f16 v31, v30, v30, s32
    v_pk_mul_f16 v28, v28, v29 neg_lo:[1,0] neg_hi:[1,0]
    v_mfma_f32_16x16x32_bf16 a[84:87], a[204:207], v[68:71], a[84:87]
    v_pk_mul_f16 v30, v30, v31 neg_lo:[1,0] neg_hi:[1,0]
    v_exp_f16 v29, v28
    v_mfma_f32_16x16x32_bf16 a[132:135], a[204:207], v[72:75], a[132:135]
    s_waitcnt lgkmcnt(6)
    v_exp_f16 v31, v30
    v_exp_f16_sdwa v29, v28 dst_sel:WORD_1 dst_unused:UNUSED_PRESERVE src0_sel:WORD_1
    v_mfma_f32_16x16x32_bf16 a[40:43], a[208:211], v[64:67], a[40:43]
    ds_read_b64_tr_b16 a[200:201], v6 offset:512
    ds_read_b64_tr_b16 a[202:203], v7 offset:512
    v_exp_f16_sdwa v31, v30 dst_sel:WORD_1 dst_unused:UNUSED_PRESERVE src0_sel:WORD_1
    v_mfma_f32_16x16x32_bf16 a[88:91], a[208:211], v[68:71], a[88:91]
    v_pk_add_f16 v28, v29, 1.0 op_sel_hi:[1,0]
    v_pk_add_f16 v30, v31, 1.0 op_sel_hi:[1,0]
    v_rcp_f16 v29, v28
    v_mfma_f32_16x16x32_bf16 a[136:139], a[208:211], v[72:75], a[136:139]
    s_waitcnt lgkmcnt(6)
    v_rcp_f16 v31, v30
    v_mfma_f32_16x16x32_bf16 a[44:47], a[212:215], v[64:67], a[44:47]
    ds_read_b64_tr_b16 a[204:205], v6 offset:520
    ds_read_b64_tr_b16 a[206:207], v7 offset:520
    v_rcp_f16_sdwa v29, v28 dst_sel:WORD_1 dst_unused:UNUSED_PRESERVE src0_sel:WORD_1
    v_mfma_f32_16x16x32_bf16 a[92:95], a[212:215], v[68:71], a[92:95]
    s_mov_b32 s33, s38
    v_rcp_f16_sdwa v31, v30 dst_sel:WORD_1 dst_unused:UNUSED_PRESERVE src0_sel:WORD_1
    v_fma_mix_f32 v28, v44, v29, 0 op_sel_hi:[0,1,0]
    v_fma_mix_f32 v30, v46, v31, 0 op_sel_hi:[0,1,0]
    v_mfma_f32_16x16x32_bf16 a[140:143], a[212:215], v[72:75], a[140:143]
    s_waitcnt lgkmcnt(6)
    v_fma_mix_f32 v29, v45, v29, 0 op_sel:[0,1,0] op_sel_hi:[0,1,0]
    v_fma_mix_f32 v31, v47, v31, 0 op_sel:[0,1,0] op_sel_hi:[0,1,0]
    v_cvt_pk_bf16_f32 v48, v28, v29
    v_cvt_pk_bf16_f32 v49, v30, v31
    s_mul_i32 s39, s28, 258048
    s_add_u32 s39, s39, s29
    s_mul_i32 s40, s28, 12288
    s_add_u32 s41, s40, 49408
    s_add_u32 s40, s40, 98816
    v_lshlrev_b32 v18, 4, v1
    v_add_u32 v19, s41, v18
    v_mfma_f32_16x16x32_bf16 a[0:3], a[192:195], v[52:55], a[0:3]
    ds_read_b64_tr_b16 a[208:209], v6 offset:1024
    ds_read_b64_tr_b16 a[210:211], v7 offset:1024
    v_cvt_pk_f16_f32 v28, v100, v101
    v_cvt_pk_f16_f32 v30, v102, v103
    v_pk_fma_f16 v29, v28, v28, s32
    v_mfma_f32_16x16x32_bf16 a[48:51], a[192:195], v[56:59], a[48:51]
    v_pk_fma_f16 v31, v30, v30, s32
    v_pk_mul_f16 v28, v28, v29 neg_lo:[1,0] neg_hi:[1,0]
    v_pk_mul_f16 v30, v30, v31 neg_lo:[1,0] neg_hi:[1,0]
    v_exp_f16 v29, v28
    v_mfma_f32_16x16x16_bf16 a[144:147], a[192:193], v[48:49], a[144:147]
    v_exp_f16 v31, v30
    v_exp_f16_sdwa v29, v28 dst_sel:WORD_1 dst_unused:UNUSED_PRESERVE src0_sel:WORD_1
    v_exp_f16_sdwa v31, v30 dst_sel:WORD_1 dst_unused:UNUSED_PRESERVE src0_sel:WORD_1
    v_mfma_f32_16x16x32_bf16 a[96:99], a[192:195], v[60:63], a[96:99]
    s_waitcnt lgkmcnt(6)
    v_pk_add_f16 v28, v29, 1.0 op_sel_hi:[1,0]
    v_pk_add_f16 v30, v31, 1.0 op_sel_hi:[1,0]
    v_rcp_f16 v29, v28
    v_mfma_f32_16x16x32_bf16 a[4:7], a[196:199], v[52:55], a[4:7]
    ds_read_b64_tr_b16 a[212:213], v6 offset:1032
    ds_read_b64_tr_b16 a[214:215], v7 offset:1032
    v_rcp_f16 v31, v30
    v_rcp_f16_sdwa v29, v28 dst_sel:WORD_1 dst_unused:UNUSED_PRESERVE src0_sel:WORD_1
    v_mfma_f32_16x16x32_bf16 a[52:55], a[196:199], v[56:59], a[52:55]
    v_rcp_f16_sdwa v31, v30 dst_sel:WORD_1 dst_unused:UNUSED_PRESERVE src0_sel:WORD_1
    v_fma_mix_f32 v28, v100, v29, 0 op_sel_hi:[0,1,0]
    v_fma_mix_f32 v30, v102, v31, 0 op_sel_hi:[0,1,0]
    v_fma_mix_f32 v29, v101, v29, 0 op_sel:[0,1,0] op_sel_hi:[0,1,0]
    v_mfma_f32_16x16x16_bf16 a[148:151], a[196:197], v[48:49], a[148:151]
    v_fma_mix_f32 v31, v103, v31, 0 op_sel:[0,1,0] op_sel_hi:[0,1,0]
    v_cvt_pk_bf16_f32 v64, v28, v29
    v_cvt_pk_bf16_f32 v65, v30, v31
    v_cvt_pk_f16_f32 v32, v104, v105
    v_cvt_pk_f16_f32 v34, v106, v107
    v_pk_fma_f16 v33, v32, v32, s32
    v_mfma_f32_16x16x32_bf16 a[100:103], a[196:199], v[60:63], a[100:103]
    s_waitcnt lgkmcnt(6)
    v_pk_fma_f16 v35, v34, v34, s32
    v_pk_mul_f16 v32, v32, v33 neg_lo:[1,0] neg_hi:[1,0]
    v_pk_mul_f16 v34, v34, v35 neg_lo:[1,0] neg_hi:[1,0]
    v_exp_f16 v33, v32
    v_mfma_f32_16x16x32_bf16 a[8:11], a[200:203], v[52:55], a[8:11]
    ds_read_b64_tr_b16 a[192:193], v6 offset:1536
    ds_read_b64_tr_b16 a[194:195], v7 offset:1536
    v_exp_f16 v35, v34
    v_mfma_f32_16x16x32_bf16 a[56:59], a[200:203], v[56:59], a[56:59]
    ds_write_b128 v19, a[144:147] offset:0
    v_mfma_f32_16x16x16_bf16 a[152:155], a[200:201], v[48:49], a[152:155]
    v_exp_f16_sdwa v33, v32 dst_sel:WORD_1 dst_unused:UNUSED_PRESERVE src0_sel:WORD_1
    v_exp_f16_sdwa v35, v34 dst_sel:WORD_1 dst_unused:UNUSED_PRESERVE src0_sel:WORD_1
    v_pk_add_f16 v32, v33, 1.0 op_sel_hi:[1,0]
    v_pk_add_f16 v34, v35, 1.0 op_sel_hi:[1,0]
    v_mfma_f32_16x16x32_bf16 a[104:107], a[200:203], v[60:63], a[104:107]
    s_waitcnt lgkmcnt(7)
    v_rcp_f16 v33, v32
    v_rcp_f16 v35, v34
    v_rcp_f16_sdwa v33, v32 dst_sel:WORD_1 dst_unused:UNUSED_PRESERVE src0_sel:WORD_1
    v_mfma_f32_16x16x32_bf16 a[12:15], a[204:207], v[52:55], a[12:15]
    ds_read_b64_tr_b16 a[196:197], v6 offset:1544
    ds_read_b64_tr_b16 a[198:199], v7 offset:1544
    v_rcp_f16_sdwa v35, v34 dst_sel:WORD_1 dst_unused:UNUSED_PRESERVE src0_sel:WORD_1
    v_fma_mix_f32 v32, v104, v33, 0 op_sel_hi:[0,1,0]
    v_fma_mix_f32 v34, v106, v35, 0 op_sel_hi:[0,1,0]
    v_mfma_f32_16x16x32_bf16 a[60:63], a[204:207], v[56:59], a[60:63]
    ds_write_b128 v19, a[148:151] offset:1024
    v_mfma_f32_16x16x16_bf16 a[156:159], a[204:205], v[48:49], a[156:159]
    v_fma_mix_f32 v33, v105, v33, 0 op_sel:[0,1,0] op_sel_hi:[0,1,0]
    v_fma_mix_f32 v35, v107, v35, 0 op_sel:[0,1,0] op_sel_hi:[0,1,0]
    v_cvt_pk_bf16_f32 v66, v32, v33
    v_cvt_pk_bf16_f32 v67, v34, v35
    v_cvt_pk_f16_f32 v28, v108, v109
    v_cvt_pk_f16_f32 v30, v110, v111
    v_mfma_f32_16x16x32_bf16 a[108:111], a[204:207], v[60:63], a[108:111]
    s_waitcnt lgkmcnt(8)
    v_pk_fma_f16 v29, v28, v28, s32
    v_pk_fma_f16 v31, v30, v30, s32
    v_pk_mul_f16 v28, v28, v29 neg_lo:[1,0] neg_hi:[1,0]
    v_pk_mul_f16 v30, v30, v31 neg_lo:[1,0] neg_hi:[1,0]
    v_mfma_f32_16x16x32_bf16 a[16:19], a[208:211], v[52:55], a[16:19]
    ds_read_b64_tr_b16 a[200:201], v6 offset:2048
    ds_read_b64_tr_b16 a[202:203], v7 offset:2048
    v_exp_f16 v29, v28
    v_exp_f16 v31, v30
    v_mfma_f32_16x16x32_bf16 a[64:67], a[208:211], v[56:59], a[64:67]
    ds_write_b128 v19, a[152:155] offset:2048
    v_mfma_f32_16x16x16_bf16 a[160:163], a[208:209], v[48:49], a[160:163]
    v_exp_f16_sdwa v29, v28 dst_sel:WORD_1 dst_unused:UNUSED_PRESERVE src0_sel:WORD_1
    v_exp_f16_sdwa v31, v30 dst_sel:WORD_1 dst_unused:UNUSED_PRESERVE src0_sel:WORD_1
    v_pk_add_f16 v28, v29, 1.0 op_sel_hi:[1,0]
    v_pk_add_f16 v30, v31, 1.0 op_sel_hi:[1,0]
    v_mfma_f32_16x16x32_bf16 a[112:115], a[208:211], v[60:63], a[112:115]
    s_waitcnt lgkmcnt(9)
    v_rcp_f16 v29, v28
    v_rcp_f16 v31, v30
    v_mfma_f32_16x16x32_bf16 a[20:23], a[212:215], v[52:55], a[20:23]
    ds_read_b64_tr_b16 a[204:205], v6 offset:2056
    ds_read_b64_tr_b16 a[206:207], v7 offset:2056
    v_rcp_f16_sdwa v29, v28 dst_sel:WORD_1 dst_unused:UNUSED_PRESERVE src0_sel:WORD_1
    v_rcp_f16_sdwa v31, v30 dst_sel:WORD_1 dst_unused:UNUSED_PRESERVE src0_sel:WORD_1
    v_mfma_f32_16x16x32_bf16 a[68:71], a[212:215], v[56:59], a[68:71]
    ds_write_b128 v19, a[156:159] offset:3072
    v_mfma_f32_16x16x16_bf16 a[164:167], a[212:213], v[48:49], a[164:167]
    v_fma_mix_f32 v28, v108, v29, 0 op_sel_hi:[0,1,0]
    v_fma_mix_f32 v30, v110, v31, 0 op_sel_hi:[0,1,0]
    v_fma_mix_f32 v29, v109, v29, 0 op_sel:[0,1,0] op_sel_hi:[0,1,0]
    v_fma_mix_f32 v31, v111, v31, 0 op_sel:[0,1,0] op_sel_hi:[0,1,0]
    v_cvt_pk_bf16_f32 v68, v28, v29
    v_cvt_pk_bf16_f32 v69, v30, v31
    v_mfma_f32_16x16x32_bf16 a[116:119], a[212:215], v[60:63], a[116:119]
    s_waitcnt lgkmcnt(10)
    v_cvt_pk_f16_f32 v32, v112, v113
    v_cvt_pk_f16_f32 v34, v114, v115
    v_pk_fma_f16 v33, v32, v32, s32
    v_pk_fma_f16 v35, v34, v34, s32
    v_pk_mul_f16 v32, v32, v33 neg_lo:[1,0] neg_hi:[1,0]
    v_mfma_f32_16x16x32_bf16 a[24:27], a[192:195], v[52:55], a[24:27]
    ds_read_b64_tr_b16 a[208:209], v6 offset:2560
    ds_read_b64_tr_b16 a[210:211], v7 offset:2560
    v_pk_mul_f16 v34, v34, v35 neg_lo:[1,0] neg_hi:[1,0]
    v_exp_f16 v33, v32
    v_mfma_f32_16x16x32_bf16 a[72:75], a[192:195], v[56:59], a[72:75]
    ds_write_b128 v19, a[160:163] offset:4096
    v_mfma_f32_16x16x16_bf16 a[168:171], a[192:193], v[48:49], a[168:171]
    v_exp_f16 v35, v34
    v_exp_f16_sdwa v33, v32 dst_sel:WORD_1 dst_unused:UNUSED_PRESERVE src0_sel:WORD_1
    v_exp_f16_sdwa v35, v34 dst_sel:WORD_1 dst_unused:UNUSED_PRESERVE src0_sel:WORD_1
    v_mfma_f32_16x16x32_bf16 a[120:123], a[192:195], v[60:63], a[120:123]
    s_waitcnt lgkmcnt(10)
    v_pk_add_f16 v32, v33, 1.0 op_sel_hi:[1,0]
    v_pk_add_f16 v34, v35, 1.0 op_sel_hi:[1,0]
    v_rcp_f16 v33, v32
    v_mfma_f32_16x16x32_bf16 a[28:31], a[196:199], v[52:55], a[28:31]
    ds_read_b64_tr_b16 a[212:213], v6 offset:2568
    ds_read_b64_tr_b16 a[214:215], v7 offset:2568
    v_rcp_f16 v35, v34
    v_rcp_f16_sdwa v33, v32 dst_sel:WORD_1 dst_unused:UNUSED_PRESERVE src0_sel:WORD_1
    v_mfma_f32_16x16x32_bf16 a[76:79], a[196:199], v[56:59], a[76:79]
    ds_write_b128 v19, a[164:167] offset:5120
    v_mfma_f32_16x16x16_bf16 a[172:175], a[196:197], v[48:49], a[172:175]
    v_rcp_f16_sdwa v35, v34 dst_sel:WORD_1 dst_unused:UNUSED_PRESERVE src0_sel:WORD_1
    v_fma_mix_f32 v32, v112, v33, 0 op_sel_hi:[0,1,0]
    v_fma_mix_f32 v34, v114, v35, 0 op_sel_hi:[0,1,0]
    v_fma_mix_f32 v33, v113, v33, 0 op_sel:[0,1,0] op_sel_hi:[0,1,0]
    v_fma_mix_f32 v35, v115, v35, 0 op_sel:[0,1,0] op_sel_hi:[0,1,0]
    v_mfma_f32_16x16x32_bf16 a[124:127], a[196:199], v[60:63], a[124:127]
    s_waitcnt lgkmcnt(10)
    v_cvt_pk_bf16_f32 v70, v32, v33
    v_cvt_pk_bf16_f32 v71, v34, v35
    v_cvt_pk_f16_f32 v28, v116, v117
    v_cvt_pk_f16_f32 v30, v118, v119
    v_pk_fma_f16 v29, v28, v28, s32
    v_mfma_f32_16x16x32_bf16 a[32:35], a[200:203], v[52:55], a[32:35]
    ds_read_b64_tr_b16 a[192:193], v8 offset:0
    ds_read_b64_tr_b16 a[194:195], v9 offset:0
    v_pk_fma_f16 v31, v30, v30, s32
    v_pk_mul_f16 v28, v28, v29 neg_lo:[1,0] neg_hi:[1,0]
    v_pk_mul_f16 v30, v30, v31 neg_lo:[1,0] neg_hi:[1,0]
    v_mfma_f32_16x16x32_bf16 a[80:83], a[200:203], v[56:59], a[80:83]
    ds_write_b128 v19, a[168:171] offset:6144
    v_mfma_f32_16x16x16_bf16 a[176:179], a[200:201], v[48:49], a[176:179]
    v_exp_f16 v29, v28
    v_exp_f16 v31, v30
    v_exp_f16_sdwa v29, v28 dst_sel:WORD_1 dst_unused:UNUSED_PRESERVE src0_sel:WORD_1
    v_mfma_f32_16x16x32_bf16 a[128:131], a[200:203], v[60:63], a[128:131]
    s_waitcnt lgkmcnt(10)
    v_exp_f16_sdwa v31, v30 dst_sel:WORD_1 dst_unused:UNUSED_PRESERVE src0_sel:WORD_1
    v_pk_add_f16 v28, v29, 1.0 op_sel_hi:[1,0]
    v_pk_add_f16 v30, v31, 1.0 op_sel_hi:[1,0]
    v_rcp_f16 v29, v28
    v_mfma_f32_16x16x32_bf16 a[36:39], a[204:207], v[52:55], a[36:39]
    ds_read_b64_tr_b16 a[196:197], v8 offset:8
    ds_read_b64_tr_b16 a[198:199], v9 offset:8
    v_rcp_f16 v31, v30
    v_mfma_f32_16x16x32_bf16 a[84:87], a[204:207], v[56:59], a[84:87]
    ds_write_b128 v19, a[172:175] offset:7168
    v_mfma_f32_16x16x16_bf16 a[180:183], a[204:205], v[48:49], a[180:183]
    v_rcp_f16_sdwa v29, v28 dst_sel:WORD_1 dst_unused:UNUSED_PRESERVE src0_sel:WORD_1
    v_rcp_f16_sdwa v31, v30 dst_sel:WORD_1 dst_unused:UNUSED_PRESERVE src0_sel:WORD_1
    v_fma_mix_f32 v28, v116, v29, 0 op_sel_hi:[0,1,0]
    v_fma_mix_f32 v30, v118, v31, 0 op_sel_hi:[0,1,0]
    v_fma_mix_f32 v29, v117, v29, 0 op_sel:[0,1,0] op_sel_hi:[0,1,0]
    v_mfma_f32_16x16x32_bf16 a[132:135], a[204:207], v[60:63], a[132:135]
    s_waitcnt lgkmcnt(10)
    v_fma_mix_f32 v31, v119, v31, 0 op_sel:[0,1,0] op_sel_hi:[0,1,0]
    v_cvt_pk_bf16_f32 v72, v28, v29
    v_cvt_pk_bf16_f32 v73, v30, v31
    v_cvt_pk_f16_f32 v32, v120, v121
    v_cvt_pk_f16_f32 v34, v122, v123
    v_mfma_f32_16x16x32_bf16 a[40:43], a[208:211], v[52:55], a[40:43]
    ds_read_b64_tr_b16 a[200:201], v8 offset:512
    ds_read_b64_tr_b16 a[202:203], v9 offset:512
    v_pk_fma_f16 v33, v32, v32, s32
    v_pk_fma_f16 v35, v34, v34, s32
    v_pk_mul_f16 v32, v32, v33 neg_lo:[1,0] neg_hi:[1,0]
    v_mfma_f32_16x16x32_bf16 a[88:91], a[208:211], v[56:59], a[88:91]
    ds_write_b128 v19, a[176:179] offset:8192
    v_mfma_f32_16x16x16_bf16 a[184:187], a[208:209], v[48:49], a[184:187]
    v_pk_mul_f16 v34, v34, v35 neg_lo:[1,0] neg_hi:[1,0]
    v_exp_f16 v33, v32
    v_exp_f16 v35, v34
    v_mfma_f32_16x16x32_bf16 a[136:139], a[208:211], v[60:63], a[136:139]
    s_waitcnt lgkmcnt(10)
    v_exp_f16_sdwa v33, v32 dst_sel:WORD_1 dst_unused:UNUSED_PRESERVE src0_sel:WORD_1
    v_exp_f16_sdwa v35, v34 dst_sel:WORD_1 dst_unused:UNUSED_PRESERVE src0_sel:WORD_1
    v_pk_add_f16 v32, v33, 1.0 op_sel_hi:[1,0]
    v_pk_add_f16 v34, v35, 1.0 op_sel_hi:[1,0]
    v_mfma_f32_16x16x32_bf16 a[44:47], a[212:215], v[52:55], a[44:47]
    ds_read_b64_tr_b16 a[204:205], v8 offset:520
    ds_read_b64_tr_b16 a[206:207], v9 offset:520
    v_rcp_f16 v33, v32
    v_mfma_f32_16x16x32_bf16 a[92:95], a[212:215], v[56:59], a[92:95]
    ds_write_b128 v19, a[180:183] offset:9216
    v_mfma_f32_16x16x16_bf16 a[188:191], a[212:213], v[48:49], a[188:191]
    v_rcp_f16 v35, v34
    v_rcp_f16_sdwa v33, v32 dst_sel:WORD_1 dst_unused:UNUSED_PRESERVE src0_sel:WORD_1
    v_rcp_f16_sdwa v35, v34 dst_sel:WORD_1 dst_unused:UNUSED_PRESERVE src0_sel:WORD_1
    v_fma_mix_f32 v32, v120, v33, 0 op_sel_hi:[0,1,0]
    v_mfma_f32_16x16x32_bf16 a[140:143], a[212:215], v[60:63], a[140:143]
    s_waitcnt lgkmcnt(10)
    v_fma_mix_f32 v34, v122, v35, 0 op_sel_hi:[0,1,0]
    v_fma_mix_f32 v33, v121, v33, 0 op_sel:[0,1,0] op_sel_hi:[0,1,0]
    v_fma_mix_f32 v35, v123, v35, 0 op_sel:[0,1,0] op_sel_hi:[0,1,0]
    v_cvt_pk_bf16_f32 v74, v32, v33
    v_cvt_pk_bf16_f32 v75, v34, v35
    v_mfma_f32_16x16x32_bf16 a[0:3], a[192:195], v[64:67], a[0:3]
    ds_read_b64_tr_b16 a[208:209], v8 offset:1024
    ds_read_b64_tr_b16 a[210:211], v9 offset:1024
    v_mfma_f32_16x16x32_bf16 a[48:51], a[192:195], v[68:71], a[48:51]
    v_and_b32 v12, 15, v1
    v_lshrrev_b32 v13, 4, v1
    v_lshl_add_u32 v2, v12, 7, s40
    v_mfma_f32_16x16x32_bf16 a[96:99], a[192:195], v[72:75], a[96:99]
    s_waitcnt lgkmcnt(9)
    ds_read_b128 v[76:79], v17 offset:1024
    v_and_b32 v12, 7, v12
    v_mfma_f32_16x16x32_bf16 a[4:7], a[196:199], v[64:67], a[4:7]
    ds_read_b64_tr_b16 a[212:213], v8 offset:1032
    ds_read_b64_tr_b16 a[214:215], v9 offset:1032
    v_mfma_f32_16x16x32_bf16 a[52:55], a[196:199], v[68:71], a[52:55]
    v_xor_b32 v13, v12, v13
    v_lshl_add_u32 v2, v13, 4, v2
    v_xor_b32 v3, 64, v2
    v_mfma_f32_16x16x32_bf16 a[100:103], a[196:199], v[72:75], a[100:103]
    s_waitcnt lgkmcnt(9)
    ds_read_b128 v[80:83], v17 offset:1040
    v_lshrrev_b32 v13, 3, v1
    v_mfma_f32_16x16x32_bf16 a[8:11], a[200:203], v[64:67], a[8:11]
    ds_read_b64_tr_b16 a[192:193], v8 offset:1536
    ds_read_b64_tr_b16 a[194:195], v9 offset:1536
    v_mfma_f32_16x16x32_bf16 a[56:59], a[200:203], v[68:71], a[56:59]
    ds_write_b128 v19, a[184:187] offset:10240
    v_mfma_f32_16x16x32_bf16 a[104:107], a[200:203], v[72:75], a[104:107]
    s_waitcnt lgkmcnt(10)
    ds_read_b128 v[84:87], v17 offset:1152
    v_xor_b32 v4, v13, v1
    v_mfma_f32_16x16x32_bf16 a[12:15], a[204:207], v[64:67], a[12:15]
    ds_read_b64_tr_b16 a[196:197], v8 offset:1544
    ds_read_b64_tr_b16 a[198:199], v9 offset:1544
    v_mfma_f32_16x16x32_bf16 a[60:63], a[204:207], v[68:71], a[60:63]
    v_lshl_add_u32 v4, v4, 4, s40
    v_mul_u32_u24 v13, 384, v13
    v_mfma_f32_16x16x32_bf16 a[108:111], a[204:207], v[72:75], a[108:111]
    s_waitcnt lgkmcnt(10)
    ds_read_b128 v[88:91], v17 offset:1168
    v_lshl_add_u32 v5, v12, 4, v13
    v_mfma_f32_16x16x32_bf16 a[16:19], a[208:211], v[64:67], a[16:19]
    ds_read_b64_tr_b16 a[200:201], v8 offset:2048
    ds_read_b64_tr_b16 a[202:203], v9 offset:2048
    v_mfma_f32_16x16x32_bf16 a[64:67], a[208:211], v[68:71], a[64:67]
    ds_write_b128 v19, a[188:191] offset:11264
    v_mfma_f32_16x16x32_bf16 a[112:115], a[208:211], v[72:75], a[112:115]
    s_waitcnt lgkmcnt(11)
    ds_read_b128 v[92:95], v17 offset:1280
    v_add_u32 v5, s39, v5
    v_mfma_f32_16x16x32_bf16 a[20:23], a[212:215], v[64:67], a[20:23]
    ds_read_b64_tr_b16 a[204:205], v8 offset:2056
    ds_read_b64_tr_b16 a[206:207], v9 offset:2056
    v_mfma_f32_16x16x32_bf16 a[68:71], a[212:215], v[68:71], a[68:71]
    v_lshlrev_b32 v208, 16, v148
    v_and_b32 v209, 0xffff0000, v148
    v_mfma_f32_16x16x32_bf16 a[116:119], a[212:215], v[72:75], a[116:119]
    s_waitcnt lgkmcnt(11)
    ds_read_b128 v[96:99], v17 offset:1296
    v_lshlrev_b32 v210, 16, v149
    v_mfma_f32_16x16x32_bf16 a[24:27], a[192:195], v[64:67], a[24:27]
    ds_read_b64_tr_b16 a[208:209], v8 offset:2560
    ds_read_b64_tr_b16 a[210:211], v9 offset:2560
    v_mfma_f32_16x16x32_bf16 a[72:75], a[192:195], v[68:71], a[72:75]
    v_and_b32 v211, 0xffff0000, v149
    v_lshlrev_b32 v212, 16, v150
    v_mfma_f32_16x16x32_bf16 a[120:123], a[192:195], v[72:75], a[120:123]
    s_waitcnt lgkmcnt(10)
    ds_read_b128 v[100:103], v17 offset:1408
    v_and_b32 v213, 0xffff0000, v150
    v_mfma_f32_16x16x32_bf16 a[28:31], a[196:199], v[64:67], a[28:31]
    ds_read_b64_tr_b16 a[212:213], v8 offset:2568
    ds_read_b64_tr_b16 a[214:215], v9 offset:2568
    v_mfma_f32_16x16x32_bf16 a[76:79], a[196:199], v[68:71], a[76:79]
    v_lshlrev_b32 v214, 16, v151
    v_and_b32 v215, 0xffff0000, v151
    v_mfma_f32_16x16x32_bf16 a[124:127], a[196:199], v[72:75], a[124:127]
    s_waitcnt lgkmcnt(10)
    ds_read_b128 v[104:107], v17 offset:1424
    v_lshlrev_b32 v216, 16, v152
    v_mfma_f32_16x16x32_bf16 a[32:35], a[200:203], v[64:67], a[32:35]
    v_and_b32 v217, 0xffff0000, v152
    v_lshlrev_b32 v218, 16, v153
    v_mfma_f32_16x16x32_bf16 a[80:83], a[200:203], v[68:71], a[80:83]
    v_and_b32 v219, 0xffff0000, v153
    v_lshlrev_b32 v220, 16, v154
    v_mfma_f32_16x16x32_bf16 a[128:131], a[200:203], v[72:75], a[128:131]
    s_waitcnt lgkmcnt(7)
    ds_read_b128 v[108:111], v17 offset:1536
    v_and_b32 v221, 0xffff0000, v154
    v_mfma_f32_16x16x32_bf16 a[36:39], a[204:207], v[64:67], a[36:39]
    v_lshlrev_b32 v222, 16, v155
    v_and_b32 v223, 0xffff0000, v155
    v_lshlrev_b32 v224, 16, v124
    v_mfma_f32_16x16x32_bf16 a[84:87], a[204:207], v[68:71], a[84:87]
    v_and_b32 v225, 0xffff0000, v124
    v_lshlrev_b32 v226, 16, v125
    v_mfma_f32_16x16x32_bf16 a[132:135], a[204:207], v[72:75], a[132:135]
    s_waitcnt lgkmcnt(5)
    ds_read_b128 v[112:115], v17 offset:1552
    v_and_b32 v227, 0xffff0000, v125
    v_mfma_f32_16x16x32_bf16 a[40:43], a[208:211], v[64:67], a[40:43]
    v_lshlrev_b32 v228, 16, v126
    v_and_b32 v229, 0xffff0000, v126
    v_mfma_f32_16x16x32_bf16 a[88:91], a[208:211], v[68:71], a[88:91]
    v_lshlrev_b32 v230, 16, v127
    v_and_b32 v231, 0xffff0000, v127
    v_lshlrev_b32 v232, 16, v128
    v_mfma_f32_16x16x32_bf16 a[136:139], a[208:211], v[72:75], a[136:139]
    s_waitcnt lgkmcnt(3)
    ds_read_b128 v[116:119], v17 offset:1664
    v_and_b32 v233, 0xffff0000, v128
    v_mfma_f32_16x16x32_bf16 a[44:47], a[212:215], v[64:67], a[44:47]
    v_lshlrev_b32 v234, 16, v129
    v_and_b32 v235, 0xffff0000, v129
    v_mfma_f32_16x16x32_bf16 a[92:95], a[212:215], v[68:71], a[92:95]
    v_lshlrev_b32 v236, 16, v130
    v_and_b32 v237, 0xffff0000, v130
    v_lshlrev_b32 v238, 16, v131
    v_mfma_f32_16x16x32_bf16 a[140:143], a[212:215], v[72:75], a[140:143]
    ds_read_b128 v[120:123], v17 offset:1680
    v_and_b32 v239, 0xffff0000, v131
    s_waitcnt lgkmcnt(0)
    s_barrier
    s_lshl_b32 s39, s28, 6
    s_add_u32 s39, s39, 1032192
    s_lshl_b32 s40, s28, 11
    s_add_u32 s40, s40, 49408
    v_add_u32 v18, s40, v18
    s_lshl_b32 s40, s28, 7
    v_add_u32 v19, s40, v17
    ds_read_b128 v[20:23], v18 offset:0
    ds_read_b128 v[24:27], v18 offset:1024
    ds_read_b128 v[28:31], v18 offset:12288
    ds_read_b128 v[32:35], v18 offset:13312
    ds_read_b128 v[44:47], v18 offset:24576
    ds_read_b128 v[48:51], v18 offset:25600
    ds_read_b128 v[240:243], v18 offset:36864
    ds_read_b128 v[244:247], v18 offset:37888
    ds_read_b128 v[248:251], v19 offset:1024
    ds_read_b128 v[252:255], v19 offset:1040
    s_mov_b32 s38, 86016
    s_mov_b32 s47, 172032
    v_accvgpr_read_b32 v160, a0
    v_accvgpr_read_b32 v161, a1
    v_accvgpr_read_b32 v162, a2
    v_accvgpr_read_b32 v163, a3
    v_accvgpr_read_b32 v164, a4
    v_accvgpr_read_b32 v165, a5
    v_accvgpr_read_b32 v166, a6
    v_accvgpr_read_b32 v167, a7
    v_accvgpr_read_b32 v192, a216
    v_accvgpr_read_b32 v193, a217
    v_accvgpr_read_b32 v194, a218
    v_accvgpr_read_b32 v195, a219
    v_lshlrev_b32 v176, 16, v192
    v_and_b32 v177, 0xffff0000, v192
    v_lshlrev_b32 v178, 16, v193
    v_and_b32 v179, 0xffff0000, v193
    v_lshlrev_b32 v180, 16, v194
    v_and_b32 v181, 0xffff0000, v194
    v_lshlrev_b32 v182, 16, v195
    v_and_b32 v183, 0xffff0000, v195
    v_pk_fma_f32 v[176:177], v[160:161], v[76:77], v[176:177]
    v_pk_fma_f32 v[178:179], v[162:163], v[78:79], v[178:179]
    v_pk_fma_f32 v[180:181], v[164:165], v[80:81], v[180:181]
    v_pk_fma_f32 v[182:183], v[166:167], v[82:83], v[182:183]
    v_cvt_pk_bf16_f32 v200, v176, v177
    v_cvt_pk_bf16_f32 v201, v178, v179
    v_cvt_pk_bf16_f32 v202, v180, v181
    v_cvt_pk_bf16_f32 v203, v182, v183
    ds_write_b128 v2, v[200:203] offset:0
    s_waitcnt lgkmcnt(1)
    v_pk_add_f32 v[20:21], v[20:21], v[28:29]
    v_pk_add_f32 v[44:45], v[44:45], v[240:241]
    v_pk_add_f32 v[22:23], v[22:23], v[30:31]
    v_pk_add_f32 v[46:47], v[46:47], v[242:243]
    v_pk_add_f32 v[24:25], v[24:25], v[32:33]
    v_pk_add_f32 v[48:49], v[48:49], v[244:245]
    v_pk_add_f32 v[26:27], v[26:27], v[34:35]
    v_pk_add_f32 v[50:51], v[50:51], v[246:247]
    v_pk_add_f32 v[20:21], v[20:21], v[44:45]
    v_pk_add_f32 v[22:23], v[22:23], v[46:47]
    v_pk_add_f32 v[24:25], v[24:25], v[48:49]
    v_pk_add_f32 v[26:27], v[26:27], v[50:51]
    v_lshlrev_b32 v28, 16, v36
    v_and_b32 v29, 0xffff0000, v36
    v_lshlrev_b32 v30, 16, v37
    v_and_b32 v31, 0xffff0000, v37
    v_lshlrev_b32 v32, 16, v38
    v_and_b32 v33, 0xffff0000, v38
    v_lshlrev_b32 v34, 16, v39
    v_and_b32 v35, 0xffff0000, v39
    v_pk_fma_f32 v[28:29], v[20:21], v[248:249], v[28:29]
    v_pk_fma_f32 v[30:31], v[22:23], v[250:251], v[30:31]
    v_pk_fma_f32 v[32:33], v[24:25], v[252:253], v[32:33]
    v_pk_fma_f32 v[34:35], v[26:27], v[254:255], v[34:35]
    v_cvt_pk_bf16_f32 v36, v28, v29
    v_cvt_pk_bf16_f32 v37, v30, v31
    v_cvt_pk_bf16_f32 v38, v32, v33
    v_cvt_pk_bf16_f32 v39, v34, v35
    buffer_store_dwordx4 v[36:39], v16, s[20:23], s39 offen offset:0 sc1
    ds_read_b128 v[20:23], v18 offset:8192
    ds_read_b128 v[24:27], v18 offset:9216
    ds_read_b128 v[28:31], v18 offset:20480
    ds_read_b128 v[32:35], v18 offset:21504
    ds_read_b128 v[44:47], v18 offset:32768
    ds_read_b128 v[48:51], v18 offset:33792
    ds_read_b128 v[240:243], v18 offset:45056
    ds_read_b128 v[244:247], v18 offset:46080
    ds_read_b128 v[248:251], v19 offset:1536
    ds_read_b128 v[252:255], v19 offset:1552
    v_accvgpr_read_b32 v168, a8
    v_accvgpr_read_b32 v169, a9
    v_accvgpr_read_b32 v170, a10
    v_accvgpr_read_b32 v171, a11
    v_accvgpr_read_b32 v172, a12
    v_accvgpr_read_b32 v173, a13
    v_accvgpr_read_b32 v174, a14
    v_accvgpr_read_b32 v175, a15
    v_accvgpr_read_b32 v196, a220
    v_accvgpr_read_b32 v197, a221
    v_accvgpr_read_b32 v198, a222
    v_accvgpr_read_b32 v199, a223
    v_lshlrev_b32 v184, 16, v196
    v_and_b32 v185, 0xffff0000, v196
    v_lshlrev_b32 v186, 16, v197
    v_and_b32 v187, 0xffff0000, v197
    v_lshlrev_b32 v188, 16, v198
    v_and_b32 v189, 0xffff0000, v198
    v_lshlrev_b32 v190, 16, v199
    v_and_b32 v191, 0xffff0000, v199
    v_pk_fma_f32 v[184:185], v[168:169], v[84:85], v[184:185]
    v_pk_fma_f32 v[186:187], v[170:171], v[86:87], v[186:187]
    v_pk_fma_f32 v[188:189], v[172:173], v[88:89], v[188:189]
    v_pk_fma_f32 v[190:191], v[174:175], v[90:91], v[190:191]
    v_cvt_pk_bf16_f32 v204, v184, v185
    v_cvt_pk_bf16_f32 v205, v186, v187
    v_cvt_pk_bf16_f32 v206, v188, v189
    v_cvt_pk_bf16_f32 v207, v190, v191
    ds_write_b128 v3, v[204:207] offset:0
    ds_read_b128 v[52:55], v4 offset:0
    ds_read_b128 v[56:59], v4 offset:1024
    v_accvgpr_read_b32 v160, a16
    v_accvgpr_read_b32 v161, a17
    v_accvgpr_read_b32 v162, a18
    v_accvgpr_read_b32 v163, a19
    v_accvgpr_read_b32 v164, a20
    v_accvgpr_read_b32 v165, a21
    v_accvgpr_read_b32 v166, a22
    v_accvgpr_read_b32 v167, a23
    v_pk_fma_f32 v[208:209], v[160:161], v[92:93], v[208:209]
    v_pk_fma_f32 v[210:211], v[162:163], v[94:95], v[210:211]
    v_pk_fma_f32 v[212:213], v[164:165], v[96:97], v[212:213]
    v_pk_fma_f32 v[214:215], v[166:167], v[98:99], v[214:215]
    v_cvt_pk_bf16_f32 v200, v208, v209
    v_cvt_pk_bf16_f32 v201, v210, v211
    v_cvt_pk_bf16_f32 v202, v212, v213
    v_cvt_pk_bf16_f32 v203, v214, v215
    s_waitcnt lgkmcnt(0)
    buffer_store_dwordx4 v[52:55], v5, s[20:23], 0 offen offset:0 sc1
    ds_write_b128 v2, v[200:203] offset:2048
    s_cmp_ge_u32 s28, 2
    s_cbranch_scc1 L_done_b1
    v_pk_add_f32 v[20:21], v[20:21], v[28:29]
    v_pk_add_f32 v[44:45], v[44:45], v[240:241]
    v_pk_add_f32 v[22:23], v[22:23], v[30:31]
    v_pk_add_f32 v[46:47], v[46:47], v[242:243]
    v_pk_add_f32 v[24:25], v[24:25], v[32:33]
    v_pk_add_f32 v[48:49], v[48:49], v[244:245]
    v_pk_add_f32 v[26:27], v[26:27], v[34:35]
    v_pk_add_f32 v[50:51], v[50:51], v[246:247]
    v_pk_add_f32 v[20:21], v[20:21], v[44:45]
    v_pk_add_f32 v[22:23], v[22:23], v[46:47]
    v_pk_add_f32 v[24:25], v[24:25], v[48:49]
    v_pk_add_f32 v[26:27], v[26:27], v[50:51]
    v_lshlrev_b32 v28, 16, v40
    v_and_b32 v29, 0xffff0000, v40
    v_lshlrev_b32 v30, 16, v41
    v_and_b32 v31, 0xffff0000, v41
    v_lshlrev_b32 v32, 16, v42
    v_and_b32 v33, 0xffff0000, v42
    v_lshlrev_b32 v34, 16, v43
    v_and_b32 v35, 0xffff0000, v43
    v_pk_fma_f32 v[28:29], v[20:21], v[248:249], v[28:29]
    v_pk_fma_f32 v[30:31], v[22:23], v[250:251], v[30:31]
    v_pk_fma_f32 v[32:33], v[24:25], v[252:253], v[32:33]
    v_pk_fma_f32 v[34:35], v[26:27], v[254:255], v[34:35]
    v_cvt_pk_bf16_f32 v40, v28, v29
    v_cvt_pk_bf16_f32 v41, v30, v31
    v_cvt_pk_bf16_f32 v42, v32, v33
    v_cvt_pk_bf16_f32 v43, v34, v35
    buffer_store_dwordx4 v[40:43], v16, s[20:23], s39 offen offset:256 sc1
L_done_b1:
    v_accvgpr_read_b32 v168, a24
    v_accvgpr_read_b32 v169, a25
    v_accvgpr_read_b32 v170, a26
    v_accvgpr_read_b32 v171, a27
    v_accvgpr_read_b32 v172, a28
    v_accvgpr_read_b32 v173, a29
    v_accvgpr_read_b32 v174, a30
    v_accvgpr_read_b32 v175, a31
    v_pk_fma_f32 v[216:217], v[168:169], v[100:101], v[216:217]
    v_pk_fma_f32 v[218:219], v[170:171], v[102:103], v[218:219]
    v_pk_fma_f32 v[220:221], v[172:173], v[104:105], v[220:221]
    v_pk_fma_f32 v[222:223], v[174:175], v[106:107], v[222:223]
    v_cvt_pk_bf16_f32 v204, v216, v217
    v_cvt_pk_bf16_f32 v205, v218, v219
    v_cvt_pk_bf16_f32 v206, v220, v221
    v_cvt_pk_bf16_f32 v207, v222, v223
    buffer_store_dwordx4 v[56:59], v5, s[20:23], 0 offen offset:3072 sc1
    ds_write_b128 v3, v[204:207] offset:2048
    ds_read_b128 v[60:63], v4 offset:2048
    ds_read_b128 v[64:67], v4 offset:3072
    v_accvgpr_read_b32 v160, a32
    v_accvgpr_read_b32 v161, a33
    v_accvgpr_read_b32 v162, a34
    v_accvgpr_read_b32 v163, a35
    v_accvgpr_read_b32 v164, a36
    v_accvgpr_read_b32 v165, a37
    v_accvgpr_read_b32 v166, a38
    v_accvgpr_read_b32 v167, a39
    v_pk_fma_f32 v[224:225], v[160:161], v[108:109], v[224:225]
    v_pk_fma_f32 v[226:227], v[162:163], v[110:111], v[226:227]
    v_pk_fma_f32 v[228:229], v[164:165], v[112:113], v[228:229]
    v_pk_fma_f32 v[230:231], v[166:167], v[114:115], v[230:231]
    v_cvt_pk_bf16_f32 v200, v224, v225
    v_cvt_pk_bf16_f32 v201, v226, v227
    v_cvt_pk_bf16_f32 v202, v228, v229
    v_cvt_pk_bf16_f32 v203, v230, v231
    s_waitcnt lgkmcnt(0)
    buffer_store_dwordx4 v[60:63], v5, s[20:23], 0 offen offset:128 sc1
    ds_write_b128 v2, v[200:203] offset:4096
    v_accvgpr_read_b32 v168, a40
    v_accvgpr_read_b32 v169, a41
    v_accvgpr_read_b32 v170, a42
    v_accvgpr_read_b32 v171, a43
    v_accvgpr_read_b32 v172, a44
    v_accvgpr_read_b32 v173, a45
    v_accvgpr_read_b32 v174, a46
    v_accvgpr_read_b32 v175, a47
    v_pk_fma_f32 v[232:233], v[168:169], v[116:117], v[232:233]
    v_pk_fma_f32 v[234:235], v[170:171], v[118:119], v[234:235]
    v_pk_fma_f32 v[236:237], v[172:173], v[120:121], v[236:237]
    v_pk_fma_f32 v[238:239], v[174:175], v[122:123], v[238:239]
    v_cvt_pk_bf16_f32 v204, v232, v233
    v_cvt_pk_bf16_f32 v205, v234, v235
    v_cvt_pk_bf16_f32 v206, v236, v237
    v_cvt_pk_bf16_f32 v207, v238, v239
    buffer_store_dwordx4 v[64:67], v5, s[20:23], 0 offen offset:3200 sc1
    ds_write_b128 v3, v[204:207] offset:4096
    ds_read_b128 v[52:55], v4 offset:4096
    ds_read_b128 v[56:59], v4 offset:5120
    v_accvgpr_read_b32 v160, a48
    v_accvgpr_read_b32 v161, a49
    v_accvgpr_read_b32 v162, a50
    v_accvgpr_read_b32 v163, a51
    v_accvgpr_read_b32 v164, a52
    v_accvgpr_read_b32 v165, a53
    v_accvgpr_read_b32 v166, a54
    v_accvgpr_read_b32 v167, a55
    v_accvgpr_read_b32 v192, a224
    v_accvgpr_read_b32 v193, a225
    v_accvgpr_read_b32 v194, a226
    v_accvgpr_read_b32 v195, a227
    v_lshlrev_b32 v176, 16, v192
    v_and_b32 v177, 0xffff0000, v192
    v_lshlrev_b32 v178, 16, v193
    v_and_b32 v179, 0xffff0000, v193
    v_lshlrev_b32 v180, 16, v194
    v_and_b32 v181, 0xffff0000, v194
    v_lshlrev_b32 v182, 16, v195
    v_and_b32 v183, 0xffff0000, v195
    v_pk_fma_f32 v[176:177], v[160:161], v[76:77], v[176:177]
    v_pk_fma_f32 v[178:179], v[162:163], v[78:79], v[178:179]
    v_pk_fma_f32 v[180:181], v[164:165], v[80:81], v[180:181]
    v_pk_fma_f32 v[182:183], v[166:167], v[82:83], v[182:183]
    v_cvt_pk_bf16_f32 v200, v176, v177
    v_cvt_pk_bf16_f32 v201, v178, v179
    v_cvt_pk_bf16_f32 v202, v180, v181
    v_cvt_pk_bf16_f32 v203, v182, v183
    s_waitcnt lgkmcnt(0)
    buffer_store_dwordx4 v[52:55], v5, s[20:23], 0 offen offset:256 sc1
    ds_write_b128 v2, v[200:203] offset:6144
    v_accvgpr_read_b32 v168, a56
    v_accvgpr_read_b32 v169, a57
    v_accvgpr_read_b32 v170, a58
    v_accvgpr_read_b32 v171, a59
    v_accvgpr_read_b32 v172, a60
    v_accvgpr_read_b32 v173, a61
    v_accvgpr_read_b32 v174, a62
    v_accvgpr_read_b32 v175, a63
    v_accvgpr_read_b32 v196, a228
    v_accvgpr_read_b32 v197, a229
    v_accvgpr_read_b32 v198, a230
    v_accvgpr_read_b32 v199, a231
    v_lshlrev_b32 v184, 16, v196
    v_and_b32 v185, 0xffff0000, v196
    v_lshlrev_b32 v186, 16, v197
    v_and_b32 v187, 0xffff0000, v197
    v_lshlrev_b32 v188, 16, v198
    v_and_b32 v189, 0xffff0000, v198
    v_lshlrev_b32 v190, 16, v199
    v_and_b32 v191, 0xffff0000, v199
    v_pk_fma_f32 v[184:185], v[168:169], v[84:85], v[184:185]
    v_pk_fma_f32 v[186:187], v[170:171], v[86:87], v[186:187]
    v_pk_fma_f32 v[188:189], v[172:173], v[88:89], v[188:189]
    v_pk_fma_f32 v[190:191], v[174:175], v[90:91], v[190:191]
    v_cvt_pk_bf16_f32 v204, v184, v185
    v_cvt_pk_bf16_f32 v205, v186, v187
    v_cvt_pk_bf16_f32 v206, v188, v189
    v_cvt_pk_bf16_f32 v207, v190, v191
    buffer_store_dwordx4 v[56:59], v5, s[20:23], 0 offen offset:3328 sc1
    ds_write_b128 v3, v[204:207] offset:6144
    ds_read_b128 v[60:63], v4 offset:6144
    ds_read_b128 v[64:67], v4 offset:7168
    v_accvgpr_read_b32 v160, a64
    v_accvgpr_read_b32 v161, a65
    v_accvgpr_read_b32 v162, a66
    v_accvgpr_read_b32 v163, a67
    v_accvgpr_read_b32 v164, a68
    v_accvgpr_read_b32 v165, a69
    v_accvgpr_read_b32 v166, a70
    v_accvgpr_read_b32 v167, a71
    v_accvgpr_read_b32 v192, a232
    v_accvgpr_read_b32 v193, a233
    v_accvgpr_read_b32 v194, a234
    v_accvgpr_read_b32 v195, a235
    v_lshlrev_b32 v176, 16, v192
    v_and_b32 v177, 0xffff0000, v192
    v_lshlrev_b32 v178, 16, v193
    v_and_b32 v179, 0xffff0000, v193
    v_lshlrev_b32 v180, 16, v194
    v_and_b32 v181, 0xffff0000, v194
    v_lshlrev_b32 v182, 16, v195
    v_and_b32 v183, 0xffff0000, v195
    v_pk_fma_f32 v[176:177], v[160:161], v[92:93], v[176:177]
    v_pk_fma_f32 v[178:179], v[162:163], v[94:95], v[178:179]
    v_pk_fma_f32 v[180:181], v[164:165], v[96:97], v[180:181]
    v_pk_fma_f32 v[182:183], v[166:167], v[98:99], v[182:183]
    v_cvt_pk_bf16_f32 v200, v176, v177
    v_cvt_pk_bf16_f32 v201, v178, v179
    v_cvt_pk_bf16_f32 v202, v180, v181
    v_cvt_pk_bf16_f32 v203, v182, v183
    s_waitcnt lgkmcnt(0)
    buffer_store_dwordx4 v[60:63], v5, s[20:23], s38 offen offset:0 sc1
    ds_write_b128 v2, v[200:203] offset:0
    v_accvgpr_read_b32 v168, a72
    v_accvgpr_read_b32 v169, a73
    v_accvgpr_read_b32 v170, a74
    v_accvgpr_read_b32 v171, a75
    v_accvgpr_read_b32 v172, a76
    v_accvgpr_read_b32 v173, a77
    v_accvgpr_read_b32 v174, a78
    v_accvgpr_read_b32 v175, a79
    v_accvgpr_read_b32 v196, a236
    v_accvgpr_read_b32 v197, a237
    v_accvgpr_read_b32 v198, a238
    v_accvgpr_read_b32 v199, a239
    v_lshlrev_b32 v184, 16, v196
    v_and_b32 v185, 0xffff0000, v196
    v_lshlrev_b32 v186, 16, v197
    v_and_b32 v187, 0xffff0000, v197
    v_lshlrev_b32 v188, 16, v198
    v_and_b32 v189, 0xffff0000, v198
    v_lshlrev_b32 v190, 16, v199
    v_and_b32 v191, 0xffff0000, v199
    v_pk_fma_f32 v[184:185], v[168:169], v[100:101], v[184:185]
    v_pk_fma_f32 v[186:187], v[170:171], v[102:103], v[186:187]
    v_pk_fma_f32 v[188:189], v[172:173], v[104:105], v[188:189]
    v_pk_fma_f32 v[190:191], v[174:175], v[106:107], v[190:191]
    v_cvt_pk_bf16_f32 v204, v184, v185
    v_cvt_pk_bf16_f32 v205, v186, v187
    v_cvt_pk_bf16_f32 v206, v188, v189
    v_cvt_pk_bf16_f32 v207, v190, v191
    buffer_store_dwordx4 v[64:67], v5, s[20:23], s38 offen offset:3072 sc1
    ds_write_b128 v3, v[204:207] offset:0
    ds_read_b128 v[52:55], v4 offset:0
    ds_read_b128 v[56:59], v4 offset:1024
    v_accvgpr_read_b32 v160, a80
    v_accvgpr_read_b32 v161, a81
    v_accvgpr_read_b32 v162, a82
    v_accvgpr_read_b32 v163, a83
    v_accvgpr_read_b32 v164, a84
    v_accvgpr_read_b32 v165, a85
    v_accvgpr_read_b32 v166, a86
    v_accvgpr_read_b32 v167, a87
    v_lshlrev_b32 v176, 16, v132
    v_and_b32 v177, 0xffff0000, v132
    v_lshlrev_b32 v178, 16, v133
    v_and_b32 v179, 0xffff0000, v133
    v_lshlrev_b32 v180, 16, v134
    v_and_b32 v181, 0xffff0000, v134
    v_lshlrev_b32 v182, 16, v135
    v_and_b32 v183, 0xffff0000, v135
    v_pk_fma_f32 v[176:177], v[160:161], v[108:109], v[176:177]
    v_pk_fma_f32 v[178:179], v[162:163], v[110:111], v[178:179]
    v_pk_fma_f32 v[180:181], v[164:165], v[112:113], v[180:181]
    v_pk_fma_f32 v[182:183], v[166:167], v[114:115], v[182:183]
    v_cvt_pk_bf16_f32 v200, v176, v177
    v_cvt_pk_bf16_f32 v201, v178, v179
    v_cvt_pk_bf16_f32 v202, v180, v181
    v_cvt_pk_bf16_f32 v203, v182, v183
    s_waitcnt lgkmcnt(0)
    buffer_store_dwordx4 v[52:55], v5, s[20:23], s38 offen offset:128 sc1
    ds_write_b128 v2, v[200:203] offset:2048
    v_accvgpr_read_b32 v168, a88
    v_accvgpr_read_b32 v169, a89
    v_accvgpr_read_b32 v170, a90
    v_accvgpr_read_b32 v171, a91
    v_accvgpr_read_b32 v172, a92
    v_accvgpr_read_b32 v173, a93
    v_accvgpr_read_b32 v174, a94
    v_accvgpr_read_b32 v175, a95
    v_lshlrev_b32 v184, 16, v136
    v_and_b32 v185, 0xffff0000, v136
    v_lshlrev_b32 v186, 16, v137
    v_and_b32 v187, 0xffff0000, v137
    v_lshlrev_b32 v188, 16, v138
    v_and_b32 v189, 0xffff0000, v138
    v_lshlrev_b32 v190, 16, v139
    v_and_b32 v191, 0xffff0000, v139
    v_pk_fma_f32 v[184:185], v[168:169], v[116:117], v[184:185]
    v_pk_fma_f32 v[186:187], v[170:171], v[118:119], v[186:187]
    v_pk_fma_f32 v[188:189], v[172:173], v[120:121], v[188:189]
    v_pk_fma_f32 v[190:191], v[174:175], v[122:123], v[190:191]
    v_cvt_pk_bf16_f32 v204, v184, v185
    v_cvt_pk_bf16_f32 v205, v186, v187
    v_cvt_pk_bf16_f32 v206, v188, v189
    v_cvt_pk_bf16_f32 v207, v190, v191
    buffer_store_dwordx4 v[56:59], v5, s[20:23], s38 offen offset:3200 sc1
    ds_write_b128 v3, v[204:207] offset:2048
    ds_read_b128 v[60:63], v4 offset:2048
    ds_read_b128 v[64:67], v4 offset:3072
    v_accvgpr_read_b32 v160, a96
    v_accvgpr_read_b32 v161, a97
    v_accvgpr_read_b32 v162, a98
    v_accvgpr_read_b32 v163, a99
    v_accvgpr_read_b32 v164, a100
    v_accvgpr_read_b32 v165, a101
    v_accvgpr_read_b32 v166, a102
    v_accvgpr_read_b32 v167, a103
    v_accvgpr_read_b32 v192, a240
    v_accvgpr_read_b32 v193, a241
    v_accvgpr_read_b32 v194, a242
    v_accvgpr_read_b32 v195, a243
    v_lshlrev_b32 v176, 16, v192
    v_and_b32 v177, 0xffff0000, v192
    v_lshlrev_b32 v178, 16, v193
    v_and_b32 v179, 0xffff0000, v193
    v_lshlrev_b32 v180, 16, v194
    v_and_b32 v181, 0xffff0000, v194
    v_lshlrev_b32 v182, 16, v195
    v_and_b32 v183, 0xffff0000, v195
    v_pk_fma_f32 v[176:177], v[160:161], v[76:77], v[176:177]
    v_pk_fma_f32 v[178:179], v[162:163], v[78:79], v[178:179]
    v_pk_fma_f32 v[180:181], v[164:165], v[80:81], v[180:181]
    v_pk_fma_f32 v[182:183], v[166:167], v[82:83], v[182:183]
    v_cvt_pk_bf16_f32 v200, v176, v177
    v_cvt_pk_bf16_f32 v201, v178, v179
    v_cvt_pk_bf16_f32 v202, v180, v181
    v_cvt_pk_bf16_f32 v203, v182, v183
    s_waitcnt lgkmcnt(0)
    buffer_store_dwordx4 v[60:63], v5, s[20:23], s38 offen offset:256 sc1
    ds_write_b128 v2, v[200:203] offset:4096
    v_accvgpr_read_b32 v168, a104
    v_accvgpr_read_b32 v169, a105
    v_accvgpr_read_b32 v170, a106
    v_accvgpr_read_b32 v171, a107
    v_accvgpr_read_b32 v172, a108
    v_accvgpr_read_b32 v173, a109
    v_accvgpr_read_b32 v174, a110
    v_accvgpr_read_b32 v175, a111
    v_accvgpr_read_b32 v196, a244
    v_accvgpr_read_b32 v197, a245
    v_accvgpr_read_b32 v198, a246
    v_accvgpr_read_b32 v199, a247
    v_lshlrev_b32 v184, 16, v196
    v_and_b32 v185, 0xffff0000, v196
    v_lshlrev_b32 v186, 16, v197
    v_and_b32 v187, 0xffff0000, v197
    v_lshlrev_b32 v188, 16, v198
    v_and_b32 v189, 0xffff0000, v198
    v_lshlrev_b32 v190, 16, v199
    v_and_b32 v191, 0xffff0000, v199
    v_pk_fma_f32 v[184:185], v[168:169], v[84:85], v[184:185]
    v_pk_fma_f32 v[186:187], v[170:171], v[86:87], v[186:187]
    v_pk_fma_f32 v[188:189], v[172:173], v[88:89], v[188:189]
    v_pk_fma_f32 v[190:191], v[174:175], v[90:91], v[190:191]
    v_cvt_pk_bf16_f32 v204, v184, v185
    v_cvt_pk_bf16_f32 v205, v186, v187
    v_cvt_pk_bf16_f32 v206, v188, v189
    v_cvt_pk_bf16_f32 v207, v190, v191
    buffer_store_dwordx4 v[64:67], v5, s[20:23], s38 offen offset:3328 sc1
    ds_write_b128 v3, v[204:207] offset:4096
    ds_read_b128 v[52:55], v4 offset:4096
    ds_read_b128 v[56:59], v4 offset:5120
    v_accvgpr_read_b32 v160, a112
    v_accvgpr_read_b32 v161, a113
    v_accvgpr_read_b32 v162, a114
    v_accvgpr_read_b32 v163, a115
    v_accvgpr_read_b32 v164, a116
    v_accvgpr_read_b32 v165, a117
    v_accvgpr_read_b32 v166, a118
    v_accvgpr_read_b32 v167, a119
    v_accvgpr_read_b32 v192, a248
    v_accvgpr_read_b32 v193, a249
    v_accvgpr_read_b32 v194, a250
    v_accvgpr_read_b32 v195, a251
    v_lshlrev_b32 v176, 16, v192
    v_and_b32 v177, 0xffff0000, v192
    v_lshlrev_b32 v178, 16, v193
    v_and_b32 v179, 0xffff0000, v193
    v_lshlrev_b32 v180, 16, v194
    v_and_b32 v181, 0xffff0000, v194
    v_lshlrev_b32 v182, 16, v195
    v_and_b32 v183, 0xffff0000, v195
    v_pk_fma_f32 v[176:177], v[160:161], v[92:93], v[176:177]
    v_pk_fma_f32 v[178:179], v[162:163], v[94:95], v[178:179]
    v_pk_fma_f32 v[180:181], v[164:165], v[96:97], v[180:181]
    v_pk_fma_f32 v[182:183], v[166:167], v[98:99], v[182:183]
    v_cvt_pk_bf16_f32 v200, v176, v177
    v_cvt_pk_bf16_f32 v201, v178, v179
    v_cvt_pk_bf16_f32 v202, v180, v181
    v_cvt_pk_bf16_f32 v203, v182, v183
    s_waitcnt lgkmcnt(0)
    buffer_store_dwordx4 v[52:55], v5, s[20:23], s47 offen offset:0 sc1
    ds_write_b128 v2, v[200:203] offset:6144
    v_accvgpr_read_b32 v168, a120
    v_accvgpr_read_b32 v169, a121
    v_accvgpr_read_b32 v170, a122
    v_accvgpr_read_b32 v171, a123
    v_accvgpr_read_b32 v172, a124
    v_accvgpr_read_b32 v173, a125
    v_accvgpr_read_b32 v174, a126
    v_accvgpr_read_b32 v175, a127
    v_accvgpr_read_b32 v196, a252
    v_accvgpr_read_b32 v197, a253
    v_accvgpr_read_b32 v198, a254
    v_accvgpr_read_b32 v199, a255
    v_lshlrev_b32 v184, 16, v196
    v_and_b32 v185, 0xffff0000, v196
    v_lshlrev_b32 v186, 16, v197
    v_and_b32 v187, 0xffff0000, v197
    v_lshlrev_b32 v188, 16, v198
    v_and_b32 v189, 0xffff0000, v198
    v_lshlrev_b32 v190, 16, v199
    v_and_b32 v191, 0xffff0000, v199
    v_pk_fma_f32 v[184:185], v[168:169], v[100:101], v[184:185]
    v_pk_fma_f32 v[186:187], v[170:171], v[102:103], v[186:187]
    v_pk_fma_f32 v[188:189], v[172:173], v[104:105], v[188:189]
    v_pk_fma_f32 v[190:191], v[174:175], v[106:107], v[190:191]
    v_cvt_pk_bf16_f32 v204, v184, v185
    v_cvt_pk_bf16_f32 v205, v186, v187
    v_cvt_pk_bf16_f32 v206, v188, v189
    v_cvt_pk_bf16_f32 v207, v190, v191
    buffer_store_dwordx4 v[56:59], v5, s[20:23], s47 offen offset:3072 sc1
    ds_write_b128 v3, v[204:207] offset:6144
    ds_read_b128 v[60:63], v4 offset:6144
    ds_read_b128 v[64:67], v4 offset:7168
    v_accvgpr_read_b32 v160, a128
    v_accvgpr_read_b32 v161, a129
    v_accvgpr_read_b32 v162, a130
    v_accvgpr_read_b32 v163, a131
    v_accvgpr_read_b32 v164, a132
    v_accvgpr_read_b32 v165, a133
    v_accvgpr_read_b32 v166, a134
    v_accvgpr_read_b32 v167, a135
    v_lshlrev_b32 v176, 16, v140
    v_and_b32 v177, 0xffff0000, v140
    v_lshlrev_b32 v178, 16, v141
    v_and_b32 v179, 0xffff0000, v141
    v_lshlrev_b32 v180, 16, v142
    v_and_b32 v181, 0xffff0000, v142
    v_lshlrev_b32 v182, 16, v143
    v_and_b32 v183, 0xffff0000, v143
    v_pk_fma_f32 v[176:177], v[160:161], v[108:109], v[176:177]
    v_pk_fma_f32 v[178:179], v[162:163], v[110:111], v[178:179]
    v_pk_fma_f32 v[180:181], v[164:165], v[112:113], v[180:181]
    v_pk_fma_f32 v[182:183], v[166:167], v[114:115], v[182:183]
    v_cvt_pk_bf16_f32 v200, v176, v177
    v_cvt_pk_bf16_f32 v201, v178, v179
    v_cvt_pk_bf16_f32 v202, v180, v181
    v_cvt_pk_bf16_f32 v203, v182, v183
    s_waitcnt lgkmcnt(0)
    buffer_store_dwordx4 v[60:63], v5, s[20:23], s47 offen offset:128 sc1
    ds_write_b128 v2, v[200:203] offset:0
    v_accvgpr_read_b32 v168, a136
    v_accvgpr_read_b32 v169, a137
    v_accvgpr_read_b32 v170, a138
    v_accvgpr_read_b32 v171, a139
    v_accvgpr_read_b32 v172, a140
    v_accvgpr_read_b32 v173, a141
    v_accvgpr_read_b32 v174, a142
    v_accvgpr_read_b32 v175, a143
    v_lshlrev_b32 v184, 16, v144
    v_and_b32 v185, 0xffff0000, v144
    v_lshlrev_b32 v186, 16, v145
    v_and_b32 v187, 0xffff0000, v145
    v_lshlrev_b32 v188, 16, v146
    v_and_b32 v189, 0xffff0000, v146
    v_lshlrev_b32 v190, 16, v147
    v_and_b32 v191, 0xffff0000, v147
    v_pk_fma_f32 v[184:185], v[168:169], v[116:117], v[184:185]
    v_pk_fma_f32 v[186:187], v[170:171], v[118:119], v[186:187]
    v_pk_fma_f32 v[188:189], v[172:173], v[120:121], v[188:189]
    v_pk_fma_f32 v[190:191], v[174:175], v[122:123], v[190:191]
    v_cvt_pk_bf16_f32 v204, v184, v185
    v_cvt_pk_bf16_f32 v205, v186, v187
    v_cvt_pk_bf16_f32 v206, v188, v189
    v_cvt_pk_bf16_f32 v207, v190, v191
    buffer_store_dwordx4 v[64:67], v5, s[20:23], s47 offen offset:3200 sc1
    ds_write_b128 v3, v[204:207] offset:0
    ds_read_b128 v[52:55], v4 offset:0
    ds_read_b128 v[56:59], v4 offset:1024
    s_waitcnt lgkmcnt(0)
    buffer_store_dwordx4 v[52:55], v5, s[20:23], s47 offen offset:256 sc1
    buffer_store_dwordx4 v[56:59], v5, s[20:23], s47 offen offset:3328 sc1
    s_endpgm
L_body0:
    s_bitcmp1_b32 s55, 24
    s_cbranch_scc1 L_defer
    v_subrev_u32 v118, s53, v118
    v_cmp_gt_u32 vcc, s56, v118
    v_add_u32 v148, s54, v148
    s_nop 0
    v_cndmask_b32 v148, v122, v148, vcc
    s_add_u32 m0, s50, 0
    s_nop 0
    buffer_load_dwordx4 v148, s[8:11], 0 offen lds
    s_mov_b32 s57, 344064
    v_add_u32 v150, s57, v148
    s_add_u32 m0, s50, 9216
    s_nop 0
    buffer_load_dwordx4 v150, s[8:11], 0 offen lds
    v_add_u32 v152, s57, v150
    v_add_u32 v116, 32, v116
    v_mul_u32_u24 v117, 3641, v116
    v_lshrrev_b32 v117, 16, v117
    v_mul_u32_u24 v119, 18, v117
    v_sub_u32 v119, v116, v119
    v_bfe_u32 v106, v119, 1, 3
    v_xor_b32 v106, v106, v121
    v_mul_u32_u24 v117, 79104, v117
    v_mad_u32_u24 v117, v116, s44, v117
    v_lshl_add_u32 v149, v106, 4, v117
    v_and_b32 v1, 63, v0
    s_add_u32 m0, s50, 18432
    s_nop 0
    buffer_load_dwordx4 v152, s[8:11], 0 offen lds
    v_add_u32 v154, s57, v152
    v_subrev_u32 v119, s53, v119
    v_cmp_gt_u32 vcc, s56, v119
    v_add_u32 v149, s54, v149
    s_nop 0
    v_cndmask_b32 v149, v122, v149, vcc
    v_mov_b32 v81, 0
    v_mov_b32 v83, 0
    v_mov_b32 v85, 0
    v_mov_b32 v87, 0
    v_mov_b32 v88, 0
    v_mov_b32 v90, 0
    s_add_u32 m0, s50, 27648
    s_nop 0
    buffer_load_dwordx4 v154, s[8:11], 0 offen lds
    s_add_u32 s30, s50, 31744
    s_mul_i32 s51, s28, 9216
    s_add_u32 s51, s51, 57600
    s_mul_i32 s40, s28, s57
    s_add_u32 s40, s40, s54
    s_cmp_lt_u32 s28, 3
    s_cselect_b32 s30, s30, 158976
    s_cselect_b32 s51, s51, 158976
    s_cselect_b32 s52, 34688, 0
    s_cselect_b32 s40, s40, 0x40000000
    v_mov_b32 v92, 0
    v_mov_b32 v94, 0
    s_add_u32 m0, s50, 4096
    s_nop 0
    buffer_load_dwordx4 v149, s[8:11], 0 offen lds
    v_add_u32 v151, s57, v149
    v_bfe_u32 v116, v0, 3, 3
    v_add_u32 v116, 64, v116
    v_mul_u32_u24 v117, 3641, v116
    v_lshrrev_b32 v117, 16, v117
    v_mul_u32_u24 v120, 18, v117
    v_sub_u32 v120, v116, v120
    v_bfe_u32 v106, v120, 1, 3
    v_xor_b32 v106, v106, v121
    v_mul_u32_u24 v117, 79104, v117
    v_mad_u32_u24 v117, v116, s44, v117
    v_lshl_add_u32 v156, v106, 4, v117
    s_add_u32 m0, s50, 13312
    s_nop 0
    buffer_load_dwordx4 v151, s[8:11], 0 offen lds
    v_add_u32 v153, s57, v151
    v_subrev_u32 v120, s53, v120
    v_cmp_gt_u32 vcc, s56, v120
    v_add_u32 v156, s40, v156
    s_nop 0
    v_cndmask_b32 v156, v122, v156, vcc
    s_mov_b32 s58, 0x98532410
    s_mov_b32 s59, 0x00000f67
    v_mul_u32_u24 v40, 2731, v0
    v_lshrrev_b32 v40, 16, v40
    v_mul_u32_u24 v41, 24, v40
    v_sub_u32 v41, v0, v41
    s_add_u32 m0, s50, 22528
    s_nop 0
    buffer_load_dwordx4 v153, s[8:11], 0 offen lds
    s_cmp_lt_u32 s28, 1
    s_cselect_b32 s41, s57, 0x40000000
    v_add_u32 v155, s41, v153
    v_lshlrev_b32 v40, 2, v40
    v_lshrrev_b64 v[42:43], v40, s[58:59]
    v_and_b32 v40, 1, v42
    v_lshlrev_b32 v40, 3, v40
    v_lshl_add_u32 v40, v41, 4, v40
    v_bfe_u32 v42, v42, 1, 3
    v_mul_u32_u24 v41, 384, v42
    s_mov_b32 m0, s30
    s_add_u32 s30, s30, s52
    buffer_load_dwordx4 v155, s[8:11], 0 offen lds
    s_mov_b32 m0, s51
    s_add_u32 s51, s51, s52
    buffer_load_dwordx4 v156, s[8:11], 0 offen lds
    s_add_u32 s29, s54, 86400
    v_cmp_gt_u32 vcc, 5, v42
    v_add_u32 v40, v40, v41
    v_mov_b32 v41, 262144
    v_cndmask_b32 v123, v41, v40, vcc
    v_and_b32 v44, 15, v1
    v_lshrrev_b32 v45, 4, v1
    s_waitcnt lgkmcnt(0)
    s_cmp_eq_u32 s28, 3
    s_cselect_b64 s[60:61], s[64:65], s[60:61]
    s_movk_i32 s62, 1536
    s_cselect_b32 s62, 384, s62
    s_mov_b32 s63, s11
    s_cselect_b32 s41, 63, -1
    v_and_b32 v103, s41, v0
    v_lshlrev_b32 v103, 3, v103
    buffer_load_dwordx2 v[96:97], v103, s[60:63], 0 offen
    v_and_b32 v46, 1, v45
    v_lshrrev_b32 v47, 1, v45
    v_lshrrev_b32 v40, 3, v44
    v_xor_b32 v40, v40, v46
    v_mul_u32_u24 v40, 262144, v40
    v_lshl_add_u32 v40, v46, 4, v40
    v_and_b32 v41, 7, v44
    v_mul_u32_u24 v41, 1936, v41
    v_add_u32 v40, v40, v41
    v_mul_u32_u24 v41, 384, v47
    s_mov_b64 s[64:65], s[66:67]
    s_movk_i32 s66, 384
    s_mov_b32 s67, s11
    v_lshlrev_b32 v103, 3, v1
    buffer_load_dwordx2 v[98:99], v103, s[64:67], 0 offen
    v_add_u32 v48, v40, v41
    v_xor_b32 v41, 1, v47
    v_mul_u32_u24 v41, 262144, v41
    v_add_u32 v49, v40, v41
    s_lshl_b32 s38, s28, 5
    v_add_u32 v50, s38, v48
    v_add_u32 v51, s38, v49
    v_mov_b32 v52, 0
    v_mov_b32 v53, 0
    v_mov_b32 v54, 0
    s_add_u32 m0, s50, 34688
    s_nop 0
    buffer_load_dwordx4 v148, s[8:11], 0 offen offset:128 lds
    v_mov_b32 v55, 0
    s_waitcnt vmcnt(12)
    v_and_b32 v80, 0xffff, v76
    v_lshrrev_b32 v82, 16, v76
    v_and_b32 v84, 0xffff, v77
    v_lshrrev_b32 v86, 16, v77
    v_and_b32 v89, 0xffff, v78
    v_lshrrev_b32 v91, 16, v78
    v_and_b32 v93, 0xffff, v79
    v_lshrrev_b32 v95, 16, v79
    ds_write_b64 v123, v[80:81] offset:24576
    ds_write_b64 v123, v[82:83] offset:26512
    ds_write_b64 v123, v[84:85] offset:28448
    ds_write_b64 v123, v[86:87] offset:30384
    ds_write_b64 v123, v[88:89] offset:32320
    ds_write_b64 v123, v[90:91] offset:34256
    ds_write_b64 v123, v[92:93] offset:36192
    ds_write_b64 v123, v[94:95] offset:38128
    v_lshrrev_b32 v40, 3, v1
    v_and_b32 v41, 7, v1
    v_and_b32 v42, 6, v40
    v_xor_b32 v41, v41, v42
    v_mul_u32_u24 v40, 1536, v40
    v_lshl_add_u32 v14, v41, 4, v40
    s_mul_i32 s38, s28, 73728
    v_add_u32 v14, s38, v14
    v_bfe_u32 v40, v1, 2, 3
    v_and_b32 v41, 4, v40
    v_mfma_f32_32x32x16_bf16 v[160:175], v[52:55], v[52:55], 0
    v_add_u32 v40, v40, v41
    v_mul_u32_u24 v40, 384, v40
    v_lshl_add_u32 v40, v47, 6, v40
    v_and_b32 v41, 3, v1
    v_lshl_add_u32 v15, v41, 4, v40
    s_add_u32 m0, s50, 38784
    s_nop 0
    buffer_load_dwordx4 v149, s[8:11], 0 offen offset:128 lds
    s_waitcnt lgkmcnt(0)
    s_barrier
    ds_read_b128 a[0:3], v48 offset:24576
    ds_read_b128 a[4:7], v48 offset:25344
    ds_read_b128 a[8:11], v49 offset:26112
    ds_read_b128 a[12:15], v48 offset:24608
    s_add_u32 m0, s50, 43904
    s_nop 0
    buffer_load_dwordx4 v150, s[8:11], 0 offen offset:128 lds
    s_mul_i32 s38, s28, 6144
    v_add_u32 v15, s38, v15
    s_mov_b32 s14, 294912
    s_mov_b32 s15, s11
    s_mov_b64 s[18:19], s[14:15]
    v_mfma_f32_32x32x16_bf16 v[176:191], v[52:55], v[52:55], 0
    s_mov_b64 s[22:23], s[10:11]
    s_mul_i32 s45, s28, 6144
    s_add_u32 s45, s45, 0
    s_mul_i32 s46, s28, 6160
    s_add_u32 s46, s46, 24576
    s_mov_b32 s35, 0
    v_add_u32 v40, 1, v41
    ds_read_b128 a[16:19], v48 offset:25376
    ds_read_b128 a[20:23], v49 offset:26144
    ds_read_b128 a[24:27], v48 offset:24640
    ds_read_b128 a[28:31], v48 offset:25408
    s_add_u32 m0, s50, 48000
    s_nop 0
    buffer_load_dwordx4 v151, s[8:11], 0 offen offset:128 lds
    v_and_b32 v40, 3, v40
    v_lshl_add_u32 v40, v40, 2, v41
    v_mul_u32_u24 v157, 0x1111, v40
    v_mfma_f32_32x32x16_bf16 v[192:207], v[52:55], v[52:55], 0
    s_mul_i32 s38, s28, 6912
    s_add_u32 s38, s38, 49408
    s_lshl_b32 s39, s28, 5
    v_add_u32 v40, v46, v44
    v_bfe_u32 v41, v40, 1, 3
    v_xor_b32 v41, v41, v47
    v_lshlrev_b32 v40, 7, v40
    v_lshl_add_u32 v40, v41, 4, v40
    v_add_u32 v140, s38, v40
    ds_read_b128 a[32:35], v49 offset:26176
    ds_read_b128 a[36:39], v48 offset:24672
    ds_read_b128 a[40:43], v48 offset:25440
    ds_read_b128 a[44:47], v49 offset:26208
    s_add_u32 m0, s50, 53120
    s_nop 0
    buffer_load_dwordx4 v152, s[8:11], 0 offen offset:128 lds
    v_xor_b32 v141, 32, v140
    v_mfma_f32_32x32x16_bf16 v[208:223], v[52:55], v[52:55], 0
    v_xor_b32 v142, 64, v140
    v_xor_b32 v143, 96, v140
    v_xor_b32 v40, s39, v40
    v_add_u32 v34, 77056, v40
    v_add_u32 v40, 2, v44
    v_bfe_u32 v41, v40, 1, 3
    v_xor_b32 v41, v41, v47
    v_lshlrev_b32 v40, 7, v40
    v_lshl_add_u32 v40, v41, 4, v40
    v_mul_u32_u24 v41, 2304, v46
    v_mfma_f32_32x32x16_bf16 v[224:239], v[52:55], v[52:55], 0
    ds_read_b128 a[48:51], v48 offset:24704
    ds_read_b128 a[52:55], v48 offset:25472
    ds_read_b128 a[56:59], v49 offset:26240
    ds_read_b128 a[60:63], v48 offset:24736
    s_add_u32 m0, s50, 57216
    s_nop 0
    buffer_load_dwordx4 v153, s[8:11], 0 offen offset:128 lds
    v_add_u32 v40, v40, v41
    v_add_u32 v144, s38, v40
    v_xor_b32 v145, 32, v144
    v_xor_b32 v146, 64, v144
    v_xor_b32 v147, 96, v144
    v_xor_b32 v40, s39, v40
    v_add_u32 v35, 77056, v40
    v_add_u32 v40, 1, v44
    v_bfe_u32 v41, v40, 1, 3
    v_xor_b32 v41, v41, v45
    v_mfma_f32_32x32x16_bf16 v[240:255], v[52:55], v[52:55], 0
    v_lshlrev_b32 v40, 7, v40
    v_lshl_add_u32 v40, v41, 4, v40
    ds_read_b128 a[64:67], v48 offset:25504
    ds_read_b128 a[68:71], v49 offset:26272
    ds_read_b128 a[72:75], v48 offset:24768
    ds_read_b128 a[76:79], v48 offset:25536
    s_add_u32 m0, s50, 62336
    s_nop 0
    buffer_load_dwordx4 v154, s[8:11], 0 offen offset:128 lds
    v_add_u32 v40, 2304, v40
    v_add_u32 v32, s38, v40
    v_xor_b32 v33, 64, v32
    s_lshr_b32 s38, s28, 1
    s_lshl_b32 s38, s38, 10
    s_and_b32 s39, s28, 1
    s_lshl_b32 s39, s39, 3
    s_add_u32 s38, s38, s39
    v_mfma_f32_16x16x32_bf16 v[20:23], v[52:55], v[52:55], 0
    v_lshl_add_u32 v19, v1, 4, s38
    v_lshlrev_b32 v159, 5, v44
    s_lshl_b32 s38, s28, 2
    v_lshl_add_u32 v158, v47, 4, v159
    ds_read_b128 a[80:83], v49 offset:26304
    ds_read_b128 a[84:87], v48 offset:24800
    ds_read_b128 a[88:91], v48 offset:25568
    ds_read_b128 a[92:95], v49 offset:26336
    s_mov_b32 m0, s30
    s_add_u32 s30, s30, s52
    buffer_load_dwordx4 v155, s[8:11], 0 offen offset:128 lds
    v_add_u32 v158, s38, v158
    v_bfe_u32 v40, v1, 2, 3
    v_and_b32 v42, 3, v1
    v_lshlrev_b32 v43, 7, v40
    v_lshl_add_u32 v43, v47, 10, v43
    v_lshl_add_u32 v43, v42, 3, v43
    v_mfma_f32_16x16x32_bf16 v[24:27], v[52:55], v[52:55], 0
    v_lshrrev_b32 v2, 1, v40
    v_xor_b32 v2, s28, v2
    v_lshl_add_u32 v2, v2, 5, v43
    v_xor_b32 v3, 32, v2
    v_xor_b32 v4, 64, v2
    v_xor_b32 v5, 96, v2
    ds_read_b128 a[96:99], v48 offset:24832
    ds_read_b128 a[100:103], v48 offset:25600
    ds_read_b128 a[104:107], v49 offset:26368
    ds_read_b128 a[108:111], v48 offset:24864
    s_mov_b32 m0, s51
    s_add_u32 s51, s51, s52
    buffer_load_dwordx4 v156, s[8:11], 0 offen offset:128 lds
    v_mul_u32_u24 v43, 3080, v46
    v_lshl_add_u32 v43, v47, 8, v43
    v_lshl_add_u32 v43, v44, 4, v43
    v_lshlrev_b32 v42, 4, v45
    v_mfma_f32_16x16x32_bf16 v[28:31], v[52:55], v[52:55], 0
    s_xor_b32 s38, s28, 0
    s_mul_i32 s39, s38, 6160
    s_add_u32 s39, s39, 73984
    v_add_u32 v6, s39, v43
    s_xor_b32 s38, s28, 1
    s_mul_i32 s39, s38, 6160
    s_add_u32 s39, s39, 73984
    v_add_u32 v7, s39, v43
    ds_read_b128 a[112:115], v48 offset:25632
    ds_read_b128 a[116:119], v49 offset:26400
    ds_read_b128 a[120:123], v48 offset:24896
    ds_read_b128 a[124:127], v48 offset:25664
    s_xor_b32 s38, s28, 2
    s_mul_i32 s39, s38, 6160
    s_add_u32 s39, s39, 73984
    v_add_u32 v8, s39, v43
    s_xor_b32 s38, s28, 3
    s_mul_i32 s39, s38, 6160
    s_add_u32 s39, s39, 73984
    v_add_u32 v9, s39, v43
    s_lshl_b32 s38, s28, 6
    s_add_u32 s38, s38, 153856
    v_add_u32 v10, s38, v42
    v_xor_b32 v11, 64, v10
    v_xor_b32 v12, 128, v10
    ds_read_b128 a[128:131], v49 offset:26432
    ds_read_b128 a[132:135], v48 offset:24928
    ds_read_b128 a[136:139], v48 offset:25696
    ds_read_b128 a[140:143], v49 offset:26464
    v_xor_b32 v13, 192, v10
    v_lshlrev_b32 v17, 5, v45
    v_add_u32 v17, 156928, v17
    v_mul_u32_u24 v16, 384, v44
    v_add3_u32 v16, v16, v42, s29
    s_waitcnt vmcnt(9)
    v_mfma_f32_32x32x16_bf16 v[76:91], v[52:55], v[52:55], 0
    s_mov_b32 s38, 0x3eefde6e
    v_lshlrev_b32 v104, 16, v96
    v_and_b32 v105, 0xffff0000, v96
    v_lshlrev_b32 v106, 16, v97
    v_and_b32 v107, 0xffff0000, v97
    v_mul_f32 v104, s38, v104
    v_mul_f32 v105, s38, v105
    v_mul_f32 v106, s38, v106
    v_mul_f32 v107, s38, v107
    s_mov_b32 s38, 0x40089ba4
    v_lshlrev_b32 v108, 16, v98
    v_and_b32 v109, 0xffff0000, v98
    v_lshlrev_b32 v110, 16, v99
    v_and_b32 v111, 0xffff0000, v99
    v_mul_f32 v108, s38, v108
    v_mul_f32 v109, s38, v109
    v_mul_f32 v110, s38, v110
    v_mul_f32 v111, s38, v111
    v_add_u32 v100, 153856, v18
    s_mov_b32 s38, 157952
    v_lshl_add_u32 v101, v1, 4, s38
    ds_write_b128 v100, v[104:107]
    ds_write_b128 v101, v[108:111]
    s_waitcnt lgkmcnt(0)
    v_mfma_f32_32x32x16_bf16 v[92:107], v[52:55], v[52:55], 0
    v_mfma_f32_32x32x16_bf16 v[108:123], v[52:55], v[52:55], 0
    s_branch L_join
L_defer:
    s_add_u32 s29, s54, 86400
    v_and_b32 v1, 63, v0
    v_mov_b32 v81, 0
    v_mov_b32 v83, 0
    v_mov_b32 v85, 0
    v_mov_b32 v87, 0
    v_mov_b32 v88, 0
    s_waitcnt lgkmcnt(0)
    s_cmp_eq_u32 s28, 3
    s_cselect_b64 s[60:61], s[64:65], s[60:61]
    s_movk_i32 s62, 1536
    s_cselect_b32 s62, 384, s62
    s_mov_b32 s63, s11
    s_cselect_b32 s41, 63, -1
    v_and_b32 v103, s41, v0
    v_lshlrev_b32 v103, 3, v103
    buffer_load_dwordx2 v[96:97], v103, s[60:63], 0 offen
    v_mov_b32 v90, 0
    v_mov_b32 v92, 0
    v_mov_b32 v94, 0
    s_mov_b32 s58, 0x98532410
    s_mov_b32 s59, 0x00000f67
    v_mul_u32_u24 v40, 2731, v0
    v_lshrrev_b32 v40, 16, v40
    v_mul_u32_u24 v41, 24, v40
    v_sub_u32 v41, v0, v41
    v_lshlrev_b32 v40, 2, v40
    s_mov_b64 s[64:65], s[66:67]
    s_movk_i32 s66, 384
    s_mov_b32 s67, s11
    v_lshlrev_b32 v103, 3, v1
    buffer_load_dwordx2 v[98:99], v103, s[64:67], 0 offen
    v_lshrrev_b64 v[42:43], v40, s[58:59]
    v_and_b32 v40, 1, v42
    v_lshlrev_b32 v40, 3, v40
    v_lshl_add_u32 v40, v41, 4, v40
    v_bfe_u32 v42, v42, 1, 3
    v_mul_u32_u24 v41, 384, v42
    v_cmp_gt_u32 vcc, 5, v42
    v_add_u32 v40, v40, v41
    v_mov_b32 v41, 262144
    v_cndmask_b32 v123, v41, v40, vcc
    v_and_b32 v44, 15, v1
    v_lshrrev_b32 v45, 4, v1
    v_and_b32 v46, 1, v45
    v_lshrrev_b32 v47, 1, v45
    v_lshrrev_b32 v40, 3, v44
    v_xor_b32 v40, v40, v46
    v_mul_u32_u24 v40, 262144, v40
    v_lshl_add_u32 v40, v46, 4, v40
    v_and_b32 v41, 7, v44
    v_mul_u32_u24 v41, 1936, v41
    v_add_u32 v40, v40, v41
    v_mul_u32_u24 v41, 384, v47
    v_add_u32 v48, v40, v41
    v_xor_b32 v41, 1, v47
    v_mul_u32_u24 v41, 262144, v41
    v_add_u32 v49, v40, v41
    s_lshl_b32 s38, s28, 5
    v_add_u32 v50, s38, v48
    v_add_u32 v51, s38, v49
    v_mov_b32 v52, 0
    v_mov_b32 v53, 0
    v_mov_b32 v54, 0
    v_mov_b32 v55, 0
    s_waitcnt vmcnt(2)
    v_and_b32 v80, 0xffff, v76
    v_lshrrev_b32 v82, 16, v76
    v_and_b32 v84, 0xffff, v77
    v_lshrrev_b32 v86, 16, v77
    v_and_b32 v89, 0xffff, v78
    v_lshrrev_b32 v91, 16, v78
    v_and_b32 v93, 0xffff, v79
    v_lshrrev_b32 v95, 16, v79
    ds_write_b64 v123, v[80:81] offset:24576
    ds_write_b64 v123, v[82:83] offset:26512
    ds_write_b64 v123, v[84:85] offset:28448
    ds_write_b64 v123, v[86:87] offset:30384
    ds_write_b64 v123, v[88:89] offset:32320
    ds_write_b64 v123, v[90:91] offset:34256
    ds_write_b64 v123, v[92:93] offset:36192
    ds_write_b64 v123, v[94:95] offset:38128
    v_lshrrev_b32 v40, 3, v1
    v_and_b32 v41, 7, v1
    v_and_b32 v42, 6, v40
    v_xor_b32 v41, v41, v42
    v_mul_u32_u24 v40, 1536, v40
    v_lshl_add_u32 v14, v41, 4, v40
    s_mul_i32 s38, s28, 73728
    v_add_u32 v14, s38, v14
    v_bfe_u32 v40, v1, 2, 3
    v_and_b32 v41, 4, v40
    v_mfma_f32_32x32x16_bf16 v[160:175], v[52:55], v[52:55], 0
    v_add_u32 v40, v40, v41
    v_mul_u32_u24 v40, 384, v40
    v_lshl_add_u32 v40, v47, 6, v40
    v_and_b32 v41, 3, v1
    v_lshl_add_u32 v15, v41, 4, v40
    s_waitcnt lgkmcnt(0)
    s_barrier
    ds_read_b128 a[0:3], v48 offset:24576
    ds_read_b128 a[4:7], v48 offset:25344
    ds_read_b128 a[8:11], v49 offset:26112
    ds_read_b128 a[12:15], v48 offset:24608
    s_mul_i32 s38, s28, 6144
    v_add_u32 v15, s38, v15
    s_mov_b32 s14, 294912
    s_mov_b32 s15, s11
    s_mov_b64 s[18:19], s[14:15]
    v_mfma_f32_32x32x16_bf16 v[176:191], v[52:55], v[52:55], 0
    s_mov_b64 s[22:23], s[10:11]
    s_mul_i32 s45, s28, 6144
    s_add_u32 s45, s45, 0
    s_mul_i32 s46, s28, 6160
    s_add_u32 s46, s46, 24576
    s_mov_b32 s35, 0
    v_add_u32 v40, 1, v41
    ds_read_b128 a[16:19], v48 offset:25376
    ds_read_b128 a[20:23], v49 offset:26144
    ds_read_b128 a[24:27], v48 offset:24640
    ds_read_b128 a[28:31], v48 offset:25408
    v_and_b32 v40, 3, v40
    v_lshl_add_u32 v40, v40, 2, v41
    v_mul_u32_u24 v157, 0x1111, v40
    v_mfma_f32_32x32x16_bf16 v[192:207], v[52:55], v[52:55], 0
    s_mul_i32 s38, s28, 6912
    s_add_u32 s38, s38, 49408
    s_lshl_b32 s39, s28, 5
    v_add_u32 v40, v46, v44
    v_bfe_u32 v41, v40, 1, 3
    v_xor_b32 v41, v41, v47
    v_lshlrev_b32 v40, 7, v40
    v_lshl_add_u32 v40, v41, 4, v40
    v_add_u32 v140, s38, v40
    ds_read_b128 a[32:35], v49 offset:26176
    ds_read_b128 a[36:39], v48 offset:24672
    ds_read_b128 a[40:43], v48 offset:25440
    ds_read_b128 a[44:47], v49 offset:26208
    v_xor_b32 v141, 32, v140
    v_mfma_f32_32x32x16_bf16 v[208:223], v[52:55], v[52:55], 0
    v_xor_b32 v142, 64, v140
    v_xor_b32 v143, 96, v140
    v_xor_b32 v40, s39, v40
    v_add_u32 v34, 77056, v40
    v_add_u32 v40, 2, v44
    v_bfe_u32 v41, v40, 1, 3
    v_xor_b32 v41, v41, v47
    v_lshlrev_b32 v40, 7, v40
    v_lshl_add_u32 v40, v41, 4, v40
    v_mul_u32_u24 v41, 2304, v46
    v_mfma_f32_32x32x16_bf16 v[224:239], v[52:55], v[52:55], 0
    ds_read_b128 a[48:51], v48 offset:24704
    ds_read_b128 a[52:55], v48 offset:25472
    ds_read_b128 a[56:59], v49 offset:26240
    ds_read_b128 a[60:63], v48 offset:24736
    v_add_u32 v40, v40, v41
    v_add_u32 v144, s38, v40
    v_xor_b32 v145, 32, v144
    v_xor_b32 v146, 64, v144
    v_xor_b32 v147, 96, v144
    v_xor_b32 v40, s39, v40
    v_add_u32 v35, 77056, v40
    v_add_u32 v40, 1, v44
    v_bfe_u32 v41, v40, 1, 3
    v_xor_b32 v41, v41, v45
    v_mfma_f32_32x32x16_bf16 v[240:255], v[52:55], v[52:55], 0
    v_lshlrev_b32 v40, 7, v40
    v_lshl_add_u32 v40, v41, 4, v40
    ds_read_b128 a[64:67], v48 offset:25504
    ds_read_b128 a[68:71], v49 offset:26272
    ds_read_b128 a[72:75], v48 offset:24768
    ds_read_b128 a[76:79], v48 offset:25536
    v_add_u32 v40, 2304, v40
    v_add_u32 v32, s38, v40
    v_xor_b32 v33, 64, v32
    s_lshr_b32 s38, s28, 1
    s_lshl_b32 s38, s38, 10
    s_and_b32 s39, s28, 1
    s_lshl_b32 s39, s39, 3
    s_add_u32 s38, s38, s39
    v_mfma_f32_16x16x32_bf16 v[20:23], v[52:55], v[52:55], 0
    v_lshl_add_u32 v19, v1, 4, s38
    v_lshlrev_b32 v159, 5, v44
    s_lshl_b32 s38, s28, 2
    v_lshl_add_u32 v158, v47, 4, v159
    ds_read_b128 a[80:83], v49 offset:26304
    ds_read_b128 a[84:87], v48 offset:24800
    ds_read_b128 a[88:91], v48 offset:25568
    ds_read_b128 a[92:95], v49 offset:26336
    v_add_u32 v158, s38, v158
    v_bfe_u32 v40, v1, 2, 3
    v_and_b32 v42, 3, v1
    v_lshlrev_b32 v43, 7, v40
    v_lshl_add_u32 v43, v47, 10, v43
    v_lshl_add_u32 v43, v42, 3, v43
    v_mfma_f32_16x16x32_bf16 v[24:27], v[52:55], v[52:55], 0
    v_lshrrev_b32 v2, 1, v40
    v_xor_b32 v2, s28, v2
    v_lshl_add_u32 v2, v2, 5, v43
    v_xor_b32 v3, 32, v2
    v_xor_b32 v4, 64, v2
    v_xor_b32 v5, 96, v2
    ds_read_b128 a[96:99], v48 offset:24832
    ds_read_b128 a[100:103], v48 offset:25600
    ds_read_b128 a[104:107], v49 offset:26368
    ds_read_b128 a[108:111], v48 offset:24864
    v_mul_u32_u24 v43, 3080, v46
    v_lshl_add_u32 v43, v47, 8, v43
    v_lshl_add_u32 v43, v44, 4, v43
    v_lshlrev_b32 v42, 4, v45
    v_mfma_f32_16x16x32_bf16 v[28:31], v[52:55], v[52:55], 0
    s_xor_b32 s38, s28, 0
    s_mul_i32 s39, s38, 6160
    s_add_u32 s39, s39, 73984
    v_add_u32 v6, s39, v43
    s_xor_b32 s38, s28, 1
    s_mul_i32 s39, s38, 6160
    s_add_u32 s39, s39, 73984
    v_add_u32 v7, s39, v43
    ds_read_b128 a[112:115], v48 offset:25632
    ds_read_b128 a[116:119], v49 offset:26400
    ds_read_b128 a[120:123], v48 offset:24896
    ds_read_b128 a[124:127], v48 offset:25664
    s_xor_b32 s38, s28, 2
    s_mul_i32 s39, s38, 6160
    s_add_u32 s39, s39, 73984
    v_add_u32 v8, s39, v43
    s_xor_b32 s38, s28, 3
    s_mul_i32 s39, s38, 6160
    s_add_u32 s39, s39, 73984
    v_add_u32 v9, s39, v43
    s_lshl_b32 s38, s28, 6
    s_add_u32 s38, s38, 153856
    v_add_u32 v10, s38, v42
    v_xor_b32 v11, 64, v10
    v_xor_b32 v12, 128, v10
    ds_read_b128 a[128:131], v49 offset:26432
    ds_read_b128 a[132:135], v48 offset:24928
    ds_read_b128 a[136:139], v48 offset:25696
    ds_read_b128 a[140:143], v49 offset:26464
    v_xor_b32 v13, 192, v10
    v_lshlrev_b32 v17, 5, v45
    v_add_u32 v17, 156928, v17
    v_mul_u32_u24 v16, 384, v44
    v_add3_u32 v16, v16, v42, s29
    s_waitcnt vmcnt(0)
    v_mfma_f32_32x32x16_bf16 v[76:91], v[52:55], v[52:55], 0
    s_mov_b32 s38, 0x3eefde6e
    v_lshlrev_b32 v104, 16, v96
    v_and_b32 v105, 0xffff0000, v96
    v_lshlrev_b32 v106, 16, v97
    v_and_b32 v107, 0xffff0000, v97
    v_mul_f32 v104, s38, v104
    v_mul_f32 v105, s38, v105
    v_mul_f32 v106, s38, v106
    v_mul_f32 v107, s38, v107
    s_mov_b32 s38, 0x40089ba4
    v_lshlrev_b32 v108, 16, v98
    v_and_b32 v109, 0xffff0000, v98
    v_lshlrev_b32 v110, 16, v99
    v_and_b32 v111, 0xffff0000, v99
    v_mul_f32 v108, s38, v108
    v_mul_f32 v109, s38, v109
    v_mul_f32 v110, s38, v110
    v_mul_f32 v111, s38, v111
    v_add_u32 v100, 153856, v18
    s_mov_b32 s38, 157952
    v_lshl_add_u32 v101, v1, 4, s38
    ds_write_b128 v100, v[104:107]
    ds_write_b128 v101, v[108:111]
    v_subrev_u32 v118, s53, v118
    v_cmp_gt_u32 vcc, s56, v118
    v_add_u32 v148, s54, v148
    s_nop 0
    v_cndmask_b32 v148, v122, v148, vcc
    s_add_u32 m0, s50, 0
    s_nop 0
    buffer_load_dwordx4 v148, s[8:11], 0 offen lds
    s_mov_b32 s57, 344064
    v_add_u32 v150, s57, v148
    s_add_u32 m0, s50, 9216
    s_nop 0
    buffer_load_dwordx4 v150, s[8:11], 0 offen lds
    v_add_u32 v152, s57, v150
    v_add_u32 v116, 32, v116
    v_mul_u32_u24 v117, 3641, v116
    v_lshrrev_b32 v117, 16, v117
    v_mul_u32_u24 v119, 18, v117
    v_sub_u32 v119, v116, v119
    v_bfe_u32 v106, v119, 1, 3
    v_xor_b32 v106, v106, v121
    v_mul_u32_u24 v117, 79104, v117
    v_mad_u32_u24 v117, v116, s44, v117
    v_lshl_add_u32 v149, v106, 4, v117
    s_add_u32 m0, s50, 18432
    s_nop 0
    buffer_load_dwordx4 v152, s[8:11], 0 offen lds
    v_add_u32 v154, s57, v152
    v_subrev_u32 v119, s53, v119
    v_cmp_gt_u32 vcc, s56, v119
    v_add_u32 v149, s54, v149
    s_nop 0
    v_cndmask_b32 v149, v122, v149, vcc
    s_add_u32 m0, s50, 27648
    s_nop 0
    buffer_load_dwordx4 v154, s[8:11], 0 offen lds
    s_add_u32 s30, s50, 31744
    s_mul_i32 s51, s28, 9216
    s_add_u32 s51, s51, 57600
    s_mul_i32 s40, s28, s57
    s_add_u32 s40, s40, s54
    s_cmp_lt_u32 s28, 3
    s_cselect_b32 s30, s30, 158976
    s_cselect_b32 s51, s51, 158976
    s_cselect_b32 s52, 34688, 0
    s_cselect_b32 s40, s40, 0x40000000
    s_add_u32 m0, s50, 4096
    s_nop 0
    buffer_load_dwordx4 v149, s[8:11], 0 offen lds
    v_add_u32 v151, s57, v149
    v_bfe_u32 v116, v0, 3, 3
    v_add_u32 v116, 64, v116
    v_mul_u32_u24 v117, 3641, v116
    v_lshrrev_b32 v117, 16, v117
    v_mul_u32_u24 v120, 18, v117
    v_sub_u32 v120, v116, v120
    v_bfe_u32 v106, v120, 1, 3
    v_xor_b32 v106, v106, v121
    v_mul_u32_u24 v117, 79104, v117
    v_mad_u32_u24 v117, v116, s44, v117
    v_lshl_add_u32 v156, v106, 4, v117
    s_add_u32 m0, s50, 13312
    s_nop 0
    buffer_load_dwordx4 v151, s[8:11], 0 offen lds
    v_add_u32 v153, s57, v151
    v_subrev_u32 v120, s53, v120
    v_cmp_gt_u32 vcc, s56, v120
    v_add_u32 v156, s40, v156
    s_nop 0
    v_cndmask_b32 v156, v122, v156, vcc
    s_add_u32 m0, s50, 22528
    s_nop 0
    buffer_load_dwordx4 v153, s[8:11], 0 offen lds
    s_cmp_lt_u32 s28, 1
    s_cselect_b32 s41, s57, 0x40000000
    v_add_u32 v155, s41, v153
    s_mov_b32 m0, s30
    s_add_u32 s30, s30, s52
    buffer_load_dwordx4 v155, s[8:11], 0 offen lds
    s_mov_b32 m0, s51
    s_add_u32 s51, s51, s52
    buffer_load_dwordx4 v156, s[8:11], 0 offen lds
    s_add_u32 m0, s50, 34688
    s_nop 0
    buffer_load_dwordx4 v148, s[8:11], 0 offen offset:128 lds
    s_add_u32 m0, s50, 38784
    s_nop 0
    buffer_load_dwordx4 v149, s[8:11], 0 offen offset:128 lds
    s_add_u32 m0, s50, 43904
    s_nop 0
    buffer_load_dwordx4 v150, s[8:11], 0 offen offset:128 lds
    s_add_u32 m0, s50, 48000
    s_nop 0
    buffer_load_dwordx4 v151, s[8:11], 0 offen offset:128 lds
    s_add_u32 m0, s50, 53120
    s_nop 0
    buffer_load_dwordx4 v152, s[8:11], 0 offen offset:128 lds
    s_add_u32 m0, s50, 57216
    s_nop 0
    buffer_load_dwordx4 v153, s[8:11], 0 offen offset:128 lds
    s_add_u32 m0, s50, 62336
    s_nop 0
    buffer_load_dwordx4 v154, s[8:11], 0 offen offset:128 lds
    s_mov_b32 m0, s30
    s_add_u32 s30, s30, s52
    buffer_load_dwordx4 v155, s[8:11], 0 offen offset:128 lds
    s_mov_b32 m0, s51
    s_add_u32 s51, s51, s52
    buffer_load_dwordx4 v156, s[8:11], 0 offen offset:128 lds
    s_waitcnt lgkmcnt(0)
    v_mfma_f32_32x32x16_bf16 v[92:107], v[52:55], v[52:55], 0
    v_mfma_f32_32x32x16_bf16 v[108:123], v[52:55], v[52:55], 0
L_join:
    s_waitcnt vmcnt(9)
    s_barrier
    ds_read_b128 a[180:183], v140 offset:0
    ds_read_b128 a[184:187], v140 offset:2304
    ds_read_b128 a[188:191], v140 offset:4608
    ds_read_b128 a[192:195], v140 offset:6912
    ds_read_b128 a[196:199], v140 offset:9216
    ds_read_b128 a[200:203], v144 offset:0
    ds_read_b128 a[204:207], v144 offset:2304
    ds_read_b128 a[208:211], v144 offset:4608
    ds_read_b128 a[212:215], v144 offset:6912
    ds_read_b128 v[52:55], v141 offset:0
    ds_read_b128 v[56:59], v141 offset:2304
    ds_read_b128 v[60:63], v141 offset:4608
    s_waitcnt lgkmcnt(10)
    v_smfmac_f32_16x16x64_bf16 v[160:163], a[0:3], a[180:187], v157
    s_waitcnt lgkmcnt(9)
    ds_read_b128 v[64:67], v141 offset:6912
    v_smfmac_f32_16x16x64_bf16 v[160:163], a[8:11], a[184:191], v157
    ds_read_b128 v[68:71], v141 offset:9216
    s_add_u32 m0, s50, 69376
    s_nop 0
    buffer_load_dwordx4 v148, s[8:11], 0 offen offset:256 lds
    v_smfmac_f32_16x16x64_bf16 v[76:79], a[0:3], a[184:191], v157
    s_waitcnt lgkmcnt(10)
    ds_read_b128 v[124:127], v145 offset:0
    v_smfmac_f32_16x16x64_bf16 v[76:79], a[8:11], a[188:195], v157
    ds_read_b128 v[128:131], v145 offset:2304
    v_smfmac_f32_16x16x64_bf16 v[208:211], a[0:3], a[188:195], v157
    s_waitcnt lgkmcnt(11)
    ds_read_b128 v[132:135], v145 offset:4608
    v_smfmac_f32_16x16x64_bf16 v[208:211], a[8:11], a[192:199], v157
    s_waitcnt lgkmcnt(10)
    ds_read_b128 v[136:139], v145 offset:6912
    s_add_u32 m0, s50, 73472
    s_nop 0
    buffer_load_dwordx4 v149, s[8:11], 0 offen offset:256 lds
    v_smfmac_f32_16x16x64_bf16 v[160:163], a[4:7], a[200:207], v157
    s_waitcnt lgkmcnt(10)
    ds_read_b128 a[180:183], v142 offset:0
    v_smfmac_f32_16x16x64_bf16 v[76:79], a[4:7], a[204:211], v157
    s_waitcnt lgkmcnt(10)
    ds_read_b128 a[184:187], v142 offset:2304
    v_smfmac_f32_16x16x64_bf16 v[208:211], a[4:7], a[208:215], v157
    s_waitcnt lgkmcnt(9)
    ds_read_b128 a[188:191], v142 offset:4608
    v_smfmac_f32_16x16x64_bf16 v[164:167], a[12:15], v[52:59], v157
    s_waitcnt lgkmcnt(9)
    ds_read_b128 a[192:195], v142 offset:6912
    s_add_u32 m0, s50, 78592
    s_nop 0
    buffer_load_dwordx4 v150, s[8:11], 0 offen offset:256 lds
    v_smfmac_f32_16x16x64_bf16 v[164:167], a[20:23], v[56:63], v157
    ds_read_b128 a[196:199], v142 offset:9216
    v_smfmac_f32_16x16x64_bf16 v[80:83], a[12:15], v[56:63], v157
    s_waitcnt lgkmcnt(10)
    ds_read_b128 a[200:203], v146 offset:0
    v_smfmac_f32_16x16x64_bf16 v[80:83], a[20:23], v[60:67], v157
    ds_read_b128 a[204:207], v146 offset:2304
    v_smfmac_f32_16x16x64_bf16 v[212:215], a[12:15], v[60:67], v157
    s_waitcnt lgkmcnt(11)
    ds_read_b128 a[208:211], v146 offset:4608
    s_add_u32 m0, s50, 82688
    s_nop 0
    buffer_load_dwordx4 v151, s[8:11], 0 offen offset:256 lds
    v_smfmac_f32_16x16x64_bf16 v[212:215], a[20:23], v[64:71], v157
    s_waitcnt lgkmcnt(10)
    ds_read_b128 a[212:215], v146 offset:6912
    v_smfmac_f32_16x16x64_bf16 v[164:167], a[16:19], v[124:131], v157
    s_waitcnt lgkmcnt(10)
    ds_read_b128 v[52:55], v143 offset:0
    v_smfmac_f32_16x16x64_bf16 v[80:83], a[16:19], v[128:135], v157
    s_waitcnt lgkmcnt(10)
    ds_read_b128 v[56:59], v143 offset:2304
    v_smfmac_f32_16x16x64_bf16 v[212:215], a[16:19], v[132:139], v157
    s_waitcnt lgkmcnt(9)
    ds_read_b128 v[60:63], v143 offset:4608
    s_add_u32 m0, s50, 87808
    s_nop 0
    buffer_load_dwordx4 v152, s[8:11], 0 offen offset:256 lds
    v_smfmac_f32_16x16x64_bf16 v[168:171], a[24:27], a[180:187], v157
    s_waitcnt lgkmcnt(9)
    ds_read_b128 v[64:67], v143 offset:6912
    v_smfmac_f32_16x16x64_bf16 v[168:171], a[32:35], a[184:191], v157
    ds_read_b128 v[68:71], v143 offset:9216
    v_smfmac_f32_16x16x64_bf16 v[84:87], a[24:27], a[184:191], v157
    s_waitcnt lgkmcnt(10)
    ds_read_b128 v[124:127], v147 offset:0
    v_smfmac_f32_16x16x64_bf16 v[84:87], a[32:35], a[188:195], v157
    ds_read_b128 v[128:131], v147 offset:2304
    s_add_u32 m0, s50, 91904
    s_nop 0
    buffer_load_dwordx4 v153, s[8:11], 0 offen offset:256 lds
    v_smfmac_f32_16x16x64_bf16 v[216:219], a[24:27], a[188:195], v157
    s_waitcnt lgkmcnt(11)
    ds_read_b128 v[132:135], v147 offset:4608
    v_smfmac_f32_16x16x64_bf16 v[216:219], a[32:35], a[192:199], v157
    s_waitcnt lgkmcnt(10)
    ds_read_b128 v[136:139], v147 offset:6912
    v_smfmac_f32_16x16x64_bf16 v[168:171], a[28:31], a[200:207], v157
    s_waitcnt lgkmcnt(10)
    s_waitcnt vmcnt(6)
    s_barrier
    ds_read_b128 a[180:183], v140 offset:34816
    v_smfmac_f32_16x16x64_bf16 v[84:87], a[28:31], a[204:211], v157
    s_waitcnt lgkmcnt(10)
    ds_read_b128 a[184:187], v140 offset:37120
    s_add_u32 m0, s50, 97024
    s_nop 0
    buffer_load_dwordx4 v154, s[8:11], 0 offen offset:256 lds
    v_smfmac_f32_16x16x64_bf16 v[216:219], a[28:31], a[208:215], v157
    s_waitcnt lgkmcnt(9)
    ds_read_b128 a[188:191], v140 offset:39424
    v_smfmac_f32_16x16x64_bf16 v[172:175], a[36:39], v[52:59], v157
    s_waitcnt lgkmcnt(9)
    ds_read_b128 a[192:195], v140 offset:41728
    v_smfmac_f32_16x16x64_bf16 v[172:175], a[44:47], v[56:63], v157
    ds_read_b128 a[196:199], v140 offset:44032
    v_smfmac_f32_16x16x64_bf16 v[88:91], a[36:39], v[56:63], v157
    s_waitcnt lgkmcnt(10)
    ds_read_b128 a[200:203], v144 offset:34816
    s_mov_b32 m0, s30
    s_add_u32 s30, s30, s52
    buffer_load_dwordx4 v155, s[8:11], 0 offen offset:256 lds
    v_smfmac_f32_16x16x64_bf16 v[88:91], a[44:47], v[60:67], v157
    ds_read_b128 a[204:207], v144 offset:37120
    v_smfmac_f32_16x16x64_bf16 v[220:223], a[36:39], v[60:67], v157
    s_waitcnt lgkmcnt(11)
    ds_read_b128 a[208:211], v144 offset:39424
    v_smfmac_f32_16x16x64_bf16 v[220:223], a[44:47], v[64:71], v157
    s_waitcnt lgkmcnt(10)
    ds_read_b128 a[212:215], v144 offset:41728
    v_smfmac_f32_16x16x64_bf16 v[172:175], a[40:43], v[124:131], v157
    s_waitcnt lgkmcnt(10)
    ds_read_b128 v[52:55], v141 offset:34816
    s_mov_b32 m0, s51
    s_add_u32 s51, s51, s52
    buffer_load_dwordx4 v156, s[8:11], 0 offen offset:256 lds
    v_smfmac_f32_16x16x64_bf16 v[88:91], a[40:43], v[128:135], v157
    s_waitcnt lgkmcnt(10)
    ds_read_b128 v[56:59], v141 offset:37120
    v_smfmac_f32_16x16x64_bf16 v[220:223], a[40:43], v[132:139], v157
    ds_read_b128 v[60:63], v141 offset:39424
    ds_read_b128 a[216:219], v32 offset:0
    ds_read_b128 a[220:223], v33 offset:0
    ds_read_b128 a[224:227], v32 offset:2304
    ds_read_b128 a[228:231], v33 offset:2304
    ds_read_b128 a[240:243], v32 offset:4608
    ds_read_b128 a[244:247], v33 offset:4608
    v_pk_add_f32 v[40:41], v[160:161], 0 op_sel_hi:[1,0]
    v_pk_mul_f32 v[42:43], v[160:161], v[160:161]
    v_pk_add_f32 v[44:45], v[76:77], 0 op_sel_hi:[1,0]
    v_pk_mul_f32 v[46:47], v[76:77], v[76:77]
    v_pk_add_f32 v[48:49], v[208:209], 0 op_sel_hi:[1,0]
    v_pk_mul_f32 v[50:51], v[208:209], v[208:209]
    v_pk_add_f32 v[40:41], v[40:41], v[162:163]
    v_pk_fma_f32 v[42:43], v[162:163], v[162:163], v[42:43]
    v_pk_add_f32 v[44:45], v[44:45], v[78:79]
    v_pk_fma_f32 v[46:47], v[78:79], v[78:79], v[46:47]
    v_pk_add_f32 v[48:49], v[48:49], v[210:211]
    v_pk_fma_f32 v[50:51], v[210:211], v[210:211], v[50:51]
    v_pk_add_f32 v[40:41], v[40:41], v[164:165]
    v_pk_fma_f32 v[42:43], v[164:165], v[164:165], v[42:43]
    v_pk_add_f32 v[44:45], v[44:45], v[80:81]
    v_pk_fma_f32 v[46:47], v[80:81], v[80:81], v[46:47]
    v_pk_add_f32 v[48:49], v[48:49], v[212:213]
    v_pk_fma_f32 v[50:51], v[212:213], v[212:213], v[50:51]
    v_pk_add_f32 v[40:41], v[40:41], v[166:167]
    v_pk_fma_f32 v[42:43], v[166:167], v[166:167], v[42:43]
    v_pk_add_f32 v[44:45], v[44:45], v[82:83]
    v_pk_fma_f32 v[46:47], v[82:83], v[82:83], v[46:47]
    v_pk_add_f32 v[48:49], v[48:49], v[214:215]
    v_pk_fma_f32 v[50:51], v[214:215], v[214:215], v[50:51]
    v_pk_add_f32 v[40:41], v[40:41], v[168:169]
    v_pk_fma_f32 v[42:43], v[168:169], v[168:169], v[42:43]
    v_pk_add_f32 v[44:45], v[44:45], v[84:85]
    v_pk_fma_f32 v[46:47], v[84:85], v[84:85], v[46:47]
    v_pk_add_f32 v[48:49], v[48:49], v[216:217]
    v_pk_fma_f32 v[50:51], v[216:217], v[216:217], v[50:51]
    v_pk_add_f32 v[40:41], v[40:41], v[170:171]
    v_pk_fma_f32 v[42:43], v[170:171], v[170:171], v[42:43]
    v_pk_add_f32 v[44:45], v[44:45], v[86:87]
    v_pk_fma_f32 v[46:47], v[86:87], v[86:87], v[46:47]
    v_pk_add_f32 v[48:49], v[48:49], v[218:219]
    v_pk_fma_f32 v[50:51], v[218:219], v[218:219], v[50:51]
    v_pk_add_f32 v[40:41], v[40:41], v[172:173]
    v_pk_fma_f32 v[42:43], v[172:173], v[172:173], v[42:43]
    v_pk_add_f32 v[44:45], v[44:45], v[88:89]
    v_pk_fma_f32 v[46:47], v[88:89], v[88:89], v[46:47]
    v_pk_add_f32 v[48:49], v[48:49], v[220:221]
    v_pk_fma_f32 v[50:51], v[220:221], v[220:221], v[50:51]
    v_pk_add_f32 v[40:41], v[40:41], v[174:175]
    v_pk_fma_f32 v[42:43], v[174:175], v[174:175], v[42:43]
    v_pk_add_f32 v[44:45], v[44:45], v[90:91]
    v_pk_fma_f32 v[46:47], v[90:91], v[90:91], v[46:47]
    v_pk_add_f32 v[48:49], v[48:49], v[222:223]
    v_pk_fma_f32 v[50:51], v[222:223], v[222:223], v[50:51]
    s_waitcnt lgkmcnt(14)
    v_smfmac_f32_16x16x64_bf16 v[176:179], a[48:51], a[180:187], v157
    s_waitcnt lgkmcnt(14)
    ds_read_b128 v[64:67], v141 offset:41728
    v_smfmac_f32_16x16x64_bf16 v[176:179], a[56:59], a[184:191], v157
    ds_read_b128 v[68:71], v141 offset:44032
    s_add_u32 m0, s45, 0
    s_add_u32 s47, s35, 0
    buffer_load_dwordx4 v14, s[12:15], s47 offen lds
    v_smfmac_f32_16x16x64_bf16 v[92:95], a[48:51], a[184:191], v157
    s_waitcnt lgkmcnt(14)
    ds_read_b128 v[124:127], v145 offset:34816
    v_smfmac_f32_16x16x64_bf16 v[92:95], a[56:59], a[188:195], v157
    ds_read_b128 v[128:131], v145 offset:37120
    v_smfmac_f32_16x16x64_bf16 v[224:227], a[48:51], a[188:195], v157
    s_waitcnt lgkmcnt(14)
    ds_read_b128 v[132:135], v145 offset:39424
    v_smfmac_f32_16x16x64_bf16 v[224:227], a[56:59], a[192:199], v157
    s_waitcnt lgkmcnt(14)
    ds_read_b128 v[136:139], v145 offset:41728
    v_smfmac_f32_16x16x64_bf16 v[176:179], a[52:55], a[200:207], v157
    s_waitcnt lgkmcnt(14)
    ds_read_b128 a[180:183], v142 offset:34816
    s_add_u32 m0, s45, 1024
    s_add_u32 s47, s35, 12288
    buffer_load_dwordx4 v14, s[12:15], s47 offen lds
    v_smfmac_f32_16x16x64_bf16 v[92:95], a[52:55], a[204:211], v157
    s_waitcnt lgkmcnt(14)
    ds_read_b128 a[184:187], v142 offset:37120
    v_smfmac_f32_16x16x64_bf16 v[224:227], a[52:55], a[208:215], v157
    s_waitcnt lgkmcnt(14)
    ds_read_b128 a[188:191], v142 offset:39424
    v_smfmac_f32_16x16x64_bf16 v[180:183], a[60:63], v[52:59], v157
    s_waitcnt lgkmcnt(14)
    ds_read_b128 a[192:195], v142 offset:41728
    v_smfmac_f32_16x16x64_bf16 v[180:183], a[68:71], v[56:63], v157
    ds_read_b128 a[196:199], v142 offset:44032
    v_smfmac_f32_16x16x64_bf16 v[96:99], a[60:63], v[56:63], v157
    s_waitcnt lgkmcnt(10)
    ds_read_b128 a[200:203], v146 offset:34816
    s_add_u32 m0, s45, 2048
    s_add_u32 s47, s35, 24576
    buffer_load_dwordx4 v14, s[12:15], s47 offen lds
    v_smfmac_f32_16x16x64_bf16 v[96:99], a[68:71], v[60:67], v157
    ds_read_b128 a[204:207], v146 offset:37120
    v_smfmac_f32_16x16x64_bf16 v[228:231], a[60:63], v[60:67], v157
    s_waitcnt lgkmcnt(11)
    ds_read_b128 a[208:211], v146 offset:39424
    v_smfmac_f32_16x16x64_bf16 v[228:231], a[68:71], v[64:71], v157
    s_waitcnt lgkmcnt(10)
    ds_read_b128 a[212:215], v146 offset:41728
    v_smfmac_f32_16x16x64_bf16 v[180:183], a[64:67], v[124:131], v157
    s_waitcnt lgkmcnt(10)
    ds_read_b128 v[52:55], v143 offset:34816
    v_smfmac_f32_16x16x64_bf16 v[96:99], a[64:67], v[128:135], v157
    s_waitcnt lgkmcnt(10)
    ds_read_b128 v[56:59], v143 offset:37120
    s_add_u32 m0, s45, 3072
    s_add_u32 s47, s35, 36864
    buffer_load_dwordx4 v14, s[12:15], s47 offen lds
    v_smfmac_f32_16x16x64_bf16 v[228:231], a[64:67], v[132:139], v157
    s_waitcnt lgkmcnt(9)
    ds_read_b128 v[60:63], v143 offset:39424
    v_smfmac_f32_16x16x64_bf16 v[184:187], a[72:75], a[180:187], v157
    s_waitcnt lgkmcnt(9)
    ds_read_b128 v[64:67], v143 offset:41728
    v_smfmac_f32_16x16x64_bf16 v[184:187], a[80:83], a[184:191], v157
    ds_read_b128 v[68:71], v143 offset:44032
    v_smfmac_f32_16x16x64_bf16 v[100:103], a[72:75], a[184:191], v157
    s_waitcnt lgkmcnt(10)
    ds_read_b128 v[124:127], v147 offset:34816
    v_smfmac_f32_16x16x64_bf16 v[100:103], a[80:83], a[188:195], v157
    ds_read_b128 v[128:131], v147 offset:37120
    s_add_u32 m0, s45, 4096
    s_add_u32 s47, s35, 49152
    buffer_load_dwordx4 v14, s[12:15], s47 offen lds
    v_smfmac_f32_16x16x64_bf16 v[232:235], a[72:75], a[188:195], v157
    s_waitcnt lgkmcnt(11)
    ds_read_b128 v[132:135], v147 offset:39424
    v_smfmac_f32_16x16x64_bf16 v[232:235], a[80:83], a[192:199], v157
    s_waitcnt lgkmcnt(10)
    ds_read_b128 v[136:139], v147 offset:41728
    v_smfmac_f32_16x16x64_bf16 v[184:187], a[76:79], a[200:207], v157
    s_waitcnt lgkmcnt(10)
    v_add_u32 v140, 69632, v140
    v_add_u32 v141, 69632, v141
    v_add_u32 v142, 69632, v142
    v_add_u32 v143, 69632, v143
    v_add_u32 v144, 69632, v144
    v_add_u32 v145, 69632, v145
    v_add_u32 v146, 69632, v146
    v_add_u32 v147, 69632, v147
    s_waitcnt vmcnt(5)
    s_barrier
    ds_read_b128 a[180:183], v140 offset:0
    v_smfmac_f32_16x16x64_bf16 v[100:103], a[76:79], a[204:211], v157
    s_waitcnt lgkmcnt(10)
    ds_read_b128 a[184:187], v140 offset:2304
    v_smfmac_f32_16x16x64_bf16 v[232:235], a[76:79], a[208:215], v157
    s_waitcnt lgkmcnt(9)
    ds_read_b128 a[188:191], v140 offset:4608
    s_add_u32 m0, s45, 5120
    s_add_u32 s47, s35, 61440
    buffer_load_dwordx4 v14, s[12:15], s47 offen lds
    v_smfmac_f32_16x16x64_bf16 v[188:191], a[84:87], v[52:59], v157
    s_waitcnt lgkmcnt(9)
    ds_read_b128 a[192:195], v140 offset:6912
    v_smfmac_f32_16x16x64_bf16 v[188:191], a[92:95], v[56:63], v157
    ds_read_b128 a[196:199], v140 offset:9216
    v_smfmac_f32_16x16x64_bf16 v[104:107], a[84:87], v[56:63], v157
    s_waitcnt lgkmcnt(10)
    ds_read_b128 a[200:203], v144 offset:0
    v_smfmac_f32_16x16x64_bf16 v[104:107], a[92:95], v[60:67], v157
    ds_read_b128 a[204:207], v144 offset:2304
    v_smfmac_f32_16x16x64_bf16 v[236:239], a[84:87], v[60:67], v157
    s_waitcnt lgkmcnt(11)
    ds_read_b128 a[208:211], v144 offset:4608
    v_smfmac_f32_16x16x64_bf16 v[236:239], a[92:95], v[64:71], v157
    s_waitcnt lgkmcnt(10)
    ds_read_b128 a[212:215], v144 offset:6912
    v_smfmac_f32_16x16x64_bf16 v[188:191], a[88:91], v[124:131], v157
    s_waitcnt lgkmcnt(10)
    ds_read_b128 v[52:55], v141 offset:0
    v_smfmac_f32_16x16x64_bf16 v[104:107], a[88:91], v[128:135], v157
    s_waitcnt lgkmcnt(10)
    ds_read_b128 v[56:59], v141 offset:2304
    v_smfmac_f32_16x16x64_bf16 v[236:239], a[88:91], v[132:139], v157
    ds_read_b128 v[60:63], v141 offset:4608
    ds_read_b128 v[148:151], v32 offset:34816
    ds_read_b128 v[152:155], v33 offset:34816
    ds_read_b128 a[232:235], v32 offset:37120
    ds_read_b128 a[236:239], v33 offset:37120
    ds_read_b128 a[248:251], v32 offset:39424
    ds_read_b128 a[252:255], v33 offset:39424
    v_add_u32 v32, 69632, v32
    v_add_u32 v33, 69632, v33
    v_pk_add_f32 v[40:41], v[40:41], v[176:177]
    v_pk_fma_f32 v[42:43], v[176:177], v[176:177], v[42:43]
    v_pk_add_f32 v[44:45], v[44:45], v[92:93]
    v_pk_fma_f32 v[46:47], v[92:93], v[92:93], v[46:47]
    v_pk_add_f32 v[48:49], v[48:49], v[224:225]
    v_pk_fma_f32 v[50:51], v[224:225], v[224:225], v[50:51]
    v_pk_add_f32 v[40:41], v[40:41], v[178:179]
    v_pk_fma_f32 v[42:43], v[178:179], v[178:179], v[42:43]
    v_pk_add_f32 v[44:45], v[44:45], v[94:95]
    v_pk_fma_f32 v[46:47], v[94:95], v[94:95], v[46:47]
    v_pk_add_f32 v[48:49], v[48:49], v[226:227]
    v_pk_fma_f32 v[50:51], v[226:227], v[226:227], v[50:51]
    v_pk_add_f32 v[40:41], v[40:41], v[180:181]
    v_pk_fma_f32 v[42:43], v[180:181], v[180:181], v[42:43]
    v_pk_add_f32 v[44:45], v[44:45], v[96:97]
    v_pk_fma_f32 v[46:47], v[96:97], v[96:97], v[46:47]
    v_pk_add_f32 v[48:49], v[48:49], v[228:229]
    v_pk_fma_f32 v[50:51], v[228:229], v[228:229], v[50:51]
    v_pk_add_f32 v[40:41], v[40:41], v[182:183]
    v_pk_fma_f32 v[42:43], v[182:183], v[182:183], v[42:43]
    v_pk_add_f32 v[44:45], v[44:45], v[98:99]
    v_pk_fma_f32 v[46:47], v[98:99], v[98:99], v[46:47]
    v_pk_add_f32 v[48:49], v[48:49], v[230:231]
    v_pk_fma_f32 v[50:51], v[230:231], v[230:231], v[50:51]
    v_pk_add_f32 v[40:41], v[40:41], v[184:185]
    v_pk_fma_f32 v[42:43], v[184:185], v[184:185], v[42:43]
    v_pk_add_f32 v[44:45], v[44:45], v[100:101]
    v_pk_fma_f32 v[46:47], v[100:101], v[100:101], v[46:47]
    v_pk_add_f32 v[48:49], v[48:49], v[232:233]
    v_pk_fma_f32 v[50:51], v[232:233], v[232:233], v[50:51]
    v_pk_add_f32 v[40:41], v[40:41], v[186:187]
    v_pk_fma_f32 v[42:43], v[186:187], v[186:187], v[42:43]
    v_pk_add_f32 v[44:45], v[44:45], v[102:103]
    v_pk_fma_f32 v[46:47], v[102:103], v[102:103], v[46:47]
    v_pk_add_f32 v[48:49], v[48:49], v[234:235]
    v_pk_fma_f32 v[50:51], v[234:235], v[234:235], v[50:51]
    v_pk_add_f32 v[40:41], v[40:41], v[188:189]
    v_pk_fma_f32 v[42:43], v[188:189], v[188:189], v[42:43]
    v_pk_add_f32 v[44:45], v[44:45], v[104:105]
    v_pk_fma_f32 v[46:47], v[104:105], v[104:105], v[46:47]
    v_pk_add_f32 v[48:49], v[48:49], v[236:237]
    v_pk_fma_f32 v[50:51], v[236:237], v[236:237], v[50:51]
    v_pk_add_f32 v[40:41], v[40:41], v[190:191]
    v_pk_fma_f32 v[42:43], v[190:191], v[190:191], v[42:43]
    v_pk_add_f32 v[44:45], v[44:45], v[106:107]
    v_pk_fma_f32 v[46:47], v[106:107], v[106:107], v[46:47]
    v_pk_add_f32 v[48:49], v[48:49], v[238:239]
    v_pk_fma_f32 v[50:51], v[238:239], v[238:239], v[50:51]
    s_waitcnt lgkmcnt(14)
    v_smfmac_f32_16x16x64_bf16 v[192:195], a[96:99], a[180:187], v157
    s_waitcnt lgkmcnt(14)
    ds_read_b128 v[64:67], v141 offset:6912
    v_smfmac_f32_16x16x64_bf16 v[192:195], a[104:107], a[184:191], v157
    ds_read_b128 v[68:71], v141 offset:9216
    v_smfmac_f32_16x16x64_bf16 v[108:111], a[96:99], a[184:191], v157
    s_waitcnt lgkmcnt(14)
    ds_read_b128 v[124:127], v145 offset:0
    v_smfmac_f32_16x16x64_bf16 v[108:111], a[104:107], a[188:195], v157
    ds_read_b128 v[128:131], v145 offset:2304
    v_smfmac_f32_16x16x64_bf16 v[240:243], a[96:99], a[188:195], v157
    s_waitcnt lgkmcnt(14)
    ds_read_b128 v[132:135], v145 offset:4608
    v_smfmac_f32_16x16x64_bf16 v[240:243], a[104:107], a[192:199], v157
    s_waitcnt lgkmcnt(14)
    ds_read_b128 v[136:139], v145 offset:6912
    v_smfmac_f32_16x16x64_bf16 v[192:195], a[100:103], a[200:207], v157
    s_waitcnt lgkmcnt(14)
    ds_read_b128 a[180:183], v142 offset:0
    v_smfmac_f32_16x16x64_bf16 v[108:111], a[100:103], a[204:211], v157
    s_waitcnt lgkmcnt(14)
    ds_read_b128 a[184:187], v142 offset:2304
    v_smfmac_f32_16x16x64_bf16 v[240:243], a[100:103], a[208:215], v157
    s_waitcnt lgkmcnt(14)
    ds_read_b128 a[188:191], v142 offset:4608
    v_smfmac_f32_16x16x64_bf16 v[196:199], a[108:111], v[52:59], v157
    s_waitcnt lgkmcnt(14)
    ds_read_b128 a[192:195], v142 offset:6912
    v_smfmac_f32_16x16x64_bf16 v[196:199], a[116:119], v[56:63], v157
    ds_read_b128 a[196:199], v142 offset:9216
    v_smfmac_f32_16x16x64_bf16 v[112:115], a[108:111], v[56:63], v157
    s_waitcnt lgkmcnt(10)
    ds_read_b128 a[200:203], v146 offset:0
    v_smfmac_f32_16x16x64_bf16 v[112:115], a[116:119], v[60:67], v157
    ds_read_b128 a[204:207], v146 offset:2304
    v_smfmac_f32_16x16x64_bf16 v[244:247], a[108:111], v[60:67], v157
    s_waitcnt lgkmcnt(11)
    ds_read_b128 a[208:211], v146 offset:4608
    v_smfmac_f32_16x16x64_bf16 v[244:247], a[116:119], v[64:71], v157
    s_waitcnt lgkmcnt(10)
    ds_read_b128 a[212:215], v146 offset:6912
    v_smfmac_f32_16x16x64_bf16 v[196:199], a[112:115], v[124:131], v157
    s_waitcnt lgkmcnt(10)
    ds_read_b128 v[52:55], v143 offset:0
    v_smfmac_f32_16x16x64_bf16 v[112:115], a[112:115], v[128:135], v157
    s_waitcnt lgkmcnt(10)
    ds_read_b128 v[56:59], v143 offset:2304
    v_smfmac_f32_16x16x64_bf16 v[244:247], a[112:115], v[132:139], v157
    s_waitcnt lgkmcnt(9)
    ds_read_b128 v[60:63], v143 offset:4608
    v_smfmac_f32_16x16x64_bf16 v[200:203], a[120:123], a[180:187], v157
    s_waitcnt lgkmcnt(9)
    ds_read_b128 v[64:67], v143 offset:6912
    v_smfmac_f32_16x16x64_bf16 v[200:203], a[128:131], a[184:191], v157
    ds_read_b128 v[68:71], v143 offset:9216
    v_smfmac_f32_16x16x64_bf16 v[116:119], a[120:123], a[184:191], v157
    s_waitcnt lgkmcnt(10)
    ds_read_b128 v[124:127], v147 offset:0
    v_smfmac_f32_16x16x64_bf16 v[116:119], a[128:131], a[188:195], v157
    ds_read_b128 v[128:131], v147 offset:2304
    v_smfmac_f32_16x16x64_bf16 v[248:251], a[120:123], a[188:195], v157
    s_waitcnt lgkmcnt(11)
    ds_read_b128 v[132:135], v147 offset:4608
    v_smfmac_f32_16x16x64_bf16 v[248:251], a[128:131], a[192:199], v157
    s_waitcnt lgkmcnt(10)
    ds_read_b128 v[136:139], v147 offset:6912
    v_smfmac_f32_16x16x64_bf16 v[200:203], a[124:127], a[200:207], v157
    s_waitcnt lgkmcnt(10)
    v_smfmac_f32_16x16x64_bf16 v[116:119], a[124:127], a[204:211], v157
    s_waitcnt lgkmcnt(9)
    v_smfmac_f32_16x16x64_bf16 v[248:251], a[124:127], a[208:215], v157
    s_waitcnt lgkmcnt(7)
    v_smfmac_f32_16x16x64_bf16 v[204:207], a[132:135], v[52:59], v157
    s_waitcnt lgkmcnt(6)
    v_smfmac_f32_16x16x64_bf16 v[204:207], a[140:143], v[56:63], v157
    v_smfmac_f32_16x16x64_bf16 v[120:123], a[132:135], v[56:63], v157
    s_waitcnt lgkmcnt(5)
    v_smfmac_f32_16x16x64_bf16 v[120:123], a[140:143], v[60:67], v157
    v_smfmac_f32_16x16x64_bf16 v[252:255], a[132:135], v[60:67], v157
    s_waitcnt lgkmcnt(4)
    v_smfmac_f32_16x16x64_bf16 v[252:255], a[140:143], v[64:71], v157
    s_waitcnt lgkmcnt(2)
    v_smfmac_f32_16x16x64_bf16 v[204:207], a[136:139], v[124:131], v157
    s_waitcnt lgkmcnt(1)
    v_smfmac_f32_16x16x64_bf16 v[120:123], a[136:139], v[128:135], v157
    s_waitcnt lgkmcnt(0)
    v_smfmac_f32_16x16x64_bf16 v[252:255], a[136:139], v[132:139], v157
    ds_read_b128 v[124:127], v32 offset:0
    ds_read_b128 v[128:131], v33 offset:0
    ds_read_b128 v[132:135], v32 offset:2304
    ds_read_b128 v[136:139], v33 offset:2304
    ds_read_b128 v[140:143], v32 offset:4608
    ds_read_b128 v[144:147], v33 offset:4608
    v_pk_add_f32 v[40:41], v[40:41], v[192:193]
    v_pk_fma_f32 v[42:43], v[192:193], v[192:193], v[42:43]
    v_pk_add_f32 v[44:45], v[44:45], v[108:109]
    v_pk_fma_f32 v[46:47], v[108:109], v[108:109], v[46:47]
    v_pk_add_f32 v[48:49], v[48:49], v[240:241]
    v_pk_fma_f32 v[50:51], v[240:241], v[240:241], v[50:51]
    v_pk_add_f32 v[40:41], v[40:41], v[194:195]
    v_pk_fma_f32 v[42:43], v[194:195], v[194:195], v[42:43]
    v_pk_add_f32 v[44:45], v[44:45], v[110:111]
    v_pk_fma_f32 v[46:47], v[110:111], v[110:111], v[46:47]
    v_pk_add_f32 v[48:49], v[48:49], v[242:243]
    v_pk_fma_f32 v[50:51], v[242:243], v[242:243], v[50:51]
    v_pk_add_f32 v[40:41], v[40:41], v[196:197]
    v_pk_fma_f32 v[42:43], v[196:197], v[196:197], v[42:43]
    v_pk_add_f32 v[44:45], v[44:45], v[112:113]
    v_pk_fma_f32 v[46:47], v[112:113], v[112:113], v[46:47]
    v_pk_add_f32 v[48:49], v[48:49], v[244:245]
    v_pk_fma_f32 v[50:51], v[244:245], v[244:245], v[50:51]
    v_pk_add_f32 v[40:41], v[40:41], v[198:199]
    v_pk_fma_f32 v[42:43], v[198:199], v[198:199], v[42:43]
    v_pk_add_f32 v[44:45], v[44:45], v[114:115]
    v_pk_fma_f32 v[46:47], v[114:115], v[114:115], v[46:47]
    v_pk_add_f32 v[48:49], v[48:49], v[246:247]
    v_pk_fma_f32 v[50:51], v[246:247], v[246:247], v[50:51]
    v_pk_add_f32 v[40:41], v[40:41], v[200:201]
    v_pk_fma_f32 v[42:43], v[200:201], v[200:201], v[42:43]
    v_pk_add_f32 v[44:45], v[44:45], v[116:117]
    v_pk_fma_f32 v[46:47], v[116:117], v[116:117], v[46:47]
    v_pk_add_f32 v[48:49], v[48:49], v[248:249]
    v_pk_fma_f32 v[50:51], v[248:249], v[248:249], v[50:51]
    v_pk_add_f32 v[40:41], v[40:41], v[202:203]
    v_pk_fma_f32 v[42:43], v[202:203], v[202:203], v[42:43]
    v_pk_add_f32 v[44:45], v[44:45], v[118:119]
    v_pk_fma_f32 v[46:47], v[118:119], v[118:119], v[46:47]
    v_pk_add_f32 v[48:49], v[48:49], v[250:251]
    v_pk_fma_f32 v[50:51], v[250:251], v[250:251], v[50:51]
    s_waitcnt vmcnt(0)
    s_waitcnt lgkmcnt(0)
    s_barrier
    s_mul_i32 s45, s28, 6144
    s_add_u32 s45, s45, 49408
    s_mul_i32 s46, s28, 6160
    s_add_u32 s46, s46, 73984
    s_mov_b32 s35, 128
    s_mov_b32 s36, 0
    s_add_u32 m0, s45, 0
    s_add_u32 s47, s35, 0
    buffer_load_dwordx4 v14, s[12:15], s47 offen lds
    v_pk_add_f32 v[40:41], v[40:41], v[204:205]
    v_pk_fma_f32 v[42:43], v[204:205], v[204:205], v[42:43]
    v_pk_add_f32 v[44:45], v[44:45], v[120:121]
    v_pk_fma_f32 v[46:47], v[120:121], v[120:121], v[46:47]
    v_pk_add_f32 v[48:49], v[48:49], v[252:253]
    v_pk_fma_f32 v[50:51], v[252:253], v[252:253], v[50:51]
    v_pk_add_f32 v[40:41], v[40:41], v[206:207]
    v_pk_fma_f32 v[42:43], v[206:207], v[206:207], v[42:43]
    v_pk_add_f32 v[44:45], v[44:45], v[122:123]
    v_pk_fma_f32 v[46:47], v[122:123], v[122:123], v[46:47]
    v_pk_add_f32 v[48:49], v[48:49], v[254:255]
    v_pk_fma_f32 v[50:51], v[254:255], v[254:255], v[50:51]
    v_add_f32 v41, v40, v41
    v_add_f32 v45, v44, v45
    v_add_f32 v49, v48, v49
    v_add_f32 v43, v42, v43
    v_add_f32 v47, v46, v47
    v_add_f32 v51, v50, v51
    s_add_u32 m0, s45, 1024
    s_add_u32 s47, s35, 12288
    buffer_load_dwordx4 v14, s[12:15], s47 offen lds
    v_permlane32_swap_b32 v41, v43
    v_permlane32_swap_b32 v45, v47
    v_permlane32_swap_b32 v49, v51
    v_add_f32 v41, v41, v43
    v_add_f32 v45, v45, v47
    v_add_f32 v49, v49, v51
    v_mov_b32 v43, v41
    v_mov_b32 v47, v45
    v_mov_b32 v51, v49
    v_permlane16_swap_b32 v41, v43
    v_permlane16_swap_b32 v45, v47
    v_permlane16_swap_b32 v49, v51
    v_add_f32 v41, v41, v43
    v_add_f32 v45, v45, v47
    v_add_f32 v49, v49, v51
    s_add_u32 m0, s45, 2048
    s_add_u32 s47, s35, 24576
    buffer_load_dwordx4 v14, s[12:15], s47 offen lds
    v_mul_f32 v41, 0x3baaaaab, v41
    v_mul_f32 v45, 0x3baaaaab, v45
    v_mul_f32 v49, 0x3baaaaab, v49
    v_mov_b32 v43, v41
    v_mov_b32 v47, v45
    v_mov_b32 v51, v49
    v_permlane32_swap_b32 v41, v43
    v_permlane32_swap_b32 v45, v47
    v_permlane32_swap_b32 v49, v51
    v_fma_f32 v43, -v41, v41, v43
    v_fma_f32 v47, -v45, v45, v47
    v_fma_f32 v51, -v49, v49, v51
    v_max_f32 v43, 0, v43
    v_max_f32 v47, 0, v47
    v_max_f32 v51, 0, v51
    s_add_u32 m0, s45, 3072
    s_add_u32 s47, s35, 36864
    buffer_load_dwordx4 v14, s[12:15], s47 offen lds
    v_add_f32 v43, 0x3727c5ac, v43
    v_add_f32 v47, 0x3727c5ac, v47
    v_add_f32 v51, 0x3727c5ac, v51
    v_rsq_f32 v43, v43
    v_rsq_f32 v47, v47
    v_rsq_f32 v51, v51
    v_mul_f32 v40, 0x3eefde6e, v43
    v_mul_f32 v44, 0x3eefde6e, v47
    v_mul_f32 v48, 0x3eefde6e, v51
    v_mul_f32 v42, v41, v40
    v_mul_f32 v46, v45, v44
    v_mul_f32 v50, v49, v48
    v_pk_fma_f32 v[160:161], v[160:161], v[40:41], v[42:43] op_sel_hi:[1,0,0] neg_lo:[0,0,1] neg_hi:[0,0,1]
    v_pk_fma_f32 v[162:163], v[162:163], v[40:41], v[42:43] op_sel_hi:[1,0,0] neg_lo:[0,0,1] neg_hi:[0,0,1]
    v_pk_fma_f32 v[164:165], v[164:165], v[40:41], v[42:43] op_sel_hi:[1,0,0] neg_lo:[0,0,1] neg_hi:[0,0,1]
    v_pk_fma_f32 v[166:167], v[166:167], v[40:41], v[42:43] op_sel_hi:[1,0,0] neg_lo:[0,0,1] neg_hi:[0,0,1]
    v_pk_fma_f32 v[168:169], v[168:169], v[40:41], v[42:43] op_sel_hi:[1,0,0] neg_lo:[0,0,1] neg_hi:[0,0,1]
    v_pk_fma_f32 v[170:171], v[170:171], v[40:41], v[42:43] op_sel_hi:[1,0,0] neg_lo:[0,0,1] neg_hi:[0,0,1]
    v_pk_fma_f32 v[172:173], v[172:173], v[40:41], v[42:43] op_sel_hi:[1,0,0] neg_lo:[0,0,1] neg_hi:[0,0,1]
    v_cvt_pk_bf16_f32 v160, v160, v161
    v_pk_fma_f32 v[174:175], v[174:175], v[40:41], v[42:43] op_sel_hi:[1,0,0] neg_lo:[0,0,1] neg_hi:[0,0,1]
    v_cvt_pk_bf16_f32 v161, v162, v163
    s_add_u32 m0, s45, 4096
    s_add_u32 s47, s35, 49152
    buffer_load_dwordx4 v14, s[12:15], s47 offen lds
    v_pk_fma_f32 v[176:177], v[176:177], v[40:41], v[42:43] op_sel_hi:[1,0,0] neg_lo:[0,0,1] neg_hi:[0,0,1]
    v_cvt_pk_bf16_f32 v162, v164, v165
    v_pk_fma_f32 v[178:179], v[178:179], v[40:41], v[42:43] op_sel_hi:[1,0,0] neg_lo:[0,0,1] neg_hi:[0,0,1]
    v_cvt_pk_bf16_f32 v163, v166, v167
    v_pk_fma_f32 v[180:181], v[180:181], v[40:41], v[42:43] op_sel_hi:[1,0,0] neg_lo:[0,0,1] neg_hi:[0,0,1]
    v_cvt_pk_bf16_f32 v164, v168, v169
    v_pk_fma_f32 v[182:183], v[182:183], v[40:41], v[42:43] op_sel_hi:[1,0,0] neg_lo:[0,0,1] neg_hi:[0,0,1]
    v_cvt_pk_bf16_f32 v165, v170, v171
    v_pk_fma_f32 v[184:185], v[184:185], v[40:41], v[42:43] op_sel_hi:[1,0,0] neg_lo:[0,0,1] neg_hi:[0,0,1]
    v_cvt_pk_bf16_f32 v166, v172, v173
    v_pk_fma_f32 v[186:187], v[186:187], v[40:41], v[42:43] op_sel_hi:[1,0,0] neg_lo:[0,0,1] neg_hi:[0,0,1]
    v_cvt_pk_bf16_f32 v167, v174, v175
    v_pk_fma_f32 v[188:189], v[188:189], v[40:41], v[42:43] op_sel_hi:[1,0,0] neg_lo:[0,0,1] neg_hi:[0,0,1]
    v_cvt_pk_bf16_f32 v168, v176, v177
    v_pk_fma_f32 v[190:191], v[190:191], v[40:41], v[42:43] op_sel_hi:[1,0,0] neg_lo:[0,0,1] neg_hi:[0,0,1]
    v_cvt_pk_bf16_f32 v169, v178, v179
    s_add_u32 m0, s45, 5120
    s_add_u32 s47, s35, 61440
    buffer_load_dwordx4 v14, s[12:15], s47 offen lds
    v_pk_fma_f32 v[192:193], v[192:193], v[40:41], v[42:43] op_sel_hi:[1,0,0] neg_lo:[0,0,1] neg_hi:[0,0,1]
    v_cvt_pk_bf16_f32 v170, v180, v181
    v_pk_fma_f32 v[194:195], v[194:195], v[40:41], v[42:43] op_sel_hi:[1,0,0] neg_lo:[0,0,1] neg_hi:[0,0,1]
    v_cvt_pk_bf16_f32 v171, v182, v183
    v_pk_fma_f32 v[196:197], v[196:197], v[40:41], v[42:43] op_sel_hi:[1,0,0] neg_lo:[0,0,1] neg_hi:[0,0,1]
    v_cvt_pk_bf16_f32 v172, v184, v185
    v_pk_fma_f32 v[198:199], v[198:199], v[40:41], v[42:43] op_sel_hi:[1,0,0] neg_lo:[0,0,1] neg_hi:[0,0,1]
    v_cvt_pk_bf16_f32 v173, v186, v187
    v_pk_fma_f32 v[200:201], v[200:201], v[40:41], v[42:43] op_sel_hi:[1,0,0] neg_lo:[0,0,1] neg_hi:[0,0,1]
    v_cvt_pk_bf16_f32 v174, v188, v189
    v_pk_fma_f32 v[202:203], v[202:203], v[40:41], v[42:43] op_sel_hi:[1,0,0] neg_lo:[0,0,1] neg_hi:[0,0,1]
    v_cvt_pk_bf16_f32 v175, v190, v191
    v_pk_fma_f32 v[204:205], v[204:205], v[40:41], v[42:43] op_sel_hi:[1,0,0] neg_lo:[0,0,1] neg_hi:[0,0,1]
    v_cvt_pk_bf16_f32 v176, v192, v193
    v_pk_fma_f32 v[206:207], v[206:207], v[40:41], v[42:43] op_sel_hi:[1,0,0] neg_lo:[0,0,1] neg_hi:[0,0,1]
    v_cvt_pk_bf16_f32 v177, v194, v195
    s_add_u32 m0, s46, 0
    s_add_u32 s47, s36, 0
    buffer_load_dwordx4 v15, s[16:19], s47 offen lds
    v_cvt_pk_bf16_f32 v178, v196, v197
    v_cvt_pk_bf16_f32 v179, v198, v199
    v_cvt_pk_bf16_f32 v180, v200, v201
    v_cvt_pk_bf16_f32 v181, v202, v203
    v_cvt_pk_bf16_f32 v182, v204, v205
    v_cvt_pk_bf16_f32 v183, v206, v207
    v_pk_fma_f32 v[76:77], v[76:77], v[44:45], v[46:47] op_sel_hi:[1,0,0] neg_lo:[0,0,1] neg_hi:[0,0,1]
    v_pk_fma_f32 v[78:79], v[78:79], v[44:45], v[46:47] op_sel_hi:[1,0,0] neg_lo:[0,0,1] neg_hi:[0,0,1]
    v_pk_fma_f32 v[80:81], v[80:81], v[44:45], v[46:47] op_sel_hi:[1,0,0] neg_lo:[0,0,1] neg_hi:[0,0,1]
    v_pk_fma_f32 v[82:83], v[82:83], v[44:45], v[46:47] op_sel_hi:[1,0,0] neg_lo:[0,0,1] neg_hi:[0,0,1]
    v_pk_fma_f32 v[84:85], v[84:85], v[44:45], v[46:47] op_sel_hi:[1,0,0] neg_lo:[0,0,1] neg_hi:[0,0,1]
    v_pk_fma_f32 v[86:87], v[86:87], v[44:45], v[46:47] op_sel_hi:[1,0,0] neg_lo:[0,0,1] neg_hi:[0,0,1]
    v_pk_fma_f32 v[88:89], v[88:89], v[44:45], v[46:47] op_sel_hi:[1,0,0] neg_lo:[0,0,1] neg_hi:[0,0,1]
    v_cvt_pk_bf16_f32 v184, v76, v77
    v_pk_fma_f32 v[90:91], v[90:91], v[44:45], v[46:47] op_sel_hi:[1,0,0] neg_lo:[0,0,1] neg_hi:[0,0,1]
    v_cvt_pk_bf16_f32 v185, v78, v79
    s_add_u32 m0, s46, 1024
    s_add_u32 s47, s36, 128
    buffer_load_dwordx4 v15, s[16:19], s47 offen lds
    v_pk_fma_f32 v[92:93], v[92:93], v[44:45], v[46:47] op_sel_hi:[1,0,0] neg_lo:[0,0,1] neg_hi:[0,0,1]
    v_cvt_pk_bf16_f32 v186, v80, v81
    v_pk_fma_f32 v[94:95], v[94:95], v[44:45], v[46:47] op_sel_hi:[1,0,0] neg_lo:[0,0,1] neg_hi:[0,0,1]
    v_cvt_pk_bf16_f32 v187, v82, v83
    v_pk_fma_f32 v[96:97], v[96:97], v[44:45], v[46:47] op_sel_hi:[1,0,0] neg_lo:[0,0,1] neg_hi:[0,0,1]
    v_cvt_pk_bf16_f32 v188, v84, v85
    v_pk_fma_f32 v[98:99], v[98:99], v[44:45], v[46:47] op_sel_hi:[1,0,0] neg_lo:[0,0,1] neg_hi:[0,0,1]
    v_cvt_pk_bf16_f32 v189, v86, v87
    v_pk_fma_f32 v[100:101], v[100:101], v[44:45], v[46:47] op_sel_hi:[1,0,0] neg_lo:[0,0,1] neg_hi:[0,0,1]
    v_cvt_pk_bf16_f32 v190, v88, v89
    v_pk_fma_f32 v[102:103], v[102:103], v[44:45], v[46:47] op_sel_hi:[1,0,0] neg_lo:[0,0,1] neg_hi:[0,0,1]
    v_cvt_pk_bf16_f32 v191, v90, v91
    v_pk_fma_f32 v[104:105], v[104:105], v[44:45], v[46:47] op_sel_hi:[1,0,0] neg_lo:[0,0,1] neg_hi:[0,0,1]
    v_cvt_pk_bf16_f32 v192, v92, v93
    v_pk_fma_f32 v[106:107], v[106:107], v[44:45], v[46:47] op_sel_hi:[1,0,0] neg_lo:[0,0,1] neg_hi:[0,0,1]
    v_cvt_pk_bf16_f32 v193, v94, v95
    s_add_u32 m0, s46, 2048
    s_add_u32 s47, s36, 256
    buffer_load_dwordx4 v15, s[16:19], s47 offen lds
    v_pk_fma_f32 v[108:109], v[108:109], v[44:45], v[46:47] op_sel_hi:[1,0,0] neg_lo:[0,0,1] neg_hi:[0,0,1]
    v_cvt_pk_bf16_f32 v194, v96, v97
    v_pk_fma_f32 v[110:111], v[110:111], v[44:45], v[46:47] op_sel_hi:[1,0,0] neg_lo:[0,0,1] neg_hi:[0,0,1]
    v_cvt_pk_bf16_f32 v195, v98, v99
    v_pk_fma_f32 v[112:113], v[112:113], v[44:45], v[46:47] op_sel_hi:[1,0,0] neg_lo:[0,0,1] neg_hi:[0,0,1]
    v_cvt_pk_bf16_f32 v196, v100, v101
    v_pk_fma_f32 v[114:115], v[114:115], v[44:45], v[46:47] op_sel_hi:[1,0,0] neg_lo:[0,0,1] neg_hi:[0,0,1]
    v_cvt_pk_bf16_f32 v197, v102, v103
    v_pk_fma_f32 v[116:117], v[116:117], v[44:45], v[46:47] op_sel_hi:[1,0,0] neg_lo:[0,0,1] neg_hi:[0,0,1]
    v_cvt_pk_bf16_f32 v198, v104, v105
    v_pk_fma_f32 v[118:119], v[118:119], v[44:45], v[46:47] op_sel_hi:[1,0,0] neg_lo:[0,0,1] neg_hi:[0,0,1]
    v_cvt_pk_bf16_f32 v199, v106, v107
    v_pk_fma_f32 v[120:121], v[120:121], v[44:45], v[46:47] op_sel_hi:[1,0,0] neg_lo:[0,0,1] neg_hi:[0,0,1]
    v_cvt_pk_bf16_f32 v200, v108, v109
    v_pk_fma_f32 v[122:123], v[122:123], v[44:45], v[46:47] op_sel_hi:[1,0,0] neg_lo:[0,0,1] neg_hi:[0,0,1]
    v_cvt_pk_bf16_f32 v201, v110, v111
    s_add_u32 m0, s46, 3080
    s_add_u32 s47, s36, 1536
    buffer_load_dwordx4 v15, s[16:19], s47 offen lds
    v_cvt_pk_bf16_f32 v202, v112, v113
    v_cvt_pk_bf16_f32 v203, v114, v115
    v_cvt_pk_bf16_f32 v204, v116, v117
    v_cvt_pk_bf16_f32 v205, v118, v119
    v_cvt_pk_bf16_f32 v206, v120, v121
    v_cvt_pk_bf16_f32 v207, v122, v123
    v_pk_fma_f32 v[208:209], v[208:209], v[48:49], v[50:51] op_sel_hi:[1,0,0] neg_lo:[0,0,1] neg_hi:[0,0,1]
    v_pk_fma_f32 v[210:211], v[210:211], v[48:49], v[50:51] op_sel_hi:[1,0,0] neg_lo:[0,0,1] neg_hi:[0,0,1]
    v_pk_fma_f32 v[212:213], v[212:213], v[48:49], v[50:51] op_sel_hi:[1,0,0] neg_lo:[0,0,1] neg_hi:[0,0,1]
    v_pk_fma_f32 v[214:215], v[214:215], v[48:49], v[50:51] op_sel_hi:[1,0,0] neg_lo:[0,0,1] neg_hi:[0,0,1]
    v_pk_fma_f32 v[216:217], v[216:217], v[48:49], v[50:51] op_sel_hi:[1,0,0] neg_lo:[0,0,1] neg_hi:[0,0,1]
    v_pk_fma_f32 v[218:219], v[218:219], v[48:49], v[50:51] op_sel_hi:[1,0,0] neg_lo:[0,0,1] neg_hi:[0,0,1]
    v_pk_fma_f32 v[220:221], v[220:221], v[48:49], v[50:51] op_sel_hi:[1,0,0] neg_lo:[0,0,1] neg_hi:[0,0,1]
    v_cvt_pk_bf16_f32 v208, v208, v209
    v_pk_fma_f32 v[222:223], v[222:223], v[48:49], v[50:51] op_sel_hi:[1,0,0] neg_lo:[0,0,1] neg_hi:[0,0,1]
    v_cvt_pk_bf16_f32 v209, v210, v211
    s_add_u32 m0, s46, 4104
    s_add_u32 s47, s36, 1664
    buffer_load_dwordx4 v15, s[16:19], s47 offen lds
    v_pk_fma_f32 v[224:225], v[224:225], v[48:49], v[50:51] op_sel_hi:[1,0,0] neg_lo:[0,0,1] neg_hi:[0,0,1]
    v_cvt_pk_bf16_f32 v210, v212, v213
    v_pk_fma_f32 v[226:227], v[226:227], v[48:49], v[50:51] op_sel_hi:[1,0,0] neg_lo:[0,0,1] neg_hi:[0,0,1]
    v_cvt_pk_bf16_f32 v211, v214, v215
    v_pk_fma_f32 v[228:229], v[228:229], v[48:49], v[50:51] op_sel_hi:[1,0,0] neg_lo:[0,0,1] neg_hi:[0,0,1]
    v_cvt_pk_bf16_f32 v212, v216, v217
    v_pk_fma_f32 v[230:231], v[230:231], v[48:49], v[50:51] op_sel_hi:[1,0,0] neg_lo:[0,0,1] neg_hi:[0,0,1]
    v_cvt_pk_bf16_f32 v213, v218, v219
    v_pk_fma_f32 v[232:233], v[232:233], v[48:49], v[50:51] op_sel_hi:[1,0,0] neg_lo:[0,0,1] neg_hi:[0,0,1]
    v_cvt_pk_bf16_f32 v214, v220, v221
    v_pk_fma_f32 v[234:235], v[234:235], v[48:49], v[50:51] op_sel_hi:[1,0,0] neg_lo:[0,0,1] neg_hi:[0,0,1]
    v_cvt_pk_bf16_f32 v215, v222, v223
    v_pk_fma_f32 v[236:237], v[236:237], v[48:49], v[50:51] op_sel_hi:[1,0,0] neg_lo:[0,0,1] neg_hi:[0,0,1]
    v_cvt_pk_bf16_f32 v216, v224, v225
    v_pk_fma_f32 v[238:239], v[238:239], v[48:49], v[50:51] op_sel_hi:[1,0,0] neg_lo:[0,0,1] neg_hi:[0,0,1]
    v_cvt_pk_bf16_f32 v217, v226, v227
    s_add_u32 m0, s46, 5128
    s_add_u32 s47, s36, 1792
    buffer_load_dwordx4 v15, s[16:19], s47 offen lds
    v_pk_fma_f32 v[240:241], v[240:241], v[48:49], v[50:51] op_sel_hi:[1,0,0] neg_lo:[0,0,1] neg_hi:[0,0,1]
    v_cvt_pk_bf16_f32 v218, v228, v229
    v_pk_fma_f32 v[242:243], v[242:243], v[48:49], v[50:51] op_sel_hi:[1,0,0] neg_lo:[0,0,1] neg_hi:[0,0,1]
    v_cvt_pk_bf16_f32 v219, v230, v231
    v_pk_fma_f32 v[244:245], v[244:245], v[48:49], v[50:51] op_sel_hi:[1,0,0] neg_lo:[0,0,1] neg_hi:[0,0,1]
    v_cvt_pk_bf16_f32 v220, v232, v233
    v_pk_fma_f32 v[246:247], v[246:247], v[48:49], v[50:51] op_sel_hi:[1,0,0] neg_lo:[0,0,1] neg_hi:[0,0,1]
    v_cvt_pk_bf16_f32 v221, v234, v235
    v_pk_fma_f32 v[248:249], v[248:249], v[48:49], v[50:51] op_sel_hi:[1,0,0] neg_lo:[0,0,1] neg_hi:[0,0,1]
    v_cvt_pk_bf16_f32 v222, v236, v237
    v_pk_fma_f32 v[250:251], v[250:251], v[48:49], v[50:51] op_sel_hi:[1,0,0] neg_lo:[0,0,1] neg_hi:[0,0,1]
    v_cvt_pk_bf16_f32 v223, v238, v239
    v_pk_fma_f32 v[252:253], v[252:253], v[48:49], v[50:51] op_sel_hi:[1,0,0] neg_lo:[0,0,1] neg_hi:[0,0,1]
    v_cvt_pk_bf16_f32 v224, v240, v241
    v_pk_fma_f32 v[254:255], v[254:255], v[48:49], v[50:51] op_sel_hi:[1,0,0] neg_lo:[0,0,1] neg_hi:[0,0,1]
    v_cvt_pk_bf16_f32 v225, v242, v243
    v_cvt_pk_bf16_f32 v226, v244, v245
    v_cvt_pk_bf16_f32 v227, v246, v247
    v_cvt_pk_bf16_f32 v228, v248, v249
    v_cvt_pk_bf16_f32 v229, v250, v251
    v_cvt_pk_bf16_f32 v230, v252, v253
    v_cvt_pk_bf16_f32 v231, v254, v255
    s_mov_b32 s32, 0x44ea44ea
    s_mul_i32 s45, s28, 6144
    s_add_u32 s45, s45, 98816
    s_mul_i32 s46, s28, 6160
    s_add_u32 s46, s46, 123392
    s_mov_b32 s35, 256
    s_mov_b32 s36, 24576
    s_mov_b32 s33, 49408
    s_mov_b32 s48, 49408
    s_mov_b32 s49, -98816
    s_mov_b32 s37, 10
    ds_read_b128 v[20:23], v10
    ds_read_b64_tr_b16 a[192:193], v2 offset:0
    ds_read_b64_tr_b16 a[194:195], v2 offset:2048
    ds_read_b64_tr_b16 a[196:197], v2 offset:4096
    ds_read_b64_tr_b16 a[198:199], v2 offset:6144
    ds_read_b64_tr_b16 a[200:201], v2 offset:8192
    ds_read_b64_tr_b16 a[202:203], v2 offset:10240
    ds_read_b64_tr_b16 a[204:205], v2 offset:12288
    ds_read_b64_tr_b16 a[206:207], v2 offset:14336
    v_add_u32 v10, 0x100, v10
    s_waitcnt lgkmcnt(6)
    v_mfma_f32_16x16x32_bf16 v[76:79], a[192:195], v[160:163], v[20:23]
    s_add_u32 m0, s45, 0
    ds_read_b64_tr_b16 a[208:209], v2 offset:16384
    ds_read_b64_tr_b16 a[210:211], v2 offset:18432
    v_mfma_f32_16x16x32_bf16 v[84:87], a[192:195], v[184:187], v[20:23]
    s_add_u32 s47, s35, 0
    buffer_load_dwordx4 v14, s[12:15], s47 offen lds
    v_mfma_f32_16x16x32_bf16 v[92:95], a[192:195], v[208:211], v[20:23]
    s_waitcnt lgkmcnt(6)
    v_mfma_f32_16x16x32_bf16 v[76:79], a[196:199], v[164:167], v[76:79]
    s_add_u32 m0, s45, 1024
    ds_read_b64_tr_b16 a[212:213], v2 offset:20480
    ds_read_b64_tr_b16 a[214:215], v2 offset:22528
    v_add_u32 v2, s33, v2
    v_mfma_f32_16x16x32_bf16 v[84:87], a[196:199], v[188:191], v[84:87]
    s_add_u32 s47, s35, 12288
    buffer_load_dwordx4 v14, s[12:15], s47 offen lds
    v_mfma_f32_16x16x32_bf16 v[92:95], a[196:199], v[212:215], v[92:95]
    s_waitcnt lgkmcnt(6)
    v_mfma_f32_16x16x32_bf16 v[76:79], a[200:203], v[168:171], v[76:79]
    s_add_u32 m0, s45, 2048
    ds_read_b128 v[24:27], v11
    ds_read_b64_tr_b16 a[192:193], v3 offset:0
    ds_read_b64_tr_b16 a[194:195], v3 offset:2048
    v_add_u32 v11, 0x100, v11
    v_mfma_f32_16x16x32_bf16 v[84:87], a[200:203], v[192:195], v[84:87]
    s_add_u32 s47, s35, 24576
    buffer_load_dwordx4 v14, s[12:15], s47 offen lds
    v_mfma_f32_16x16x32_bf16 v[92:95], a[200:203], v[216:219], v[92:95]
    s_waitcnt lgkmcnt(7)
    v_mfma_f32_16x16x32_bf16 v[76:79], a[204:207], v[172:175], v[76:79]
    s_add_u32 m0, s45, 3072
    ds_read_b64_tr_b16 a[196:197], v3 offset:4096
    ds_read_b64_tr_b16 a[198:199], v3 offset:6144
    v_mfma_f32_16x16x32_bf16 v[84:87], a[204:207], v[196:199], v[84:87]
    s_add_u32 s47, s35, 36864
    buffer_load_dwordx4 v14, s[12:15], s47 offen lds
    v_mfma_f32_16x16x32_bf16 v[92:95], a[204:207], v[220:223], v[92:95]
    s_waitcnt lgkmcnt(7)
    v_mfma_f32_16x16x32_bf16 v[76:79], a[208:211], v[176:179], v[76:79]
    s_add_u32 m0, s45, 4096
    ds_read_b64_tr_b16 a[200:201], v3 offset:8192
    ds_read_b64_tr_b16 a[202:203], v3 offset:10240
    v_mfma_f32_16x16x32_bf16 v[84:87], a[208:211], v[200:203], v[84:87]
    s_add_u32 s47, s35, 49152
    buffer_load_dwordx4 v14, s[12:15], s47 offen lds
    v_mfma_f32_16x16x32_bf16 v[92:95], a[208:211], v[224:227], v[92:95]
    s_waitcnt lgkmcnt(7)
    v_mfma_f32_16x16x32_bf16 v[76:79], a[212:215], v[180:183], v[76:79]
    s_add_u32 m0, s45, 5120
    ds_read_b64_tr_b16 a[204:205], v3 offset:12288
    ds_read_b64_tr_b16 a[206:207], v3 offset:14336
    v_mfma_f32_16x16x32_bf16 v[84:87], a[212:215], v[204:207], v[84:87]
    s_add_u32 s47, s35, 61440
    buffer_load_dwordx4 v14, s[12:15], s47 offen lds
    v_mfma_f32_16x16x32_bf16 v[92:95], a[212:215], v[228:231], v[92:95]
    s_waitcnt lgkmcnt(6)
    v_mfma_f32_16x16x32_bf16 v[80:83], a[192:195], v[160:163], v[24:27]
    s_add_u32 m0, s46, 0
    ds_read_b64_tr_b16 a[208:209], v3 offset:16384
    ds_read_b64_tr_b16 a[210:211], v3 offset:18432
    v_mfma_f32_16x16x32_bf16 v[88:91], a[192:195], v[184:187], v[24:27]
    s_add_u32 s47, s36, 0
    buffer_load_dwordx4 v15, s[16:19], s47 offen lds
    v_mfma_f32_16x16x32_bf16 v[96:99], a[192:195], v[208:211], v[24:27]
    s_waitcnt lgkmcnt(6)
    v_mfma_f32_16x16x32_bf16 v[80:83], a[196:199], v[164:167], v[80:83]
    s_add_u32 m0, s46, 1024
    ds_read_b64_tr_b16 a[212:213], v3 offset:20480
    ds_read_b64_tr_b16 a[214:215], v3 offset:22528
    v_add_u32 v3, s33, v3
    v_mfma_f32_16x16x32_bf16 v[88:91], a[196:199], v[188:191], v[88:91]
    s_add_u32 s47, s36, 128
    buffer_load_dwordx4 v15, s[16:19], s47 offen lds
    v_mfma_f32_16x16x32_bf16 v[96:99], a[196:199], v[212:215], v[96:99]
    s_waitcnt lgkmcnt(6)
    v_mfma_f32_16x16x32_bf16 v[80:83], a[200:203], v[168:171], v[80:83]
    s_add_u32 m0, s46, 2048
    ds_read_b128 v[20:23], v12
    ds_read_b64_tr_b16 a[192:193], v4 offset:0
    ds_read_b64_tr_b16 a[194:195], v4 offset:2048
    v_add_u32 v12, 0x100, v12
    v_mfma_f32_16x16x32_bf16 v[88:91], a[200:203], v[192:195], v[88:91]
    s_add_u32 s47, s36, 256
    buffer_load_dwordx4 v15, s[16:19], s47 offen lds
    v_mfma_f32_16x16x32_bf16 v[96:99], a[200:203], v[216:219], v[96:99]
    s_waitcnt lgkmcnt(7)
    v_mfma_f32_16x16x32_bf16 v[80:83], a[204:207], v[172:175], v[80:83]
    s_add_u32 m0, s46, 3080
    ds_read_b64_tr_b16 a[196:197], v4 offset:4096
    ds_read_b64_tr_b16 a[198:199], v4 offset:6144
    v_mfma_f32_16x16x32_bf16 v[88:91], a[204:207], v[196:199], v[88:91]
    s_add_u32 s47, s36, 1536
    buffer_load_dwordx4 v15, s[16:19], s47 offen lds
    v_mfma_f32_16x16x32_bf16 v[96:99], a[204:207], v[220:223], v[96:99]
    s_waitcnt lgkmcnt(7)
    v_mfma_f32_16x16x32_bf16 v[80:83], a[208:211], v[176:179], v[80:83]
    s_add_u32 m0, s46, 4104
    ds_read_b64_tr_b16 a[200:201], v4 offset:8192
    ds_read_b64_tr_b16 a[202:203], v4 offset:10240
    v_mfma_f32_16x16x32_bf16 v[88:91], a[208:211], v[200:203], v[88:91]
    s_add_u32 s47, s36, 1664
    buffer_load_dwordx4 v15, s[16:19], s47 offen lds
    v_mfma_f32_16x16x32_bf16 v[96:99], a[208:211], v[224:227], v[96:99]
    s_waitcnt lgkmcnt(7)
    v_mfma_f32_16x16x32_bf16 v[80:83], a[212:215], v[180:183], v[80:83]
    s_add_u32 m0, s46, 5128
    ds_read_b64_tr_b16 a[204:205], v4 offset:12288
    ds_read_b64_tr_b16 a[206:207], v4 offset:14336
    v_mfma_f32_16x16x32_bf16 v[88:91], a[212:215], v[204:207], v[88:91]
    s_add_u32 s47, s36, 1792
    buffer_load_dwordx4 v15, s[16:19], s47 offen lds
    v_mfma_f32_16x16x32_bf16 v[96:99], a[212:215], v[228:231], v[96:99]
    s_waitcnt lgkmcnt(6)
    v_mfma_f32_16x16x32_bf16 v[100:103], a[192:195], v[160:163], v[20:23]
    s_add_u32 s45, s45, s49
    ds_read_b64_tr_b16 a[208:209], v4 offset:16384
    ds_read_b64_tr_b16 a[210:211], v4 offset:18432
    v_cvt_pk_f16_f32 v28, v76, v77
    v_cvt_pk_f16_f32 v30, v78, v79
    v_pk_fma_f16 v29, v28, v28, s32
    v_pk_fma_f16 v31, v30, v30, s32
    v_mfma_f32_16x16x32_bf16 v[108:111], a[192:195], v[184:187], v[20:23]
    v_pk_mul_f16 v28, v28, v29 neg_lo:[1,0] neg_hi:[1,0]
    v_pk_mul_f16 v30, v30, v31 neg_lo:[1,0] neg_hi:[1,0]
    v_exp_f16 v29, v28
    v_exp_f16 v31, v30
    v_mfma_f32_16x16x32_bf16 v[116:119], a[192:195], v[208:211], v[20:23]
    s_waitcnt lgkmcnt(6)
    ds_read_b128 a[0:3], v17 offset:0
    v_exp_f16_sdwa v29, v28 dst_sel:WORD_1 dst_unused:UNUSED_PRESERVE src0_sel:WORD_1
    v_exp_f16_sdwa v31, v30 dst_sel:WORD_1 dst_unused:UNUSED_PRESERVE src0_sel:WORD_1
    v_pk_add_f16 v28, v29, 1.0 op_sel_hi:[1,0]
    v_pk_add_f16 v30, v31, 1.0 op_sel_hi:[1,0]
    v_mfma_f32_16x16x32_bf16 v[100:103], a[196:199], v[164:167], v[100:103]
    s_add_u32 s46, s46, s49
    ds_read_b64_tr_b16 a[212:213], v4 offset:20480
    ds_read_b64_tr_b16 a[214:215], v4 offset:22528
    v_add_u32 v4, s33, v4
    v_rcp_f16 v29, v28
    v_mfma_f32_16x16x32_bf16 v[108:111], a[196:199], v[188:191], v[108:111]
    v_rcp_f16 v31, v30
    v_rcp_f16_sdwa v29, v28 dst_sel:WORD_1 dst_unused:UNUSED_PRESERVE src0_sel:WORD_1
    v_rcp_f16_sdwa v31, v30 dst_sel:WORD_1 dst_unused:UNUSED_PRESERVE src0_sel:WORD_1
    v_fma_mix_f32 v28, v76, v29, 0 op_sel_hi:[0,1,0]
    v_mfma_f32_16x16x32_bf16 v[116:119], a[196:199], v[212:215], v[116:119]
    s_waitcnt lgkmcnt(7)
    ds_read_b128 a[4:7], v17 offset:16
    v_fma_mix_f32 v30, v78, v31, 0 op_sel_hi:[0,1,0]
    v_fma_mix_f32 v29, v77, v29, 0 op_sel:[0,1,0] op_sel_hi:[0,1,0]
    v_fma_mix_f32 v31, v79, v31, 0 op_sel:[0,1,0] op_sel_hi:[0,1,0]
    v_cvt_pk_bf16_f32 v52, v28, v29
    v_cvt_pk_bf16_f32 v53, v30, v31
    v_mfma_f32_16x16x32_bf16 v[100:103], a[200:203], v[168:171], v[100:103]
    s_add_u32 s35, s35, 128
    ds_read_b128 v[24:27], v13
    ds_read_b64_tr_b16 a[192:193], v5 offset:0
    ds_read_b64_tr_b16 a[194:195], v5 offset:2048
    v_add_u32 v13, 0x100, v13
    v_cvt_pk_f16_f32 v32, v80, v81
    v_cvt_pk_f16_f32 v34, v82, v83
    v_mfma_f32_16x16x32_bf16 v[108:111], a[200:203], v[192:195], v[108:111]
    v_pk_fma_f16 v33, v32, v32, s32
    v_pk_fma_f16 v35, v34, v34, s32
    v_pk_mul_f16 v32, v32, v33 neg_lo:[1,0] neg_hi:[1,0]
    v_pk_mul_f16 v34, v34, v35 neg_lo:[1,0] neg_hi:[1,0]
    v_exp_f16 v33, v32
    v_mfma_f32_16x16x32_bf16 v[116:119], a[200:203], v[216:219], v[116:119]
    s_waitcnt lgkmcnt(9)
    ds_read_b128 a[8:11], v17 offset:128
    v_exp_f16 v35, v34
    v_exp_f16_sdwa v33, v32 dst_sel:WORD_1 dst_unused:UNUSED_PRESERVE src0_sel:WORD_1
    v_exp_f16_sdwa v35, v34 dst_sel:WORD_1 dst_unused:UNUSED_PRESERVE src0_sel:WORD_1
    v_mfma_f32_16x16x32_bf16 v[100:103], a[204:207], v[172:175], v[100:103]
    s_add_u32 s36, s36, 24576
    ds_read_b64_tr_b16 a[196:197], v5 offset:4096
    ds_read_b64_tr_b16 a[198:199], v5 offset:6144
    v_pk_add_f16 v32, v33, 1.0 op_sel_hi:[1,0]
    v_pk_add_f16 v34, v35, 1.0 op_sel_hi:[1,0]
    v_rcp_f16 v33, v32
    v_mfma_f32_16x16x32_bf16 v[108:111], a[204:207], v[196:199], v[108:111]
    v_rcp_f16 v35, v34
    v_rcp_f16_sdwa v33, v32 dst_sel:WORD_1 dst_unused:UNUSED_PRESERVE src0_sel:WORD_1
    v_rcp_f16_sdwa v35, v34 dst_sel:WORD_1 dst_unused:UNUSED_PRESERVE src0_sel:WORD_1
    v_mfma_f32_16x16x32_bf16 v[116:119], a[204:207], v[220:223], v[116:119]
    s_waitcnt lgkmcnt(10)
    ds_read_b128 a[12:15], v17 offset:144
    v_fma_mix_f32 v32, v80, v33, 0 op_sel_hi:[0,1,0]
    v_fma_mix_f32 v34, v82, v35, 0 op_sel_hi:[0,1,0]
    v_fma_mix_f32 v33, v81, v33, 0 op_sel:[0,1,0] op_sel_hi:[0,1,0]
    v_fma_mix_f32 v35, v83, v35, 0 op_sel:[0,1,0] op_sel_hi:[0,1,0]
    v_cvt_pk_bf16_f32 v54, v32, v33
    v_mfma_f32_16x16x32_bf16 v[100:103], a[208:211], v[176:179], v[100:103]
    s_mov_b32 s38, s48
    ds_read_b64_tr_b16 a[200:201], v5 offset:8192
    ds_read_b64_tr_b16 a[202:203], v5 offset:10240
    v_cvt_pk_bf16_f32 v55, v34, v35
    v_cvt_pk_f16_f32 v28, v84, v85
    v_cvt_pk_f16_f32 v30, v86, v87
    v_pk_fma_f16 v29, v28, v28, s32
    v_mfma_f32_16x16x32_bf16 v[108:111], a[208:211], v[200:203], v[108:111]
    v_pk_fma_f16 v31, v30, v30, s32
    v_pk_mul_f16 v28, v28, v29 neg_lo:[1,0] neg_hi:[1,0]
    v_pk_mul_f16 v30, v30, v31 neg_lo:[1,0] neg_hi:[1,0]
    v_exp_f16 v29, v28
    v_mfma_f32_16x16x32_bf16 v[116:119], a[208:211], v[224:227], v[116:119]
    s_waitcnt lgkmcnt(10)
    ds_read_b128 a[16:19], v17 offset:256
    v_exp_f16 v31, v30
    v_exp_f16_sdwa v29, v28 dst_sel:WORD_1 dst_unused:UNUSED_PRESERVE src0_sel:WORD_1
    v_exp_f16_sdwa v31, v30 dst_sel:WORD_1 dst_unused:UNUSED_PRESERVE src0_sel:WORD_1
    v_pk_add_f16 v28, v29, 1.0 op_sel_hi:[1,0]
    v_mfma_f32_16x16x32_bf16 v[100:103], a[212:215], v[180:183], v[100:103]
    s_mov_b32 s48, s49
    ds_read_b64_tr_b16 a[204:205], v5 offset:12288
    ds_read_b64_tr_b16 a[206:207], v5 offset:14336
    v_pk_add_f16 v30, v31, 1.0 op_sel_hi:[1,0]
    v_rcp_f16 v29, v28
    v_mfma_f32_16x16x32_bf16 v[108:111], a[212:215], v[204:207], v[108:111]
    v_rcp_f16 v31, v30
    v_rcp_f16_sdwa v29, v28 dst_sel:WORD_1 dst_unused:UNUSED_PRESERVE src0_sel:WORD_1
    v_rcp_f16_sdwa v31, v30 dst_sel:WORD_1 dst_unused:UNUSED_PRESERVE src0_sel:WORD_1
    v_fma_mix_f32 v28, v84, v29, 0 op_sel_hi:[0,1,0]
    v_mfma_f32_16x16x32_bf16 v[116:119], a[212:215], v[228:231], v[116:119]
    s_waitcnt lgkmcnt(9)
    ds_read_b128 a[20:23], v17 offset:272
    v_fma_mix_f32 v30, v86, v31, 0 op_sel_hi:[0,1,0]
    v_fma_mix_f32 v29, v85, v29, 0 op_sel:[0,1,0] op_sel_hi:[0,1,0]
    v_fma_mix_f32 v31, v87, v31, 0 op_sel:[0,1,0] op_sel_hi:[0,1,0]
    v_cvt_pk_bf16_f32 v56, v28, v29
    v_cvt_pk_bf16_f32 v57, v30, v31
    v_mfma_f32_16x16x32_bf16 v[104:107], a[192:195], v[160:163], v[24:27]
    s_waitcnt vmcnt(12)
    s_barrier
    s_mov_b32 s49, s33
    ds_read_b64_tr_b16 a[208:209], v5 offset:16384
    ds_read_b64_tr_b16 a[210:211], v5 offset:18432
    v_cvt_pk_f16_f32 v32, v88, v89
    v_cvt_pk_f16_f32 v34, v90, v91
    v_pk_fma_f16 v33, v32, v32, s32
    v_pk_fma_f16 v35, v34, v34, s32
    v_mfma_f32_16x16x32_bf16 v[112:115], a[192:195], v[184:187], v[24:27]
    v_pk_mul_f16 v32, v32, v33 neg_lo:[1,0] neg_hi:[1,0]
    v_pk_mul_f16 v34, v34, v35 neg_lo:[1,0] neg_hi:[1,0]
    v_exp_f16 v33, v32
    v_exp_f16 v35, v34
    v_mfma_f32_16x16x32_bf16 v[120:123], a[192:195], v[208:211], v[24:27]
    s_waitcnt lgkmcnt(9)
    ds_read_b128 a[24:27], v17 offset:384
    v_exp_f16_sdwa v33, v32 dst_sel:WORD_1 dst_unused:UNUSED_PRESERVE src0_sel:WORD_1
    v_exp_f16_sdwa v35, v34 dst_sel:WORD_1 dst_unused:UNUSED_PRESERVE src0_sel:WORD_1
    v_pk_add_f16 v32, v33, 1.0 op_sel_hi:[1,0]
    v_pk_add_f16 v34, v35, 1.0 op_sel_hi:[1,0]
    v_mfma_f32_16x16x32_bf16 v[104:107], a[196:199], v[164:167], v[104:107]
    s_sub_u32 s37, s37, 1
    ds_read_b64_tr_b16 a[212:213], v5 offset:20480
    ds_read_b64_tr_b16 a[214:215], v5 offset:22528
    v_add_u32 v5, s33, v5
    v_rcp_f16 v33, v32
    v_mfma_f32_16x16x32_bf16 v[112:115], a[196:199], v[188:191], v[112:115]
    v_rcp_f16 v35, v34
    v_rcp_f16_sdwa v33, v32 dst_sel:WORD_1 dst_unused:UNUSED_PRESERVE src0_sel:WORD_1
    v_rcp_f16_sdwa v35, v34 dst_sel:WORD_1 dst_unused:UNUSED_PRESERVE src0_sel:WORD_1
    v_fma_mix_f32 v32, v88, v33, 0 op_sel_hi:[0,1,0]
    v_mfma_f32_16x16x32_bf16 v[120:123], a[196:199], v[212:215], v[120:123]
    s_waitcnt lgkmcnt(9)
    ds_read_b128 a[28:31], v17 offset:400
    v_fma_mix_f32 v34, v90, v35, 0 op_sel_hi:[0,1,0]
    v_fma_mix_f32 v33, v89, v33, 0 op_sel:[0,1,0] op_sel_hi:[0,1,0]
    v_fma_mix_f32 v35, v91, v35, 0 op_sel:[0,1,0] op_sel_hi:[0,1,0]
    v_cvt_pk_bf16_f32 v58, v32, v33
    v_cvt_pk_bf16_f32 v59, v34, v35
    v_mfma_f32_16x16x32_bf16 v[104:107], a[200:203], v[168:171], v[104:107]
    s_cmp_lg_u32 s37, 0
    ds_read_b128 v[20:23], v10
    ds_read_b64_tr_b16 a[192:193], v2 offset:0
    ds_read_b64_tr_b16 a[194:195], v2 offset:2048
    v_add_u32 v10, 0x100, v10
    v_cvt_pk_f16_f32 v28, v92, v93
    v_cvt_pk_f16_f32 v30, v94, v95
    v_mfma_f32_16x16x32_bf16 v[112:115], a[200:203], v[192:195], v[112:115]
    v_pk_fma_f16 v29, v28, v28, s32
    v_pk_fma_f16 v31, v30, v30, s32
    v_pk_mul_f16 v28, v28, v29 neg_lo:[1,0] neg_hi:[1,0]
    v_pk_mul_f16 v30, v30, v31 neg_lo:[1,0] neg_hi:[1,0]
    v_exp_f16 v29, v28
    v_mfma_f32_16x16x32_bf16 v[120:123], a[200:203], v[216:219], v[120:123]
    s_waitcnt lgkmcnt(10)
    ds_read_b128 a[32:35], v17 offset:512
    v_exp_f16 v31, v30
    v_exp_f16_sdwa v29, v28 dst_sel:WORD_1 dst_unused:UNUSED_PRESERVE src0_sel:WORD_1
    v_exp_f16_sdwa v31, v30 dst_sel:WORD_1 dst_unused:UNUSED_PRESERVE src0_sel:WORD_1
    v_mfma_f32_16x16x32_bf16 v[104:107], a[204:207], v[172:175], v[104:107]
    ds_read_b64_tr_b16 a[196:197], v2 offset:4096
    ds_read_b64_tr_b16 a[198:199], v2 offset:6144
    v_pk_add_f16 v28, v29, 1.0 op_sel_hi:[1,0]
    v_pk_add_f16 v30, v31, 1.0 op_sel_hi:[1,0]
    v_rcp_f16 v29, v28
    v_mfma_f32_16x16x32_bf16 v[112:115], a[204:207], v[196:199], v[112:115]
    v_rcp_f16 v31, v30
    v_rcp_f16_sdwa v29, v28 dst_sel:WORD_1 dst_unused:UNUSED_PRESERVE src0_sel:WORD_1
    v_rcp_f16_sdwa v31, v30 dst_sel:WORD_1 dst_unused:UNUSED_PRESERVE src0_sel:WORD_1
    v_mfma_f32_16x16x32_bf16 v[120:123], a[204:207], v[220:223], v[120:123]
    s_waitcnt lgkmcnt(10)
    ds_read_b128 a[36:39], v17 offset:528
    v_fma_mix_f32 v28, v92, v29, 0 op_sel_hi:[0,1,0]
    v_fma_mix_f32 v30, v94, v31, 0 op_sel_hi:[0,1,0]
    v_fma_mix_f32 v29, v93, v29, 0 op_sel:[0,1,0] op_sel_hi:[0,1,0]
    v_fma_mix_f32 v31, v95, v31, 0 op_sel:[0,1,0] op_sel_hi:[0,1,0]
    v_cvt_pk_bf16_f32 v60, v28, v29
    v_mfma_f32_16x16x32_bf16 v[104:107], a[208:211], v[176:179], v[104:107]
    ds_read_b64_tr_b16 a[200:201], v2 offset:8192
    ds_read_b64_tr_b16 a[202:203], v2 offset:10240
    v_cvt_pk_bf16_f32 v61, v30, v31
    v_cvt_pk_f16_f32 v32, v96, v97
    v_cvt_pk_f16_f32 v34, v98, v99
    v_pk_fma_f16 v33, v32, v32, s32
    v_mfma_f32_16x16x32_bf16 v[112:115], a[208:211], v[200:203], v[112:115]
    v_pk_fma_f16 v35, v34, v34, s32
    v_pk_mul_f16 v32, v32, v33 neg_lo:[1,0] neg_hi:[1,0]
    v_pk_mul_f16 v34, v34, v35 neg_lo:[1,0] neg_hi:[1,0]
    v_exp_f16 v33, v32
    v_mfma_f32_16x16x32_bf16 v[120:123], a[208:211], v[224:227], v[120:123]
    s_waitcnt lgkmcnt(10)
    ds_read_b128 a[40:43], v17 offset:640
    v_exp_f16 v35, v34
    v_exp_f16_sdwa v33, v32 dst_sel:WORD_1 dst_unused:UNUSED_PRESERVE src0_sel:WORD_1
    v_exp_f16_sdwa v35, v34 dst_sel:WORD_1 dst_unused:UNUSED_PRESERVE src0_sel:WORD_1
    v_pk_add_f16 v32, v33, 1.0 op_sel_hi:[1,0]
    v_mfma_f32_16x16x32_bf16 v[104:107], a[212:215], v[180:183], v[104:107]
    ds_read_b64_tr_b16 a[204:205], v2 offset:12288
    ds_read_b64_tr_b16 a[206:207], v2 offset:14336
    v_pk_add_f16 v34, v35, 1.0 op_sel_hi:[1,0]
    v_rcp_f16 v33, v32
    v_mfma_f32_16x16x32_bf16 v[112:115], a[212:215], v[204:207], v[112:115]
    s_mov_b32 s33, s38
    v_rcp_f16 v35, v34
    v_rcp_f16_sdwa v33, v32 dst_sel:WORD_1 dst_unused:UNUSED_PRESERVE src0_sel:WORD_1
    v_rcp_f16_sdwa v35, v34 dst_sel:WORD_1 dst_unused:UNUSED_PRESERVE src0_sel:WORD_1
    v_fma_mix_f32 v32, v96, v33, 0 op_sel_hi:[0,1,0]
    v_mfma_f32_16x16x32_bf16 v[120:123], a[212:215], v[228:231], v[120:123]
    s_waitcnt lgkmcnt(9)
    ds_read_b128 a[44:47], v17 offset:656
    v_fma_mix_f32 v34, v98, v35, 0 op_sel_hi:[0,1,0]
    v_fma_mix_f32 v33, v97, v33, 0 op_sel:[0,1,0] op_sel_hi:[0,1,0]
    v_fma_mix_f32 v35, v99, v35, 0 op_sel:[0,1,0] op_sel_hi:[0,1,0]
    v_cvt_pk_bf16_f32 v62, v32, v33
    v_cvt_pk_bf16_f32 v63, v34, v35
    s_waitcnt vmcnt(0)
    s_barrier
    v_mfma_f32_16x16x32_bf16 v[76:79], a[192:195], v[160:163], v[20:23]
    s_add_u32 m0, s45, 0
    ds_read_b64_tr_b16 a[208:209], v2 offset:16384
    ds_read_b64_tr_b16 a[210:211], v2 offset:18432
    v_cvt_pk_f16_f32 v28, v100, v101
    v_cvt_pk_f16_f32 v30, v102, v103
    v_mfma_f32_16x16x32_bf16 v[84:87], a[192:195], v[184:187], v[20:23]
    s_add_u32 s47, s35, 0
    buffer_load_dwordx4 v14, s[12:15], s47 offen lds
    v_pk_fma_f16 v29, v28, v28, s32
    v_mfma_f32_16x16x32_bf16 v[92:95], a[192:195], v[208:211], v[20:23]
    s_waitcnt lgkmcnt(9)
    v_pk_fma_f16 v31, v30, v30, s32
    v_pk_mul_f16 v28, v28, v29 neg_lo:[1,0] neg_hi:[1,0]
    v_pk_mul_f16 v30, v30, v31 neg_lo:[1,0] neg_hi:[1,0]
    v_mfma_f32_16x16x32_bf16 v[76:79], a[196:199], v[164:167], v[76:79]
    s_add_u32 m0, s45, 1024
    ds_read_b64_tr_b16 a[212:213], v2 offset:20480
    ds_read_b64_tr_b16 a[214:215], v2 offset:22528
    v_add_u32 v2, s33, v2
    v_mfma_f32_16x16x32_bf16 v[84:87], a[196:199], v[188:191], v[84:87]
    s_add_u32 s47, s35, 12288
    buffer_load_dwordx4 v14, s[12:15], s47 offen lds
    v_exp_f16 v29, v28
    v_mfma_f32_16x16x32_bf16 v[92:95], a[196:199], v[212:215], v[92:95]
    s_waitcnt lgkmcnt(8)
    v_exp_f16 v31, v30
    v_exp_f16_sdwa v29, v28 dst_sel:WORD_1 dst_unused:UNUSED_PRESERVE src0_sel:WORD_1
    v_mfma_f32_16x16x32_bf16 v[76:79], a[200:203], v[168:171], v[76:79]
    s_add_u32 m0, s45, 2048
    ds_read_b128 v[24:27], v11
    ds_read_b64_tr_b16 a[192:193], v3 offset:0
    ds_read_b64_tr_b16 a[194:195], v3 offset:2048
    v_add_u32 v11, 0x100, v11
    v_mfma_f32_16x16x32_bf16 v[84:87], a[200:203], v[192:195], v[84:87]
    s_add_u32 s47, s35, 24576
    buffer_load_dwordx4 v14, s[12:15], s47 offen lds
    v_mfma_f32_16x16x32_bf16 v[92:95], a[200:203], v[216:219], v[92:95]
    s_waitcnt lgkmcnt(8)
    v_exp_f16_sdwa v31, v30 dst_sel:WORD_1 dst_unused:UNUSED_PRESERVE src0_sel:WORD_1
    v_pk_add_f16 v28, v29, 1.0 op_sel_hi:[1,0]
    v_pk_add_f16 v30, v31, 1.0 op_sel_hi:[1,0]
    v_mfma_f32_16x16x32_bf16 v[76:79], a[204:207], v[172:175], v[76:79]
    s_add_u32 m0, s45, 3072
    ds_read_b64_tr_b16 a[196:197], v3 offset:4096
    ds_read_b64_tr_b16 a[198:199], v3 offset:6144
    v_rcp_f16 v29, v28
    v_mfma_f32_16x16x32_bf16 v[84:87], a[204:207], v[196:199], v[84:87]
    s_add_u32 s47, s35, 36864
    buffer_load_dwordx4 v14, s[12:15], s47 offen lds
    v_mfma_f32_16x16x32_bf16 v[92:95], a[204:207], v[220:223], v[92:95]
    s_waitcnt lgkmcnt(7)
    v_rcp_f16 v31, v30
    v_rcp_f16_sdwa v29, v28 dst_sel:WORD_1 dst_unused:UNUSED_PRESERVE src0_sel:WORD_1
    v_mfma_f32_16x16x32_bf16 v[76:79], a[208:211], v[176:179], v[76:79]
    s_add_u32 m0, s45, 4096
    ds_read_b64_tr_b16 a[200:201], v3 offset:8192
    ds_read_b64_tr_b16 a[202:203], v3 offset:10240
    v_rcp_f16_sdwa v31, v30 dst_sel:WORD_1 dst_unused:UNUSED_PRESERVE src0_sel:WORD_1
    v_mfma_f32_16x16x32_bf16 v[84:87], a[208:211], v[200:203], v[84:87]
    s_add_u32 s47, s35, 49152
    buffer_load_dwordx4 v14, s[12:15], s47 offen lds
    v_fma_mix_f32 v28, v100, v29, 0 op_sel_hi:[0,1,0]
    v_mfma_f32_16x16x32_bf16 v[92:95], a[208:211], v[224:227], v[92:95]
    s_waitcnt lgkmcnt(7)
    v_fma_mix_f32 v30, v102, v31, 0 op_sel_hi:[0,1,0]
    v_fma_mix_f32 v29, v101, v29, 0 op_sel:[0,1,0] op_sel_hi:[0,1,0]
    v_fma_mix_f32 v31, v103, v31, 0 op_sel:[0,1,0] op_sel_hi:[0,1,0]
    v_cvt_pk_bf16_f32 v64, v28, v29
    v_mfma_f32_16x16x32_bf16 v[76:79], a[212:215], v[180:183], v[76:79]
    s_add_u32 m0, s45, 5120
    ds_read_b64_tr_b16 a[204:205], v3 offset:12288
    ds_read_b64_tr_b16 a[206:207], v3 offset:14336
    v_cvt_pk_bf16_f32 v65, v30, v31
    v_mfma_f32_16x16x32_bf16 v[84:87], a[212:215], v[204:207], v[84:87]
    s_add_u32 s47, s35, 61440
    buffer_load_dwordx4 v14, s[12:15], s47 offen lds
    v_cvt_pk_f16_f32 v32, v104, v105
    v_mfma_f32_16x16x32_bf16 v[92:95], a[212:215], v[228:231], v[92:95]
    s_waitcnt lgkmcnt(6)
    v_cvt_pk_f16_f32 v34, v106, v107
    v_pk_fma_f16 v33, v32, v32, s32
    v_pk_fma_f16 v35, v34, v34, s32
    v_pk_mul_f16 v32, v32, v33 neg_lo:[1,0] neg_hi:[1,0]
    v_mfma_f32_16x16x32_bf16 v[80:83], a[192:195], v[160:163], v[24:27]
    s_add_u32 m0, s46, 0
    ds_read_b64_tr_b16 a[208:209], v3 offset:16384
    ds_read_b64_tr_b16 a[210:211], v3 offset:18432
    v_pk_mul_f16 v34, v34, v35 neg_lo:[1,0] neg_hi:[1,0]
    v_mfma_f32_16x16x32_bf16 v[88:91], a[192:195], v[184:187], v[24:27]
    s_add_u32 s47, s36, 0
    buffer_load_dwordx4 v15, s[16:19], s47 offen lds
    v_exp_f16 v33, v32
    v_mfma_f32_16x16x32_bf16 v[96:99], a[192:195], v[208:211], v[24:27]
    s_waitcnt lgkmcnt(6)
    v_exp_f16 v35, v34
    v_mfma_f32_16x16x32_bf16 v[80:83], a[196:199], v[164:167], v[80:83]
    s_add_u32 m0, s46, 1024
    ds_read_b64_tr_b16 a[212:213], v3 offset:20480
    ds_read_b64_tr_b16 a[214:215], v3 offset:22528
    v_add_u32 v3, s33, v3
    v_exp_f16_sdwa v33, v32 dst_sel:WORD_1 dst_unused:UNUSED_PRESERVE src0_sel:WORD_1
    v_mfma_f32_16x16x32_bf16 v[88:91], a[196:199], v[188:191], v[88:91]
    s_add_u32 s47, s36, 128
    buffer_load_dwordx4 v15, s[16:19], s47 offen lds
    v_mfma_f32_16x16x32_bf16 v[96:99], a[196:199], v[212:215], v[96:99]
    s_waitcnt lgkmcnt(6)
    v_exp_f16_sdwa v35, v34 dst_sel:WORD_1 dst_unused:UNUSED_PRESERVE src0_sel:WORD_1
    v_pk_add_f16 v32, v33, 1.0 op_sel_hi:[1,0]
    v_pk_add_f16 v34, v35, 1.0 op_sel_hi:[1,0]
    v_mfma_f32_16x16x32_bf16 v[80:83], a[200:203], v[168:171], v[80:83]
    s_add_u32 m0, s46, 2048
    ds_read_b64_tr_b16 a[192:193], v6 offset:0
    ds_read_b64_tr_b16 a[194:195], v7 offset:0
    v_rcp_f16 v33, v32
    v_mfma_f32_16x16x32_bf16 v[88:91], a[200:203], v[192:195], v[88:91]
    s_add_u32 s47, s36, 256
    buffer_load_dwordx4 v15, s[16:19], s47 offen lds
    v_mfma_f32_16x16x32_bf16 v[96:99], a[200:203], v[216:219], v[96:99]
    s_waitcnt lgkmcnt(6)
    v_rcp_f16 v35, v34
    v_rcp_f16_sdwa v33, v32 dst_sel:WORD_1 dst_unused:UNUSED_PRESERVE src0_sel:WORD_1
    v_mfma_f32_16x16x32_bf16 v[80:83], a[204:207], v[172:175], v[80:83]
    s_add_u32 m0, s46, 3080
    ds_read_b64_tr_b16 a[196:197], v6 offset:8
    ds_read_b64_tr_b16 a[198:199], v7 offset:8
    v_rcp_f16_sdwa v35, v34 dst_sel:WORD_1 dst_unused:UNUSED_PRESERVE src0_sel:WORD_1
    v_fma_mix_f32 v32, v104, v33, 0 op_sel_hi:[0,1,0]
    v_mfma_f32_16x16x32_bf16 v[88:91], a[204:207], v[196:199], v[88:91]
    s_add_u32 s47, s36, 1536
    buffer_load_dwordx4 v15, s[16:19], s47 offen lds
    v_fma_mix_f32 v34, v106, v35, 0 op_sel_hi:[0,1,0]
    v_mfma_f32_16x16x32_bf16 v[96:99], a[204:207], v[220:223], v[96:99]
    s_waitcnt lgkmcnt(6)
    v_fma_mix_f32 v33, v105, v33, 0 op_sel:[0,1,0] op_sel_hi:[0,1,0]
    v_fma_mix_f32 v35, v107, v35, 0 op_sel:[0,1,0] op_sel_hi:[0,1,0]
    v_cvt_pk_bf16_f32 v66, v32, v33
    v_mfma_f32_16x16x32_bf16 v[80:83], a[208:211], v[176:179], v[80:83]
    s_add_u32 m0, s46, 4104
    ds_read_b64_tr_b16 a[200:201], v6 offset:512
    ds_read_b64_tr_b16 a[202:203], v7 offset:512
    v_cvt_pk_bf16_f32 v67, v34, v35
    v_cvt_pk_f16_f32 v28, v108, v109
    v_mfma_f32_16x16x32_bf16 v[88:91], a[208:211], v[200:203], v[88:91]
    s_add_u32 s47, s36, 1664
    buffer_load_dwordx4 v15, s[16:19], s47 offen lds
    v_cvt_pk_f16_f32 v30, v110, v111
    v_mfma_f32_16x16x32_bf16 v[96:99], a[208:211], v[224:227], v[96:99]
    s_waitcnt lgkmcnt(6)
    v_pk_fma_f16 v29, v28, v28, s32
    v_pk_fma_f16 v31, v30, v30, s32
    v_pk_mul_f16 v28, v28, v29 neg_lo:[1,0] neg_hi:[1,0]
    v_pk_mul_f16 v30, v30, v31 neg_lo:[1,0] neg_hi:[1,0]
    v_mfma_f32_16x16x32_bf16 v[80:83], a[212:215], v[180:183], v[80:83]
    s_add_u32 m0, s46, 5128
    ds_read_b64_tr_b16 a[204:205], v6 offset:520
    ds_read_b64_tr_b16 a[206:207], v7 offset:520
    v_mfma_f32_16x16x32_bf16 v[88:91], a[212:215], v[204:207], v[88:91]
    s_add_u32 s47, s36, 1792
    buffer_load_dwordx4 v15, s[16:19], s47 offen lds
    v_exp_f16 v29, v28
    v_mfma_f32_16x16x32_bf16 v[96:99], a[212:215], v[228:231], v[96:99]
    s_waitcnt lgkmcnt(6)
    v_exp_f16 v31, v30
    v_exp_f16_sdwa v29, v28 dst_sel:WORD_1 dst_unused:UNUSED_PRESERVE src0_sel:WORD_1
    v_mfma_f32_16x16x32_bf16 a[48:51], a[192:195], v[56:59], a[0:3]
    ds_read_b64_tr_b16 a[208:209], v6 offset:1024
    ds_read_b64_tr_b16 a[210:211], v7 offset:1024
    v_exp_f16_sdwa v31, v30 dst_sel:WORD_1 dst_unused:UNUSED_PRESERVE src0_sel:WORD_1
    v_mfma_f32_16x16x32_bf16 a[96:99], a[192:195], v[60:63], a[0:3]
    v_pk_add_f16 v28, v29, 1.0 op_sel_hi:[1,0]
    v_pk_add_f16 v30, v31, 1.0 op_sel_hi:[1,0]
    v_rcp_f16 v29, v28
    v_mfma_f32_16x16x32_bf16 a[0:3], a[192:195], v[52:55], a[0:3]
    s_waitcnt lgkmcnt(6)
    v_rcp_f16 v31, v30
    v_mfma_f32_16x16x32_bf16 a[52:55], a[196:199], v[56:59], a[4:7]
    ds_read_b64_tr_b16 a[212:213], v6 offset:1032
    ds_read_b64_tr_b16 a[214:215], v7 offset:1032
    v_rcp_f16_sdwa v29, v28 dst_sel:WORD_1 dst_unused:UNUSED_PRESERVE src0_sel:WORD_1
    v_mfma_f32_16x16x32_bf16 a[100:103], a[196:199], v[60:63], a[4:7]
    v_rcp_f16_sdwa v31, v30 dst_sel:WORD_1 dst_unused:UNUSED_PRESERVE src0_sel:WORD_1
    v_fma_mix_f32 v28, v108, v29, 0 op_sel_hi:[0,1,0]
    v_fma_mix_f32 v30, v110, v31, 0 op_sel_hi:[0,1,0]
    v_fma_mix_f32 v29, v109, v29, 0 op_sel:[0,1,0] op_sel_hi:[0,1,0]
    v_mfma_f32_16x16x32_bf16 a[4:7], a[196:199], v[52:55], a[4:7]
    s_waitcnt lgkmcnt(6)
    v_fma_mix_f32 v31, v111, v31, 0 op_sel:[0,1,0] op_sel_hi:[0,1,0]
    v_cvt_pk_bf16_f32 v68, v28, v29
    v_cvt_pk_bf16_f32 v69, v30, v31
    v_cvt_pk_f16_f32 v32, v112, v113
    v_mfma_f32_16x16x32_bf16 a[56:59], a[200:203], v[56:59], a[8:11]
    ds_read_b64_tr_b16 a[192:193], v6 offset:1536
    ds_read_b64_tr_b16 a[194:195], v7 offset:1536
    v_cvt_pk_f16_f32 v34, v114, v115
    v_mfma_f32_16x16x32_bf16 a[104:107], a[200:203], v[60:63], a[8:11]
    v_pk_fma_f16 v33, v32, v32, s32
    v_pk_fma_f16 v35, v34, v34, s32
    v_pk_mul_f16 v32, v32, v33 neg_lo:[1,0] neg_hi:[1,0]
    v_pk_mul_f16 v34, v34, v35 neg_lo:[1,0] neg_hi:[1,0]
    v_mfma_f32_16x16x32_bf16 a[8:11], a[200:203], v[52:55], a[8:11]
    s_waitcnt lgkmcnt(6)
    v_exp_f16 v33, v32
    v_exp_f16 v35, v34
    v_mfma_f32_16x16x32_bf16 a[60:63], a[204:207], v[56:59], a[12:15]
    ds_read_b64_tr_b16 a[196:197], v6 offset:1544
    ds_read_b64_tr_b16 a[198:199], v7 offset:1544
    v_exp_f16_sdwa v33, v32 dst_sel:WORD_1 dst_unused:UNUSED_PRESERVE src0_sel:WORD_1
    v_mfma_f32_16x16x32_bf16 a[108:111], a[204:207], v[60:63], a[12:15]
    v_exp_f16_sdwa v35, v34 dst_sel:WORD_1 dst_unused:UNUSED_PRESERVE src0_sel:WORD_1
    v_pk_add_f16 v32, v33, 1.0 op_sel_hi:[1,0]
    v_pk_add_f16 v34, v35, 1.0 op_sel_hi:[1,0]
    v_mfma_f32_16x16x32_bf16 a[12:15], a[204:207], v[52:55], a[12:15]
    s_waitcnt lgkmcnt(6)
    v_rcp_f16 v33, v32
    v_mfma_f32_16x16x32_bf16 a[64:67], a[208:211], v[56:59], a[16:19]
    ds_read_b64_tr_b16 a[200:201], v6 offset:2048
    ds_read_b64_tr_b16 a[202:203], v7 offset:2048
    v_rcp_f16 v35, v34
    v_mfma_f32_16x16x32_bf16 a[112:115], a[208:211], v[60:63], a[16:19]
    v_rcp_f16_sdwa v33, v32 dst_sel:WORD_1 dst_unused:UNUSED_PRESERVE src0_sel:WORD_1
    v_rcp_f16_sdwa v35, v34 dst_sel:WORD_1 dst_unused:UNUSED_PRESERVE src0_sel:WORD_1
    v_fma_mix_f32 v32, v112, v33, 0 op_sel_hi:[0,1,0]
    v_mfma_f32_16x16x32_bf16 a[16:19], a[208:211], v[52:55], a[16:19]
    s_waitcnt lgkmcnt(6)
    v_fma_mix_f32 v34, v114, v35, 0 op_sel_hi:[0,1,0]
    v_fma_mix_f32 v33, v113, v33, 0 op_sel:[0,1,0] op_sel_hi:[0,1,0]
    v_fma_mix_f32 v35, v115, v35, 0 op_sel:[0,1,0] op_sel_hi:[0,1,0]
    v_cvt_pk_bf16_f32 v70, v32, v33
    v_mfma_f32_16x16x32_bf16 a[68:71], a[212:215], v[56:59], a[20:23]
    ds_read_b64_tr_b16 a[204:205], v6 offset:2056
    ds_read_b64_tr_b16 a[206:207], v7 offset:2056
    v_cvt_pk_bf16_f32 v71, v34, v35
    v_mfma_f32_16x16x32_bf16 a[116:119], a[212:215], v[60:63], a[20:23]
    v_cvt_pk_f16_f32 v28, v116, v117
    v_cvt_pk_f16_f32 v30, v118, v119
    v_pk_fma_f16 v29, v28, v28, s32
    v_pk_fma_f16 v31, v30, v30, s32
    v_mfma_f32_16x16x32_bf16 a[20:23], a[212:215], v[52:55], a[20:23]
    s_waitcnt lgkmcnt(6)
    v_pk_mul_f16 v28, v28, v29 neg_lo:[1,0] neg_hi:[1,0]
    v_pk_mul_f16 v30, v30, v31 neg_lo:[1,0] neg_hi:[1,0]
    v_exp_f16 v29, v28
    v_mfma_f32_16x16x32_bf16 a[72:75], a[192:195], v[56:59], a[24:27]
    ds_read_b64_tr_b16 a[208:209], v6 offset:2560
    ds_read_b64_tr_b16 a[210:211], v7 offset:2560
    v_exp_f16 v31, v30
    v_mfma_f32_16x16x32_bf16 a[120:123], a[192:195], v[60:63], a[24:27]
    v_exp_f16_sdwa v29, v28 dst_sel:WORD_1 dst_unused:UNUSED_PRESERVE src0_sel:WORD_1
    v_exp_f16_sdwa v31, v30 dst_sel:WORD_1 dst_unused:UNUSED_PRESERVE src0_sel:WORD_1
    v_mfma_f32_16x16x32_bf16 a[24:27], a[192:195], v[52:55], a[24:27]
    s_waitcnt lgkmcnt(6)
    v_pk_add_f16 v28, v29, 1.0 op_sel_hi:[1,0]
    v_pk_add_f16 v30, v31, 1.0 op_sel_hi:[1,0]
    v_mfma_f32_16x16x32_bf16 a[76:79], a[196:199], v[56:59], a[28:31]
    ds_read_b64_tr_b16 a[212:213], v6 offset:2568
    ds_read_b64_tr_b16 a[214:215], v7 offset:2568
    v_add_u32 v6, s33, v6
    v_add_u32 v7, s33, v7
    v_mfma_f32_16x16x32_bf16 a[124:127], a[196:199], v[60:63], a[28:31]
    v_rcp_f16 v29, v28
    v_rcp_f16 v31, v30
    v_mfma_f32_16x16x32_bf16 a[28:31], a[196:199], v[52:55], a[28:31]
    s_waitcnt lgkmcnt(6)
    v_rcp_f16_sdwa v29, v28 dst_sel:WORD_1 dst_unused:UNUSED_PRESERVE src0_sel:WORD_1
    v_rcp_f16_sdwa v31, v30 dst_sel:WORD_1 dst_unused:UNUSED_PRESERVE src0_sel:WORD_1
    v_fma_mix_f32 v28, v116, v29, 0 op_sel_hi:[0,1,0]
    v_mfma_f32_16x16x32_bf16 a[80:83], a[200:203], v[56:59], a[32:35]
    ds_read_b128 v[20:23], v12
    ds_read_b64_tr_b16 a[192:193], v4 offset:0
    ds_read_b64_tr_b16 a[194:195], v4 offset:2048
    v_add_u32 v12, 0x100, v12
    v_mfma_f32_16x16x32_bf16 a[128:131], a[200:203], v[60:63], a[32:35]
    v_fma_mix_f32 v30, v118, v31, 0 op_sel_hi:[0,1,0]
    v_fma_mix_f32 v29, v117, v29, 0 op_sel:[0,1,0] op_sel_hi:[0,1,0]
    v_fma_mix_f32 v31, v119, v31, 0 op_sel:[0,1,0] op_sel_hi:[0,1,0]
    v_mfma_f32_16x16x32_bf16 a[32:35], a[200:203], v[52:55], a[32:35]
    s_waitcnt lgkmcnt(7)
    v_cvt_pk_bf16_f32 v72, v28, v29
    v_cvt_pk_bf16_f32 v73, v30, v31
    v_cvt_pk_f16_f32 v32, v120, v121
    v_cvt_pk_f16_f32 v34, v122, v123
    v_mfma_f32_16x16x32_bf16 a[84:87], a[204:207], v[56:59], a[36:39]
    ds_read_b64_tr_b16 a[196:197], v4 offset:4096
    ds_read_b64_tr_b16 a[198:199], v4 offset:6144
    v_pk_fma_f16 v33, v32, v32, s32
    v_pk_fma_f16 v35, v34, v34, s32
    v_mfma_f32_16x16x32_bf16 a[132:135], a[204:207], v[60:63], a[36:39]
    v_pk_mul_f16 v32, v32, v33 neg_lo:[1,0] neg_hi:[1,0]
    v_pk_mul_f16 v34, v34, v35 neg_lo:[1,0] neg_hi:[1,0]
    v_exp_f16 v33, v32
    v_mfma_f32_16x16x32_bf16 a[36:39], a[204:207], v[52:55], a[36:39]
    s_waitcnt lgkmcnt(7)
    v_exp_f16 v35, v34
    v_mfma_f32_16x16x32_bf16 a[88:91], a[208:211], v[56:59], a[40:43]
    ds_read_b64_tr_b16 a[200:201], v4 offset:8192
    ds_read_b64_tr_b16 a[202:203], v4 offset:10240
    v_exp_f16_sdwa v33, v32 dst_sel:WORD_1 dst_unused:UNUSED_PRESERVE src0_sel:WORD_1
    v_mfma_f32_16x16x32_bf16 a[136:139], a[208:211], v[60:63], a[40:43]
    v_exp_f16_sdwa v35, v34 dst_sel:WORD_1 dst_unused:UNUSED_PRESERVE src0_sel:WORD_1
    v_pk_add_f16 v32, v33, 1.0 op_sel_hi:[1,0]
    v_pk_add_f16 v34, v35, 1.0 op_sel_hi:[1,0]
    v_mfma_f32_16x16x32_bf16 a[40:43], a[208:211], v[52:55], a[40:43]
    s_waitcnt lgkmcnt(7)
    v_rcp_f16 v33, v32
    v_rcp_f16 v35, v34
    v_mfma_f32_16x16x32_bf16 a[92:95], a[212:215], v[56:59], a[44:47]
    ds_read_b64_tr_b16 a[204:205], v4 offset:12288
    ds_read_b64_tr_b16 a[206:207], v4 offset:14336
    v_rcp_f16_sdwa v33, v32 dst_sel:WORD_1 dst_unused:UNUSED_PRESERVE src0_sel:WORD_1
    v_mfma_f32_16x16x32_bf16 a[140:143], a[212:215], v[60:63], a[44:47]
    v_rcp_f16_sdwa v35, v34 dst_sel:WORD_1 dst_unused:UNUSED_PRESERVE src0_sel:WORD_1
    v_fma_mix_f32 v32, v120, v33, 0 op_sel_hi:[0,1,0]
    v_fma_mix_f32 v34, v122, v35, 0 op_sel_hi:[0,1,0]
    v_mfma_f32_16x16x32_bf16 a[44:47], a[212:215], v[52:55], a[44:47]
    s_waitcnt lgkmcnt(6)
    v_fma_mix_f32 v33, v121, v33, 0 op_sel:[0,1,0] op_sel_hi:[0,1,0]
    v_fma_mix_f32 v35, v123, v35, 0 op_sel:[0,1,0] op_sel_hi:[0,1,0]
    v_cvt_pk_bf16_f32 v74, v32, v33
    v_cvt_pk_bf16_f32 v75, v34, v35
    v_mfma_f32_16x16x32_bf16 v[100:103], a[192:195], v[160:163], v[20:23]
    s_add_u32 s45, s45, s49
    ds_read_b64_tr_b16 a[208:209], v4 offset:16384
    ds_read_b64_tr_b16 a[210:211], v4 offset:18432
    v_cvt_pk_f16_f32 v28, v76, v77
    v_mfma_f32_16x16x32_bf16 v[108:111], a[192:195], v[184:187], v[20:23]
    v_cvt_pk_f16_f32 v30, v78, v79
    v_pk_fma_f16 v29, v28, v28, s32
    v_pk_fma_f16 v31, v30, v30, s32
    v_pk_mul_f16 v28, v28, v29 neg_lo:[1,0] neg_hi:[1,0]
    v_mfma_f32_16x16x32_bf16 v[116:119], a[192:195], v[208:211], v[20:23]
    s_waitcnt lgkmcnt(6)
    v_pk_mul_f16 v30, v30, v31 neg_lo:[1,0] neg_hi:[1,0]
    v_exp_f16 v29, v28
    v_mfma_f32_16x16x32_bf16 v[100:103], a[196:199], v[164:167], v[100:103]
    s_add_u32 s46, s46, s49
    ds_read_b64_tr_b16 a[212:213], v4 offset:20480
    ds_read_b64_tr_b16 a[214:215], v4 offset:22528
    v_add_u32 v4, s33, v4
    v_mfma_f32_16x16x32_bf16 v[108:111], a[196:199], v[188:191], v[108:111]
    v_exp_f16 v31, v30
    v_mfma_f32_16x16x32_bf16 v[116:119], a[196:199], v[212:215], v[116:119]
    s_waitcnt lgkmcnt(6)
    v_exp_f16_sdwa v29, v28 dst_sel:WORD_1 dst_unused:UNUSED_PRESERVE src0_sel:WORD_1
    v_exp_f16_sdwa v31, v30 dst_sel:WORD_1 dst_unused:UNUSED_PRESERVE src0_sel:WORD_1
    v_pk_add_f16 v28, v29, 1.0 op_sel_hi:[1,0]
    v_mfma_f32_16x16x32_bf16 v[100:103], a[200:203], v[168:171], v[100:103]
    s_add_u32 s35, s35, 128
    ds_read_b128 v[24:27], v13
    ds_read_b64_tr_b16 a[192:193], v5 offset:0
    ds_read_b64_tr_b16 a[194:195], v5 offset:2048
    v_add_u32 v13, 0x100, v13
    v_mfma_f32_16x16x32_bf16 v[108:111], a[200:203], v[192:195], v[108:111]
    v_pk_add_f16 v30, v31, 1.0 op_sel_hi:[1,0]
    v_rcp_f16 v29, v28
    v_mfma_f32_16x16x32_bf16 v[116:119], a[200:203], v[216:219], v[116:119]
    s_waitcnt lgkmcnt(7)
    v_rcp_f16 v31, v30
    v_mfma_f32_16x16x32_bf16 v[100:103], a[204:207], v[172:175], v[100:103]
    s_add_u32 s36, s36, 24576
    ds_read_b64_tr_b16 a[196:197], v5 offset:4096
    ds_read_b64_tr_b16 a[198:199], v5 offset:6144
    v_rcp_f16_sdwa v29, v28 dst_sel:WORD_1 dst_unused:UNUSED_PRESERVE src0_sel:WORD_1
    v_mfma_f32_16x16x32_bf16 v[108:111], a[204:207], v[196:199], v[108:111]
    v_rcp_f16_sdwa v31, v30 dst_sel:WORD_1 dst_unused:UNUSED_PRESERVE src0_sel:WORD_1
    v_fma_mix_f32 v28, v76, v29, 0 op_sel_hi:[0,1,0]
    v_mfma_f32_16x16x32_bf16 v[116:119], a[204:207], v[220:223], v[116:119]
    s_waitcnt lgkmcnt(7)
    v_fma_mix_f32 v30, v78, v31, 0 op_sel_hi:[0,1,0]
    v_fma_mix_f32 v29, v77, v29, 0 op_sel:[0,1,0] op_sel_hi:[0,1,0]
    v_fma_mix_f32 v31, v79, v31, 0 op_sel:[0,1,0] op_sel_hi:[0,1,0]
    v_mfma_f32_16x16x32_bf16 v[100:103], a[208:211], v[176:179], v[100:103]
    s_mov_b32 s38, s48
    ds_read_b64_tr_b16 a[200:201], v5 offset:8192
    ds_read_b64_tr_b16 a[202:203], v5 offset:10240
    v_cvt_pk_bf16_f32 v52, v28, v29
    v_cvt_pk_bf16_f32 v53, v30, v31
    v_mfma_f32_16x16x32_bf16 v[108:111], a[208:211], v[200:203], v[108:111]
    v_cvt_pk_f16_f32 v32, v80, v81
    v_cvt_pk_f16_f32 v34, v82, v83
    v_pk_fma_f16 v33, v32, v32, s32
    v_mfma_f32_16x16x32_bf16 v[116:119], a[208:211], v[224:227], v[116:119]
    s_waitcnt lgkmcnt(7)
    v_pk_fma_f16 v35, v34, v34, s32
    v_pk_mul_f16 v32, v32, v33 neg_lo:[1,0] neg_hi:[1,0]
    v_pk_mul_f16 v34, v34, v35 neg_lo:[1,0] neg_hi:[1,0]
    v_mfma_f32_16x16x32_bf16 v[100:103], a[212:215], v[180:183], v[100:103]
    s_mov_b32 s48, s49
    ds_read_b64_tr_b16 a[204:205], v5 offset:12288
    ds_read_b64_tr_b16 a[206:207], v5 offset:14336
    v_mfma_f32_16x16x32_bf16 v[108:111], a[212:215], v[204:207], v[108:111]
    v_exp_f16 v33, v32
    v_exp_f16 v35, v34
    v_mfma_f32_16x16x32_bf16 v[116:119], a[212:215], v[228:231], v[116:119]
    s_waitcnt lgkmcnt(6)
    v_exp_f16_sdwa v33, v32 dst_sel:WORD_1 dst_unused:UNUSED_PRESERVE src0_sel:WORD_1
    v_exp_f16_sdwa v35, v34 dst_sel:WORD_1 dst_unused:UNUSED_PRESERVE src0_sel:WORD_1
    v_mfma_f32_16x16x32_bf16 v[104:107], a[192:195], v[160:163], v[24:27]
    s_mov_b32 s49, s33
    ds_read_b64_tr_b16 a[208:209], v5 offset:16384
    ds_read_b64_tr_b16 a[210:211], v5 offset:18432
    v_pk_add_f16 v32, v33, 1.0 op_sel_hi:[1,0]
    v_mfma_f32_16x16x32_bf16 v[112:115], a[192:195], v[184:187], v[24:27]
    v_pk_add_f16 v34, v35, 1.0 op_sel_hi:[1,0]
    v_rcp_f16 v33, v32
    v_mfma_f32_16x16x32_bf16 v[120:123], a[192:195], v[208:211], v[24:27]
    s_waitcnt lgkmcnt(6)
    v_rcp_f16 v35, v34
    v_rcp_f16_sdwa v33, v32 dst_sel:WORD_1 dst_unused:UNUSED_PRESERVE src0_sel:WORD_1
    v_mfma_f32_16x16x32_bf16 v[104:107], a[196:199], v[164:167], v[104:107]
    s_sub_u32 s37, s37, 1
    ds_read_b64_tr_b16 a[212:213], v5 offset:20480
    ds_read_b64_tr_b16 a[214:215], v5 offset:22528
    v_add_u32 v5, s33, v5
    v_mfma_f32_16x16x32_bf16 v[112:115], a[196:199], v[188:191], v[112:115]
    v_rcp_f16_sdwa v35, v34 dst_sel:WORD_1 dst_unused:UNUSED_PRESERVE src0_sel:WORD_1
    v_fma_mix_f32 v32, v80, v33, 0 op_sel_hi:[0,1,0]
    v_mfma_f32_16x16x32_bf16 v[120:123], a[196:199], v[212:215], v[120:123]
    s_waitcnt lgkmcnt(6)
    v_fma_mix_f32 v34, v82, v35, 0 op_sel_hi:[0,1,0]
    v_fma_mix_f32 v33, v81, v33, 0 op_sel:[0,1,0] op_sel_hi:[0,1,0]
    v_fma_mix_f32 v35, v83, v35, 0 op_sel:[0,1,0] op_sel_hi:[0,1,0]
    v_cvt_pk_bf16_f32 v54, v32, v33
    v_mfma_f32_16x16x32_bf16 v[104:107], a[200:203], v[168:171], v[104:107]
    s_cmp_lg_u32 s37, 0
    ds_read_b64_tr_b16 a[192:193], v8 offset:0
    ds_read_b64_tr_b16 a[194:195], v9 offset:0
    v_cvt_pk_bf16_f32 v55, v34, v35
    v_mfma_f32_16x16x32_bf16 v[112:115], a[200:203], v[192:195], v[112:115]
    v_cvt_pk_f16_f32 v28, v84, v85
    v_cvt_pk_f16_f32 v30, v86, v87
    v_pk_fma_f16 v29, v28, v28, s32
    v_mfma_f32_16x16x32_bf16 v[120:123], a[200:203], v[216:219], v[120:123]
    s_waitcnt lgkmcnt(6)
    v_pk_fma_f16 v31, v30, v30, s32
    v_pk_mul_f16 v28, v28, v29 neg_lo:[1,0] neg_hi:[1,0]
    v_pk_mul_f16 v30, v30, v31 neg_lo:[1,0] neg_hi:[1,0]
    v_mfma_f32_16x16x32_bf16 v[104:107], a[204:207], v[172:175], v[104:107]
    ds_read_b64_tr_b16 a[196:197], v8 offset:8
    ds_read_b64_tr_b16 a[198:199], v9 offset:8
    v_exp_f16 v29, v28
    v_mfma_f32_16x16x32_bf16 v[112:115], a[204:207], v[196:199], v[112:115]
    v_exp_f16 v31, v30
    v_mfma_f32_16x16x32_bf16 v[120:123], a[204:207], v[220:223], v[120:123]
    s_waitcnt lgkmcnt(6)
    v_exp_f16_sdwa v29, v28 dst_sel:WORD_1 dst_unused:UNUSED_PRESERVE src0_sel:WORD_1
    v_exp_f16_sdwa v31, v30 dst_sel:WORD_1 dst_unused:UNUSED_PRESERVE src0_sel:WORD_1
    v_mfma_f32_16x16x32_bf16 v[104:107], a[208:211], v[176:179], v[104:107]
    ds_read_b64_tr_b16 a[200:201], v8 offset:512
    ds_read_b64_tr_b16 a[202:203], v9 offset:512
    v_pk_add_f16 v28, v29, 1.0 op_sel_hi:[1,0]
    v_pk_add_f16 v30, v31, 1.0 op_sel_hi:[1,0]
    v_mfma_f32_16x16x32_bf16 v[112:115], a[208:211], v[200:203], v[112:115]
    v_rcp_f16 v29, v28
    v_mfma_f32_16x16x32_bf16 v[120:123], a[208:211], v[224:227], v[120:123]
    s_waitcnt lgkmcnt(6)
    v_rcp_f16 v31, v30
    v_rcp_f16_sdwa v29, v28 dst_sel:WORD_1 dst_unused:UNUSED_PRESERVE src0_sel:WORD_1
    v_mfma_f32_16x16x32_bf16 v[104:107], a[212:215], v[180:183], v[104:107]
    ds_read_b64_tr_b16 a[204:205], v8 offset:520
    ds_read_b64_tr_b16 a[206:207], v9 offset:520
    v_mfma_f32_16x16x32_bf16 v[112:115], a[212:215], v[204:207], v[112:115]
    v_rcp_f16_sdwa v31, v30 dst_sel:WORD_1 dst_unused:UNUSED_PRESERVE src0_sel:WORD_1
    v_fma_mix_f32 v28, v84, v29, 0 op_sel_hi:[0,1,0]
    v_fma_mix_f32 v30, v86, v31, 0 op_sel_hi:[0,1,0]
    v_fma_mix_f32 v29, v85, v29, 0 op_sel:[0,1,0] op_sel_hi:[0,1,0]
    v_mfma_f32_16x16x32_bf16 v[120:123], a[212:215], v[228:231], v[120:123]
    s_waitcnt lgkmcnt(6)
    v_fma_mix_f32 v31, v87, v31, 0 op_sel:[0,1,0] op_sel_hi:[0,1,0]
    v_cvt_pk_bf16_f32 v56, v28, v29
    v_cvt_pk_bf16_f32 v57, v30, v31
    v_mfma_f32_16x16x32_bf16 a[0:3], a[192:195], v[64:67], a[0:3]
    ds_read_b64_tr_b16 a[208:209], v8 offset:1024
    ds_read_b64_tr_b16 a[210:211], v9 offset:1024
    v_cvt_pk_f16_f32 v32, v88, v89
    v_mfma_f32_16x16x32_bf16 a[48:51], a[192:195], v[68:71], a[48:51]
    v_cvt_pk_f16_f32 v34, v90, v91
    v_pk_fma_f16 v33, v32, v32, s32
    v_pk_fma_f16 v35, v34, v34, s32
    v_pk_mul_f16 v32, v32, v33 neg_lo:[1,0] neg_hi:[1,0]
    v_mfma_f32_16x16x32_bf16 a[96:99], a[192:195], v[72:75], a[96:99]
    s_waitcnt lgkmcnt(6)
    v_pk_mul_f16 v34, v34, v35 neg_lo:[1,0] neg_hi:[1,0]
    v_exp_f16 v33, v32
    v_mfma_f32_16x16x32_bf16 a[4:7], a[196:199], v[64:67], a[4:7]
    ds_read_b64_tr_b16 a[212:213], v8 offset:1032
    ds_read_b64_tr_b16 a[214:215], v9 offset:1032
    v_mfma_f32_16x16x32_bf16 a[52:55], a[196:199], v[68:71], a[52:55]
    v_exp_f16 v35, v34
    v_exp_f16_sdwa v33, v32 dst_sel:WORD_1 dst_unused:UNUSED_PRESERVE src0_sel:WORD_1
    v_mfma_f32_16x16x32_bf16 a[100:103], a[196:199], v[72:75], a[100:103]
    s_waitcnt lgkmcnt(6)
    v_exp_f16_sdwa v35, v34 dst_sel:WORD_1 dst_unused:UNUSED_PRESERVE src0_sel:WORD_1
    v_pk_add_f16 v32, v33, 1.0 op_sel_hi:[1,0]
    v_pk_add_f16 v34, v35, 1.0 op_sel_hi:[1,0]
    v_mfma_f32_16x16x32_bf16 a[8:11], a[200:203], v[64:67], a[8:11]
    ds_read_b64_tr_b16 a[192:193], v8 offset:1536
    ds_read_b64_tr_b16 a[194:195], v9 offset:1536
    v_mfma_f32_16x16x32_bf16 a[56:59], a[200:203], v[68:71], a[56:59]
    v_rcp_f16 v33, v32
    v_rcp_f16 v35, v34
    v_mfma_f32_16x16x32_bf16 a[104:107], a[200:203], v[72:75], a[104:107]
    s_waitcnt lgkmcnt(6)
    v_rcp_f16_sdwa v33, v32 dst_sel:WORD_1 dst_unused:UNUSED_PRESERVE src0_sel:WORD_1
    v_rcp_f16_sdwa v35, v34 dst_sel:WORD_1 dst_unused:UNUSED_PRESERVE src0_sel:WORD_1
    v_mfma_f32_16x16x32_bf16 a[12:15], a[204:207], v[64:67], a[12:15]
    ds_read_b64_tr_b16 a[196:197], v8 offset:1544
    ds_read_b64_tr_b16 a[198:199], v9 offset:1544
    v_fma_mix_f32 v32, v88, v33, 0 op_sel_hi:[0,1,0]
    v_mfma_f32_16x16x32_bf16 a[60:63], a[204:207], v[68:71], a[60:63]
    v_fma_mix_f32 v34, v90, v35, 0 op_sel_hi:[0,1,0]
    v_fma_mix_f32 v33, v89, v33, 0 op_sel:[0,1,0] op_sel_hi:[0,1,0]
    v_fma_mix_f32 v35, v91, v35, 0 op_sel:[0,1,0] op_sel_hi:[0,1,0]
    v_mfma_f32_16x16x32_bf16 a[108:111], a[204:207], v[72:75], a[108:111]
    s_waitcnt lgkmcnt(6)
    v_cvt_pk_bf16_f32 v58, v32, v33
    v_cvt_pk_bf16_f32 v59, v34, v35
    v_cvt_pk_f16_f32 v28, v92, v93
    v_mfma_f32_16x16x32_bf16 a[16:19], a[208:211], v[64:67], a[16:19]
    ds_read_b64_tr_b16 a[200:201], v8 offset:2048
    ds_read_b64_tr_b16 a[202:203], v9 offset:2048
    v_cvt_pk_f16_f32 v30, v94, v95
    v_pk_fma_f16 v29, v28, v28, s32
    v_mfma_f32_16x16x32_bf16 a[64:67], a[208:211], v[68:71], a[64:67]
    v_pk_fma_f16 v31, v30, v30, s32
    v_pk_mul_f16 v28, v28, v29 neg_lo:[1,0] neg_hi:[1,0]
    v_pk_mul_f16 v30, v30, v31 neg_lo:[1,0] neg_hi:[1,0]
    v_mfma_f32_16x16x32_bf16 a[112:115], a[208:211], v[72:75], a[112:115]
    s_waitcnt lgkmcnt(6)
    v_exp_f16 v29, v28
    v_mfma_f32_16x16x32_bf16 a[20:23], a[212:215], v[64:67], a[20:23]
    ds_read_b64_tr_b16 a[204:205], v8 offset:2056
    ds_read_b64_tr_b16 a[206:207], v9 offset:2056
    v_exp_f16 v31, v30
    v_mfma_f32_16x16x32_bf16 a[68:71], a[212:215], v[68:71], a[68:71]
    v_exp_f16_sdwa v29, v28 dst_sel:WORD_1 dst_unused:UNUSED_PRESERVE src0_sel:WORD_1
    v_exp_f16_sdwa v31, v30 dst_sel:WORD_1 dst_unused:UNUSED_PRESERVE src0_sel:WORD_1
    v_mfma_f32_16x16x32_bf16 a[116:119], a[212:215], v[72:75], a[116:119]
    s_waitcnt lgkmcnt(6)
    v_pk_add_f16 v28, v29, 1.0 op_sel_hi:[1,0]
    v_pk_add_f16 v30, v31, 1.0 op_sel_hi:[1,0]
    v_mfma_f32_16x16x32_bf16 a[24:27], a[192:195], v[64:67], a[24:27]
    ds_read_b64_tr_b16 a[208:209], v8 offset:2560
    ds_read_b64_tr_b16 a[210:211], v9 offset:2560
    v_rcp_f16 v29, v28
    v_mfma_f32_16x16x32_bf16 a[72:75], a[192:195], v[68:71], a[72:75]
    v_rcp_f16 v31, v30
    v_rcp_f16_sdwa v29, v28 dst_sel:WORD_1 dst_unused:UNUSED_PRESERVE src0_sel:WORD_1
    v_mfma_f32_16x16x32_bf16 a[120:123], a[192:195], v[72:75], a[120:123]
    s_waitcnt lgkmcnt(6)
    v_rcp_f16_sdwa v31, v30 dst_sel:WORD_1 dst_unused:UNUSED_PRESERVE src0_sel:WORD_1
    v_fma_mix_f32 v28, v92, v29, 0 op_sel_hi:[0,1,0]
    v_mfma_f32_16x16x32_bf16 a[28:31], a[196:199], v[64:67], a[28:31]
    ds_read_b64_tr_b16 a[212:213], v8 offset:2568
    ds_read_b64_tr_b16 a[214:215], v9 offset:2568
    v_add_u32 v8, s33, v8
    v_add_u32 v9, s33, v9
    v_mfma_f32_16x16x32_bf16 a[76:79], a[196:199], v[68:71], a[76:79]
    v_fma_mix_f32 v30, v94, v31, 0 op_sel_hi:[0,1,0]
    v_fma_mix_f32 v29, v93, v29, 0 op_sel:[0,1,0] op_sel_hi:[0,1,0]
    v_mfma_f32_16x16x32_bf16 a[124:127], a[196:199], v[72:75], a[124:127]
    s_waitcnt lgkmcnt(6)
    v_fma_mix_f32 v31, v95, v31, 0 op_sel:[0,1,0] op_sel_hi:[0,1,0]
    v_cvt_pk_bf16_f32 v60, v28, v29
    v_cvt_pk_bf16_f32 v61, v30, v31
    v_cvt_pk_f16_f32 v32, v96, v97
    v_mfma_f32_16x16x32_bf16 a[32:35], a[200:203], v[64:67], a[32:35]
    ds_read_b128 v[20:23], v10
    ds_read_b64_tr_b16 a[192:193], v2 offset:0
    ds_read_b64_tr_b16 a[194:195], v2 offset:2048
    v_add_u32 v10, 0x100, v10
    v_mfma_f32_16x16x32_bf16 a[80:83], a[200:203], v[68:71], a[80:83]
    v_cvt_pk_f16_f32 v34, v98, v99
    v_pk_fma_f16 v33, v32, v32, s32
    v_mfma_f32_16x16x32_bf16 a[128:131], a[200:203], v[72:75], a[128:131]
    s_waitcnt lgkmcnt(7)
    v_pk_fma_f16 v35, v34, v34, s32
    v_pk_mul_f16 v32, v32, v33 neg_lo:[1,0] neg_hi:[1,0]
    v_pk_mul_f16 v34, v34, v35 neg_lo:[1,0] neg_hi:[1,0]
    v_mfma_f32_16x16x32_bf16 a[36:39], a[204:207], v[64:67], a[36:39]
    ds_read_b64_tr_b16 a[196:197], v2 offset:4096
    ds_read_b64_tr_b16 a[198:199], v2 offset:6144
    v_exp_f16 v33, v32
    v_mfma_f32_16x16x32_bf16 a[84:87], a[204:207], v[68:71], a[84:87]
    v_exp_f16 v35, v34
    v_mfma_f32_16x16x32_bf16 a[132:135], a[204:207], v[72:75], a[132:135]
    s_waitcnt lgkmcnt(7)
    v_exp_f16_sdwa v33, v32 dst_sel:WORD_1 dst_unused:UNUSED_PRESERVE src0_sel:WORD_1
    v_exp_f16_sdwa v35, v34 dst_sel:WORD_1 dst_unused:UNUSED_PRESERVE src0_sel:WORD_1
    v_mfma_f32_16x16x32_bf16 a[40:43], a[208:211], v[64:67], a[40:43]
    ds_read_b64_tr_b16 a[200:201], v2 offset:8192
    ds_read_b64_tr_b16 a[202:203], v2 offset:10240
    v_pk_add_f16 v32, v33, 1.0 op_sel_hi:[1,0]
    v_pk_add_f16 v34, v35, 1.0 op_sel_hi:[1,0]
    v_mfma_f32_16x16x32_bf16 a[88:91], a[208:211], v[68:71], a[88:91]
    v_rcp_f16 v33, v32
    v_mfma_f32_16x16x32_bf16 a[136:139], a[208:211], v[72:75], a[136:139]
    s_waitcnt lgkmcnt(7)
    v_rcp_f16 v35, v34
    v_rcp_f16_sdwa v33, v32 dst_sel:WORD_1 dst_unused:UNUSED_PRESERVE src0_sel:WORD_1
    v_mfma_f32_16x16x32_bf16 a[44:47], a[212:215], v[64:67], a[44:47]
    ds_read_b64_tr_b16 a[204:205], v2 offset:12288
    ds_read_b64_tr_b16 a[206:207], v2 offset:14336
    v_mfma_f32_16x16x32_bf16 a[92:95], a[212:215], v[68:71], a[92:95]
    s_mov_b32 s33, s38
    v_rcp_f16_sdwa v35, v34 dst_sel:WORD_1 dst_unused:UNUSED_PRESERVE src0_sel:WORD_1
    v_fma_mix_f32 v32, v96, v33, 0 op_sel_hi:[0,1,0]
    v_fma_mix_f32 v34, v98, v35, 0 op_sel_hi:[0,1,0]
    v_fma_mix_f32 v33, v97, v33, 0 op_sel:[0,1,0] op_sel_hi:[0,1,0]
    v_mfma_f32_16x16x32_bf16 a[140:143], a[212:215], v[72:75], a[140:143]
    s_waitcnt lgkmcnt(6)
    v_fma_mix_f32 v35, v99, v35, 0 op_sel:[0,1,0] op_sel_hi:[0,1,0]
    v_cvt_pk_bf16_f32 v62, v32, v33
    v_cvt_pk_bf16_f32 v63, v34, v35
    s_waitcnt vmcnt(0)
    s_barrier
.p2align 6
L_loop_b0:
    v_mfma_f32_16x16x32_bf16 v[76:79], a[192:195], v[160:163], v[20:23]
    s_add_u32 m0, s45, 0
    ds_read_b64_tr_b16 a[208:209], v2 offset:16384
    ds_read_b64_tr_b16 a[210:211], v2 offset:18432
    v_cvt_pk_f16_f32 v28, v100, v101
    v_cvt_pk_f16_f32 v30, v102, v103
    v_mfma_f32_16x16x32_bf16 v[84:87], a[192:195], v[184:187], v[20:23]
    s_add_u32 s47, s35, 0
    buffer_load_dwordx4 v14, s[12:15], s47 offen lds
    v_pk_fma_f16 v29, v28, v28, s32
    v_mfma_f32_16x16x32_bf16 v[92:95], a[192:195], v[208:211], v[20:23]
    s_waitcnt lgkmcnt(6)
    v_pk_fma_f16 v31, v30, v30, s32
    v_pk_mul_f16 v28, v28, v29 neg_lo:[1,0] neg_hi:[1,0]
    v_pk_mul_f16 v30, v30, v31 neg_lo:[1,0] neg_hi:[1,0]
    v_mfma_f32_16x16x32_bf16 v[76:79], a[196:199], v[164:167], v[76:79]
    s_add_u32 m0, s45, 1024
    ds_read_b64_tr_b16 a[212:213], v2 offset:20480
    ds_read_b64_tr_b16 a[214:215], v2 offset:22528
    v_add_u32 v2, s33, v2
    v_mfma_f32_16x16x32_bf16 v[84:87], a[196:199], v[188:191], v[84:87]
    s_add_u32 s47, s35, 12288
    buffer_load_dwordx4 v14, s[12:15], s47 offen lds
    v_exp_f16 v29, v28
    v_mfma_f32_16x16x32_bf16 v[92:95], a[196:199], v[212:215], v[92:95]
    s_waitcnt lgkmcnt(6)
    v_exp_f16 v31, v30
    v_exp_f16_sdwa v29, v28 dst_sel:WORD_1 dst_unused:UNUSED_PRESERVE src0_sel:WORD_1
    v_mfma_f32_16x16x32_bf16 v[76:79], a[200:203], v[168:171], v[76:79]
    s_add_u32 m0, s45, 2048
    ds_read_b128 v[24:27], v11
    ds_read_b64_tr_b16 a[192:193], v3 offset:0
    ds_read_b64_tr_b16 a[194:195], v3 offset:2048
    v_add_u32 v11, 0x100, v11
    v_mfma_f32_16x16x32_bf16 v[84:87], a[200:203], v[192:195], v[84:87]
    s_add_u32 s47, s35, 24576
    buffer_load_dwordx4 v14, s[12:15], s47 offen lds
    v_mfma_f32_16x16x32_bf16 v[92:95], a[200:203], v[216:219], v[92:95]
    s_waitcnt lgkmcnt(7)
    v_exp_f16_sdwa v31, v30 dst_sel:WORD_1 dst_unused:UNUSED_PRESERVE src0_sel:WORD_1
    v_pk_add_f16 v28, v29, 1.0 op_sel_hi:[1,0]
    v_pk_add_f16 v30, v31, 1.0 op_sel_hi:[1,0]
    v_mfma_f32_16x16x32_bf16 v[76:79], a[204:207], v[172:175], v[76:79]
    s_add_u32 m0, s45, 3072
    ds_read_b64_tr_b16 a[196:197], v3 offset:4096
    ds_read_b64_tr_b16 a[198:199], v3 offset:6144
    v_rcp_f16 v29, v28
    v_mfma_f32_16x16x32_bf16 v[84:87], a[204:207], v[196:199], v[84:87]
    s_add_u32 s47, s35, 36864
    buffer_load_dwordx4 v14, s[12:15], s47 offen lds
    v_mfma_f32_16x16x32_bf16 v[92:95], a[204:207], v[220:223], v[92:95]
    s_waitcnt lgkmcnt(7)
    v_rcp_f16 v31, v30
    v_rcp_f16_sdwa v29, v28 dst_sel:WORD_1 dst_unused:UNUSED_PRESERVE src0_sel:WORD_1
    v_mfma_f32_16x16x32_bf16 v[76:79], a[208:211], v[176:179], v[76:79]
    s_add_u32 m0, s45, 4096
    ds_read_b64_tr_b16 a[200:201], v3 offset:8192
    ds_read_b64_tr_b16 a[202:203], v3 offset:10240
    v_rcp_f16_sdwa v31, v30 dst_sel:WORD_1 dst_unused:UNUSED_PRESERVE src0_sel:WORD_1
    v_mfma_f32_16x16x32_bf16 v[84:87], a[208:211], v[200:203], v[84:87]
    s_add_u32 s47, s35, 49152
    buffer_load_dwordx4 v14, s[12:15], s47 offen lds
    v_fma_mix_f32 v28, v100, v29, 0 op_sel_hi:[0,1,0]
    v_mfma_f32_16x16x32_bf16 v[92:95], a[208:211], v[224:227], v[92:95]
    s_waitcnt lgkmcnt(7)
    v_fma_mix_f32 v30, v102, v31, 0 op_sel_hi:[0,1,0]
    v_fma_mix_f32 v29, v101, v29, 0 op_sel:[0,1,0] op_sel_hi:[0,1,0]
    v_fma_mix_f32 v31, v103, v31, 0 op_sel:[0,1,0] op_sel_hi:[0,1,0]
    v_cvt_pk_bf16_f32 v64, v28, v29
    v_mfma_f32_16x16x32_bf16 v[76:79], a[212:215], v[180:183], v[76:79]
    s_add_u32 m0, s45, 5120
    ds_read_b64_tr_b16 a[204:205], v3 offset:12288
    ds_read_b64_tr_b16 a[206:207], v3 offset:14336
    v_cvt_pk_bf16_f32 v65, v30, v31
    v_mfma_f32_16x16x32_bf16 v[84:87], a[212:215], v[204:207], v[84:87]
    s_add_u32 s47, s35, 61440
    buffer_load_dwordx4 v14, s[12:15], s47 offen lds
    v_cvt_pk_f16_f32 v32, v104, v105
    v_mfma_f32_16x16x32_bf16 v[92:95], a[212:215], v[228:231], v[92:95]
    s_waitcnt lgkmcnt(6)
    v_cvt_pk_f16_f32 v34, v106, v107
    v_pk_fma_f16 v33, v32, v32, s32
    v_pk_fma_f16 v35, v34, v34, s32
    v_pk_mul_f16 v32, v32, v33 neg_lo:[1,0] neg_hi:[1,0]
    v_mfma_f32_16x16x32_bf16 v[80:83], a[192:195], v[160:163], v[24:27]
    s_add_u32 m0, s46, 0
    ds_read_b64_tr_b16 a[208:209], v3 offset:16384
    ds_read_b64_tr_b16 a[210:211], v3 offset:18432
    v_pk_mul_f16 v34, v34, v35 neg_lo:[1,0] neg_hi:[1,0]
    v_mfma_f32_16x16x32_bf16 v[88:91], a[192:195], v[184:187], v[24:27]
    s_add_u32 s47, s36, 0
    buffer_load_dwordx4 v15, s[16:19], s47 offen lds
    v_exp_f16 v33, v32
    v_mfma_f32_16x16x32_bf16 v[96:99], a[192:195], v[208:211], v[24:27]
    s_waitcnt lgkmcnt(6)
    v_exp_f16 v35, v34
    v_mfma_f32_16x16x32_bf16 v[80:83], a[196:199], v[164:167], v[80:83]
    s_add_u32 m0, s46, 1024
    ds_read_b64_tr_b16 a[212:213], v3 offset:20480
    ds_read_b64_tr_b16 a[214:215], v3 offset:22528
    v_add_u32 v3, s33, v3
    v_exp_f16_sdwa v33, v32 dst_sel:WORD_1 dst_unused:UNUSED_PRESERVE src0_sel:WORD_1
    v_mfma_f32_16x16x32_bf16 v[88:91], a[196:199], v[188:191], v[88:91]
    s_add_u32 s47, s36, 128
    buffer_load_dwordx4 v15, s[16:19], s47 offen lds
    v_mfma_f32_16x16x32_bf16 v[96:99], a[196:199], v[212:215], v[96:99]
    s_waitcnt lgkmcnt(6)
    v_exp_f16_sdwa v35, v34 dst_sel:WORD_1 dst_unused:UNUSED_PRESERVE src0_sel:WORD_1
    v_pk_add_f16 v32, v33, 1.0 op_sel_hi:[1,0]
    v_pk_add_f16 v34, v35, 1.0 op_sel_hi:[1,0]
    v_mfma_f32_16x16x32_bf16 v[80:83], a[200:203], v[168:171], v[80:83]
    s_add_u32 m0, s46, 2048
    ds_read_b64_tr_b16 a[192:193], v6 offset:0
    ds_read_b64_tr_b16 a[194:195], v7 offset:0
    v_rcp_f16 v33, v32
    v_mfma_f32_16x16x32_bf16 v[88:91], a[200:203], v[192:195], v[88:91]
    s_add_u32 s47, s36, 256
    buffer_load_dwordx4 v15, s[16:19], s47 offen lds
    v_mfma_f32_16x16x32_bf16 v[96:99], a[200:203], v[216:219], v[96:99]
    s_waitcnt lgkmcnt(6)
    v_rcp_f16 v35, v34
    v_rcp_f16_sdwa v33, v32 dst_sel:WORD_1 dst_unused:UNUSED_PRESERVE src0_sel:WORD_1
    v_mfma_f32_16x16x32_bf16 v[80:83], a[204:207], v[172:175], v[80:83]
    s_add_u32 m0, s46, 3080
    ds_read_b64_tr_b16 a[196:197], v6 offset:8
    ds_read_b64_tr_b16 a[198:199], v7 offset:8
    v_rcp_f16_sdwa v35, v34 dst_sel:WORD_1 dst_unused:UNUSED_PRESERVE src0_sel:WORD_1
    v_fma_mix_f32 v32, v104, v33, 0 op_sel_hi:[0,1,0]
    v_mfma_f32_16x16x32_bf16 v[88:91], a[204:207], v[196:199], v[88:91]
    s_add_u32 s47, s36, 1536
    buffer_load_dwordx4 v15, s[16:19], s47 offen lds
    v_fma_mix_f32 v34, v106, v35, 0 op_sel_hi:[0,1,0]
    v_mfma_f32_16x16x32_bf16 v[96:99], a[204:207], v[220:223], v[96:99]
    s_waitcnt lgkmcnt(6)
    v_fma_mix_f32 v33, v105, v33, 0 op_sel:[0,1,0] op_sel_hi:[0,1,0]
    v_fma_mix_f32 v35, v107, v35, 0 op_sel:[0,1,0] op_sel_hi:[0,1,0]
    v_cvt_pk_bf16_f32 v66, v32, v33
    v_mfma_f32_16x16x32_bf16 v[80:83], a[208:211], v[176:179], v[80:83]
    s_add_u32 m0, s46, 4104
    ds_read_b64_tr_b16 a[200:201], v6 offset:512
    ds_read_b64_tr_b16 a[202:203], v7 offset:512
    v_cvt_pk_bf16_f32 v67, v34, v35
    v_cvt_pk_f16_f32 v28, v108, v109
    v_mfma_f32_16x16x32_bf16 v[88:91], a[208:211], v[200:203], v[88:91]
    s_add_u32 s47, s36, 1664
    buffer_load_dwordx4 v15, s[16:19], s47 offen lds
    v_cvt_pk_f16_f32 v30, v110, v111
    v_mfma_f32_16x16x32_bf16 v[96:99], a[208:211], v[224:227], v[96:99]
    s_waitcnt lgkmcnt(6)
    v_pk_fma_f16 v29, v28, v28, s32
    v_pk_fma_f16 v31, v30, v30, s32
    v_pk_mul_f16 v28, v28, v29 neg_lo:[1,0] neg_hi:[1,0]
    v_pk_mul_f16 v30, v30, v31 neg_lo:[1,0] neg_hi:[1,0]
    v_mfma_f32_16x16x32_bf16 v[80:83], a[212:215], v[180:183], v[80:83]
    s_add_u32 m0, s46, 5128
    ds_read_b64_tr_b16 a[204:205], v6 offset:520
    ds_read_b64_tr_b16 a[206:207], v7 offset:520
    v_mfma_f32_16x16x32_bf16 v[88:91], a[212:215], v[204:207], v[88:91]
    s_add_u32 s47, s36, 1792
    buffer_load_dwordx4 v15, s[16:19], s47 offen lds
    v_exp_f16 v29, v28
    v_mfma_f32_16x16x32_bf16 v[96:99], a[212:215], v[228:231], v[96:99]
    s_waitcnt lgkmcnt(6)
    v_exp_f16 v31, v30
    v_exp_f16_sdwa v29, v28 dst_sel:WORD_1 dst_unused:UNUSED_PRESERVE src0_sel:WORD_1
    v_mfma_f32_16x16x32_bf16 a[0:3], a[192:195], v[52:55], a[0:3]
    ds_read_b64_tr_b16 a[208:209], v6 offset:1024
    ds_read_b64_tr_b16 a[210:211], v7 offset:1024
    v_exp_f16_sdwa v31, v30 dst_sel:WORD_1 dst_unused:UNUSED_PRESERVE src0_sel:WORD_1
    v_mfma_f32_16x16x32_bf16 a[48:51], a[192:195], v[56:59], a[48:51]
    v_pk_add_f16 v28, v29, 1.0 op_sel_hi:[1,0]
    v_pk_add_f16 v30, v31, 1.0 op_sel_hi:[1,0]
    v_rcp_f16 v29, v28
    v_mfma_f32_16x16x32_bf16 a[96:99], a[192:195], v[60:63], a[96:99]
    s_waitcnt lgkmcnt(6)
    v_rcp_f16 v31, v30
    v_mfma_f32_16x16x32_bf16 a[4:7], a[196:199], v[52:55], a[4:7]
    ds_read_b64_tr_b16 a[212:213], v6 offset:1032
    ds_read_b64_tr_b16 a[214:215], v7 offset:1032
    v_rcp_f16_sdwa v29, v28 dst_sel:WORD_1 dst_unused:UNUSED_PRESERVE src0_sel:WORD_1
    v_mfma_f32_16x16x32_bf16 a[52:55], a[196:199], v[56:59], a[52:55]
    v_rcp_f16_sdwa v31, v30 dst_sel:WORD_1 dst_unused:UNUSED_PRESERVE src0_sel:WORD_1
    v_fma_mix_f32 v28, v108, v29, 0 op_sel_hi:[0,1,0]
    v_fma_mix_f32 v30, v110, v31, 0 op_sel_hi:[0,1,0]
    v_fma_mix_f32 v29, v109, v29, 0 op_sel:[0,1,0] op_sel_hi:[0,1,0]
    v_mfma_f32_16x16x32_bf16 a[100:103], a[196:199], v[60:63], a[100:103]
    s_waitcnt lgkmcnt(6)
    v_fma_mix_f32 v31, v111, v31, 0 op_sel:[0,1,0] op_sel_hi:[0,1,0]
    v_cvt_pk_bf16_f32 v68, v28, v29
    v_cvt_pk_bf16_f32 v69, v30, v31
    v_cvt_pk_f16_f32 v32, v112, v113
    v_mfma_f32_16x16x32_bf16 a[8:11], a[200:203], v[52:55], a[8:11]
    ds_read_b64_tr_b16 a[192:193], v6 offset:1536
    ds_read_b64_tr_b16 a[194:195], v7 offset:1536
    v_cvt_pk_f16_f32 v34, v114, v115
    v_mfma_f32_16x16x32_bf16 a[56:59], a[200:203], v[56:59], a[56:59]
    v_pk_fma_f16 v33, v32, v32, s32
    v_pk_fma_f16 v35, v34, v34, s32
    v_pk_mul_f16 v32, v32, v33 neg_lo:[1,0] neg_hi:[1,0]
    v_pk_mul_f16 v34, v34, v35 neg_lo:[1,0] neg_hi:[1,0]
    v_mfma_f32_16x16x32_bf16 a[104:107], a[200:203], v[60:63], a[104:107]
    s_waitcnt lgkmcnt(6)
    v_exp_f16 v33, v32
    v_exp_f16 v35, v34
    v_mfma_f32_16x16x32_bf16 a[12:15], a[204:207], v[52:55], a[12:15]
    ds_read_b64_tr_b16 a[196:197], v6 offset:1544
    ds_read_b64_tr_b16 a[198:199], v7 offset:1544
    v_exp_f16_sdwa v33, v32 dst_sel:WORD_1 dst_unused:UNUSED_PRESERVE src0_sel:WORD_1
    v_mfma_f32_16x16x32_bf16 a[60:63], a[204:207], v[56:59], a[60:63]
    v_exp_f16_sdwa v35, v34 dst_sel:WORD_1 dst_unused:UNUSED_PRESERVE src0_sel:WORD_1
    v_pk_add_f16 v32, v33, 1.0 op_sel_hi:[1,0]
    v_pk_add_f16 v34, v35, 1.0 op_sel_hi:[1,0]
    v_mfma_f32_16x16x32_bf16 a[108:111], a[204:207], v[60:63], a[108:111]
    s_waitcnt lgkmcnt(6)
    v_rcp_f16 v33, v32
    v_mfma_f32_16x16x32_bf16 a[16:19], a[208:211], v[52:55], a[16:19]
    ds_read_b64_tr_b16 a[200:201], v6 offset:2048
    ds_read_b64_tr_b16 a[202:203], v7 offset:2048
    v_rcp_f16 v35, v34
    v_mfma_f32_16x16x32_bf16 a[64:67], a[208:211], v[56:59], a[64:67]
    v_rcp_f16_sdwa v33, v32 dst_sel:WORD_1 dst_unused:UNUSED_PRESERVE src0_sel:WORD_1
    v_rcp_f16_sdwa v35, v34 dst_sel:WORD_1 dst_unused:UNUSED_PRESERVE src0_sel:WORD_1
    v_fma_mix_f32 v32, v112, v33, 0 op_sel_hi:[0,1,0]
    v_mfma_f32_16x16x32_bf16 a[112:115], a[208:211], v[60:63], a[112:115]
    s_waitcnt lgkmcnt(6)
    v_fma_mix_f32 v34, v114, v35, 0 op_sel_hi:[0,1,0]
    v_fma_mix_f32 v33, v113, v33, 0 op_sel:[0,1,0] op_sel_hi:[0,1,0]
    v_fma_mix_f32 v35, v115, v35, 0 op_sel:[0,1,0] op_sel_hi:[0,1,0]
    v_cvt_pk_bf16_f32 v70, v32, v33
    v_mfma_f32_16x16x32_bf16 a[20:23], a[212:215], v[52:55], a[20:23]
    ds_read_b64_tr_b16 a[204:205], v6 offset:2056
    ds_read_b64_tr_b16 a[206:207], v7 offset:2056
    v_cvt_pk_bf16_f32 v71, v34, v35
    v_mfma_f32_16x16x32_bf16 a[68:71], a[212:215], v[56:59], a[68:71]
    v_cvt_pk_f16_f32 v28, v116, v117
    v_cvt_pk_f16_f32 v30, v118, v119
    v_pk_fma_f16 v29, v28, v28, s32
    v_pk_fma_f16 v31, v30, v30, s32
    v_mfma_f32_16x16x32_bf16 a[116:119], a[212:215], v[60:63], a[116:119]
    s_waitcnt lgkmcnt(6)
    v_pk_mul_f16 v28, v28, v29 neg_lo:[1,0] neg_hi:[1,0]
    v_pk_mul_f16 v30, v30, v31 neg_lo:[1,0] neg_hi:[1,0]
    v_exp_f16 v29, v28
    v_mfma_f32_16x16x32_bf16 a[24:27], a[192:195], v[52:55], a[24:27]
    ds_read_b64_tr_b16 a[208:209], v6 offset:2560
    ds_read_b64_tr_b16 a[210:211], v7 offset:2560
    v_exp_f16 v31, v30
    v_mfma_f32_16x16x32_bf16 a[72:75], a[192:195], v[56:59], a[72:75]
    v_exp_f16_sdwa v29, v28 dst_sel:WORD_1 dst_unused:UNUSED_PRESERVE src0_sel:WORD_1
    v_exp_f16_sdwa v31, v30 dst_sel:WORD_1 dst_unused:UNUSED_PRESERVE src0_sel:WORD_1
    v_mfma_f32_16x16x32_bf16 a[120:123], a[192:195], v[60:63], a[120:123]
    s_waitcnt lgkmcnt(6)
    v_pk_add_f16 v28, v29, 1.0 op_sel_hi:[1,0]
    v_pk_add_f16 v30, v31, 1.0 op_sel_hi:[1,0]
    v_mfma_f32_16x16x32_bf16 a[28:31], a[196:199], v[52:55], a[28:31]
    ds_read_b64_tr_b16 a[212:213], v6 offset:2568
    ds_read_b64_tr_b16 a[214:215], v7 offset:2568
    v_add_u32 v6, s33, v6
    v_add_u32 v7, s33, v7
    v_mfma_f32_16x16x32_bf16 a[76:79], a[196:199], v[56:59], a[76:79]
    v_rcp_f16 v29, v28
    v_rcp_f16 v31, v30
    v_mfma_f32_16x16x32_bf16 a[124:127], a[196:199], v[60:63], a[124:127]
    s_waitcnt lgkmcnt(6)
    v_rcp_f16_sdwa v29, v28 dst_sel:WORD_1 dst_unused:UNUSED_PRESERVE src0_sel:WORD_1
    v_rcp_f16_sdwa v31, v30 dst_sel:WORD_1 dst_unused:UNUSED_PRESERVE src0_sel:WORD_1
    v_fma_mix_f32 v28, v116, v29, 0 op_sel_hi:[0,1,0]
    v_mfma_f32_16x16x32_bf16 a[32:35], a[200:203], v[52:55], a[32:35]
    ds_read_b128 v[20:23], v12
    ds_read_b64_tr_b16 a[192:193], v4 offset:0
    ds_read_b64_tr_b16 a[194:195], v4 offset:2048
    v_add_u32 v12, 0x100, v12
    v_mfma_f32_16x16x32_bf16 a[80:83], a[200:203], v[56:59], a[80:83]
    v_fma_mix_f32 v30, v118, v31, 0 op_sel_hi:[0,1,0]
    v_fma_mix_f32 v29, v117, v29, 0 op_sel:[0,1,0] op_sel_hi:[0,1,0]
    v_fma_mix_f32 v31, v119, v31, 0 op_sel:[0,1,0] op_sel_hi:[0,1,0]
    v_mfma_f32_16x16x32_bf16 a[128:131], a[200:203], v[60:63], a[128:131]
    s_waitcnt lgkmcnt(7)
    v_cvt_pk_bf16_f32 v72, v28, v29
    v_cvt_pk_bf16_f32 v73, v30, v31
    v_cvt_pk_f16_f32 v32, v120, v121
    v_cvt_pk_f16_f32 v34, v122, v123
    v_mfma_f32_16x16x32_bf16 a[36:39], a[204:207], v[52:55], a[36:39]
    ds_read_b64_tr_b16 a[196:197], v4 offset:4096
    ds_read_b64_tr_b16 a[198:199], v4 offset:6144
    v_pk_fma_f16 v33, v32, v32, s32
    v_pk_fma_f16 v35, v34, v34, s32
    v_mfma_f32_16x16x32_bf16 a[84:87], a[204:207], v[56:59], a[84:87]
    v_pk_mul_f16 v32, v32, v33 neg_lo:[1,0] neg_hi:[1,0]
    v_pk_mul_f16 v34, v34, v35 neg_lo:[1,0] neg_hi:[1,0]
    v_exp_f16 v33, v32
    v_mfma_f32_16x16x32_bf16 a[132:135], a[204:207], v[60:63], a[132:135]
    s_waitcnt lgkmcnt(7)
    v_exp_f16 v35, v34
    v_mfma_f32_16x16x32_bf16 a[40:43], a[208:211], v[52:55], a[40:43]
    ds_read_b64_tr_b16 a[200:201], v4 offset:8192
    ds_read_b64_tr_b16 a[202:203], v4 offset:10240
    v_exp_f16_sdwa v33, v32 dst_sel:WORD_1 dst_unused:UNUSED_PRESERVE src0_sel:WORD_1
    v_mfma_f32_16x16x32_bf16 a[88:91], a[208:211], v[56:59], a[88:91]
    v_exp_f16_sdwa v35, v34 dst_sel:WORD_1 dst_unused:UNUSED_PRESERVE src0_sel:WORD_1
    v_pk_add_f16 v32, v33, 1.0 op_sel_hi:[1,0]
    v_pk_add_f16 v34, v35, 1.0 op_sel_hi:[1,0]
    v_mfma_f32_16x16x32_bf16 a[136:139], a[208:211], v[60:63], a[136:139]
    s_waitcnt lgkmcnt(7)
    v_rcp_f16 v33, v32
    v_rcp_f16 v35, v34
    v_mfma_f32_16x16x32_bf16 a[44:47], a[212:215], v[52:55], a[44:47]
    ds_read_b64_tr_b16 a[204:205], v4 offset:12288
    ds_read_b64_tr_b16 a[206:207], v4 offset:14336
    v_rcp_f16_sdwa v33, v32 dst_sel:WORD_1 dst_unused:UNUSED_PRESERVE src0_sel:WORD_1
    v_mfma_f32_16x16x32_bf16 a[92:95], a[212:215], v[56:59], a[92:95]
    v_rcp_f16_sdwa v35, v34 dst_sel:WORD_1 dst_unused:UNUSED_PRESERVE src0_sel:WORD_1
    v_fma_mix_f32 v32, v120, v33, 0 op_sel_hi:[0,1,0]
    v_fma_mix_f32 v34, v122, v35, 0 op_sel_hi:[0,1,0]
    v_mfma_f32_16x16x32_bf16 a[140:143], a[212:215], v[60:63], a[140:143]
    s_waitcnt lgkmcnt(6)
    v_fma_mix_f32 v33, v121, v33, 0 op_sel:[0,1,0] op_sel_hi:[0,1,0]
    v_fma_mix_f32 v35, v123, v35, 0 op_sel:[0,1,0] op_sel_hi:[0,1,0]
    v_cvt_pk_bf16_f32 v74, v32, v33
    v_cvt_pk_bf16_f32 v75, v34, v35
    v_mfma_f32_16x16x32_bf16 v[100:103], a[192:195], v[160:163], v[20:23]
    s_add_u32 s45, s45, s49
    ds_read_b64_tr_b16 a[208:209], v4 offset:16384
    ds_read_b64_tr_b16 a[210:211], v4 offset:18432
    v_cvt_pk_f16_f32 v28, v76, v77
    v_mfma_f32_16x16x32_bf16 v[108:111], a[192:195], v[184:187], v[20:23]
    v_cvt_pk_f16_f32 v30, v78, v79
    v_pk_fma_f16 v29, v28, v28, s32
    v_pk_fma_f16 v31, v30, v30, s32
    v_pk_mul_f16 v28, v28, v29 neg_lo:[1,0] neg_hi:[1,0]
    v_mfma_f32_16x16x32_bf16 v[116:119], a[192:195], v[208:211], v[20:23]
    s_waitcnt lgkmcnt(6)
    v_pk_mul_f16 v30, v30, v31 neg_lo:[1,0] neg_hi:[1,0]
    v_exp_f16 v29, v28
    v_mfma_f32_16x16x32_bf16 v[100:103], a[196:199], v[164:167], v[100:103]
    s_add_u32 s46, s46, s49
    ds_read_b64_tr_b16 a[212:213], v4 offset:20480
    ds_read_b64_tr_b16 a[214:215], v4 offset:22528
    v_add_u32 v4, s33, v4
    v_mfma_f32_16x16x32_bf16 v[108:111], a[196:199], v[188:191], v[108:111]
    v_exp_f16 v31, v30
    v_mfma_f32_16x16x32_bf16 v[116:119], a[196:199], v[212:215], v[116:119]
    s_waitcnt lgkmcnt(6)
    v_exp_f16_sdwa v29, v28 dst_sel:WORD_1 dst_unused:UNUSED_PRESERVE src0_sel:WORD_1
    v_exp_f16_sdwa v31, v30 dst_sel:WORD_1 dst_unused:UNUSED_PRESERVE src0_sel:WORD_1
    v_pk_add_f16 v28, v29, 1.0 op_sel_hi:[1,0]
    v_mfma_f32_16x16x32_bf16 v[100:103], a[200:203], v[168:171], v[100:103]
    s_add_u32 s35, s35, 128
    ds_read_b128 v[24:27], v13
    ds_read_b64_tr_b16 a[192:193], v5 offset:0
    ds_read_b64_tr_b16 a[194:195], v5 offset:2048
    v_add_u32 v13, 0x100, v13
    v_mfma_f32_16x16x32_bf16 v[108:111], a[200:203], v[192:195], v[108:111]
    v_pk_add_f16 v30, v31, 1.0 op_sel_hi:[1,0]
    v_rcp_f16 v29, v28
    v_mfma_f32_16x16x32_bf16 v[116:119], a[200:203], v[216:219], v[116:119]
    s_waitcnt lgkmcnt(7)
    v_rcp_f16 v31, v30
    v_mfma_f32_16x16x32_bf16 v[100:103], a[204:207], v[172:175], v[100:103]
    s_add_u32 s36, s36, 24576
    ds_read_b64_tr_b16 a[196:197], v5 offset:4096
    ds_read_b64_tr_b16 a[198:199], v5 offset:6144
    v_rcp_f16_sdwa v29, v28 dst_sel:WORD_1 dst_unused:UNUSED_PRESERVE src0_sel:WORD_1
    v_mfma_f32_16x16x32_bf16 v[108:111], a[204:207], v[196:199], v[108:111]
    v_rcp_f16_sdwa v31, v30 dst_sel:WORD_1 dst_unused:UNUSED_PRESERVE src0_sel:WORD_1
    v_fma_mix_f32 v28, v76, v29, 0 op_sel_hi:[0,1,0]
    v_mfma_f32_16x16x32_bf16 v[116:119], a[204:207], v[220:223], v[116:119]
    s_waitcnt lgkmcnt(7)
    v_fma_mix_f32 v30, v78, v31, 0 op_sel_hi:[0,1,0]
    v_fma_mix_f32 v29, v77, v29, 0 op_sel:[0,1,0] op_sel_hi:[0,1,0]
    v_fma_mix_f32 v31, v79, v31, 0 op_sel:[0,1,0] op_sel_hi:[0,1,0]
    v_mfma_f32_16x16x32_bf16 v[100:103], a[208:211], v[176:179], v[100:103]
    s_mov_b32 s38, s48
    ds_read_b64_tr_b16 a[200:201], v5 offset:8192
    ds_read_b64_tr_b16 a[202:203], v5 offset:10240
    v_cvt_pk_bf16_f32 v52, v28, v29
    v_cvt_pk_bf16_f32 v53, v30, v31
    v_mfma_f32_16x16x32_bf16 v[108:111], a[208:211], v[200:203], v[108:111]
    v_cvt_pk_f16_f32 v32, v80, v81
    v_cvt_pk_f16_f32 v34, v82, v83
    v_pk_fma_f16 v33, v32, v32, s32
    v_mfma_f32_16x16x32_bf16 v[116:119], a[208:211], v[224:227], v[116:119]
    s_waitcnt lgkmcnt(7)
    v_pk_fma_f16 v35, v34, v34, s32
    v_pk_mul_f16 v32, v32, v33 neg_lo:[1,0] neg_hi:[1,0]
    v_pk_mul_f16 v34, v34, v35 neg_lo:[1,0] neg_hi:[1,0]
    v_mfma_f32_16x16x32_bf16 v[100:103], a[212:215], v[180:183], v[100:103]
    s_mov_b32 s48, s49
    ds_read_b64_tr_b16 a[204:205], v5 offset:12288
    ds_read_b64_tr_b16 a[206:207], v5 offset:14336
    v_mfma_f32_16x16x32_bf16 v[108:111], a[212:215], v[204:207], v[108:111]
    v_exp_f16 v33, v32
    v_exp_f16 v35, v34
    v_mfma_f32_16x16x32_bf16 v[116:119], a[212:215], v[228:231], v[116:119]
    s_waitcnt lgkmcnt(6)
    v_exp_f16_sdwa v33, v32 dst_sel:WORD_1 dst_unused:UNUSED_PRESERVE src0_sel:WORD_1
    v_exp_f16_sdwa v35, v34 dst_sel:WORD_1 dst_unused:UNUSED_PRESERVE src0_sel:WORD_1
    v_mfma_f32_16x16x32_bf16 v[104:107], a[192:195], v[160:163], v[24:27]
    s_mov_b32 s49, s33
    ds_read_b64_tr_b16 a[208:209], v5 offset:16384
    ds_read_b64_tr_b16 a[210:211], v5 offset:18432
    v_pk_add_f16 v32, v33, 1.0 op_sel_hi:[1,0]
    v_mfma_f32_16x16x32_bf16 v[112:115], a[192:195], v[184:187], v[24:27]
    v_pk_add_f16 v34, v35, 1.0 op_sel_hi:[1,0]
    v_rcp_f16 v33, v32
    v_mfma_f32_16x16x32_bf16 v[120:123], a[192:195], v[208:211], v[24:27]
    s_waitcnt lgkmcnt(6)
    v_rcp_f16 v35, v34
    v_rcp_f16_sdwa v33, v32 dst_sel:WORD_1 dst_unused:UNUSED_PRESERVE src0_sel:WORD_1
    v_mfma_f32_16x16x32_bf16 v[104:107], a[196:199], v[164:167], v[104:107]
    s_sub_u32 s37, s37, 1
    ds_read_b64_tr_b16 a[212:213], v5 offset:20480
    ds_read_b64_tr_b16 a[214:215], v5 offset:22528
    v_add_u32 v5, s33, v5
    v_mfma_f32_16x16x32_bf16 v[112:115], a[196:199], v[188:191], v[112:115]
    v_rcp_f16_sdwa v35, v34 dst_sel:WORD_1 dst_unused:UNUSED_PRESERVE src0_sel:WORD_1
    v_fma_mix_f32 v32, v80, v33, 0 op_sel_hi:[0,1,0]
    v_mfma_f32_16x16x32_bf16 v[120:123], a[196:199], v[212:215], v[120:123]
    s_waitcnt lgkmcnt(6)
    v_fma_mix_f32 v34, v82, v35, 0 op_sel_hi:[0,1,0]
    v_fma_mix_f32 v33, v81, v33, 0 op_sel:[0,1,0] op_sel_hi:[0,1,0]
    v_fma_mix_f32 v35, v83, v35, 0 op_sel:[0,1,0] op_sel_hi:[0,1,0]
    v_cvt_pk_bf16_f32 v54, v32, v33
    v_mfma_f32_16x16x32_bf16 v[104:107], a[200:203], v[168:171], v[104:107]
    s_cmp_lg_u32 s37, 0
    ds_read_b64_tr_b16 a[192:193], v8 offset:0
    ds_read_b64_tr_b16 a[194:195], v9 offset:0
    v_cvt_pk_bf16_f32 v55, v34, v35
    v_mfma_f32_16x16x32_bf16 v[112:115], a[200:203], v[192:195], v[112:115]
    v_cvt_pk_f16_f32 v28, v84, v85
    v_cvt_pk_f16_f32 v30, v86, v87
    v_pk_fma_f16 v29, v28, v28, s32
    v_mfma_f32_16x16x32_bf16 v[120:123], a[200:203], v[216:219], v[120:123]
    s_waitcnt lgkmcnt(6)
    v_pk_fma_f16 v31, v30, v30, s32
    v_pk_mul_f16 v28, v28, v29 neg_lo:[1,0] neg_hi:[1,0]
    v_pk_mul_f16 v30, v30, v31 neg_lo:[1,0] neg_hi:[1,0]
    v_mfma_f32_16x16x32_bf16 v[104:107], a[204:207], v[172:175], v[104:107]
    ds_read_b64_tr_b16 a[196:197], v8 offset:8
    ds_read_b64_tr_b16 a[198:199], v9 offset:8
    v_exp_f16 v29, v28
    v_mfma_f32_16x16x32_bf16 v[112:115], a[204:207], v[196:199], v[112:115]
    v_exp_f16 v31, v30
    v_mfma_f32_16x16x32_bf16 v[120:123], a[204:207], v[220:223], v[120:123]
    s_waitcnt lgkmcnt(6)
    v_exp_f16_sdwa v29, v28 dst_sel:WORD_1 dst_unused:UNUSED_PRESERVE src0_sel:WORD_1
    v_exp_f16_sdwa v31, v30 dst_sel:WORD_1 dst_unused:UNUSED_PRESERVE src0_sel:WORD_1
    v_mfma_f32_16x16x32_bf16 v[104:107], a[208:211], v[176:179], v[104:107]
    ds_read_b64_tr_b16 a[200:201], v8 offset:512
    ds_read_b64_tr_b16 a[202:203], v9 offset:512
    v_pk_add_f16 v28, v29, 1.0 op_sel_hi:[1,0]
    v_pk_add_f16 v30, v31, 1.0 op_sel_hi:[1,0]
    v_mfma_f32_16x16x32_bf16 v[112:115], a[208:211], v[200:203], v[112:115]
    v_rcp_f16 v29, v28
    v_mfma_f32_16x16x32_bf16 v[120:123], a[208:211], v[224:227], v[120:123]
    s_waitcnt lgkmcnt(6)
    v_rcp_f16 v31, v30
    v_rcp_f16_sdwa v29, v28 dst_sel:WORD_1 dst_unused:UNUSED_PRESERVE src0_sel:WORD_1
    v_mfma_f32_16x16x32_bf16 v[104:107], a[212:215], v[180:183], v[104:107]
    ds_read_b64_tr_b16 a[204:205], v8 offset:520
    ds_read_b64_tr_b16 a[206:207], v9 offset:520
    v_mfma_f32_16x16x32_bf16 v[112:115], a[212:215], v[204:207], v[112:115]
    v_rcp_f16_sdwa v31, v30 dst_sel:WORD_1 dst_unused:UNUSED_PRESERVE src0_sel:WORD_1
    v_fma_mix_f32 v28, v84, v29, 0 op_sel_hi:[0,1,0]
    v_fma_mix_f32 v30, v86, v31, 0 op_sel_hi:[0,1,0]
    v_fma_mix_f32 v29, v85, v29, 0 op_sel:[0,1,0] op_sel_hi:[0,1,0]
    v_mfma_f32_16x16x32_bf16 v[120:123], a[212:215], v[228:231], v[120:123]
    s_waitcnt lgkmcnt(6)
    v_fma_mix_f32 v31, v87, v31, 0 op_sel:[0,1,0] op_sel_hi:[0,1,0]
    v_cvt_pk_bf16_f32 v56, v28, v29
    v_cvt_pk_bf16_f32 v57, v30, v31
    v_mfma_f32_16x16x32_bf16 a[0:3], a[192:195], v[64:67], a[0:3]
    ds_read_b64_tr_b16 a[208:209], v8 offset:1024
    ds_read_b64_tr_b16 a[210:211], v9 offset:1024
    v_cvt_pk_f16_f32 v32, v88, v89
    v_mfma_f32_16x16x32_bf16 a[48:51], a[192:195], v[68:71], a[48:51]
    v_cvt_pk_f16_f32 v34, v90, v91
    v_pk_fma_f16 v33, v32, v32, s32
    v_pk_fma_f16 v35, v34, v34, s32
    v_pk_mul_f16 v32, v32, v33 neg_lo:[1,0] neg_hi:[1,0]
    v_mfma_f32_16x16x32_bf16 a[96:99], a[192:195], v[72:75], a[96:99]
    s_waitcnt lgkmcnt(6)
    v_pk_mul_f16 v34, v34, v35 neg_lo:[1,0] neg_hi:[1,0]
    v_exp_f16 v33, v32
    v_mfma_f32_16x16x32_bf16 a[4:7], a[196:199], v[64:67], a[4:7]
    ds_read_b64_tr_b16 a[212:213], v8 offset:1032
    ds_read_b64_tr_b16 a[214:215], v9 offset:1032
    v_mfma_f32_16x16x32_bf16 a[52:55], a[196:199], v[68:71], a[52:55]
    v_exp_f16 v35, v34
    v_exp_f16_sdwa v33, v32 dst_sel:WORD_1 dst_unused:UNUSED_PRESERVE src0_sel:WORD_1
    v_mfma_f32_16x16x32_bf16 a[100:103], a[196:199], v[72:75], a[100:103]
    s_waitcnt lgkmcnt(6)
    v_exp_f16_sdwa v35, v34 dst_sel:WORD_1 dst_unused:UNUSED_PRESERVE src0_sel:WORD_1
    v_pk_add_f16 v32, v33, 1.0 op_sel_hi:[1,0]
    v_pk_add_f16 v34, v35, 1.0 op_sel_hi:[1,0]
    v_mfma_f32_16x16x32_bf16 a[8:11], a[200:203], v[64:67], a[8:11]
    ds_read_b64_tr_b16 a[192:193], v8 offset:1536
    ds_read_b64_tr_b16 a[194:195], v9 offset:1536
    v_mfma_f32_16x16x32_bf16 a[56:59], a[200:203], v[68:71], a[56:59]
    v_rcp_f16 v33, v32
    v_rcp_f16 v35, v34
    v_mfma_f32_16x16x32_bf16 a[104:107], a[200:203], v[72:75], a[104:107]
    s_waitcnt lgkmcnt(6)
    v_rcp_f16_sdwa v33, v32 dst_sel:WORD_1 dst_unused:UNUSED_PRESERVE src0_sel:WORD_1
    v_rcp_f16_sdwa v35, v34 dst_sel:WORD_1 dst_unused:UNUSED_PRESERVE src0_sel:WORD_1
    v_mfma_f32_16x16x32_bf16 a[12:15], a[204:207], v[64:67], a[12:15]
    ds_read_b64_tr_b16 a[196:197], v8 offset:1544
    ds_read_b64_tr_b16 a[198:199], v9 offset:1544
    v_fma_mix_f32 v32, v88, v33, 0 op_sel_hi:[0,1,0]
    v_mfma_f32_16x16x32_bf16 a[60:63], a[204:207], v[68:71], a[60:63]
    v_fma_mix_f32 v34, v90, v35, 0 op_sel_hi:[0,1,0]
    v_fma_mix_f32 v33, v89, v33, 0 op_sel:[0,1,0] op_sel_hi:[0,1,0]
    v_fma_mix_f32 v35, v91, v35, 0 op_sel:[0,1,0] op_sel_hi:[0,1,0]
    v_mfma_f32_16x16x32_bf16 a[108:111], a[204:207], v[72:75], a[108:111]
    s_waitcnt lgkmcnt(6)
    v_cvt_pk_bf16_f32 v58, v32, v33
    v_cvt_pk_bf16_f32 v59, v34, v35
    v_cvt_pk_f16_f32 v28, v92, v93
    v_mfma_f32_16x16x32_bf16 a[16:19], a[208:211], v[64:67], a[16:19]
    ds_read_b64_tr_b16 a[200:201], v8 offset:2048
    ds_read_b64_tr_b16 a[202:203], v9 offset:2048
    v_cvt_pk_f16_f32 v30, v94, v95
    v_pk_fma_f16 v29, v28, v28, s32
    v_mfma_f32_16x16x32_bf16 a[64:67], a[208:211], v[68:71], a[64:67]
    v_pk_fma_f16 v31, v30, v30, s32
    v_pk_mul_f16 v28, v28, v29 neg_lo:[1,0] neg_hi:[1,0]
    v_pk_mul_f16 v30, v30, v31 neg_lo:[1,0] neg_hi:[1,0]
    v_mfma_f32_16x16x32_bf16 a[112:115], a[208:211], v[72:75], a[112:115]
    s_waitcnt lgkmcnt(6)
    v_exp_f16 v29, v28
    v_mfma_f32_16x16x32_bf16 a[20:23], a[212:215], v[64:67], a[20:23]
    ds_read_b64_tr_b16 a[204:205], v8 offset:2056
    ds_read_b64_tr_b16 a[206:207], v9 offset:2056
    v_exp_f16 v31, v30
    v_mfma_f32_16x16x32_bf16 a[68:71], a[212:215], v[68:71], a[68:71]
    v_exp_f16_sdwa v29, v28 dst_sel:WORD_1 dst_unused:UNUSED_PRESERVE src0_sel:WORD_1
    v_exp_f16_sdwa v31, v30 dst_sel:WORD_1 dst_unused:UNUSED_PRESERVE src0_sel:WORD_1
    v_mfma_f32_16x16x32_bf16 a[116:119], a[212:215], v[72:75], a[116:119]
    s_waitcnt lgkmcnt(6)
    v_pk_add_f16 v28, v29, 1.0 op_sel_hi:[1,0]
    v_pk_add_f16 v30, v31, 1.0 op_sel_hi:[1,0]
    v_mfma_f32_16x16x32_bf16 a[24:27], a[192:195], v[64:67], a[24:27]
    ds_read_b64_tr_b16 a[208:209], v8 offset:2560
    ds_read_b64_tr_b16 a[210:211], v9 offset:2560
    v_rcp_f16 v29, v28
    v_mfma_f32_16x16x32_bf16 a[72:75], a[192:195], v[68:71], a[72:75]
    v_rcp_f16 v31, v30
    v_rcp_f16_sdwa v29, v28 dst_sel:WORD_1 dst_unused:UNUSED_PRESERVE src0_sel:WORD_1
    v_mfma_f32_16x16x32_bf16 a[120:123], a[192:195], v[72:75], a[120:123]
    s_waitcnt lgkmcnt(6)
    v_rcp_f16_sdwa v31, v30 dst_sel:WORD_1 dst_unused:UNUSED_PRESERVE src0_sel:WORD_1
    v_fma_mix_f32 v28, v92, v29, 0 op_sel_hi:[0,1,0]
    v_mfma_f32_16x16x32_bf16 a[28:31], a[196:199], v[64:67], a[28:31]
    ds_read_b64_tr_b16 a[212:213], v8 offset:2568
    ds_read_b64_tr_b16 a[214:215], v9 offset:2568
    v_add_u32 v8, s33, v8
    v_add_u32 v9, s33, v9
    v_mfma_f32_16x16x32_bf16 a[76:79], a[196:199], v[68:71], a[76:79]
    v_fma_mix_f32 v30, v94, v31, 0 op_sel_hi:[0,1,0]
    v_fma_mix_f32 v29, v93, v29, 0 op_sel:[0,1,0] op_sel_hi:[0,1,0]
    v_mfma_f32_16x16x32_bf16 a[124:127], a[196:199], v[72:75], a[124:127]
    s_waitcnt lgkmcnt(6)
    v_fma_mix_f32 v31, v95, v31, 0 op_sel:[0,1,0] op_sel_hi:[0,1,0]
    v_cvt_pk_bf16_f32 v60, v28, v29
    v_cvt_pk_bf16_f32 v61, v30, v31
    v_cvt_pk_f16_f32 v32, v96, v97
    v_mfma_f32_16x16x32_bf16 a[32:35], a[200:203], v[64:67], a[32:35]
    ds_read_b128 v[20:23], v10
    ds_read_b64_tr_b16 a[192:193], v2 offset:0
    ds_read_b64_tr_b16 a[194:195], v2 offset:2048
    v_add_u32 v10, 0x100, v10
    v_mfma_f32_16x16x32_bf16 a[80:83], a[200:203], v[68:71], a[80:83]
    v_cvt_pk_f16_f32 v34, v98, v99
    v_pk_fma_f16 v33, v32, v32, s32
    v_mfma_f32_16x16x32_bf16 a[128:131], a[200:203], v[72:75], a[128:131]
    s_waitcnt lgkmcnt(7)
    v_pk_fma_f16 v35, v34, v34, s32
    v_pk_mul_f16 v32, v32, v33 neg_lo:[1,0] neg_hi:[1,0]
    v_pk_mul_f16 v34, v34, v35 neg_lo:[1,0] neg_hi:[1,0]
    v_mfma_f32_16x16x32_bf16 a[36:39], a[204:207], v[64:67], a[36:39]
    ds_read_b64_tr_b16 a[196:197], v2 offset:4096
    ds_read_b64_tr_b16 a[198:199], v2 offset:6144
    v_exp_f16 v33, v32
    v_mfma_f32_16x16x32_bf16 a[84:87], a[204:207], v[68:71], a[84:87]
    v_exp_f16 v35, v34
    v_mfma_f32_16x16x32_bf16 a[132:135], a[204:207], v[72:75], a[132:135]
    s_waitcnt lgkmcnt(7)
    v_exp_f16_sdwa v33, v32 dst_sel:WORD_1 dst_unused:UNUSED_PRESERVE src0_sel:WORD_1
    v_exp_f16_sdwa v35, v34 dst_sel:WORD_1 dst_unused:UNUSED_PRESERVE src0_sel:WORD_1
    v_mfma_f32_16x16x32_bf16 a[40:43], a[208:211], v[64:67], a[40:43]
    ds_read_b64_tr_b16 a[200:201], v2 offset:8192
    ds_read_b64_tr_b16 a[202:203], v2 offset:10240
    v_pk_add_f16 v32, v33, 1.0 op_sel_hi:[1,0]
    v_pk_add_f16 v34, v35, 1.0 op_sel_hi:[1,0]
    v_mfma_f32_16x16x32_bf16 a[88:91], a[208:211], v[68:71], a[88:91]
    v_rcp_f16 v33, v32
    v_mfma_f32_16x16x32_bf16 a[136:139], a[208:211], v[72:75], a[136:139]
    s_waitcnt lgkmcnt(7)
    v_rcp_f16 v35, v34
    v_rcp_f16_sdwa v33, v32 dst_sel:WORD_1 dst_unused:UNUSED_PRESERVE src0_sel:WORD_1
    v_mfma_f32_16x16x32_bf16 a[44:47], a[212:215], v[64:67], a[44:47]
    ds_read_b64_tr_b16 a[204:205], v2 offset:12288
    ds_read_b64_tr_b16 a[206:207], v2 offset:14336
    v_mfma_f32_16x16x32_bf16 a[92:95], a[212:215], v[68:71], a[92:95]
    s_mov_b32 s33, s38
    v_rcp_f16_sdwa v35, v34 dst_sel:WORD_1 dst_unused:UNUSED_PRESERVE src0_sel:WORD_1
    v_fma_mix_f32 v32, v96, v33, 0 op_sel_hi:[0,1,0]
    v_fma_mix_f32 v34, v98, v35, 0 op_sel_hi:[0,1,0]
    v_fma_mix_f32 v33, v97, v33, 0 op_sel:[0,1,0] op_sel_hi:[0,1,0]
    v_mfma_f32_16x16x32_bf16 a[140:143], a[212:215], v[72:75], a[140:143]
    s_waitcnt lgkmcnt(6)
    v_fma_mix_f32 v35, v99, v35, 0 op_sel:[0,1,0] op_sel_hi:[0,1,0]
    v_cvt_pk_bf16_f32 v62, v32, v33
    v_cvt_pk_bf16_f32 v63, v34, v35
    s_waitcnt vmcnt(0)
    s_barrier
    v_mfma_f32_16x16x32_bf16 v[76:79], a[192:195], v[160:163], v[20:23]
    s_add_u32 m0, s45, 0
    ds_read_b64_tr_b16 a[208:209], v2 offset:16384
    ds_read_b64_tr_b16 a[210:211], v2 offset:18432
    v_cvt_pk_f16_f32 v28, v100, v101
    v_cvt_pk_f16_f32 v30, v102, v103
    v_mfma_f32_16x16x32_bf16 v[84:87], a[192:195], v[184:187], v[20:23]
    s_add_u32 s47, s35, 0
    buffer_load_dwordx4 v14, s[12:15], s47 offen lds
    v_pk_fma_f16 v29, v28, v28, s32
    v_mfma_f32_16x16x32_bf16 v[92:95], a[192:195], v[208:211], v[20:23]
    s_waitcnt lgkmcnt(6)
    v_pk_fma_f16 v31, v30, v30, s32
    v_pk_mul_f16 v28, v28, v29 neg_lo:[1,0] neg_hi:[1,0]
    v_pk_mul_f16 v30, v30, v31 neg_lo:[1,0] neg_hi:[1,0]
    v_mfma_f32_16x16x32_bf16 v[76:79], a[196:199], v[164:167], v[76:79]
    s_add_u32 m0, s45, 1024
    ds_read_b64_tr_b16 a[212:213], v2 offset:20480
    ds_read_b64_tr_b16 a[214:215], v2 offset:22528
    v_add_u32 v2, s33, v2
    v_mfma_f32_16x16x32_bf16 v[84:87], a[196:199], v[188:191], v[84:87]
    s_add_u32 s47, s35, 12288
    buffer_load_dwordx4 v14, s[12:15], s47 offen lds
    v_exp_f16 v29, v28
    v_mfma_f32_16x16x32_bf16 v[92:95], a[196:199], v[212:215], v[92:95]
    s_waitcnt lgkmcnt(6)
    v_exp_f16 v31, v30
    v_exp_f16_sdwa v29, v28 dst_sel:WORD_1 dst_unused:UNUSED_PRESERVE src0_sel:WORD_1
    v_mfma_f32_16x16x32_bf16 v[76:79], a[200:203], v[168:171], v[76:79]
    s_add_u32 m0, s45, 2048
    ds_read_b128 v[24:27], v11
    ds_read_b64_tr_b16 a[192:193], v3 offset:0
    ds_read_b64_tr_b16 a[194:195], v3 offset:2048
    v_add_u32 v11, 0x100, v11
    v_mfma_f32_16x16x32_bf16 v[84:87], a[200:203], v[192:195], v[84:87]
    s_add_u32 s47, s35, 24576
    buffer_load_dwordx4 v14, s[12:15], s47 offen lds
    v_mfma_f32_16x16x32_bf16 v[92:95], a[200:203], v[216:219], v[92:95]
    s_waitcnt lgkmcnt(7)
    v_exp_f16_sdwa v31, v30 dst_sel:WORD_1 dst_unused:UNUSED_PRESERVE src0_sel:WORD_1
    v_pk_add_f16 v28, v29, 1.0 op_sel_hi:[1,0]
    v_pk_add_f16 v30, v31, 1.0 op_sel_hi:[1,0]
    v_mfma_f32_16x16x32_bf16 v[76:79], a[204:207], v[172:175], v[76:79]
    s_add_u32 m0, s45, 3072
    ds_read_b64_tr_b16 a[196:197], v3 offset:4096
    ds_read_b64_tr_b16 a[198:199], v3 offset:6144
    v_rcp_f16 v29, v28
    v_mfma_f32_16x16x32_bf16 v[84:87], a[204:207], v[196:199], v[84:87]
    s_add_u32 s47, s35, 36864
    buffer_load_dwordx4 v14, s[12:15], s47 offen lds
    v_mfma_f32_16x16x32_bf16 v[92:95], a[204:207], v[220:223], v[92:95]
    s_waitcnt lgkmcnt(7)
    v_rcp_f16 v31, v30
    v_rcp_f16_sdwa v29, v28 dst_sel:WORD_1 dst_unused:UNUSED_PRESERVE src0_sel:WORD_1
    v_mfma_f32_16x16x32_bf16 v[76:79], a[208:211], v[176:179], v[76:79]
    s_add_u32 m0, s45, 4096
    ds_read_b64_tr_b16 a[200:201], v3 offset:8192
    ds_read_b64_tr_b16 a[202:203], v3 offset:10240
    v_rcp_f16_sdwa v31, v30 dst_sel:WORD_1 dst_unused:UNUSED_PRESERVE src0_sel:WORD_1
    v_mfma_f32_16x16x32_bf16 v[84:87], a[208:211], v[200:203], v[84:87]
    s_add_u32 s47, s35, 49152
    buffer_load_dwordx4 v14, s[12:15], s47 offen lds
    v_fma_mix_f32 v28, v100, v29, 0 op_sel_hi:[0,1,0]
    v_mfma_f32_16x16x32_bf16 v[92:95], a[208:211], v[224:227], v[92:95]
    s_waitcnt lgkmcnt(7)
    v_fma_mix_f32 v30, v102, v31, 0 op_sel_hi:[0,1,0]
    v_fma_mix_f32 v29, v101, v29, 0 op_sel:[0,1,0] op_sel_hi:[0,1,0]
    v_fma_mix_f32 v31, v103, v31, 0 op_sel:[0,1,0] op_sel_hi:[0,1,0]
    v_cvt_pk_bf16_f32 v64, v28, v29
    v_mfma_f32_16x16x32_bf16 v[76:79], a[212:215], v[180:183], v[76:79]
    s_add_u32 m0, s45, 5120
    ds_read_b64_tr_b16 a[204:205], v3 offset:12288
    ds_read_b64_tr_b16 a[206:207], v3 offset:14336
    v_cvt_pk_bf16_f32 v65, v30, v31
    v_mfma_f32_16x16x32_bf16 v[84:87], a[212:215], v[204:207], v[84:87]
    s_add_u32 s47, s35, 61440
    buffer_load_dwordx4 v14, s[12:15], s47 offen lds
    v_cvt_pk_f16_f32 v32, v104, v105
    v_mfma_f32_16x16x32_bf16 v[92:95], a[212:215], v[228:231], v[92:95]
    s_waitcnt lgkmcnt(6)
    v_cvt_pk_f16_f32 v34, v106, v107
    v_pk_fma_f16 v33, v32, v32, s32
    v_pk_fma_f16 v35, v34, v34, s32
    v_pk_mul_f16 v32, v32, v33 neg_lo:[1,0] neg_hi:[1,0]
    v_mfma_f32_16x16x32_bf16 v[80:83], a[192:195], v[160:163], v[24:27]
    s_add_u32 m0, s46, 0
    ds_read_b64_tr_b16 a[208:209], v3 offset:16384
    ds_read_b64_tr_b16 a[210:211], v3 offset:18432
    v_pk_mul_f16 v34, v34, v35 neg_lo:[1,0] neg_hi:[1,0]
    v_mfma_f32_16x16x32_bf16 v[88:91], a[192:195], v[184:187], v[24:27]
    s_add_u32 s47, s36, 0
    buffer_load_dwordx4 v15, s[16:19], s47 offen lds
    v_exp_f16 v33, v32
    v_mfma_f32_16x16x32_bf16 v[96:99], a[192:195], v[208:211], v[24:27]
    s_waitcnt lgkmcnt(6)
    v_exp_f16 v35, v34
    v_mfma_f32_16x16x32_bf16 v[80:83], a[196:199], v[164:167], v[80:83]
    s_add_u32 m0, s46, 1024
    ds_read_b64_tr_b16 a[212:213], v3 offset:20480
    ds_read_b64_tr_b16 a[214:215], v3 offset:22528
    v_add_u32 v3, s33, v3
    v_exp_f16_sdwa v33, v32 dst_sel:WORD_1 dst_unused:UNUSED_PRESERVE src0_sel:WORD_1
    v_mfma_f32_16x16x32_bf16 v[88:91], a[196:199], v[188:191], v[88:91]
    s_add_u32 s47, s36, 128
    buffer_load_dwordx4 v15, s[16:19], s47 offen lds
    v_mfma_f32_16x16x32_bf16 v[96:99], a[196:199], v[212:215], v[96:99]
    s_waitcnt lgkmcnt(6)
    v_exp_f16_sdwa v35, v34 dst_sel:WORD_1 dst_unused:UNUSED_PRESERVE src0_sel:WORD_1
    v_pk_add_f16 v32, v33, 1.0 op_sel_hi:[1,0]
    v_pk_add_f16 v34, v35, 1.0 op_sel_hi:[1,0]
    v_mfma_f32_16x16x32_bf16 v[80:83], a[200:203], v[168:171], v[80:83]
    s_add_u32 m0, s46, 2048
    ds_read_b64_tr_b16 a[192:193], v6 offset:0
    ds_read_b64_tr_b16 a[194:195], v7 offset:0
    v_rcp_f16 v33, v32
    v_mfma_f32_16x16x32_bf16 v[88:91], a[200:203], v[192:195], v[88:91]
    s_add_u32 s47, s36, 256
    buffer_load_dwordx4 v15, s[16:19], s47 offen lds
    v_mfma_f32_16x16x32_bf16 v[96:99], a[200:203], v[216:219], v[96:99]
    s_waitcnt lgkmcnt(6)
    v_rcp_f16 v35, v34
    v_rcp_f16_sdwa v33, v32 dst_sel:WORD_1 dst_unused:UNUSED_PRESERVE src0_sel:WORD_1
    v_mfma_f32_16x16x32_bf16 v[80:83], a[204:207], v[172:175], v[80:83]
    s_add_u32 m0, s46, 3080
    ds_read_b64_tr_b16 a[196:197], v6 offset:8
    ds_read_b64_tr_b16 a[198:199], v7 offset:8
    v_rcp_f16_sdwa v35, v34 dst_sel:WORD_1 dst_unused:UNUSED_PRESERVE src0_sel:WORD_1
    v_fma_mix_f32 v32, v104, v33, 0 op_sel_hi:[0,1,0]
    v_mfma_f32_16x16x32_bf16 v[88:91], a[204:207], v[196:199], v[88:91]
    s_add_u32 s47, s36, 1536
    buffer_load_dwordx4 v15, s[16:19], s47 offen lds
    v_fma_mix_f32 v34, v106, v35, 0 op_sel_hi:[0,1,0]
    v_mfma_f32_16x16x32_bf16 v[96:99], a[204:207], v[220:223], v[96:99]
    s_waitcnt lgkmcnt(6)
    v_fma_mix_f32 v33, v105, v33, 0 op_sel:[0,1,0] op_sel_hi:[0,1,0]
    v_fma_mix_f32 v35, v107, v35, 0 op_sel:[0,1,0] op_sel_hi:[0,1,0]
    v_cvt_pk_bf16_f32 v66, v32, v33
    v_mfma_f32_16x16x32_bf16 v[80:83], a[208:211], v[176:179], v[80:83]
    s_add_u32 m0, s46, 4104
    ds_read_b64_tr_b16 a[200:201], v6 offset:512
    ds_read_b64_tr_b16 a[202:203], v7 offset:512
    v_cvt_pk_bf16_f32 v67, v34, v35
    v_cvt_pk_f16_f32 v28, v108, v109
    v_mfma_f32_16x16x32_bf16 v[88:91], a[208:211], v[200:203], v[88:91]
    s_add_u32 s47, s36, 1664
    buffer_load_dwordx4 v15, s[16:19], s47 offen lds
    v_cvt_pk_f16_f32 v30, v110, v111
    v_mfma_f32_16x16x32_bf16 v[96:99], a[208:211], v[224:227], v[96:99]
    s_waitcnt lgkmcnt(6)
    v_pk_fma_f16 v29, v28, v28, s32
    v_pk_fma_f16 v31, v30, v30, s32
    v_pk_mul_f16 v28, v28, v29 neg_lo:[1,0] neg_hi:[1,0]
    v_pk_mul_f16 v30, v30, v31 neg_lo:[1,0] neg_hi:[1,0]
    v_mfma_f32_16x16x32_bf16 v[80:83], a[212:215], v[180:183], v[80:83]
    s_add_u32 m0, s46, 5128
    ds_read_b64_tr_b16 a[204:205], v6 offset:520
    ds_read_b64_tr_b16 a[206:207], v7 offset:520
    v_mfma_f32_16x16x32_bf16 v[88:91], a[212:215], v[204:207], v[88:91]
    s_add_u32 s47, s36, 1792
    buffer_load_dwordx4 v15, s[16:19], s47 offen lds
    v_exp_f16 v29, v28
    v_mfma_f32_16x16x32_bf16 v[96:99], a[212:215], v[228:231], v[96:99]
    s_waitcnt lgkmcnt(6)
    v_exp_f16 v31, v30
    v_exp_f16_sdwa v29, v28 dst_sel:WORD_1 dst_unused:UNUSED_PRESERVE src0_sel:WORD_1
    v_mfma_f32_16x16x32_bf16 a[0:3], a[192:195], v[52:55], a[0:3]
    ds_read_b64_tr_b16 a[208:209], v6 offset:1024
    ds_read_b64_tr_b16 a[210:211], v7 offset:1024
    v_exp_f16_sdwa v31, v30 dst_sel:WORD_1 dst_unused:UNUSED_PRESERVE src0_sel:WORD_1
    v_mfma_f32_16x16x32_bf16 a[48:51], a[192:195], v[56:59], a[48:51]
    v_pk_add_f16 v28, v29, 1.0 op_sel_hi:[1,0]
    v_pk_add_f16 v30, v31, 1.0 op_sel_hi:[1,0]
    v_rcp_f16 v29, v28
    v_mfma_f32_16x16x32_bf16 a[96:99], a[192:195], v[60:63], a[96:99]
    s_waitcnt lgkmcnt(6)
    v_rcp_f16 v31, v30
    v_mfma_f32_16x16x32_bf16 a[4:7], a[196:199], v[52:55], a[4:7]
    ds_read_b64_tr_b16 a[212:213], v6 offset:1032
    ds_read_b64_tr_b16 a[214:215], v7 offset:1032
    v_rcp_f16_sdwa v29, v28 dst_sel:WORD_1 dst_unused:UNUSED_PRESERVE src0_sel:WORD_1
    v_mfma_f32_16x16x32_bf16 a[52:55], a[196:199], v[56:59], a[52:55]
    v_rcp_f16_sdwa v31, v30 dst_sel:WORD_1 dst_unused:UNUSED_PRESERVE src0_sel:WORD_1
    v_fma_mix_f32 v28, v108, v29, 0 op_sel_hi:[0,1,0]
    v_fma_mix_f32 v30, v110, v31, 0 op_sel_hi:[0,1,0]
    v_fma_mix_f32 v29, v109, v29, 0 op_sel:[0,1,0] op_sel_hi:[0,1,0]
    v_mfma_f32_16x16x32_bf16 a[100:103], a[196:199], v[60:63], a[100:103]
    s_waitcnt lgkmcnt(6)
    v_fma_mix_f32 v31, v111, v31, 0 op_sel:[0,1,0] op_sel_hi:[0,1,0]
    v_cvt_pk_bf16_f32 v68, v28, v29
    v_cvt_pk_bf16_f32 v69, v30, v31
    v_cvt_pk_f16_f32 v32, v112, v113
    v_mfma_f32_16x16x32_bf16 a[8:11], a[200:203], v[52:55], a[8:11]
    ds_read_b64_tr_b16 a[192:193], v6 offset:1536
    ds_read_b64_tr_b16 a[194:195], v7 offset:1536
    v_cvt_pk_f16_f32 v34, v114, v115
    v_mfma_f32_16x16x32_bf16 a[56:59], a[200:203], v[56:59], a[56:59]
    v_pk_fma_f16 v33, v32, v32, s32
    v_pk_fma_f16 v35, v34, v34, s32
    v_pk_mul_f16 v32, v32, v33 neg_lo:[1,0] neg_hi:[1,0]
    v_pk_mul_f16 v34, v34, v35 neg_lo:[1,0] neg_hi:[1,0]
    v_mfma_f32_16x16x32_bf16 a[104:107], a[200:203], v[60:63], a[104:107]
    s_waitcnt lgkmcnt(6)
    v_exp_f16 v33, v32
    v_exp_f16 v35, v34
    v_mfma_f32_16x16x32_bf16 a[12:15], a[204:207], v[52:55], a[12:15]
    ds_read_b64_tr_b16 a[196:197], v6 offset:1544
    ds_read_b64_tr_b16 a[198:199], v7 offset:1544
    v_exp_f16_sdwa v33, v32 dst_sel:WORD_1 dst_unused:UNUSED_PRESERVE src0_sel:WORD_1
    v_mfma_f32_16x16x32_bf16 a[60:63], a[204:207], v[56:59], a[60:63]
    v_exp_f16_sdwa v35, v34 dst_sel:WORD_1 dst_unused:UNUSED_PRESERVE src0_sel:WORD_1
    v_pk_add_f16 v32, v33, 1.0 op_sel_hi:[1,0]
    v_pk_add_f16 v34, v35, 1.0 op_sel_hi:[1,0]
    v_mfma_f32_16x16x32_bf16 a[108:111], a[204:207], v[60:63], a[108:111]
    s_waitcnt lgkmcnt(6)
    v_rcp_f16 v33, v32
    v_mfma_f32_16x16x32_bf16 a[16:19], a[208:211], v[52:55], a[16:19]
    ds_read_b64_tr_b16 a[200:201], v6 offset:2048
    ds_read_b64_tr_b16 a[202:203], v7 offset:2048
    v_rcp_f16 v35, v34
    v_mfma_f32_16x16x32_bf16 a[64:67], a[208:211], v[56:59], a[64:67]
    v_rcp_f16_sdwa v33, v32 dst_sel:WORD_1 dst_unused:UNUSED_PRESERVE src0_sel:WORD_1
    v_rcp_f16_sdwa v35, v34 dst_sel:WORD_1 dst_unused:UNUSED_PRESERVE src0_sel:WORD_1
    v_fma_mix_f32 v32, v112, v33, 0 op_sel_hi:[0,1,0]
    v_mfma_f32_16x16x32_bf16 a[112:115], a[208:211], v[60:63], a[112:115]
    s_waitcnt lgkmcnt(6)
    v_fma_mix_f32 v34, v114, v35, 0 op_sel_hi:[0,1,0]
    v_fma_mix_f32 v33, v113, v33, 0 op_sel:[0,1,0] op_sel_hi:[0,1,0]
    v_fma_mix_f32 v35, v115, v35, 0 op_sel:[0,1,0] op_sel_hi:[0,1,0]
    v_cvt_pk_bf16_f32 v70, v32, v33
    v_mfma_f32_16x16x32_bf16 a[20:23], a[212:215], v[52:55], a[20:23]
    ds_read_b64_tr_b16 a[204:205], v6 offset:2056
    ds_read_b64_tr_b16 a[206:207], v7 offset:2056
    v_cvt_pk_bf16_f32 v71, v34, v35
    v_mfma_f32_16x16x32_bf16 a[68:71], a[212:215], v[56:59], a[68:71]
    v_cvt_pk_f16_f32 v28, v116, v117
    v_cvt_pk_f16_f32 v30, v118, v119
    v_pk_fma_f16 v29, v28, v28, s32
    v_pk_fma_f16 v31, v30, v30, s32
    v_mfma_f32_16x16x32_bf16 a[116:119], a[212:215], v[60:63], a[116:119]
    s_waitcnt lgkmcnt(6)
    v_pk_mul_f16 v28, v28, v29 neg_lo:[1,0] neg_hi:[1,0]
    v_pk_mul_f16 v30, v30, v31 neg_lo:[1,0] neg_hi:[1,0]
    v_exp_f16 v29, v28
    v_mfma_f32_16x16x32_bf16 a[24:27], a[192:195], v[52:55], a[24:27]
    ds_read_b64_tr_b16 a[208:209], v6 offset:2560
    ds_read_b64_tr_b16 a[210:211], v7 offset:2560
    v_exp_f16 v31, v30
    v_mfma_f32_16x16x32_bf16 a[72:75], a[192:195], v[56:59], a[72:75]
    v_exp_f16_sdwa v29, v28 dst_sel:WORD_1 dst_unused:UNUSED_PRESERVE src0_sel:WORD_1
    v_exp_f16_sdwa v31, v30 dst_sel:WORD_1 dst_unused:UNUSED_PRESERVE src0_sel:WORD_1
    v_mfma_f32_16x16x32_bf16 a[120:123], a[192:195], v[60:63], a[120:123]
    s_waitcnt lgkmcnt(6)
    v_pk_add_f16 v28, v29, 1.0 op_sel_hi:[1,0]
    v_pk_add_f16 v30, v31, 1.0 op_sel_hi:[1,0]
    v_mfma_f32_16x16x32_bf16 a[28:31], a[196:199], v[52:55], a[28:31]
    ds_read_b64_tr_b16 a[212:213], v6 offset:2568
    ds_read_b64_tr_b16 a[214:215], v7 offset:2568
    v_add_u32 v6, s33, v6
    v_add_u32 v7, s33, v7
    v_mfma_f32_16x16x32_bf16 a[76:79], a[196:199], v[56:59], a[76:79]
    v_rcp_f16 v29, v28
    v_rcp_f16 v31, v30
    v_mfma_f32_16x16x32_bf16 a[124:127], a[196:199], v[60:63], a[124:127]
    s_waitcnt lgkmcnt(6)
    v_rcp_f16_sdwa v29, v28 dst_sel:WORD_1 dst_unused:UNUSED_PRESERVE src0_sel:WORD_1
    v_rcp_f16_sdwa v31, v30 dst_sel:WORD_1 dst_unused:UNUSED_PRESERVE src0_sel:WORD_1
    v_fma_mix_f32 v28, v116, v29, 0 op_sel_hi:[0,1,0]
    v_mfma_f32_16x16x32_bf16 a[32:35], a[200:203], v[52:55], a[32:35]
    ds_read_b128 v[20:23], v12
    ds_read_b64_tr_b16 a[192:193], v4 offset:0
    ds_read_b64_tr_b16 a[194:195], v4 offset:2048
    v_add_u32 v12, 0x100, v12
    v_mfma_f32_16x16x32_bf16 a[80:83], a[200:203], v[56:59], a[80:83]
    v_fma_mix_f32 v30, v118, v31, 0 op_sel_hi:[0,1,0]
    v_fma_mix_f32 v29, v117, v29, 0 op_sel:[0,1,0] op_sel_hi:[0,1,0]
    v_fma_mix_f32 v31, v119, v31, 0 op_sel:[0,1,0] op_sel_hi:[0,1,0]
    v_mfma_f32_16x16x32_bf16 a[128:131], a[200:203], v[60:63], a[128:131]
    s_waitcnt lgkmcnt(7)
    v_cvt_pk_bf16_f32 v72, v28, v29
    v_cvt_pk_bf16_f32 v73, v30, v31
    v_cvt_pk_f16_f32 v32, v120, v121
    v_cvt_pk_f16_f32 v34, v122, v123
    v_mfma_f32_16x16x32_bf16 a[36:39], a[204:207], v[52:55], a[36:39]
    ds_read_b64_tr_b16 a[196:197], v4 offset:4096
    ds_read_b64_tr_b16 a[198:199], v4 offset:6144
    v_pk_fma_f16 v33, v32, v32, s32
    v_pk_fma_f16 v35, v34, v34, s32
    v_mfma_f32_16x16x32_bf16 a[84:87], a[204:207], v[56:59], a[84:87]
    v_pk_mul_f16 v32, v32, v33 neg_lo:[1,0] neg_hi:[1,0]
    v_pk_mul_f16 v34, v34, v35 neg_lo:[1,0] neg_hi:[1,0]
    v_exp_f16 v33, v32
    v_mfma_f32_16x16x32_bf16 a[132:135], a[204:207], v[60:63], a[132:135]
    s_waitcnt lgkmcnt(7)
    v_exp_f16 v35, v34
    v_mfma_f32_16x16x32_bf16 a[40:43], a[208:211], v[52:55], a[40:43]
    ds_read_b64_tr_b16 a[200:201], v4 offset:8192
    ds_read_b64_tr_b16 a[202:203], v4 offset:10240
    v_exp_f16_sdwa v33, v32 dst_sel:WORD_1 dst_unused:UNUSED_PRESERVE src0_sel:WORD_1
    v_mfma_f32_16x16x32_bf16 a[88:91], a[208:211], v[56:59], a[88:91]
    v_exp_f16_sdwa v35, v34 dst_sel:WORD_1 dst_unused:UNUSED_PRESERVE src0_sel:WORD_1
    v_pk_add_f16 v32, v33, 1.0 op_sel_hi:[1,0]
    v_pk_add_f16 v34, v35, 1.0 op_sel_hi:[1,0]
    v_mfma_f32_16x16x32_bf16 a[136:139], a[208:211], v[60:63], a[136:139]
    s_waitcnt lgkmcnt(7)
    v_rcp_f16 v33, v32
    v_rcp_f16 v35, v34
    v_mfma_f32_16x16x32_bf16 a[44:47], a[212:215], v[52:55], a[44:47]
    ds_read_b64_tr_b16 a[204:205], v4 offset:12288
    ds_read_b64_tr_b16 a[206:207], v4 offset:14336
    v_rcp_f16_sdwa v33, v32 dst_sel:WORD_1 dst_unused:UNUSED_PRESERVE src0_sel:WORD_1
    v_mfma_f32_16x16x32_bf16 a[92:95], a[212:215], v[56:59], a[92:95]
    v_rcp_f16_sdwa v35, v34 dst_sel:WORD_1 dst_unused:UNUSED_PRESERVE src0_sel:WORD_1
    v_fma_mix_f32 v32, v120, v33, 0 op_sel_hi:[0,1,0]
    v_fma_mix_f32 v34, v122, v35, 0 op_sel_hi:[0,1,0]
    v_mfma_f32_16x16x32_bf16 a[140:143], a[212:215], v[60:63], a[140:143]
    s_waitcnt lgkmcnt(6)
    v_fma_mix_f32 v33, v121, v33, 0 op_sel:[0,1,0] op_sel_hi:[0,1,0]
    v_fma_mix_f32 v35, v123, v35, 0 op_sel:[0,1,0] op_sel_hi:[0,1,0]
    v_cvt_pk_bf16_f32 v74, v32, v33
    v_cvt_pk_bf16_f32 v75, v34, v35
    v_mfma_f32_16x16x32_bf16 v[100:103], a[192:195], v[160:163], v[20:23]
    s_add_u32 s45, s45, s49
    ds_read_b64_tr_b16 a[208:209], v4 offset:16384
    ds_read_b64_tr_b16 a[210:211], v4 offset:18432
    v_cvt_pk_f16_f32 v28, v76, v77
    v_mfma_f32_16x16x32_bf16 v[108:111], a[192:195], v[184:187], v[20:23]
    v_cvt_pk_f16_f32 v30, v78, v79
    v_pk_fma_f16 v29, v28, v28, s32
    v_pk_fma_f16 v31, v30, v30, s32
    v_pk_mul_f16 v28, v28, v29 neg_lo:[1,0] neg_hi:[1,0]
    v_mfma_f32_16x16x32_bf16 v[116:119], a[192:195], v[208:211], v[20:23]
    s_waitcnt lgkmcnt(6)
    v_pk_mul_f16 v30, v30, v31 neg_lo:[1,0] neg_hi:[1,0]
    v_exp_f16 v29, v28
    v_mfma_f32_16x16x32_bf16 v[100:103], a[196:199], v[164:167], v[100:103]
    s_add_u32 s46, s46, s49
    ds_read_b64_tr_b16 a[212:213], v4 offset:20480
    ds_read_b64_tr_b16 a[214:215], v4 offset:22528
    v_add_u32 v4, s33, v4
    v_mfma_f32_16x16x32_bf16 v[108:111], a[196:199], v[188:191], v[108:111]
    v_exp_f16 v31, v30
    v_mfma_f32_16x16x32_bf16 v[116:119], a[196:199], v[212:215], v[116:119]
    s_waitcnt lgkmcnt(6)
    v_exp_f16_sdwa v29, v28 dst_sel:WORD_1 dst_unused:UNUSED_PRESERVE src0_sel:WORD_1
    v_exp_f16_sdwa v31, v30 dst_sel:WORD_1 dst_unused:UNUSED_PRESERVE src0_sel:WORD_1
    v_pk_add_f16 v28, v29, 1.0 op_sel_hi:[1,0]
    v_mfma_f32_16x16x32_bf16 v[100:103], a[200:203], v[168:171], v[100:103]
    s_add_u32 s35, s35, 128
    ds_read_b128 v[24:27], v13
    ds_read_b64_tr_b16 a[192:193], v5 offset:0
    ds_read_b64_tr_b16 a[194:195], v5 offset:2048
    v_add_u32 v13, 0x100, v13
    v_mfma_f32_16x16x32_bf16 v[108:111], a[200:203], v[192:195], v[108:111]
    v_pk_add_f16 v30, v31, 1.0 op_sel_hi:[1,0]
    v_rcp_f16 v29, v28
    v_mfma_f32_16x16x32_bf16 v[116:119], a[200:203], v[216:219], v[116:119]
    s_waitcnt lgkmcnt(7)
    v_rcp_f16 v31, v30
    v_mfma_f32_16x16x32_bf16 v[100:103], a[204:207], v[172:175], v[100:103]
    s_add_u32 s36, s36, 24576
    ds_read_b64_tr_b16 a[196:197], v5 offset:4096
    ds_read_b64_tr_b16 a[198:199], v5 offset:6144
    v_rcp_f16_sdwa v29, v28 dst_sel:WORD_1 dst_unused:UNUSED_PRESERVE src0_sel:WORD_1
    v_mfma_f32_16x16x32_bf16 v[108:111], a[204:207], v[196:199], v[108:111]
    v_rcp_f16_sdwa v31, v30 dst_sel:WORD_1 dst_unused:UNUSED_PRESERVE src0_sel:WORD_1
    v_fma_mix_f32 v28, v76, v29, 0 op_sel_hi:[0,1,0]
    v_mfma_f32_16x16x32_bf16 v[116:119], a[204:207], v[220:223], v[116:119]
    s_waitcnt lgkmcnt(7)
    v_fma_mix_f32 v30, v78, v31, 0 op_sel_hi:[0,1,0]
    v_fma_mix_f32 v29, v77, v29, 0 op_sel:[0,1,0] op_sel_hi:[0,1,0]
    v_fma_mix_f32 v31, v79, v31, 0 op_sel:[0,1,0] op_sel_hi:[0,1,0]
    v_mfma_f32_16x16x32_bf16 v[100:103], a[208:211], v[176:179], v[100:103]
    s_mov_b32 s38, s48
    ds_read_b64_tr_b16 a[200:201], v5 offset:8192
    ds_read_b64_tr_b16 a[202:203], v5 offset:10240
    v_cvt_pk_bf16_f32 v52, v28, v29
    v_cvt_pk_bf16_f32 v53, v30, v31
    v_mfma_f32_16x16x32_bf16 v[108:111], a[208:211], v[200:203], v[108:111]
    v_cvt_pk_f16_f32 v32, v80, v81
    v_cvt_pk_f16_f32 v34, v82, v83
    v_pk_fma_f16 v33, v32, v32, s32
    v_mfma_f32_16x16x32_bf16 v[116:119], a[208:211], v[224:227], v[116:119]
    s_waitcnt lgkmcnt(7)
    v_pk_fma_f16 v35, v34, v34, s32
    v_pk_mul_f16 v32, v32, v33 neg_lo:[1,0] neg_hi:[1,0]
    v_pk_mul_f16 v34, v34, v35 neg_lo:[1,0] neg_hi:[1,0]
    v_mfma_f32_16x16x32_bf16 v[100:103], a[212:215], v[180:183], v[100:103]
    s_mov_b32 s48, s49
    ds_read_b64_tr_b16 a[204:205], v5 offset:12288
    ds_read_b64_tr_b16 a[206:207], v5 offset:14336
    v_mfma_f32_16x16x32_bf16 v[108:111], a[212:215], v[204:207], v[108:111]
    v_exp_f16 v33, v32
    v_exp_f16 v35, v34
    v_mfma_f32_16x16x32_bf16 v[116:119], a[212:215], v[228:231], v[116:119]
    s_waitcnt lgkmcnt(6)
    v_exp_f16_sdwa v33, v32 dst_sel:WORD_1 dst_unused:UNUSED_PRESERVE src0_sel:WORD_1
    v_exp_f16_sdwa v35, v34 dst_sel:WORD_1 dst_unused:UNUSED_PRESERVE src0_sel:WORD_1
    v_mfma_f32_16x16x32_bf16 v[104:107], a[192:195], v[160:163], v[24:27]
    s_mov_b32 s49, s33
    ds_read_b64_tr_b16 a[208:209], v5 offset:16384
    ds_read_b64_tr_b16 a[210:211], v5 offset:18432
    v_pk_add_f16 v32, v33, 1.0 op_sel_hi:[1,0]
    v_mfma_f32_16x16x32_bf16 v[112:115], a[192:195], v[184:187], v[24:27]
    v_pk_add_f16 v34, v35, 1.0 op_sel_hi:[1,0]
    v_rcp_f16 v33, v32
    v_mfma_f32_16x16x32_bf16 v[120:123], a[192:195], v[208:211], v[24:27]
    s_waitcnt lgkmcnt(6)
    v_rcp_f16 v35, v34
    v_rcp_f16_sdwa v33, v32 dst_sel:WORD_1 dst_unused:UNUSED_PRESERVE src0_sel:WORD_1
    v_mfma_f32_16x16x32_bf16 v[104:107], a[196:199], v[164:167], v[104:107]
    s_sub_u32 s37, s37, 1
    ds_read_b64_tr_b16 a[212:213], v5 offset:20480
    ds_read_b64_tr_b16 a[214:215], v5 offset:22528
    v_add_u32 v5, s33, v5
    v_mfma_f32_16x16x32_bf16 v[112:115], a[196:199], v[188:191], v[112:115]
    v_rcp_f16_sdwa v35, v34 dst_sel:WORD_1 dst_unused:UNUSED_PRESERVE src0_sel:WORD_1
    v_fma_mix_f32 v32, v80, v33, 0 op_sel_hi:[0,1,0]
    v_mfma_f32_16x16x32_bf16 v[120:123], a[196:199], v[212:215], v[120:123]
    s_waitcnt lgkmcnt(6)
    v_fma_mix_f32 v34, v82, v35, 0 op_sel_hi:[0,1,0]
    v_fma_mix_f32 v33, v81, v33, 0 op_sel:[0,1,0] op_sel_hi:[0,1,0]
    v_fma_mix_f32 v35, v83, v35, 0 op_sel:[0,1,0] op_sel_hi:[0,1,0]
    v_cvt_pk_bf16_f32 v54, v32, v33
    v_mfma_f32_16x16x32_bf16 v[104:107], a[200:203], v[168:171], v[104:107]
    s_cmp_lg_u32 s37, 0
    ds_read_b64_tr_b16 a[192:193], v8 offset:0
    ds_read_b64_tr_b16 a[194:195], v9 offset:0
    v_cvt_pk_bf16_f32 v55, v34, v35
    v_mfma_f32_16x16x32_bf16 v[112:115], a[200:203], v[192:195], v[112:115]
    v_cvt_pk_f16_f32 v28, v84, v85
    v_cvt_pk_f16_f32 v30, v86, v87
    v_pk_fma_f16 v29, v28, v28, s32
    v_mfma_f32_16x16x32_bf16 v[120:123], a[200:203], v[216:219], v[120:123]
    s_waitcnt lgkmcnt(6)
    v_pk_fma_f16 v31, v30, v30, s32
    v_pk_mul_f16 v28, v28, v29 neg_lo:[1,0] neg_hi:[1,0]
    v_pk_mul_f16 v30, v30, v31 neg_lo:[1,0] neg_hi:[1,0]
    v_mfma_f32_16x16x32_bf16 v[104:107], a[204:207], v[172:175], v[104:107]
    ds_read_b64_tr_b16 a[196:197], v8 offset:8
    ds_read_b64_tr_b16 a[198:199], v9 offset:8
    v_exp_f16 v29, v28
    v_mfma_f32_16x16x32_bf16 v[112:115], a[204:207], v[196:199], v[112:115]
    v_exp_f16 v31, v30
    v_mfma_f32_16x16x32_bf16 v[120:123], a[204:207], v[220:223], v[120:123]
    s_waitcnt lgkmcnt(6)
    v_exp_f16_sdwa v29, v28 dst_sel:WORD_1 dst_unused:UNUSED_PRESERVE src0_sel:WORD_1
    v_exp_f16_sdwa v31, v30 dst_sel:WORD_1 dst_unused:UNUSED_PRESERVE src0_sel:WORD_1
    v_mfma_f32_16x16x32_bf16 v[104:107], a[208:211], v[176:179], v[104:107]
    ds_read_b64_tr_b16 a[200:201], v8 offset:512
    ds_read_b64_tr_b16 a[202:203], v9 offset:512
    v_pk_add_f16 v28, v29, 1.0 op_sel_hi:[1,0]
    v_pk_add_f16 v30, v31, 1.0 op_sel_hi:[1,0]
    v_mfma_f32_16x16x32_bf16 v[112:115], a[208:211], v[200:203], v[112:115]
    v_rcp_f16 v29, v28
    v_mfma_f32_16x16x32_bf16 v[120:123], a[208:211], v[224:227], v[120:123]
    s_waitcnt lgkmcnt(6)
    v_rcp_f16 v31, v30
    v_rcp_f16_sdwa v29, v28 dst_sel:WORD_1 dst_unused:UNUSED_PRESERVE src0_sel:WORD_1
    v_mfma_f32_16x16x32_bf16 v[104:107], a[212:215], v[180:183], v[104:107]
    ds_read_b64_tr_b16 a[204:205], v8 offset:520
    ds_read_b64_tr_b16 a[206:207], v9 offset:520
    v_mfma_f32_16x16x32_bf16 v[112:115], a[212:215], v[204:207], v[112:115]
    v_rcp_f16_sdwa v31, v30 dst_sel:WORD_1 dst_unused:UNUSED_PRESERVE src0_sel:WORD_1
    v_fma_mix_f32 v28, v84, v29, 0 op_sel_hi:[0,1,0]
    v_fma_mix_f32 v30, v86, v31, 0 op_sel_hi:[0,1,0]
    v_fma_mix_f32 v29, v85, v29, 0 op_sel:[0,1,0] op_sel_hi:[0,1,0]
    v_mfma_f32_16x16x32_bf16 v[120:123], a[212:215], v[228:231], v[120:123]
    s_waitcnt lgkmcnt(6)
    v_fma_mix_f32 v31, v87, v31, 0 op_sel:[0,1,0] op_sel_hi:[0,1,0]
    v_cvt_pk_bf16_f32 v56, v28, v29
    v_cvt_pk_bf16_f32 v57, v30, v31
    v_mfma_f32_16x16x32_bf16 a[0:3], a[192:195], v[64:67], a[0:3]
    ds_read_b64_tr_b16 a[208:209], v8 offset:1024
    ds_read_b64_tr_b16 a[210:211], v9 offset:1024
    v_cvt_pk_f16_f32 v32, v88, v89
    v_mfma_f32_16x16x32_bf16 a[48:51], a[192:195], v[68:71], a[48:51]
    v_cvt_pk_f16_f32 v34, v90, v91
    v_pk_fma_f16 v33, v32, v32, s32
    v_pk_fma_f16 v35, v34, v34, s32
    v_pk_mul_f16 v32, v32, v33 neg_lo:[1,0] neg_hi:[1,0]
    v_mfma_f32_16x16x32_bf16 a[96:99], a[192:195], v[72:75], a[96:99]
    s_waitcnt lgkmcnt(6)
    v_pk_mul_f16 v34, v34, v35 neg_lo:[1,0] neg_hi:[1,0]
    v_exp_f16 v33, v32
    v_mfma_f32_16x16x32_bf16 a[4:7], a[196:199], v[64:67], a[4:7]
    ds_read_b64_tr_b16 a[212:213], v8 offset:1032
    ds_read_b64_tr_b16 a[214:215], v9 offset:1032
    v_mfma_f32_16x16x32_bf16 a[52:55], a[196:199], v[68:71], a[52:55]
    v_exp_f16 v35, v34
    v_exp_f16_sdwa v33, v32 dst_sel:WORD_1 dst_unused:UNUSED_PRESERVE src0_sel:WORD_1
    v_mfma_f32_16x16x32_bf16 a[100:103], a[196:199], v[72:75], a[100:103]
    s_waitcnt lgkmcnt(6)
    v_exp_f16_sdwa v35, v34 dst_sel:WORD_1 dst_unused:UNUSED_PRESERVE src0_sel:WORD_1
    v_pk_add_f16 v32, v33, 1.0 op_sel_hi:[1,0]
    v_pk_add_f16 v34, v35, 1.0 op_sel_hi:[1,0]
    v_mfma_f32_16x16x32_bf16 a[8:11], a[200:203], v[64:67], a[8:11]
    ds_read_b64_tr_b16 a[192:193], v8 offset:1536
    ds_read_b64_tr_b16 a[194:195], v9 offset:1536
    v_mfma_f32_16x16x32_bf16 a[56:59], a[200:203], v[68:71], a[56:59]
    v_rcp_f16 v33, v32
    v_rcp_f16 v35, v34
    v_mfma_f32_16x16x32_bf16 a[104:107], a[200:203], v[72:75], a[104:107]
    s_waitcnt lgkmcnt(6)
    v_rcp_f16_sdwa v33, v32 dst_sel:WORD_1 dst_unused:UNUSED_PRESERVE src0_sel:WORD_1
    v_rcp_f16_sdwa v35, v34 dst_sel:WORD_1 dst_unused:UNUSED_PRESERVE src0_sel:WORD_1
    v_mfma_f32_16x16x32_bf16 a[12:15], a[204:207], v[64:67], a[12:15]
    ds_read_b64_tr_b16 a[196:197], v8 offset:1544
    ds_read_b64_tr_b16 a[198:199], v9 offset:1544
    v_fma_mix_f32 v32, v88, v33, 0 op_sel_hi:[0,1,0]
    v_mfma_f32_16x16x32_bf16 a[60:63], a[204:207], v[68:71], a[60:63]
    v_fma_mix_f32 v34, v90, v35, 0 op_sel_hi:[0,1,0]
    v_fma_mix_f32 v33, v89, v33, 0 op_sel:[0,1,0] op_sel_hi:[0,1,0]
    v_fma_mix_f32 v35, v91, v35, 0 op_sel:[0,1,0] op_sel_hi:[0,1,0]
    v_mfma_f32_16x16x32_bf16 a[108:111], a[204:207], v[72:75], a[108:111]
    s_waitcnt lgkmcnt(6)
    v_cvt_pk_bf16_f32 v58, v32, v33
    v_cvt_pk_bf16_f32 v59, v34, v35
    v_cvt_pk_f16_f32 v28, v92, v93
    v_mfma_f32_16x16x32_bf16 a[16:19], a[208:211], v[64:67], a[16:19]
    ds_read_b64_tr_b16 a[200:201], v8 offset:2048
    ds_read_b64_tr_b16 a[202:203], v9 offset:2048
    v_cvt_pk_f16_f32 v30, v94, v95
    v_pk_fma_f16 v29, v28, v28, s32
    v_mfma_f32_16x16x32_bf16 a[64:67], a[208:211], v[68:71], a[64:67]
    v_pk_fma_f16 v31, v30, v30, s32
    v_pk_mul_f16 v28, v28, v29 neg_lo:[1,0] neg_hi:[1,0]
    v_pk_mul_f16 v30, v30, v31 neg_lo:[1,0] neg_hi:[1,0]
    v_mfma_f32_16x16x32_bf16 a[112:115], a[208:211], v[72:75], a[112:115]
    s_waitcnt lgkmcnt(6)
    v_exp_f16 v29, v28
    v_mfma_f32_16x16x32_bf16 a[20:23], a[212:215], v[64:67], a[20:23]
    ds_read_b64_tr_b16 a[204:205], v8 offset:2056
    ds_read_b64_tr_b16 a[206:207], v9 offset:2056
    v_exp_f16 v31, v30
    v_mfma_f32_16x16x32_bf16 a[68:71], a[212:215], v[68:71], a[68:71]
    v_exp_f16_sdwa v29, v28 dst_sel:WORD_1 dst_unused:UNUSED_PRESERVE src0_sel:WORD_1
    v_exp_f16_sdwa v31, v30 dst_sel:WORD_1 dst_unused:UNUSED_PRESERVE src0_sel:WORD_1
    v_mfma_f32_16x16x32_bf16 a[116:119], a[212:215], v[72:75], a[116:119]
    s_waitcnt lgkmcnt(6)
    v_pk_add_f16 v28, v29, 1.0 op_sel_hi:[1,0]
    v_pk_add_f16 v30, v31, 1.0 op_sel_hi:[1,0]
    v_mfma_f32_16x16x32_bf16 a[24:27], a[192:195], v[64:67], a[24:27]
    ds_read_b64_tr_b16 a[208:209], v8 offset:2560
    ds_read_b64_tr_b16 a[210:211], v9 offset:2560
    v_rcp_f16 v29, v28
    v_mfma_f32_16x16x32_bf16 a[72:75], a[192:195], v[68:71], a[72:75]
    v_rcp_f16 v31, v30
    v_rcp_f16_sdwa v29, v28 dst_sel:WORD_1 dst_unused:UNUSED_PRESERVE src0_sel:WORD_1
    v_mfma_f32_16x16x32_bf16 a[120:123], a[192:195], v[72:75], a[120:123]
    s_waitcnt lgkmcnt(6)
    v_rcp_f16_sdwa v31, v30 dst_sel:WORD_1 dst_unused:UNUSED_PRESERVE src0_sel:WORD_1
    v_fma_mix_f32 v28, v92, v29, 0 op_sel_hi:[0,1,0]
    v_mfma_f32_16x16x32_bf16 a[28:31], a[196:199], v[64:67], a[28:31]
    ds_read_b64_tr_b16 a[212:213], v8 offset:2568
    ds_read_b64_tr_b16 a[214:215], v9 offset:2568
    v_add_u32 v8, s33, v8
    v_add_u32 v9, s33, v9
    v_mfma_f32_16x16x32_bf16 a[76:79], a[196:199], v[68:71], a[76:79]
    v_fma_mix_f32 v30, v94, v31, 0 op_sel_hi:[0,1,0]
    v_fma_mix_f32 v29, v93, v29, 0 op_sel:[0,1,0] op_sel_hi:[0,1,0]
    v_mfma_f32_16x16x32_bf16 a[124:127], a[196:199], v[72:75], a[124:127]
    s_waitcnt lgkmcnt(6)
    v_fma_mix_f32 v31, v95, v31, 0 op_sel:[0,1,0] op_sel_hi:[0,1,0]
    v_cvt_pk_bf16_f32 v60, v28, v29
    v_cvt_pk_bf16_f32 v61, v30, v31
    v_cvt_pk_f16_f32 v32, v96, v97
    v_mfma_f32_16x16x32_bf16 a[32:35], a[200:203], v[64:67], a[32:35]
    ds_read_b128 v[20:23], v10
    ds_read_b64_tr_b16 a[192:193], v2 offset:0
    ds_read_b64_tr_b16 a[194:195], v2 offset:2048
    v_add_u32 v10, 0x100, v10
    v_mfma_f32_16x16x32_bf16 a[80:83], a[200:203], v[68:71], a[80:83]
    v_cvt_pk_f16_f32 v34, v98, v99
    v_pk_fma_f16 v33, v32, v32, s32
    v_mfma_f32_16x16x32_bf16 a[128:131], a[200:203], v[72:75], a[128:131]
    s_waitcnt lgkmcnt(7)
    v_pk_fma_f16 v35, v34, v34, s32
    v_pk_mul_f16 v32, v32, v33 neg_lo:[1,0] neg_hi:[1,0]
    v_pk_mul_f16 v34, v34, v35 neg_lo:[1,0] neg_hi:[1,0]
    v_mfma_f32_16x16x32_bf16 a[36:39], a[204:207], v[64:67], a[36:39]
    ds_read_b64_tr_b16 a[196:197], v2 offset:4096
    ds_read_b64_tr_b16 a[198:199], v2 offset:6144
    v_exp_f16 v33, v32
    v_mfma_f32_16x16x32_bf16 a[84:87], a[204:207], v[68:71], a[84:87]
    v_exp_f16 v35, v34
    v_mfma_f32_16x16x32_bf16 a[132:135], a[204:207], v[72:75], a[132:135]
    s_waitcnt lgkmcnt(7)
    v_exp_f16_sdwa v33, v32 dst_sel:WORD_1 dst_unused:UNUSED_PRESERVE src0_sel:WORD_1
    v_exp_f16_sdwa v35, v34 dst_sel:WORD_1 dst_unused:UNUSED_PRESERVE src0_sel:WORD_1
    v_mfma_f32_16x16x32_bf16 a[40:43], a[208:211], v[64:67], a[40:43]
    ds_read_b64_tr_b16 a[200:201], v2 offset:8192
    ds_read_b64_tr_b16 a[202:203], v2 offset:10240
    v_pk_add_f16 v32, v33, 1.0 op_sel_hi:[1,0]
    v_pk_add_f16 v34, v35, 1.0 op_sel_hi:[1,0]
    v_mfma_f32_16x16x32_bf16 a[88:91], a[208:211], v[68:71], a[88:91]
    v_rcp_f16 v33, v32
    v_mfma_f32_16x16x32_bf16 a[136:139], a[208:211], v[72:75], a[136:139]
    s_waitcnt lgkmcnt(7)
    v_rcp_f16 v35, v34
    v_rcp_f16_sdwa v33, v32 dst_sel:WORD_1 dst_unused:UNUSED_PRESERVE src0_sel:WORD_1
    v_mfma_f32_16x16x32_bf16 a[44:47], a[212:215], v[64:67], a[44:47]
    ds_read_b64_tr_b16 a[204:205], v2 offset:12288
    ds_read_b64_tr_b16 a[206:207], v2 offset:14336
    v_mfma_f32_16x16x32_bf16 a[92:95], a[212:215], v[68:71], a[92:95]
    s_mov_b32 s33, s38
    v_rcp_f16_sdwa v35, v34 dst_sel:WORD_1 dst_unused:UNUSED_PRESERVE src0_sel:WORD_1
    v_fma_mix_f32 v32, v96, v33, 0 op_sel_hi:[0,1,0]
    v_fma_mix_f32 v34, v98, v35, 0 op_sel_hi:[0,1,0]
    v_fma_mix_f32 v33, v97, v33, 0 op_sel:[0,1,0] op_sel_hi:[0,1,0]
    v_mfma_f32_16x16x32_bf16 a[140:143], a[212:215], v[72:75], a[140:143]
    s_waitcnt lgkmcnt(6)
    v_fma_mix_f32 v35, v99, v35, 0 op_sel:[0,1,0] op_sel_hi:[0,1,0]
    v_cvt_pk_bf16_f32 v62, v32, v33
    v_cvt_pk_bf16_f32 v63, v34, v35
    s_waitcnt vmcnt(0)
    s_barrier
    s_cbranch_scc1 L_loop_b0
    v_mfma_f32_16x16x32_bf16 v[76:79], a[192:195], v[160:163], v[20:23]
    s_add_u32 m0, s46, 0
    ds_read_b64_tr_b16 a[208:209], v2 offset:16384
    ds_read_b64_tr_b16 a[210:211], v2 offset:18432
    v_cvt_pk_f16_f32 v28, v100, v101
    v_cvt_pk_f16_f32 v30, v102, v103
    v_mfma_f32_16x16x32_bf16 v[84:87], a[192:195], v[184:187], v[20:23]
    s_add_u32 s47, s36, 0
    buffer_load_dwordx4 v15, s[16:19], s47 offen lds
    v_mfma_f32_16x16x32_bf16 v[92:95], a[192:195], v[208:211], v[20:23]
    s_waitcnt lgkmcnt(6)
    v_pk_fma_f16 v29, v28, v28, s32
    v_pk_fma_f16 v31, v30, v30, s32
    v_pk_mul_f16 v28, v28, v29 neg_lo:[1,0] neg_hi:[1,0]
    v_pk_mul_f16 v30, v30, v31 neg_lo:[1,0] neg_hi:[1,0]
    v_mfma_f32_16x16x32_bf16 v[76:79], a[196:199], v[164:167], v[76:79]
    s_add_u32 m0, s46, 1024
    ds_read_b64_tr_b16 a[212:213], v2 offset:20480
    ds_read_b64_tr_b16 a[214:215], v2 offset:22528
    v_add_u32 v2, s33, v2
    v_mfma_f32_16x16x32_bf16 v[84:87], a[196:199], v[188:191], v[84:87]
    s_add_u32 s47, s36, 128
    buffer_load_dwordx4 v15, s[16:19], s47 offen lds
    v_mfma_f32_16x16x32_bf16 v[92:95], a[196:199], v[212:215], v[92:95]
    s_waitcnt lgkmcnt(6)
    v_exp_f16 v29, v28
    v_exp_f16 v31, v30
    v_mfma_f32_16x16x32_bf16 v[76:79], a[200:203], v[168:171], v[76:79]
    s_add_u32 m0, s46, 2048
    ds_read_b128 v[24:27], v11
    ds_read_b64_tr_b16 a[192:193], v3 offset:0
    ds_read_b64_tr_b16 a[194:195], v3 offset:2048
    v_add_u32 v11, 0x100, v11
    v_mfma_f32_16x16x32_bf16 v[84:87], a[200:203], v[192:195], v[84:87]
    s_add_u32 s47, s36, 256
    buffer_load_dwordx4 v15, s[16:19], s47 offen lds
    v_mfma_f32_16x16x32_bf16 v[92:95], a[200:203], v[216:219], v[92:95]
    s_waitcnt lgkmcnt(7)
    v_exp_f16_sdwa v29, v28 dst_sel:WORD_1 dst_unused:UNUSED_PRESERVE src0_sel:WORD_1
    v_exp_f16_sdwa v31, v30 dst_sel:WORD_1 dst_unused:UNUSED_PRESERVE src0_sel:WORD_1
    v_mfma_f32_16x16x32_bf16 v[76:79], a[204:207], v[172:175], v[76:79]
    s_add_u32 m0, s46, 3080
    ds_read_b64_tr_b16 a[196:197], v3 offset:4096
    ds_read_b64_tr_b16 a[198:199], v3 offset:6144
    v_pk_add_f16 v28, v29, 1.0 op_sel_hi:[1,0]
    v_mfma_f32_16x16x32_bf16 v[84:87], a[204:207], v[196:199], v[84:87]
    s_add_u32 s47, s36, 1536
    buffer_load_dwordx4 v15, s[16:19], s47 offen lds
    v_pk_add_f16 v30, v31, 1.0 op_sel_hi:[1,0]
    v_mfma_f32_16x16x32_bf16 v[92:95], a[204:207], v[220:223], v[92:95]
    s_waitcnt lgkmcnt(7)
    v_rcp_f16 v29, v28
    v_mfma_f32_16x16x32_bf16 v[76:79], a[208:211], v[176:179], v[76:79]
    s_add_u32 m0, s46, 4104
    ds_read_b64_tr_b16 a[200:201], v3 offset:8192
    ds_read_b64_tr_b16 a[202:203], v3 offset:10240
    v_rcp_f16 v31, v30
    v_mfma_f32_16x16x32_bf16 v[84:87], a[208:211], v[200:203], v[84:87]
    s_add_u32 s47, s36, 1664
    buffer_load_dwordx4 v15, s[16:19], s47 offen lds
    v_mfma_f32_16x16x32_bf16 v[92:95], a[208:211], v[224:227], v[92:95]
    s_waitcnt lgkmcnt(7)
    v_rcp_f16_sdwa v29, v28 dst_sel:WORD_1 dst_unused:UNUSED_PRESERVE src0_sel:WORD_1
    v_rcp_f16_sdwa v31, v30 dst_sel:WORD_1 dst_unused:UNUSED_PRESERVE src0_sel:WORD_1
    v_fma_mix_f32 v28, v100, v29, 0 op_sel_hi:[0,1,0]
    v_mfma_f32_16x16x32_bf16 v[76:79], a[212:215], v[180:183], v[76:79]
    s_add_u32 m0, s46, 5128
    ds_read_b64_tr_b16 a[204:205], v3 offset:12288
    ds_read_b64_tr_b16 a[206:207], v3 offset:14336
    v_fma_mix_f32 v30, v102, v31, 0 op_sel_hi:[0,1,0]
    v_mfma_f32_16x16x32_bf16 v[84:87], a[212:215], v[204:207], v[84:87]
    s_add_u32 s47, s36, 1792
    buffer_load_dwordx4 v15, s[16:19], s47 offen lds
    v_fma_mix_f32 v29, v101, v29, 0 op_sel:[0,1,0] op_sel_hi:[0,1,0]
    v_mfma_f32_16x16x32_bf16 v[92:95], a[212:215], v[228:231], v[92:95]
    s_waitcnt lgkmcnt(6)
    v_fma_mix_f32 v31, v103, v31, 0 op_sel:[0,1,0] op_sel_hi:[0,1,0]
    v_cvt_pk_bf16_f32 v64, v28, v29
    v_cvt_pk_bf16_f32 v65, v30, v31
    v_cvt_pk_f16_f32 v32, v104, v105
    v_mfma_f32_16x16x32_bf16 v[80:83], a[192:195], v[160:163], v[24:27]
    ds_read_b64_tr_b16 a[208:209], v3 offset:16384
    ds_read_b64_tr_b16 a[210:211], v3 offset:18432
    v_cvt_pk_f16_f32 v34, v106, v107
    v_mfma_f32_16x16x32_bf16 v[88:91], a[192:195], v[184:187], v[24:27]
    v_pk_fma_f16 v33, v32, v32, s32
    v_pk_fma_f16 v35, v34, v34, s32
    v_pk_mul_f16 v32, v32, v33 neg_lo:[1,0] neg_hi:[1,0]
    v_pk_mul_f16 v34, v34, v35 neg_lo:[1,0] neg_hi:[1,0]
    v_mfma_f32_16x16x32_bf16 v[96:99], a[192:195], v[208:211], v[24:27]
    s_waitcnt lgkmcnt(6)
    v_exp_f16 v33, v32
    v_mfma_f32_16x16x32_bf16 v[80:83], a[196:199], v[164:167], v[80:83]
    ds_read_b64_tr_b16 a[212:213], v3 offset:20480
    ds_read_b64_tr_b16 a[214:215], v3 offset:22528
    v_add_u32 v3, s33, v3
    v_exp_f16 v35, v34
    v_mfma_f32_16x16x32_bf16 v[88:91], a[196:199], v[188:191], v[88:91]
    v_exp_f16_sdwa v33, v32 dst_sel:WORD_1 dst_unused:UNUSED_PRESERVE src0_sel:WORD_1
    v_mfma_f32_16x16x32_bf16 v[96:99], a[196:199], v[212:215], v[96:99]
    s_waitcnt lgkmcnt(6)
    v_exp_f16_sdwa v35, v34 dst_sel:WORD_1 dst_unused:UNUSED_PRESERVE src0_sel:WORD_1
    v_pk_add_f16 v32, v33, 1.0 op_sel_hi:[1,0]
    v_pk_add_f16 v34, v35, 1.0 op_sel_hi:[1,0]
    v_mfma_f32_16x16x32_bf16 v[80:83], a[200:203], v[168:171], v[80:83]
    ds_read_b64_tr_b16 a[192:193], v6 offset:0
    ds_read_b64_tr_b16 a[194:195], v7 offset:0
    v_rcp_f16 v33, v32
    v_mfma_f32_16x16x32_bf16 v[88:91], a[200:203], v[192:195], v[88:91]
    v_rcp_f16 v35, v34
    v_rcp_f16_sdwa v33, v32 dst_sel:WORD_1 dst_unused:UNUSED_PRESERVE src0_sel:WORD_1
    v_mfma_f32_16x16x32_bf16 v[96:99], a[200:203], v[216:219], v[96:99]
    s_waitcnt lgkmcnt(6)
    v_rcp_f16_sdwa v35, v34 dst_sel:WORD_1 dst_unused:UNUSED_PRESERVE src0_sel:WORD_1
    v_fma_mix_f32 v32, v104, v33, 0 op_sel_hi:[0,1,0]
    v_mfma_f32_16x16x32_bf16 v[80:83], a[204:207], v[172:175], v[80:83]
    ds_read_b64_tr_b16 a[196:197], v6 offset:8
    ds_read_b64_tr_b16 a[198:199], v7 offset:8
    v_fma_mix_f32 v34, v106, v35, 0 op_sel_hi:[0,1,0]
    v_fma_mix_f32 v33, v105, v33, 0 op_sel:[0,1,0] op_sel_hi:[0,1,0]
    v_mfma_f32_16x16x32_bf16 v[88:91], a[204:207], v[196:199], v[88:91]
    v_fma_mix_f32 v35, v107, v35, 0 op_sel:[0,1,0] op_sel_hi:[0,1,0]
    v_cvt_pk_bf16_f32 v66, v32, v33
    v_cvt_pk_bf16_f32 v67, v34, v35
    v_mfma_f32_16x16x32_bf16 v[96:99], a[204:207], v[220:223], v[96:99]
    s_waitcnt lgkmcnt(6)
    v_cvt_pk_f16_f32 v28, v108, v109
    v_cvt_pk_f16_f32 v30, v110, v111
    v_pk_fma_f16 v29, v28, v28, s32
    v_pk_fma_f16 v31, v30, v30, s32
    v_mfma_f32_16x16x32_bf16 v[80:83], a[208:211], v[176:179], v[80:83]
    ds_read_b64_tr_b16 a[200:201], v6 offset:512
    ds_read_b64_tr_b16 a[202:203], v7 offset:512
    v_pk_mul_f16 v28, v28, v29 neg_lo:[1,0] neg_hi:[1,0]
    v_mfma_f32_16x16x32_bf16 v[88:91], a[208:211], v[200:203], v[88:91]
    v_pk_mul_f16 v30, v30, v31 neg_lo:[1,0] neg_hi:[1,0]
    v_exp_f16 v29, v28
    v_mfma_f32_16x16x32_bf16 v[96:99], a[208:211], v[224:227], v[96:99]
    s_waitcnt lgkmcnt(6)
    v_exp_f16 v31, v30
    v_exp_f16_sdwa v29, v28 dst_sel:WORD_1 dst_unused:UNUSED_PRESERVE src0_sel:WORD_1
    v_mfma_f32_16x16x32_bf16 v[80:83], a[212:215], v[180:183], v[80:83]
    ds_read_b64_tr_b16 a[204:205], v6 offset:520
    ds_read_b64_tr_b16 a[206:207], v7 offset:520
    v_exp_f16_sdwa v31, v30 dst_sel:WORD_1 dst_unused:UNUSED_PRESERVE src0_sel:WORD_1
    v_mfma_f32_16x16x32_bf16 v[88:91], a[212:215], v[204:207], v[88:91]
    v_pk_add_f16 v28, v29, 1.0 op_sel_hi:[1,0]
    v_pk_add_f16 v30, v31, 1.0 op_sel_hi:[1,0]
    v_mfma_f32_16x16x32_bf16 v[96:99], a[212:215], v[228:231], v[96:99]
    s_waitcnt lgkmcnt(6)
    v_rcp_f16 v29, v28
    v_rcp_f16 v31, v30
    v_mfma_f32_16x16x32_bf16 a[0:3], a[192:195], v[52:55], a[0:3]
    ds_read_b64_tr_b16 a[208:209], v6 offset:1024
    ds_read_b64_tr_b16 a[210:211], v7 offset:1024
    v_rcp_f16_sdwa v29, v28 dst_sel:WORD_1 dst_unused:UNUSED_PRESERVE src0_sel:WORD_1
    v_mfma_f32_16x16x32_bf16 a[48:51], a[192:195], v[56:59], a[48:51]
    v_rcp_f16_sdwa v31, v30 dst_sel:WORD_1 dst_unused:UNUSED_PRESERVE src0_sel:WORD_1
    v_fma_mix_f32 v28, v108, v29, 0 op_sel_hi:[0,1,0]
    v_fma_mix_f32 v30, v110, v31, 0 op_sel_hi:[0,1,0]
    v_mfma_f32_16x16x32_bf16 a[96:99], a[192:195], v[60:63], a[96:99]
    s_waitcnt lgkmcnt(6)
    v_fma_mix_f32 v29, v109, v29, 0 op_sel:[0,1,0] op_sel_hi:[0,1,0]
    v_fma_mix_f32 v31, v111, v31, 0 op_sel:[0,1,0] op_sel_hi:[0,1,0]
    v_cvt_pk_bf16_f32 v68, v28, v29
    v_cvt_pk_bf16_f32 v69, v30, v31
    v_mfma_f32_16x16x32_bf16 a[4:7], a[196:199], v[52:55], a[4:7]
    ds_read_b64_tr_b16 a[212:213], v6 offset:1032
    ds_read_b64_tr_b16 a[214:215], v7 offset:1032
    v_cvt_pk_f16_f32 v32, v112, v113
    v_mfma_f32_16x16x32_bf16 a[52:55], a[196:199], v[56:59], a[52:55]
    v_cvt_pk_f16_f32 v34, v114, v115
    v_pk_fma_f16 v33, v32, v32, s32
    v_pk_fma_f16 v35, v34, v34, s32
    v_pk_mul_f16 v32, v32, v33 neg_lo:[1,0] neg_hi:[1,0]
    v_mfma_f32_16x16x32_bf16 a[100:103], a[196:199], v[60:63], a[100:103]
    s_waitcnt lgkmcnt(6)
    v_pk_mul_f16 v34, v34, v35 neg_lo:[1,0] neg_hi:[1,0]
    v_exp_f16 v33, v32
    v_mfma_f32_16x16x32_bf16 a[8:11], a[200:203], v[52:55], a[8:11]
    ds_read_b64_tr_b16 a[192:193], v6 offset:1536
    ds_read_b64_tr_b16 a[194:195], v7 offset:1536
    v_exp_f16 v35, v34
    v_mfma_f32_16x16x32_bf16 a[56:59], a[200:203], v[56:59], a[56:59]
    v_exp_f16_sdwa v33, v32 dst_sel:WORD_1 dst_unused:UNUSED_PRESERVE src0_sel:WORD_1
    v_mfma_f32_16x16x32_bf16 a[104:107], a[200:203], v[60:63], a[104:107]
    s_waitcnt lgkmcnt(6)
    v_exp_f16_sdwa v35, v34 dst_sel:WORD_1 dst_unused:UNUSED_PRESERVE src0_sel:WORD_1
    v_pk_add_f16 v32, v33, 1.0 op_sel_hi:[1,0]
    v_pk_add_f16 v34, v35, 1.0 op_sel_hi:[1,0]
    v_mfma_f32_16x16x32_bf16 a[12:15], a[204:207], v[52:55], a[12:15]
    ds_read_b64_tr_b16 a[196:197], v6 offset:1544
    ds_read_b64_tr_b16 a[198:199], v7 offset:1544
    v_rcp_f16 v33, v32
    v_mfma_f32_16x16x32_bf16 a[60:63], a[204:207], v[56:59], a[60:63]
    v_rcp_f16 v35, v34
    v_rcp_f16_sdwa v33, v32 dst_sel:WORD_1 dst_unused:UNUSED_PRESERVE src0_sel:WORD_1
    v_mfma_f32_16x16x32_bf16 a[108:111], a[204:207], v[60:63], a[108:111]
    s_waitcnt lgkmcnt(6)
    v_rcp_f16_sdwa v35, v34 dst_sel:WORD_1 dst_unused:UNUSED_PRESERVE src0_sel:WORD_1
    v_fma_mix_f32 v32, v112, v33, 0 op_sel_hi:[0,1,0]
    v_mfma_f32_16x16x32_bf16 a[16:19], a[208:211], v[52:55], a[16:19]
    ds_read_b64_tr_b16 a[200:201], v6 offset:2048
    ds_read_b64_tr_b16 a[202:203], v7 offset:2048
    v_fma_mix_f32 v34, v114, v35, 0 op_sel_hi:[0,1,0]
    v_fma_mix_f32 v33, v113, v33, 0 op_sel:[0,1,0] op_sel_hi:[0,1,0]
    v_mfma_f32_16x16x32_bf16 a[64:67], a[208:211], v[56:59], a[64:67]
    v_fma_mix_f32 v35, v115, v35, 0 op_sel:[0,1,0] op_sel_hi:[0,1,0]
    v_cvt_pk_bf16_f32 v70, v32, v33
    v_cvt_pk_bf16_f32 v71, v34, v35
    v_mfma_f32_16x16x32_bf16 a[112:115], a[208:211], v[60:63], a[112:115]
    s_waitcnt lgkmcnt(6)
    v_cvt_pk_f16_f32 v28, v116, v117
    v_cvt_pk_f16_f32 v30, v118, v119
    v_pk_fma_f16 v29, v28, v28, s32
    v_pk_fma_f16 v31, v30, v30, s32
    v_mfma_f32_16x16x32_bf16 a[20:23], a[212:215], v[52:55], a[20:23]
    ds_read_b64_tr_b16 a[204:205], v6 offset:2056
    ds_read_b64_tr_b16 a[206:207], v7 offset:2056
    v_pk_mul_f16 v28, v28, v29 neg_lo:[1,0] neg_hi:[1,0]
    v_mfma_f32_16x16x32_bf16 a[68:71], a[212:215], v[56:59], a[68:71]
    v_pk_mul_f16 v30, v30, v31 neg_lo:[1,0] neg_hi:[1,0]
    v_exp_f16 v29, v28
    v_mfma_f32_16x16x32_bf16 a[116:119], a[212:215], v[60:63], a[116:119]
    s_waitcnt lgkmcnt(6)
    v_exp_f16 v31, v30
    v_exp_f16_sdwa v29, v28 dst_sel:WORD_1 dst_unused:UNUSED_PRESERVE src0_sel:WORD_1
    v_mfma_f32_16x16x32_bf16 a[24:27], a[192:195], v[52:55], a[24:27]
    ds_read_b64_tr_b16 a[208:209], v6 offset:2560
    ds_read_b64_tr_b16 a[210:211], v7 offset:2560
    v_exp_f16_sdwa v31, v30 dst_sel:WORD_1 dst_unused:UNUSED_PRESERVE src0_sel:WORD_1
    v_mfma_f32_16x16x32_bf16 a[72:75], a[192:195], v[56:59], a[72:75]
    v_pk_add_f16 v28, v29, 1.0 op_sel_hi:[1,0]
    v_pk_add_f16 v30, v31, 1.0 op_sel_hi:[1,0]
    v_rcp_f16 v29, v28
    v_mfma_f32_16x16x32_bf16 a[120:123], a[192:195], v[60:63], a[120:123]
    s_waitcnt lgkmcnt(6)
    v_rcp_f16 v31, v30
    v_mfma_f32_16x16x32_bf16 a[28:31], a[196:199], v[52:55], a[28:31]
    ds_read_b64_tr_b16 a[212:213], v6 offset:2568
    ds_read_b64_tr_b16 a[214:215], v7 offset:2568
    v_add_u32 v6, s33, v6
    v_add_u32 v7, s33, v7
    v_mfma_f32_16x16x32_bf16 a[76:79], a[196:199], v[56:59], a[76:79]
    v_rcp_f16_sdwa v29, v28 dst_sel:WORD_1 dst_unused:UNUSED_PRESERVE src0_sel:WORD_1
    v_rcp_f16_sdwa v31, v30 dst_sel:WORD_1 dst_unused:UNUSED_PRESERVE src0_sel:WORD_1
    v_mfma_f32_16x16x32_bf16 a[124:127], a[196:199], v[60:63], a[124:127]
    s_waitcnt lgkmcnt(6)
    v_fma_mix_f32 v28, v116, v29, 0 op_sel_hi:[0,1,0]
    v_fma_mix_f32 v30, v118, v31, 0 op_sel_hi:[0,1,0]
    v_fma_mix_f32 v29, v117, v29, 0 op_sel:[0,1,0] op_sel_hi:[0,1,0]
    v_fma_mix_f32 v31, v119, v31, 0 op_sel:[0,1,0] op_sel_hi:[0,1,0]
    v_mfma_f32_16x16x32_bf16 a[32:35], a[200:203], v[52:55], a[32:35]
    ds_read_b128 v[20:23], v12
    ds_read_b64_tr_b16 a[192:193], v4 offset:0
    ds_read_b64_tr_b16 a[194:195], v4 offset:2048
    v_add_u32 v12, 0x100, v12
    v_mfma_f32_16x16x32_bf16 a[80:83], a[200:203], v[56:59], a[80:83]
    v_cvt_pk_bf16_f32 v72, v28, v29
    v_cvt_pk_bf16_f32 v73, v30, v31
    v_cvt_pk_f16_f32 v32, v120, v121
    v_mfma_f32_16x16x32_bf16 a[128:131], a[200:203], v[60:63], a[128:131]
    s_waitcnt lgkmcnt(7)
    v_cvt_pk_f16_f32 v34, v122, v123
    v_pk_fma_f16 v33, v32, v32, s32
    v_pk_fma_f16 v35, v34, v34, s32
    v_mfma_f32_16x16x32_bf16 a[36:39], a[204:207], v[52:55], a[36:39]
    ds_read_b64_tr_b16 a[196:197], v4 offset:4096
    ds_read_b64_tr_b16 a[198:199], v4 offset:6144
    v_pk_mul_f16 v32, v32, v33 neg_lo:[1,0] neg_hi:[1,0]
    v_pk_mul_f16 v34, v34, v35 neg_lo:[1,0] neg_hi:[1,0]
    v_mfma_f32_16x16x32_bf16 a[84:87], a[204:207], v[56:59], a[84:87]
    v_exp_f16 v33, v32
    v_mfma_f32_16x16x32_bf16 a[132:135], a[204:207], v[60:63], a[132:135]
    s_waitcnt lgkmcnt(7)
    v_exp_f16 v35, v34
    v_exp_f16_sdwa v33, v32 dst_sel:WORD_1 dst_unused:UNUSED_PRESERVE src0_sel:WORD_1
    v_mfma_f32_16x16x32_bf16 a[40:43], a[208:211], v[52:55], a[40:43]
    ds_read_b64_tr_b16 a[200:201], v4 offset:8192
    ds_read_b64_tr_b16 a[202:203], v4 offset:10240
    v_exp_f16_sdwa v35, v34 dst_sel:WORD_1 dst_unused:UNUSED_PRESERVE src0_sel:WORD_1
    v_mfma_f32_16x16x32_bf16 a[88:91], a[208:211], v[56:59], a[88:91]
    v_pk_add_f16 v32, v33, 1.0 op_sel_hi:[1,0]
    v_pk_add_f16 v34, v35, 1.0 op_sel_hi:[1,0]
    v_rcp_f16 v33, v32
    v_mfma_f32_16x16x32_bf16 a[136:139], a[208:211], v[60:63], a[136:139]
    s_waitcnt lgkmcnt(7)
    v_rcp_f16 v35, v34
    v_mfma_f32_16x16x32_bf16 a[44:47], a[212:215], v[52:55], a[44:47]
    ds_read_b64_tr_b16 a[204:205], v4 offset:12288
    ds_read_b64_tr_b16 a[206:207], v4 offset:14336
    v_rcp_f16_sdwa v33, v32 dst_sel:WORD_1 dst_unused:UNUSED_PRESERVE src0_sel:WORD_1
    v_mfma_f32_16x16x32_bf16 a[92:95], a[212:215], v[56:59], a[92:95]
    v_rcp_f16_sdwa v35, v34 dst_sel:WORD_1 dst_unused:UNUSED_PRESERVE src0_sel:WORD_1
    v_fma_mix_f32 v32, v120, v33, 0 op_sel_hi:[0,1,0]
    v_fma_mix_f32 v34, v122, v35, 0 op_sel_hi:[0,1,0]
    v_mfma_f32_16x16x32_bf16 a[140:143], a[212:215], v[60:63], a[140:143]
    s_waitcnt lgkmcnt(6)
    v_fma_mix_f32 v33, v121, v33, 0 op_sel:[0,1,0] op_sel_hi:[0,1,0]
    v_fma_mix_f32 v35, v123, v35, 0 op_sel:[0,1,0] op_sel_hi:[0,1,0]
    v_cvt_pk_bf16_f32 v74, v32, v33
    v_cvt_pk_bf16_f32 v75, v34, v35
    v_mfma_f32_16x16x32_bf16 v[100:103], a[192:195], v[160:163], v[20:23]
    s_add_u32 s45, s45, s49
    ds_read_b64_tr_b16 a[208:209], v4 offset:16384
    ds_read_b64_tr_b16 a[210:211], v4 offset:18432
    v_cvt_pk_f16_f32 v28, v76, v77
    v_mfma_f32_16x16x32_bf16 v[108:111], a[192:195], v[184:187], v[20:23]
    v_cvt_pk_f16_f32 v30, v78, v79
    v_pk_fma_f16 v29, v28, v28, s32
    v_pk_fma_f16 v31, v30, v30, s32
    v_pk_mul_f16 v28, v28, v29 neg_lo:[1,0] neg_hi:[1,0]
    v_mfma_f32_16x16x32_bf16 v[116:119], a[192:195], v[208:211], v[20:23]
    s_waitcnt lgkmcnt(6)
    v_pk_mul_f16 v30, v30, v31 neg_lo:[1,0] neg_hi:[1,0]
    v_exp_f16 v29, v28
    v_mfma_f32_16x16x32_bf16 v[100:103], a[196:199], v[164:167], v[100:103]
    s_add_u32 s46, s46, s49
    ds_read_b64_tr_b16 a[212:213], v4 offset:20480
    ds_read_b64_tr_b16 a[214:215], v4 offset:22528
    v_add_u32 v4, s33, v4
    v_mfma_f32_16x16x32_bf16 v[108:111], a[196:199], v[188:191], v[108:111]
    v_exp_f16 v31, v30
    v_mfma_f32_16x16x32_bf16 v[116:119], a[196:199], v[212:215], v[116:119]
    s_waitcnt lgkmcnt(6)
    v_exp_f16_sdwa v29, v28 dst_sel:WORD_1 dst_unused:UNUSED_PRESERVE src0_sel:WORD_1
    v_exp_f16_sdwa v31, v30 dst_sel:WORD_1 dst_unused:UNUSED_PRESERVE src0_sel:WORD_1
    v_pk_add_f16 v28, v29, 1.0 op_sel_hi:[1,0]
    v_mfma_f32_16x16x32_bf16 v[100:103], a[200:203], v[168:171], v[100:103]
    s_add_u32 s35, s35, 128
    ds_read_b128 v[24:27], v13
    ds_read_b64_tr_b16 a[192:193], v5 offset:0
    ds_read_b64_tr_b16 a[194:195], v5 offset:2048
    v_add_u32 v13, 0x100, v13
    v_mfma_f32_16x16x32_bf16 v[108:111], a[200:203], v[192:195], v[108:111]
    v_pk_add_f16 v30, v31, 1.0 op_sel_hi:[1,0]
    v_rcp_f16 v29, v28
    v_mfma_f32_16x16x32_bf16 v[116:119], a[200:203], v[216:219], v[116:119]
    s_waitcnt lgkmcnt(7)
    v_rcp_f16 v31, v30
    v_mfma_f32_16x16x32_bf16 v[100:103], a[204:207], v[172:175], v[100:103]
    s_add_u32 s36, s36, 24576
    ds_read_b64_tr_b16 a[196:197], v5 offset:4096
    ds_read_b64_tr_b16 a[198:199], v5 offset:6144
    v_rcp_f16_sdwa v29, v28 dst_sel:WORD_1 dst_unused:UNUSED_PRESERVE src0_sel:WORD_1
    v_mfma_f32_16x16x32_bf16 v[108:111], a[204:207], v[196:199], v[108:111]
    v_rcp_f16_sdwa v31, v30 dst_sel:WORD_1 dst_unused:UNUSED_PRESERVE src0_sel:WORD_1
    v_fma_mix_f32 v28, v76, v29, 0 op_sel_hi:[0,1,0]
    v_mfma_f32_16x16x32_bf16 v[116:119], a[204:207], v[220:223], v[116:119]
    s_waitcnt lgkmcnt(7)
    v_fma_mix_f32 v30, v78, v31, 0 op_sel_hi:[0,1,0]
    v_fma_mix_f32 v29, v77, v29, 0 op_sel:[0,1,0] op_sel_hi:[0,1,0]
    v_fma_mix_f32 v31, v79, v31, 0 op_sel:[0,1,0] op_sel_hi:[0,1,0]
    v_mfma_f32_16x16x32_bf16 v[100:103], a[208:211], v[176:179], v[100:103]
    s_mov_b32 s38, s48
    ds_read_b64_tr_b16 a[200:201], v5 offset:8192
    ds_read_b64_tr_b16 a[202:203], v5 offset:10240
    v_cvt_pk_bf16_f32 v52, v28, v29
    v_mfma_f32_16x16x32_bf16 v[108:111], a[208:211], v[200:203], v[108:111]
    v_cvt_pk_bf16_f32 v53, v30, v31
    v_cvt_pk_f16_f32 v32, v80, v81
    v_cvt_pk_f16_f32 v34, v82, v83
    v_pk_fma_f16 v33, v32, v32, s32
    v_mfma_f32_16x16x32_bf16 v[116:119], a[208:211], v[224:227], v[116:119]
    s_waitcnt lgkmcnt(7)
    v_pk_fma_f16 v35, v34, v34, s32
    v_pk_mul_f16 v32, v32, v33 neg_lo:[1,0] neg_hi:[1,0]
    v_pk_mul_f16 v34, v34, v35 neg_lo:[1,0] neg_hi:[1,0]
    v_mfma_f32_16x16x32_bf16 v[100:103], a[212:215], v[180:183], v[100:103]
    s_mov_b32 s48, s49
    ds_read_b64_tr_b16 a[204:205], v5 offset:12288
    ds_read_b64_tr_b16 a[206:207], v5 offset:14336
    v_mfma_f32_16x16x32_bf16 v[108:111], a[212:215], v[204:207], v[108:111]
    v_exp_f16 v33, v32
    v_exp_f16 v35, v34
    v_mfma_f32_16x16x32_bf16 v[116:119], a[212:215], v[228:231], v[116:119]
    s_waitcnt lgkmcnt(6)
    v_exp_f16_sdwa v33, v32 dst_sel:WORD_1 dst_unused:UNUSED_PRESERVE src0_sel:WORD_1
    v_exp_f16_sdwa v35, v34 dst_sel:WORD_1 dst_unused:UNUSED_PRESERVE src0_sel:WORD_1
    v_mfma_f32_16x16x32_bf16 v[104:107], a[192:195], v[160:163], v[24:27]
    s_mov_b32 s49, s33
    ds_read_b64_tr_b16 a[208:209], v5 offset:16384
    ds_read_b64_tr_b16 a[210:211], v5 offset:18432
    v_pk_add_f16 v32, v33, 1.0 op_sel_hi:[1,0]
    v_mfma_f32_16x16x32_bf16 v[112:115], a[192:195], v[184:187], v[24:27]
    v_pk_add_f16 v34, v35, 1.0 op_sel_hi:[1,0]
    v_rcp_f16 v33, v32
    v_mfma_f32_16x16x32_bf16 v[120:123], a[192:195], v[208:211], v[24:27]
    s_waitcnt lgkmcnt(6)
    v_rcp_f16 v35, v34
    v_rcp_f16_sdwa v33, v32 dst_sel:WORD_1 dst_unused:UNUSED_PRESERVE src0_sel:WORD_1
    v_mfma_f32_16x16x32_bf16 v[104:107], a[196:199], v[164:167], v[104:107]
    s_sub_u32 s37, s37, 1
    ds_read_b64_tr_b16 a[212:213], v5 offset:20480
    ds_read_b64_tr_b16 a[214:215], v5 offset:22528
    v_add_u32 v5, s33, v5
    v_mfma_f32_16x16x32_bf16 v[112:115], a[196:199], v[188:191], v[112:115]
    v_rcp_f16_sdwa v35, v34 dst_sel:WORD_1 dst_unused:UNUSED_PRESERVE src0_sel:WORD_1
    v_fma_mix_f32 v32, v80, v33, 0 op_sel_hi:[0,1,0]
    v_mfma_f32_16x16x32_bf16 v[120:123], a[196:199], v[212:215], v[120:123]
    s_waitcnt lgkmcnt(6)
    v_fma_mix_f32 v34, v82, v35, 0 op_sel_hi:[0,1,0]
    v_fma_mix_f32 v33, v81, v33, 0 op_sel:[0,1,0] op_sel_hi:[0,1,0]
    v_fma_mix_f32 v35, v83, v35, 0 op_sel:[0,1,0] op_sel_hi:[0,1,0]
    v_mfma_f32_16x16x32_bf16 v[104:107], a[200:203], v[168:171], v[104:107]
    s_cmp_lg_u32 s37, 0
    ds_read_b64_tr_b16 a[192:193], v8 offset:0
    ds_read_b64_tr_b16 a[194:195], v9 offset:0
    v_cvt_pk_bf16_f32 v54, v32, v33
    v_cvt_pk_bf16_f32 v55, v34, v35
    v_mfma_f32_16x16x32_bf16 v[112:115], a[200:203], v[192:195], v[112:115]
    v_cvt_pk_f16_f32 v28, v84, v85
    v_cvt_pk_f16_f32 v30, v86, v87
    v_pk_fma_f16 v29, v28, v28, s32
    v_mfma_f32_16x16x32_bf16 v[120:123], a[200:203], v[216:219], v[120:123]
    s_waitcnt lgkmcnt(6)
    v_pk_fma_f16 v31, v30, v30, s32
    v_pk_mul_f16 v28, v28, v29 neg_lo:[1,0] neg_hi:[1,0]
    v_pk_mul_f16 v30, v30, v31 neg_lo:[1,0] neg_hi:[1,0]
    v_mfma_f32_16x16x32_bf16 v[104:107], a[204:207], v[172:175], v[104:107]
    ds_read_b64_tr_b16 a[196:197], v8 offset:8
    ds_read_b64_tr_b16 a[198:199], v9 offset:8
    v_mfma_f32_16x16x32_bf16 v[112:115], a[204:207], v[196:199], v[112:115]
    v_exp_f16 v29, v28
    v_exp_f16 v31, v30
    v_mfma_f32_16x16x32_bf16 v[120:123], a[204:207], v[220:223], v[120:123]
    s_waitcnt lgkmcnt(6)
    v_exp_f16_sdwa v29, v28 dst_sel:WORD_1 dst_unused:UNUSED_PRESERVE src0_sel:WORD_1
    v_exp_f16_sdwa v31, v30 dst_sel:WORD_1 dst_unused:UNUSED_PRESERVE src0_sel:WORD_1
    v_mfma_f32_16x16x32_bf16 v[104:107], a[208:211], v[176:179], v[104:107]
    ds_read_b64_tr_b16 a[200:201], v8 offset:512
    ds_read_b64_tr_b16 a[202:203], v9 offset:512
    v_pk_add_f16 v28, v29, 1.0 op_sel_hi:[1,0]
    v_mfma_f32_16x16x32_bf16 v[112:115], a[208:211], v[200:203], v[112:115]
    v_pk_add_f16 v30, v31, 1.0 op_sel_hi:[1,0]
    v_rcp_f16 v29, v28
    v_mfma_f32_16x16x32_bf16 v[120:123], a[208:211], v[224:227], v[120:123]
    s_waitcnt lgkmcnt(6)
    v_rcp_f16 v31, v30
    v_rcp_f16_sdwa v29, v28 dst_sel:WORD_1 dst_unused:UNUSED_PRESERVE src0_sel:WORD_1
    v_mfma_f32_16x16x32_bf16 v[104:107], a[212:215], v[180:183], v[104:107]
    ds_read_b64_tr_b16 a[204:205], v8 offset:520
    ds_read_b64_tr_b16 a[206:207], v9 offset:520
    v_mfma_f32_16x16x32_bf16 v[112:115], a[212:215], v[204:207], v[112:115]
    v_rcp_f16_sdwa v31, v30 dst_sel:WORD_1 dst_unused:UNUSED_PRESERVE src0_sel:WORD_1
    v_fma_mix_f32 v28, v84, v29, 0 op_sel_hi:[0,1,0]
    v_fma_mix_f32 v30, v86, v31, 0 op_sel_hi:[0,1,0]
    v_mfma_f32_16x16x32_bf16 v[120:123], a[212:215], v[228:231], v[120:123]
    s_waitcnt lgkmcnt(6)
    v_fma_mix_f32 v29, v85, v29, 0 op_sel:[0,1,0] op_sel_hi:[0,1,0]
    v_fma_mix_f32 v31, v87, v31, 0 op_sel:[0,1,0] op_sel_hi:[0,1,0]
    v_cvt_pk_bf16_f32 v56, v28, v29
    v_cvt_pk_bf16_f32 v57, v30, v31
    v_mfma_f32_16x16x32_bf16 a[0:3], a[192:195], v[64:67], a[0:3]
    ds_read_b64_tr_b16 a[208:209], v8 offset:1024
    ds_read_b64_tr_b16 a[210:211], v9 offset:1024
    v_cvt_pk_f16_f32 v32, v88, v89
    v_mfma_f32_16x16x32_bf16 a[48:51], a[192:195], v[68:71], a[48:51]
    v_cvt_pk_f16_f32 v34, v90, v91
    v_pk_fma_f16 v33, v32, v32, s32
    v_pk_fma_f16 v35, v34, v34, s32
    v_mfma_f32_16x16x32_bf16 a[96:99], a[192:195], v[72:75], a[96:99]
    s_waitcnt lgkmcnt(6)
    v_pk_mul_f16 v32, v32, v33 neg_lo:[1,0] neg_hi:[1,0]
    v_pk_mul_f16 v34, v34, v35 neg_lo:[1,0] neg_hi:[1,0]
    v_mfma_f32_16x16x32_bf16 a[4:7], a[196:199], v[64:67], a[4:7]
    ds_read_b64_tr_b16 a[212:213], v8 offset:1032
    ds_read_b64_tr_b16 a[214:215], v9 offset:1032
    v_exp_f16 v33, v32
    v_mfma_f32_16x16x32_bf16 a[52:55], a[196:199], v[68:71], a[52:55]
    v_exp_f16 v35, v34
    v_exp_f16_sdwa v33, v32 dst_sel:WORD_1 dst_unused:UNUSED_PRESERVE src0_sel:WORD_1
    v_mfma_f32_16x16x32_bf16 a[100:103], a[196:199], v[72:75], a[100:103]
    s_waitcnt lgkmcnt(6)
    v_exp_f16_sdwa v35, v34 dst_sel:WORD_1 dst_unused:UNUSED_PRESERVE src0_sel:WORD_1
    v_pk_add_f16 v32, v33, 1.0 op_sel_hi:[1,0]
    v_mfma_f32_16x16x32_bf16 a[8:11], a[200:203], v[64:67], a[8:11]
    ds_read_b64_tr_b16 a[192:193], v8 offset:1536
    ds_read_b64_tr_b16 a[194:195], v9 offset:1536
    v_pk_add_f16 v34, v35, 1.0 op_sel_hi:[1,0]
    v_mfma_f32_16x16x32_bf16 a[56:59], a[200:203], v[68:71], a[56:59]
    v_rcp_f16 v33, v32
    v_rcp_f16 v35, v34
    v_mfma_f32_16x16x32_bf16 a[104:107], a[200:203], v[72:75], a[104:107]
    s_waitcnt lgkmcnt(6)
    v_rcp_f16_sdwa v33, v32 dst_sel:WORD_1 dst_unused:UNUSED_PRESERVE src0_sel:WORD_1
    v_mfma_f32_16x16x32_bf16 a[12:15], a[204:207], v[64:67], a[12:15]
    ds_read_b64_tr_b16 a[196:197], v8 offset:1544
    ds_read_b64_tr_b16 a[198:199], v9 offset:1544
    v_rcp_f16_sdwa v35, v34 dst_sel:WORD_1 dst_unused:UNUSED_PRESERVE src0_sel:WORD_1
    v_mfma_f32_16x16x32_bf16 a[60:63], a[204:207], v[68:71], a[60:63]
    v_fma_mix_f32 v32, v88, v33, 0 op_sel_hi:[0,1,0]
    v_fma_mix_f32 v34, v90, v35, 0 op_sel_hi:[0,1,0]
    v_fma_mix_f32 v33, v89, v33, 0 op_sel:[0,1,0] op_sel_hi:[0,1,0]
    v_mfma_f32_16x16x32_bf16 a[108:111], a[204:207], v[72:75], a[108:111]
    s_waitcnt lgkmcnt(6)
    v_fma_mix_f32 v35, v91, v35, 0 op_sel:[0,1,0] op_sel_hi:[0,1,0]
    v_cvt_pk_bf16_f32 v58, v32, v33
    v_cvt_pk_bf16_f32 v59, v34, v35
    v_cvt_pk_f16_f32 v28, v92, v93
    v_mfma_f32_16x16x32_bf16 a[16:19], a[208:211], v[64:67], a[16:19]
    ds_read_b64_tr_b16 a[200:201], v8 offset:2048
    ds_read_b64_tr_b16 a[202:203], v9 offset:2048
    v_cvt_pk_f16_f32 v30, v94, v95
    v_mfma_f32_16x16x32_bf16 a[64:67], a[208:211], v[68:71], a[64:67]
    v_pk_fma_f16 v29, v28, v28, s32
    v_pk_fma_f16 v31, v30, v30, s32
    v_pk_mul_f16 v28, v28, v29 neg_lo:[1,0] neg_hi:[1,0]
    v_mfma_f32_16x16x32_bf16 a[112:115], a[208:211], v[72:75], a[112:115]
    s_waitcnt lgkmcnt(6)
    v_pk_mul_f16 v30, v30, v31 neg_lo:[1,0] neg_hi:[1,0]
    v_exp_f16 v29, v28
    v_mfma_f32_16x16x32_bf16 a[20:23], a[212:215], v[64:67], a[20:23]
    ds_read_b64_tr_b16 a[204:205], v8 offset:2056
    ds_read_b64_tr_b16 a[206:207], v9 offset:2056
    v_exp_f16 v31, v30
    v_mfma_f32_16x16x32_bf16 a[68:71], a[212:215], v[68:71], a[68:71]
    v_exp_f16_sdwa v29, v28 dst_sel:WORD_1 dst_unused:UNUSED_PRESERVE src0_sel:WORD_1
    v_mfma_f32_16x16x32_bf16 a[116:119], a[212:215], v[72:75], a[116:119]
    s_waitcnt lgkmcnt(6)
    v_exp_f16_sdwa v31, v30 dst_sel:WORD_1 dst_unused:UNUSED_PRESERVE src0_sel:WORD_1
    v_pk_add_f16 v28, v29, 1.0 op_sel_hi:[1,0]
    v_pk_add_f16 v30, v31, 1.0 op_sel_hi:[1,0]
    v_mfma_f32_16x16x32_bf16 a[24:27], a[192:195], v[64:67], a[24:27]
    ds_read_b64_tr_b16 a[208:209], v8 offset:2560
    ds_read_b64_tr_b16 a[210:211], v9 offset:2560
    v_rcp_f16 v29, v28
    v_mfma_f32_16x16x32_bf16 a[72:75], a[192:195], v[68:71], a[72:75]
    v_rcp_f16 v31, v30
    v_mfma_f32_16x16x32_bf16 a[120:123], a[192:195], v[72:75], a[120:123]
    s_waitcnt lgkmcnt(6)
    v_rcp_f16_sdwa v29, v28 dst_sel:WORD_1 dst_unused:UNUSED_PRESERVE src0_sel:WORD_1
    v_rcp_f16_sdwa v31, v30 dst_sel:WORD_1 dst_unused:UNUSED_PRESERVE src0_sel:WORD_1
    v_mfma_f32_16x16x32_bf16 a[28:31], a[196:199], v[64:67], a[28:31]
    ds_read_b64_tr_b16 a[212:213], v8 offset:2568
    ds_read_b64_tr_b16 a[214:215], v9 offset:2568
    v_add_u32 v8, s33, v8
    v_add_u32 v9, s33, v9
    v_mfma_f32_16x16x32_bf16 a[76:79], a[196:199], v[68:71], a[76:79]
    v_fma_mix_f32 v28, v92, v29, 0 op_sel_hi:[0,1,0]
    v_fma_mix_f32 v30, v94, v31, 0 op_sel_hi:[0,1,0]
    v_fma_mix_f32 v29, v93, v29, 0 op_sel:[0,1,0] op_sel_hi:[0,1,0]
    v_mfma_f32_16x16x32_bf16 a[124:127], a[196:199], v[72:75], a[124:127]
    s_waitcnt lgkmcnt(6)
    v_fma_mix_f32 v31, v95, v31, 0 op_sel:[0,1,0] op_sel_hi:[0,1,0]
    v_cvt_pk_bf16_f32 v60, v28, v29
    v_cvt_pk_bf16_f32 v61, v30, v31
    v_mfma_f32_16x16x32_bf16 a[32:35], a[200:203], v[64:67], a[32:35]
    ds_read_b128 v[20:23], v10
    ds_read_b64_tr_b16 a[192:193], v2 offset:0
    ds_read_b64_tr_b16 a[194:195], v2 offset:2048
    v_mfma_f32_16x16x32_bf16 a[80:83], a[200:203], v[68:71], a[80:83]
    v_cvt_pk_f16_f32 v32, v96, v97
    v_cvt_pk_f16_f32 v34, v98, v99
    v_pk_fma_f16 v33, v32, v32, s32
    v_mfma_f32_16x16x32_bf16 a[128:131], a[200:203], v[72:75], a[128:131]
    s_waitcnt lgkmcnt(7)
    v_pk_fma_f16 v35, v34, v34, s32
    v_pk_mul_f16 v32, v32, v33 neg_lo:[1,0] neg_hi:[1,0]
    v_pk_mul_f16 v34, v34, v35 neg_lo:[1,0] neg_hi:[1,0]
    v_mfma_f32_16x16x32_bf16 a[36:39], a[204:207], v[64:67], a[36:39]
    ds_read_b64_tr_b16 a[196:197], v2 offset:4096
    ds_read_b64_tr_b16 a[198:199], v2 offset:6144
    v_exp_f16 v33, v32
    v_mfma_f32_16x16x32_bf16 a[84:87], a[204:207], v[68:71], a[84:87]
    v_exp_f16 v35, v34
    v_mfma_f32_16x16x32_bf16 a[132:135], a[204:207], v[72:75], a[132:135]
    s_waitcnt lgkmcnt(7)
    v_exp_f16_sdwa v33, v32 dst_sel:WORD_1 dst_unused:UNUSED_PRESERVE src0_sel:WORD_1
    v_exp_f16_sdwa v35, v34 dst_sel:WORD_1 dst_unused:UNUSED_PRESERVE src0_sel:WORD_1
    v_mfma_f32_16x16x32_bf16 a[40:43], a[208:211], v[64:67], a[40:43]
    ds_read_b64_tr_b16 a[200:201], v2 offset:8192
    ds_read_b64_tr_b16 a[202:203], v2 offset:10240
    v_pk_add_f16 v32, v33, 1.0 op_sel_hi:[1,0]
    v_pk_add_f16 v34, v35, 1.0 op_sel_hi:[1,0]
    v_mfma_f32_16x16x32_bf16 a[88:91], a[208:211], v[68:71], a[88:91]
    v_rcp_f16 v33, v32
    v_mfma_f32_16x16x32_bf16 a[136:139], a[208:211], v[72:75], a[136:139]
    s_waitcnt lgkmcnt(7)
    v_rcp_f16 v35, v34
    v_rcp_f16_sdwa v33, v32 dst_sel:WORD_1 dst_unused:UNUSED_PRESERVE src0_sel:WORD_1
    v_mfma_f32_16x16x32_bf16 a[44:47], a[212:215], v[64:67], a[44:47]
    ds_read_b64_tr_b16 a[204:205], v2 offset:12288
    ds_read_b64_tr_b16 a[206:207], v2 offset:14336
    v_mfma_f32_16x16x32_bf16 a[92:95], a[212:215], v[68:71], a[92:95]
    s_mov_b32 s33, s38
    v_rcp_f16_sdwa v35, v34 dst_sel:WORD_1 dst_unused:UNUSED_PRESERVE src0_sel:WORD_1
    v_fma_mix_f32 v32, v96, v33, 0 op_sel_hi:[0,1,0]
    v_fma_mix_f32 v34, v98, v35, 0 op_sel_hi:[0,1,0]
    v_fma_mix_f32 v33, v97, v33, 0 op_sel:[0,1,0] op_sel_hi:[0,1,0]
    v_mfma_f32_16x16x32_bf16 a[140:143], a[212:215], v[72:75], a[140:143]
    s_waitcnt lgkmcnt(6)
    v_fma_mix_f32 v35, v99, v35, 0 op_sel:[0,1,0] op_sel_hi:[0,1,0]
    v_cvt_pk_bf16_f32 v62, v32, v33
    v_cvt_pk_bf16_f32 v63, v34, v35
    s_waitcnt vmcnt(0)
    s_barrier
    v_mfma_f32_16x16x32_bf16 v[76:79], a[192:195], v[160:163], v[20:23]
    ds_read_b64_tr_b16 a[208:209], v2 offset:16384
    ds_read_b64_tr_b16 a[210:211], v2 offset:18432
    v_cvt_pk_f16_f32 v28, v100, v101
    v_mfma_f32_16x16x32_bf16 v[84:87], a[192:195], v[184:187], v[20:23]
    v_cvt_pk_f16_f32 v30, v102, v103
    v_pk_fma_f16 v29, v28, v28, s32
    v_pk_fma_f16 v31, v30, v30, s32
    v_mfma_f32_16x16x32_bf16 v[92:95], a[192:195], v[208:211], v[20:23]
    s_waitcnt lgkmcnt(6)
    v_pk_mul_f16 v28, v28, v29 neg_lo:[1,0] neg_hi:[1,0]
    v_pk_mul_f16 v30, v30, v31 neg_lo:[1,0] neg_hi:[1,0]
    v_exp_f16 v29, v28
    v_mfma_f32_16x16x32_bf16 v[76:79], a[196:199], v[164:167], v[76:79]
    ds_read_b64_tr_b16 a[212:213], v2 offset:20480
    ds_read_b64_tr_b16 a[214:215], v2 offset:22528
    v_mfma_f32_16x16x32_bf16 v[84:87], a[196:199], v[188:191], v[84:87]
    v_exp_f16 v31, v30
    v_exp_f16_sdwa v29, v28 dst_sel:WORD_1 dst_unused:UNUSED_PRESERVE src0_sel:WORD_1
    v_mfma_f32_16x16x32_bf16 v[92:95], a[196:199], v[212:215], v[92:95]
    s_waitcnt lgkmcnt(6)
    v_exp_f16_sdwa v31, v30 dst_sel:WORD_1 dst_unused:UNUSED_PRESERVE src0_sel:WORD_1
    v_pk_add_f16 v28, v29, 1.0 op_sel_hi:[1,0]
    v_mfma_f32_16x16x32_bf16 v[76:79], a[200:203], v[168:171], v[76:79]
    ds_read_b128 v[24:27], v11
    ds_read_b64_tr_b16 a[192:193], v3 offset:0
    ds_read_b64_tr_b16 a[194:195], v3 offset:2048
    v_pk_add_f16 v30, v31, 1.0 op_sel_hi:[1,0]
    v_mfma_f32_16x16x32_bf16 v[84:87], a[200:203], v[192:195], v[84:87]
    v_rcp_f16 v29, v28
    v_mfma_f32_16x16x32_bf16 v[92:95], a[200:203], v[216:219], v[92:95]
    s_waitcnt lgkmcnt(7)
    v_rcp_f16 v31, v30
    v_rcp_f16_sdwa v29, v28 dst_sel:WORD_1 dst_unused:UNUSED_PRESERVE src0_sel:WORD_1
    v_mfma_f32_16x16x32_bf16 v[76:79], a[204:207], v[172:175], v[76:79]
    ds_read_b64_tr_b16 a[196:197], v3 offset:4096
    ds_read_b64_tr_b16 a[198:199], v3 offset:6144
    v_mfma_f32_16x16x32_bf16 v[84:87], a[204:207], v[196:199], v[84:87]
    v_rcp_f16_sdwa v31, v30 dst_sel:WORD_1 dst_unused:UNUSED_PRESERVE src0_sel:WORD_1
    v_fma_mix_f32 v28, v100, v29, 0 op_sel_hi:[0,1,0]
    v_fma_mix_f32 v30, v102, v31, 0 op_sel_hi:[0,1,0]
    v_mfma_f32_16x16x32_bf16 v[92:95], a[204:207], v[220:223], v[92:95]
    s_waitcnt lgkmcnt(7)
    v_fma_mix_f32 v29, v101, v29, 0 op_sel:[0,1,0] op_sel_hi:[0,1,0]
    v_fma_mix_f32 v31, v103, v31, 0 op_sel:[0,1,0] op_sel_hi:[0,1,0]
    v_cvt_pk_bf16_f32 v64, v28, v29
    v_cvt_pk_bf16_f32 v65, v30, v31
    v_mfma_f32_16x16x32_bf16 v[76:79], a[208:211], v[176:179], v[76:79]
    ds_read_b64_tr_b16 a[200:201], v3 offset:8192
    ds_read_b64_tr_b16 a[202:203], v3 offset:10240
    v_cvt_pk_f16_f32 v32, v104, v105
    v_mfma_f32_16x16x32_bf16 v[84:87], a[208:211], v[200:203], v[84:87]
    v_cvt_pk_f16_f32 v34, v106, v107
    v_pk_fma_f16 v33, v32, v32, s32
    v_pk_fma_f16 v35, v34, v34, s32
    v_mfma_f32_16x16x32_bf16 v[92:95], a[208:211], v[224:227], v[92:95]
    s_waitcnt lgkmcnt(7)
    v_pk_mul_f16 v32, v32, v33 neg_lo:[1,0] neg_hi:[1,0]
    v_pk_mul_f16 v34, v34, v35 neg_lo:[1,0] neg_hi:[1,0]
    v_mfma_f32_16x16x32_bf16 v[76:79], a[212:215], v[180:183], v[76:79]
    ds_read_b64_tr_b16 a[204:205], v3 offset:12288
    ds_read_b64_tr_b16 a[206:207], v3 offset:14336
    v_exp_f16 v33, v32
    v_mfma_f32_16x16x32_bf16 v[84:87], a[212:215], v[204:207], v[84:87]
    v_exp_f16 v35, v34
    v_exp_f16_sdwa v33, v32 dst_sel:WORD_1 dst_unused:UNUSED_PRESERVE src0_sel:WORD_1
    v_mfma_f32_16x16x32_bf16 v[92:95], a[212:215], v[228:231], v[92:95]
    s_waitcnt lgkmcnt(6)
    v_exp_f16_sdwa v35, v34 dst_sel:WORD_1 dst_unused:UNUSED_PRESERVE src0_sel:WORD_1
    v_pk_add_f16 v32, v33, 1.0 op_sel_hi:[1,0]
    v_mfma_f32_16x16x32_bf16 v[80:83], a[192:195], v[160:163], v[24:27]
    ds_read_b64_tr_b16 a[208:209], v3 offset:16384
    ds_read_b64_tr_b16 a[210:211], v3 offset:18432
    v_pk_add_f16 v34, v35, 1.0 op_sel_hi:[1,0]
    v_mfma_f32_16x16x32_bf16 v[88:91], a[192:195], v[184:187], v[24:27]
    v_rcp_f16 v33, v32
    v_mfma_f32_16x16x32_bf16 v[96:99], a[192:195], v[208:211], v[24:27]
    s_waitcnt lgkmcnt(6)
    v_rcp_f16 v35, v34
    v_rcp_f16_sdwa v33, v32 dst_sel:WORD_1 dst_unused:UNUSED_PRESERVE src0_sel:WORD_1
    v_mfma_f32_16x16x32_bf16 v[80:83], a[196:199], v[164:167], v[80:83]
    ds_read_b64_tr_b16 a[212:213], v3 offset:20480
    ds_read_b64_tr_b16 a[214:215], v3 offset:22528
    v_rcp_f16_sdwa v35, v34 dst_sel:WORD_1 dst_unused:UNUSED_PRESERVE src0_sel:WORD_1
    v_mfma_f32_16x16x32_bf16 v[88:91], a[196:199], v[188:191], v[88:91]
    v_fma_mix_f32 v32, v104, v33, 0 op_sel_hi:[0,1,0]
    v_fma_mix_f32 v34, v106, v35, 0 op_sel_hi:[0,1,0]
    v_fma_mix_f32 v33, v105, v33, 0 op_sel:[0,1,0] op_sel_hi:[0,1,0]
    v_mfma_f32_16x16x32_bf16 v[96:99], a[196:199], v[212:215], v[96:99]
    s_waitcnt lgkmcnt(6)
    v_fma_mix_f32 v35, v107, v35, 0 op_sel:[0,1,0] op_sel_hi:[0,1,0]
    v_cvt_pk_bf16_f32 v66, v32, v33
    v_cvt_pk_bf16_f32 v67, v34, v35
    v_mfma_f32_16x16x32_bf16 v[80:83], a[200:203], v[168:171], v[80:83]
    ds_read_b64_tr_b16 a[192:193], v6 offset:0
    ds_read_b64_tr_b16 a[194:195], v7 offset:0
    v_cvt_pk_f16_f32 v28, v108, v109
    v_cvt_pk_f16_f32 v30, v110, v111
    v_mfma_f32_16x16x32_bf16 v[88:91], a[200:203], v[192:195], v[88:91]
    v_pk_fma_f16 v29, v28, v28, s32
    v_pk_fma_f16 v31, v30, v30, s32
    v_pk_mul_f16 v28, v28, v29 neg_lo:[1,0] neg_hi:[1,0]
    v_mfma_f32_16x16x32_bf16 v[96:99], a[200:203], v[216:219], v[96:99]
    s_waitcnt lgkmcnt(6)
    v_pk_mul_f16 v30, v30, v31 neg_lo:[1,0] neg_hi:[1,0]
    v_exp_f16 v29, v28
    v_mfma_f32_16x16x32_bf16 v[80:83], a[204:207], v[172:175], v[80:83]
    ds_read_b64_tr_b16 a[196:197], v6 offset:8
    ds_read_b64_tr_b16 a[198:199], v7 offset:8
    v_mfma_f32_16x16x32_bf16 v[88:91], a[204:207], v[196:199], v[88:91]
    v_exp_f16 v31, v30
    v_exp_f16_sdwa v29, v28 dst_sel:WORD_1 dst_unused:UNUSED_PRESERVE src0_sel:WORD_1
    v_mfma_f32_16x16x32_bf16 v[96:99], a[204:207], v[220:223], v[96:99]
    s_waitcnt lgkmcnt(6)
    v_exp_f16_sdwa v31, v30 dst_sel:WORD_1 dst_unused:UNUSED_PRESERVE src0_sel:WORD_1
    v_pk_add_f16 v28, v29, 1.0 op_sel_hi:[1,0]
    v_pk_add_f16 v30, v31, 1.0 op_sel_hi:[1,0]
    v_mfma_f32_16x16x32_bf16 v[80:83], a[208:211], v[176:179], v[80:83]
    ds_read_b64_tr_b16 a[200:201], v6 offset:512
    ds_read_b64_tr_b16 a[202:203], v7 offset:512
    v_mfma_f32_16x16x32_bf16 v[88:91], a[208:211], v[200:203], v[88:91]
    v_rcp_f16 v29, v28
    v_rcp_f16 v31, v30
    v_mfma_f32_16x16x32_bf16 v[96:99], a[208:211], v[224:227], v[96:99]
    s_waitcnt lgkmcnt(6)
    v_rcp_f16_sdwa v29, v28 dst_sel:WORD_1 dst_unused:UNUSED_PRESERVE src0_sel:WORD_1
    v_mfma_f32_16x16x32_bf16 v[80:83], a[212:215], v[180:183], v[80:83]
    ds_read_b64_tr_b16 a[204:205], v6 offset:520
    ds_read_b64_tr_b16 a[206:207], v7 offset:520
    v_rcp_f16_sdwa v31, v30 dst_sel:WORD_1 dst_unused:UNUSED_PRESERVE src0_sel:WORD_1
    v_fma_mix_f32 v28, v108, v29, 0 op_sel_hi:[0,1,0]
    v_mfma_f32_16x16x32_bf16 v[88:91], a[212:215], v[204:207], v[88:91]
    v_fma_mix_f32 v30, v110, v31, 0 op_sel_hi:[0,1,0]
    v_fma_mix_f32 v29, v109, v29, 0 op_sel:[0,1,0] op_sel_hi:[0,1,0]
    v_fma_mix_f32 v31, v111, v31, 0 op_sel:[0,1,0] op_sel_hi:[0,1,0]
    v_mfma_f32_16x16x32_bf16 v[96:99], a[212:215], v[228:231], v[96:99]
    s_waitcnt lgkmcnt(6)
    v_cvt_pk_bf16_f32 v68, v28, v29
    v_cvt_pk_bf16_f32 v69, v30, v31
    v_cvt_pk_f16_f32 v32, v112, v113
    v_mfma_f32_16x16x32_bf16 a[0:3], a[192:195], v[52:55], a[0:3]
    ds_read_b64_tr_b16 a[208:209], v6 offset:1024
    ds_read_b64_tr_b16 a[210:211], v7 offset:1024
    v_cvt_pk_f16_f32 v34, v114, v115
    v_mfma_f32_16x16x32_bf16 a[48:51], a[192:195], v[56:59], a[48:51]
    v_pk_fma_f16 v33, v32, v32, s32
    v_pk_fma_f16 v35, v34, v34, s32
    v_pk_mul_f16 v32, v32, v33 neg_lo:[1,0] neg_hi:[1,0]
    v_mfma_f32_16x16x32_bf16 a[96:99], a[192:195], v[60:63], a[96:99]
    s_waitcnt lgkmcnt(6)
    v_pk_mul_f16 v34, v34, v35 neg_lo:[1,0] neg_hi:[1,0]
    v_exp_f16 v33, v32
    v_mfma_f32_16x16x32_bf16 a[4:7], a[196:199], v[52:55], a[4:7]
    ds_read_b64_tr_b16 a[212:213], v6 offset:1032
    ds_read_b64_tr_b16 a[214:215], v7 offset:1032
    v_exp_f16 v35, v34
    v_mfma_f32_16x16x32_bf16 a[52:55], a[196:199], v[56:59], a[52:55]
    v_exp_f16_sdwa v33, v32 dst_sel:WORD_1 dst_unused:UNUSED_PRESERVE src0_sel:WORD_1
    v_mfma_f32_16x16x32_bf16 a[100:103], a[196:199], v[60:63], a[100:103]
    s_waitcnt lgkmcnt(6)
    v_exp_f16_sdwa v35, v34 dst_sel:WORD_1 dst_unused:UNUSED_PRESERVE src0_sel:WORD_1
    v_pk_add_f16 v32, v33, 1.0 op_sel_hi:[1,0]
    v_pk_add_f16 v34, v35, 1.0 op_sel_hi:[1,0]
    v_mfma_f32_16x16x32_bf16 a[8:11], a[200:203], v[52:55], a[8:11]
    ds_read_b64_tr_b16 a[192:193], v6 offset:1536
    ds_read_b64_tr_b16 a[194:195], v7 offset:1536
    v_rcp_f16 v33, v32
    v_mfma_f32_16x16x32_bf16 a[56:59], a[200:203], v[56:59], a[56:59]
    v_rcp_f16 v35, v34
    v_mfma_f32_16x16x32_bf16 a[104:107], a[200:203], v[60:63], a[104:107]
    s_waitcnt lgkmcnt(6)
    v_rcp_f16_sdwa v33, v32 dst_sel:WORD_1 dst_unused:UNUSED_PRESERVE src0_sel:WORD_1
    v_rcp_f16_sdwa v35, v34 dst_sel:WORD_1 dst_unused:UNUSED_PRESERVE src0_sel:WORD_1
    v_mfma_f32_16x16x32_bf16 a[12:15], a[204:207], v[52:55], a[12:15]
    ds_read_b64_tr_b16 a[196:197], v6 offset:1544
    ds_read_b64_tr_b16 a[198:199], v7 offset:1544
    v_fma_mix_f32 v32, v112, v33, 0 op_sel_hi:[0,1,0]
    v_mfma_f32_16x16x32_bf16 a[60:63], a[204:207], v[56:59], a[60:63]
    v_fma_mix_f32 v34, v114, v35, 0 op_sel_hi:[0,1,0]
    v_fma_mix_f32 v33, v113, v33, 0 op_sel:[0,1,0] op_sel_hi:[0,1,0]
    v_fma_mix_f32 v35, v115, v35, 0 op_sel:[0,1,0] op_sel_hi:[0,1,0]
    v_mfma_f32_16x16x32_bf16 a[108:111], a[204:207], v[60:63], a[108:111]
    s_waitcnt lgkmcnt(6)
    v_cvt_pk_bf16_f32 v70, v32, v33
    v_cvt_pk_bf16_f32 v71, v34, v35
    v_cvt_pk_f16_f32 v28, v116, v117
    v_cvt_pk_f16_f32 v30, v118, v119
    v_mfma_f32_16x16x32_bf16 a[16:19], a[208:211], v[52:55], a[16:19]
    ds_read_b64_tr_b16 a[200:201], v6 offset:2048
    ds_read_b64_tr_b16 a[202:203], v7 offset:2048
    v_pk_fma_f16 v29, v28, v28, s32
    v_mfma_f32_16x16x32_bf16 a[64:67], a[208:211], v[56:59], a[64:67]
    v_pk_fma_f16 v31, v30, v30, s32
    v_pk_mul_f16 v28, v28, v29 neg_lo:[1,0] neg_hi:[1,0]
    v_pk_mul_f16 v30, v30, v31 neg_lo:[1,0] neg_hi:[1,0]
    v_mfma_f32_16x16x32_bf16 a[112:115], a[208:211], v[60:63], a[112:115]
    s_waitcnt lgkmcnt(6)
    v_exp_f16 v29, v28
    v_mfma_f32_16x16x32_bf16 a[20:23], a[212:215], v[52:55], a[20:23]
    ds_read_b64_tr_b16 a[204:205], v6 offset:2056
    ds_read_b64_tr_b16 a[206:207], v7 offset:2056
    v_exp_f16 v31, v30
    v_mfma_f32_16x16x32_bf16 a[68:71], a[212:215], v[56:59], a[68:71]
    v_exp_f16_sdwa v29, v28 dst_sel:WORD_1 dst_unused:UNUSED_PRESERVE src0_sel:WORD_1
    v_exp_f16_sdwa v31, v30 dst_sel:WORD_1 dst_unused:UNUSED_PRESERVE src0_sel:WORD_1
    v_mfma_f32_16x16x32_bf16 a[116:119], a[212:215], v[60:63], a[116:119]
    s_waitcnt lgkmcnt(6)
    v_pk_add_f16 v28, v29, 1.0 op_sel_hi:[1,0]
    v_pk_add_f16 v30, v31, 1.0 op_sel_hi:[1,0]
    v_mfma_f32_16x16x32_bf16 a[24:27], a[192:195], v[52:55], a[24:27]
    ds_read_b64_tr_b16 a[208:209], v6 offset:2560
    ds_read_b64_tr_b16 a[210:211], v7 offset:2560
    v_rcp_f16 v29, v28
    v_mfma_f32_16x16x32_bf16 a[72:75], a[192:195], v[56:59], a[72:75]
    v_rcp_f16 v31, v30
    v_mfma_f32_16x16x32_bf16 a[120:123], a[192:195], v[60:63], a[120:123]
    s_waitcnt lgkmcnt(6)
    v_rcp_f16_sdwa v29, v28 dst_sel:WORD_1 dst_unused:UNUSED_PRESERVE src0_sel:WORD_1
    v_rcp_f16_sdwa v31, v30 dst_sel:WORD_1 dst_unused:UNUSED_PRESERVE src0_sel:WORD_1
    v_fma_mix_f32 v28, v116, v29, 0 op_sel_hi:[0,1,0]
    v_mfma_f32_16x16x32_bf16 a[28:31], a[196:199], v[52:55], a[28:31]
    ds_read_b64_tr_b16 a[212:213], v6 offset:2568
    ds_read_b64_tr_b16 a[214:215], v7 offset:2568
    v_add_u32 v6, s33, v6
    v_add_u32 v7, s33, v7
    v_mfma_f32_16x16x32_bf16 a[76:79], a[196:199], v[56:59], a[76:79]
    v_fma_mix_f32 v30, v118, v31, 0 op_sel_hi:[0,1,0]
    v_fma_mix_f32 v29, v117, v29, 0 op_sel:[0,1,0] op_sel_hi:[0,1,0]
    v_mfma_f32_16x16x32_bf16 a[124:127], a[196:199], v[60:63], a[124:127]
    s_waitcnt lgkmcnt(6)
    v_fma_mix_f32 v31, v119, v31, 0 op_sel:[0,1,0] op_sel_hi:[0,1,0]
    v_cvt_pk_bf16_f32 v72, v28, v29
    v_cvt_pk_bf16_f32 v73, v30, v31
    v_mfma_f32_16x16x32_bf16 a[32:35], a[200:203], v[52:55], a[32:35]
    ds_read_b128 v[20:23], v12
    ds_read_b64_tr_b16 a[192:193], v4 offset:0
    ds_read_b64_tr_b16 a[194:195], v4 offset:2048
    v_cvt_pk_f16_f32 v32, v120, v121
    v_mfma_f32_16x16x32_bf16 a[80:83], a[200:203], v[56:59], a[80:83]
    v_cvt_pk_f16_f32 v34, v122, v123
    v_pk_fma_f16 v33, v32, v32, s32
    v_pk_fma_f16 v35, v34, v34, s32
    v_mfma_f32_16x16x32_bf16 a[128:131], a[200:203], v[60:63], a[128:131]
    s_waitcnt lgkmcnt(7)
    v_pk_mul_f16 v32, v32, v33 neg_lo:[1,0] neg_hi:[1,0]
    v_pk_mul_f16 v34, v34, v35 neg_lo:[1,0] neg_hi:[1,0]
    v_mfma_f32_16x16x32_bf16 a[36:39], a[204:207], v[52:55], a[36:39]
    ds_read_b64_tr_b16 a[196:197], v4 offset:4096
    ds_read_b64_tr_b16 a[198:199], v4 offset:6144
    v_exp_f16 v33, v32
    v_mfma_f32_16x16x32_bf16 a[84:87], a[204:207], v[56:59], a[84:87]
    v_exp_f16 v35, v34
    v_mfma_f32_16x16x32_bf16 a[132:135], a[204:207], v[60:63], a[132:135]
    s_waitcnt lgkmcnt(7)
    v_exp_f16_sdwa v33, v32 dst_sel:WORD_1 dst_unused:UNUSED_PRESERVE src0_sel:WORD_1
    v_exp_f16_sdwa v35, v34 dst_sel:WORD_1 dst_unused:UNUSED_PRESERVE src0_sel:WORD_1
    v_pk_add_f16 v32, v33, 1.0 op_sel_hi:[1,0]
    v_mfma_f32_16x16x32_bf16 a[40:43], a[208:211], v[52:55], a[40:43]
    ds_read_b64_tr_b16 a[200:201], v4 offset:8192
    ds_read_b64_tr_b16 a[202:203], v4 offset:10240
    v_pk_add_f16 v34, v35, 1.0 op_sel_hi:[1,0]
    v_mfma_f32_16x16x32_bf16 a[88:91], a[208:211], v[56:59], a[88:91]
    v_rcp_f16 v33, v32
    v_mfma_f32_16x16x32_bf16 a[136:139], a[208:211], v[60:63], a[136:139]
    s_waitcnt lgkmcnt(7)
    v_rcp_f16 v35, v34
    v_rcp_f16_sdwa v33, v32 dst_sel:WORD_1 dst_unused:UNUSED_PRESERVE src0_sel:WORD_1
    v_mfma_f32_16x16x32_bf16 a[44:47], a[212:215], v[52:55], a[44:47]
    ds_read_b64_tr_b16 a[204:205], v4 offset:12288
    ds_read_b64_tr_b16 a[206:207], v4 offset:14336
    v_rcp_f16_sdwa v35, v34 dst_sel:WORD_1 dst_unused:UNUSED_PRESERVE src0_sel:WORD_1
    v_mfma_f32_16x16x32_bf16 a[92:95], a[212:215], v[56:59], a[92:95]
    v_fma_mix_f32 v32, v120, v33, 0 op_sel_hi:[0,1,0]
    v_fma_mix_f32 v34, v122, v35, 0 op_sel_hi:[0,1,0]
    v_fma_mix_f32 v33, v121, v33, 0 op_sel:[0,1,0] op_sel_hi:[0,1,0]
    v_mfma_f32_16x16x32_bf16 a[140:143], a[212:215], v[60:63], a[140:143]
    s_waitcnt lgkmcnt(6)
    v_fma_mix_f32 v35, v123, v35, 0 op_sel:[0,1,0] op_sel_hi:[0,1,0]
    v_cvt_pk_bf16_f32 v74, v32, v33
    v_cvt_pk_bf16_f32 v75, v34, v35
    v_mfma_f32_16x16x32_bf16 v[100:103], a[192:195], v[160:163], v[20:23]
    s_add_u32 s45, s45, s49
    ds_read_b64_tr_b16 a[208:209], v4 offset:16384
    ds_read_b64_tr_b16 a[210:211], v4 offset:18432
    v_cvt_pk_f16_f32 v28, v76, v77
    v_mfma_f32_16x16x32_bf16 v[108:111], a[192:195], v[184:187], v[20:23]
    v_cvt_pk_f16_f32 v30, v78, v79
    v_pk_fma_f16 v29, v28, v28, s32
    v_pk_fma_f16 v31, v30, v30, s32
    v_mfma_f32_16x16x32_bf16 v[116:119], a[192:195], v[208:211], v[20:23]
    s_waitcnt lgkmcnt(6)
    v_pk_mul_f16 v28, v28, v29 neg_lo:[1,0] neg_hi:[1,0]
    v_pk_mul_f16 v30, v30, v31 neg_lo:[1,0] neg_hi:[1,0]
    v_exp_f16 v29, v28
    v_mfma_f32_16x16x32_bf16 v[100:103], a[196:199], v[164:167], v[100:103]
    s_add_u32 s46, s46, s49
    ds_read_b64_tr_b16 a[212:213], v4 offset:20480
    ds_read_b64_tr_b16 a[214:215], v4 offset:22528
    v_mfma_f32_16x16x32_bf16 v[108:111], a[196:199], v[188:191], v[108:111]
    v_exp_f16 v31, v30
    v_exp_f16_sdwa v29, v28 dst_sel:WORD_1 dst_unused:UNUSED_PRESERVE src0_sel:WORD_1
    v_mfma_f32_16x16x32_bf16 v[116:119], a[196:199], v[212:215], v[116:119]
    s_waitcnt lgkmcnt(6)
    v_exp_f16_sdwa v31, v30 dst_sel:WORD_1 dst_unused:UNUSED_PRESERVE src0_sel:WORD_1
    v_pk_add_f16 v28, v29, 1.0 op_sel_hi:[1,0]
    v_mfma_f32_16x16x32_bf16 v[100:103], a[200:203], v[168:171], v[100:103]
    s_add_u32 s35, s35, 128
    ds_read_b128 v[24:27], v13
    ds_read_b64_tr_b16 a[192:193], v5 offset:0
    ds_read_b64_tr_b16 a[194:195], v5 offset:2048
    v_mfma_f32_16x16x32_bf16 v[108:111], a[200:203], v[192:195], v[108:111]
    v_pk_add_f16 v30, v31, 1.0 op_sel_hi:[1,0]
    v_rcp_f16 v29, v28
    v_mfma_f32_16x16x32_bf16 v[116:119], a[200:203], v[216:219], v[116:119]
    s_waitcnt lgkmcnt(7)
    v_rcp_f16 v31, v30
    v_rcp_f16_sdwa v29, v28 dst_sel:WORD_1 dst_unused:UNUSED_PRESERVE src0_sel:WORD_1
    v_mfma_f32_16x16x32_bf16 v[100:103], a[204:207], v[172:175], v[100:103]
    s_add_u32 s36, s36, 24576
    ds_read_b64_tr_b16 a[196:197], v5 offset:4096
    ds_read_b64_tr_b16 a[198:199], v5 offset:6144
    v_mfma_f32_16x16x32_bf16 v[108:111], a[204:207], v[196:199], v[108:111]
    v_rcp_f16_sdwa v31, v30 dst_sel:WORD_1 dst_unused:UNUSED_PRESERVE src0_sel:WORD_1
    v_fma_mix_f32 v28, v76, v29, 0 op_sel_hi:[0,1,0]
    v_fma_mix_f32 v30, v78, v31, 0 op_sel_hi:[0,1,0]
    v_mfma_f32_16x16x32_bf16 v[116:119], a[204:207], v[220:223], v[116:119]
    s_waitcnt lgkmcnt(7)
    v_fma_mix_f32 v29, v77, v29, 0 op_sel:[0,1,0] op_sel_hi:[0,1,0]
    v_fma_mix_f32 v31, v79, v31, 0 op_sel:[0,1,0] op_sel_hi:[0,1,0]
    v_cvt_pk_bf16_f32 v52, v28, v29
    v_cvt_pk_bf16_f32 v53, v30, v31
    v_mfma_f32_16x16x32_bf16 v[100:103], a[208:211], v[176:179], v[100:103]
    s_mov_b32 s38, s48
    ds_read_b64_tr_b16 a[200:201], v5 offset:8192
    ds_read_b64_tr_b16 a[202:203], v5 offset:10240
    v_cvt_pk_f16_f32 v32, v80, v81
    v_mfma_f32_16x16x32_bf16 v[108:111], a[208:211], v[200:203], v[108:111]
    v_cvt_pk_f16_f32 v34, v82, v83
    v_pk_fma_f16 v33, v32, v32, s32
    v_pk_fma_f16 v35, v34, v34, s32
    v_mfma_f32_16x16x32_bf16 v[116:119], a[208:211], v[224:227], v[116:119]
    s_waitcnt lgkmcnt(7)
    v_pk_mul_f16 v32, v32, v33 neg_lo:[1,0] neg_hi:[1,0]
    v_pk_mul_f16 v34, v34, v35 neg_lo:[1,0] neg_hi:[1,0]
    v_mfma_f32_16x16x32_bf16 v[100:103], a[212:215], v[180:183], v[100:103]
    s_mov_b32 s48, s49
    ds_read_b64_tr_b16 a[204:205], v5 offset:12288
    ds_read_b64_tr_b16 a[206:207], v5 offset:14336
    v_exp_f16 v33, v32
    v_mfma_f32_16x16x32_bf16 v[108:111], a[212:215], v[204:207], v[108:111]
    v_exp_f16 v35, v34
    v_exp_f16_sdwa v33, v32 dst_sel:WORD_1 dst_unused:UNUSED_PRESERVE src0_sel:WORD_1
    v_mfma_f32_16x16x32_bf16 v[116:119], a[212:215], v[228:231], v[116:119]
    s_waitcnt lgkmcnt(6)
    v_exp_f16_sdwa v35, v34 dst_sel:WORD_1 dst_unused:UNUSED_PRESERVE src0_sel:WORD_1
    v_pk_add_f16 v32, v33, 1.0 op_sel_hi:[1,0]
    v_mfma_f32_16x16x32_bf16 v[104:107], a[192:195], v[160:163], v[24:27]
    s_mov_b32 s49, s33
    ds_read_b64_tr_b16 a[208:209], v5 offset:16384
    ds_read_b64_tr_b16 a[210:211], v5 offset:18432
    v_pk_add_f16 v34, v35, 1.0 op_sel_hi:[1,0]
    v_mfma_f32_16x16x32_bf16 v[112:115], a[192:195], v[184:187], v[24:27]
    v_rcp_f16 v33, v32
    v_mfma_f32_16x16x32_bf16 v[120:123], a[192:195], v[208:211], v[24:27]
    s_waitcnt lgkmcnt(6)
    v_rcp_f16 v35, v34
    v_rcp_f16_sdwa v33, v32 dst_sel:WORD_1 dst_unused:UNUSED_PRESERVE src0_sel:WORD_1
    v_mfma_f32_16x16x32_bf16 v[104:107], a[196:199], v[164:167], v[104:107]
    s_sub_u32 s37, s37, 1
    ds_read_b64_tr_b16 a[212:213], v5 offset:20480
    ds_read_b64_tr_b16 a[214:215], v5 offset:22528
    v_rcp_f16_sdwa v35, v34 dst_sel:WORD_1 dst_unused:UNUSED_PRESERVE src0_sel:WORD_1
    v_mfma_f32_16x16x32_bf16 v[112:115], a[196:199], v[188:191], v[112:115]
    v_fma_mix_f32 v32, v80, v33, 0 op_sel_hi:[0,1,0]
    v_fma_mix_f32 v34, v82, v35, 0 op_sel_hi:[0,1,0]
    v_fma_mix_f32 v33, v81, v33, 0 op_sel:[0,1,0] op_sel_hi:[0,1,0]
    v_mfma_f32_16x16x32_bf16 v[120:123], a[196:199], v[212:215], v[120:123]
    s_waitcnt lgkmcnt(6)
    v_fma_mix_f32 v35, v83, v35, 0 op_sel:[0,1,0] op_sel_hi:[0,1,0]
    v_cvt_pk_bf16_f32 v54, v32, v33
    v_cvt_pk_bf16_f32 v55, v34, v35
    v_mfma_f32_16x16x32_bf16 v[104:107], a[200:203], v[168:171], v[104:107]
    s_cmp_lg_u32 s37, 0
    ds_read_b64_tr_b16 a[192:193], v8 offset:0
    ds_read_b64_tr_b16 a[194:195], v9 offset:0
    v_cvt_pk_f16_f32 v28, v84, v85
    v_mfma_f32_16x16x32_bf16 v[112:115], a[200:203], v[192:195], v[112:115]
    v_cvt_pk_f16_f32 v30, v86, v87
    v_pk_fma_f16 v29, v28, v28, s32
    v_pk_fma_f16 v31, v30, v30, s32
    v_mfma_f32_16x16x32_bf16 v[120:123], a[200:203], v[216:219], v[120:123]
    s_waitcnt lgkmcnt(6)
    v_pk_mul_f16 v28, v28, v29 neg_lo:[1,0] neg_hi:[1,0]
    v_pk_mul_f16 v30, v30, v31 neg_lo:[1,0] neg_hi:[1,0]
    v_exp_f16 v29, v28
    v_mfma_f32_16x16x32_bf16 v[104:107], a[204:207], v[172:175], v[104:107]
    ds_read_b64_tr_b16 a[196:197], v8 offset:8
    ds_read_b64_tr_b16 a[198:199], v9 offset:8
    v_mfma_f32_16x16x32_bf16 v[112:115], a[204:207], v[196:199], v[112:115]
    v_exp_f16 v31, v30
    v_exp_f16_sdwa v29, v28 dst_sel:WORD_1 dst_unused:UNUSED_PRESERVE src0_sel:WORD_1
    v_mfma_f32_16x16x32_bf16 v[120:123], a[204:207], v[220:223], v[120:123]
    s_waitcnt lgkmcnt(6)
    v_exp_f16_sdwa v31, v30 dst_sel:WORD_1 dst_unused:UNUSED_PRESERVE src0_sel:WORD_1
    v_pk_add_f16 v28, v29, 1.0 op_sel_hi:[1,0]
    v_mfma_f32_16x16x32_bf16 v[104:107], a[208:211], v[176:179], v[104:107]
    ds_read_b64_tr_b16 a[200:201], v8 offset:512
    ds_read_b64_tr_b16 a[202:203], v9 offset:512
    v_pk_add_f16 v30, v31, 1.0 op_sel_hi:[1,0]
    v_mfma_f32_16x16x32_bf16 v[112:115], a[208:211], v[200:203], v[112:115]
    v_rcp_f16 v29, v28
    v_rcp_f16 v31, v30
    v_mfma_f32_16x16x32_bf16 v[120:123], a[208:211], v[224:227], v[120:123]
    s_waitcnt lgkmcnt(6)
    v_rcp_f16_sdwa v29, v28 dst_sel:WORD_1 dst_unused:UNUSED_PRESERVE src0_sel:WORD_1
    v_mfma_f32_16x16x32_bf16 v[104:107], a[212:215], v[180:183], v[104:107]
    ds_read_b64_tr_b16 a[204:205], v8 offset:520
    ds_read_b64_tr_b16 a[206:207], v9 offset:520
    v_rcp_f16_sdwa v31, v30 dst_sel:WORD_1 dst_unused:UNUSED_PRESERVE src0_sel:WORD_1
    v_mfma_f32_16x16x32_bf16 v[112:115], a[212:215], v[204:207], v[112:115]
    v_fma_mix_f32 v28, v84, v29, 0 op_sel_hi:[0,1,0]
    v_fma_mix_f32 v30, v86, v31, 0 op_sel_hi:[0,1,0]
    v_fma_mix_f32 v29, v85, v29, 0 op_sel:[0,1,0] op_sel_hi:[0,1,0]
    v_mfma_f32_16x16x32_bf16 v[120:123], a[212:215], v[228:231], v[120:123]
    s_waitcnt lgkmcnt(6)
    v_fma_mix_f32 v31, v87, v31, 0 op_sel:[0,1,0] op_sel_hi:[0,1,0]
    v_cvt_pk_bf16_f32 v56, v28, v29
    v_cvt_pk_bf16_f32 v57, v30, v31
    v_cvt_pk_f16_f32 v32, v88, v89
    v_mfma_f32_16x16x32_bf16 a[0:3], a[192:195], v[64:67], a[0:3]
    ds_read_b64_tr_b16 a[208:209], v8 offset:1024
    ds_read_b64_tr_b16 a[210:211], v9 offset:1024
    v_cvt_pk_f16_f32 v34, v90, v91
    v_mfma_f32_16x16x32_bf16 a[48:51], a[192:195], v[68:71], a[48:51]
    v_pk_fma_f16 v33, v32, v32, s32
    v_pk_fma_f16 v35, v34, v34, s32
    v_pk_mul_f16 v32, v32, v33 neg_lo:[1,0] neg_hi:[1,0]
    v_mfma_f32_16x16x32_bf16 a[96:99], a[192:195], v[72:75], a[96:99]
    s_waitcnt lgkmcnt(6)
    v_pk_mul_f16 v34, v34, v35 neg_lo:[1,0] neg_hi:[1,0]
    v_exp_f16 v33, v32
    v_mfma_f32_16x16x32_bf16 a[4:7], a[196:199], v[64:67], a[4:7]
    ds_read_b64_tr_b16 a[212:213], v8 offset:1032
    ds_read_b64_tr_b16 a[214:215], v9 offset:1032
    v_mfma_f32_16x16x32_bf16 a[52:55], a[196:199], v[68:71], a[52:55]
    v_exp_f16 v35, v34
    v_exp_f16_sdwa v33, v32 dst_sel:WORD_1 dst_unused:UNUSED_PRESERVE src0_sel:WORD_1
    v_mfma_f32_16x16x32_bf16 a[100:103], a[196:199], v[72:75], a[100:103]
    s_waitcnt lgkmcnt(6)
    v_exp_f16_sdwa v35, v34 dst_sel:WORD_1 dst_unused:UNUSED_PRESERVE src0_sel:WORD_1
    v_pk_add_f16 v32, v33, 1.0 op_sel_hi:[1,0]
    v_pk_add_f16 v34, v35, 1.0 op_sel_hi:[1,0]
    v_mfma_f32_16x16x32_bf16 a[8:11], a[200:203], v[64:67], a[8:11]
    ds_read_b64_tr_b16 a[192:193], v8 offset:1536
    ds_read_b64_tr_b16 a[194:195], v9 offset:1536
    v_mfma_f32_16x16x32_bf16 a[56:59], a[200:203], v[68:71], a[56:59]
    v_rcp_f16 v33, v32
    v_rcp_f16 v35, v34
    v_mfma_f32_16x16x32_bf16 a[104:107], a[200:203], v[72:75], a[104:107]
    s_waitcnt lgkmcnt(6)
    v_rcp_f16_sdwa v33, v32 dst_sel:WORD_1 dst_unused:UNUSED_PRESERVE src0_sel:WORD_1
    v_mfma_f32_16x16x32_bf16 a[12:15], a[204:207], v[64:67], a[12:15]
    ds_read_b64_tr_b16 a[196:197], v8 offset:1544
    ds_read_b64_tr_b16 a[198:199], v9 offset:1544
    v_rcp_f16_sdwa v35, v34 dst_sel:WORD_1 dst_unused:UNUSED_PRESERVE src0_sel:WORD_1
    v_fma_mix_f32 v32, v88, v33, 0 op_sel_hi:[0,1,0]
    v_mfma_f32_16x16x32_bf16 a[60:63], a[204:207], v[68:71], a[60:63]
    v_fma_mix_f32 v34, v90, v35, 0 op_sel_hi:[0,1,0]
    v_fma_mix_f32 v33, v89, v33, 0 op_sel:[0,1,0] op_sel_hi:[0,1,0]
    v_fma_mix_f32 v35, v91, v35, 0 op_sel:[0,1,0] op_sel_hi:[0,1,0]
    v_mfma_f32_16x16x32_bf16 a[108:111], a[204:207], v[72:75], a[108:111]
    s_waitcnt lgkmcnt(6)
    v_cvt_pk_bf16_f32 v58, v32, v33
    v_cvt_pk_bf16_f32 v59, v34, v35
    v_cvt_pk_f16_f32 v28, v92, v93
    v_mfma_f32_16x16x32_bf16 a[16:19], a[208:211], v[64:67], a[16:19]
    ds_read_b64_tr_b16 a[200:201], v8 offset:2048
    ds_read_b64_tr_b16 a[202:203], v9 offset:2048
    v_cvt_pk_f16_f32 v30, v94, v95
    v_mfma_f32_16x16x32_bf16 a[64:67], a[208:211], v[68:71], a[64:67]
    v_pk_fma_f16 v29, v28, v28, s32
    v_pk_fma_f16 v31, v30, v30, s32
    v_pk_mul_f16 v28, v28, v29 neg_lo:[1,0] neg_hi:[1,0]
    v_mfma_f32_16x16x32_bf16 a[112:115], a[208:211], v[72:75], a[112:115]
    s_waitcnt lgkmcnt(6)
    v_pk_mul_f16 v30, v30, v31 neg_lo:[1,0] neg_hi:[1,0]
    v_exp_f16 v29, v28
    v_mfma_f32_16x16x32_bf16 a[20:23], a[212:215], v[64:67], a[20:23]
    ds_read_b64_tr_b16 a[204:205], v8 offset:2056
    ds_read_b64_tr_b16 a[206:207], v9 offset:2056
    v_exp_f16 v31, v30
    v_mfma_f32_16x16x32_bf16 a[68:71], a[212:215], v[68:71], a[68:71]
    v_exp_f16_sdwa v29, v28 dst_sel:WORD_1 dst_unused:UNUSED_PRESERVE src0_sel:WORD_1
    v_mfma_f32_16x16x32_bf16 a[116:119], a[212:215], v[72:75], a[116:119]
    s_waitcnt lgkmcnt(6)
    v_exp_f16_sdwa v31, v30 dst_sel:WORD_1 dst_unused:UNUSED_PRESERVE src0_sel:WORD_1
    v_pk_add_f16 v28, v29, 1.0 op_sel_hi:[1,0]
    v_pk_add_f16 v30, v31, 1.0 op_sel_hi:[1,0]
    v_mfma_f32_16x16x32_bf16 a[24:27], a[192:195], v[64:67], a[24:27]
    ds_read_b64_tr_b16 a[208:209], v8 offset:2560
    ds_read_b64_tr_b16 a[210:211], v9 offset:2560
    v_mfma_f32_16x16x32_bf16 a[72:75], a[192:195], v[68:71], a[72:75]
    v_rcp_f16 v29, v28
    v_rcp_f16 v31, v30
    v_mfma_f32_16x16x32_bf16 a[120:123], a[192:195], v[72:75], a[120:123]
    s_waitcnt lgkmcnt(6)
    v_rcp_f16_sdwa v29, v28 dst_sel:WORD_1 dst_unused:UNUSED_PRESERVE src0_sel:WORD_1
    v_rcp_f16_sdwa v31, v30 dst_sel:WORD_1 dst_unused:UNUSED_PRESERVE src0_sel:WORD_1
    v_mfma_f32_16x16x32_bf16 a[28:31], a[196:199], v[64:67], a[28:31]
    ds_read_b64_tr_b16 a[212:213], v8 offset:2568
    ds_read_b64_tr_b16 a[214:215], v9 offset:2568
    v_add_u32 v8, s33, v8
    v_add_u32 v9, s33, v9
    v_mfma_f32_16x16x32_bf16 a[76:79], a[196:199], v[68:71], a[76:79]
    v_fma_mix_f32 v28, v92, v29, 0 op_sel_hi:[0,1,0]
    v_fma_mix_f32 v30, v94, v31, 0 op_sel_hi:[0,1,0]
    v_mfma_f32_16x16x32_bf16 a[124:127], a[196:199], v[72:75], a[124:127]
    s_waitcnt lgkmcnt(6)
    v_fma_mix_f32 v29, v93, v29, 0 op_sel:[0,1,0] op_sel_hi:[0,1,0]
    v_fma_mix_f32 v31, v95, v31, 0 op_sel:[0,1,0] op_sel_hi:[0,1,0]
    v_cvt_pk_bf16_f32 v60, v28, v29
    v_cvt_pk_bf16_f32 v61, v30, v31
    v_mfma_f32_16x16x32_bf16 a[32:35], a[200:203], v[64:67], a[32:35]
    ds_read_b64_tr_b16 a[192:193], v6 offset:0
    ds_read_b64_tr_b16 a[194:195], v7 offset:0
    v_cvt_pk_f16_f32 v32, v96, v97
    v_mfma_f32_16x16x32_bf16 a[80:83], a[200:203], v[68:71], a[80:83]
    v_cvt_pk_f16_f32 v34, v98, v99
    v_pk_fma_f16 v33, v32, v32, s32
    v_pk_fma_f16 v35, v34, v34, s32
    v_mfma_f32_16x16x32_bf16 a[128:131], a[200:203], v[72:75], a[128:131]
    s_waitcnt lgkmcnt(6)
    v_pk_mul_f16 v32, v32, v33 neg_lo:[1,0] neg_hi:[1,0]
    v_pk_mul_f16 v34, v34, v35 neg_lo:[1,0] neg_hi:[1,0]
    v_mfma_f32_16x16x32_bf16 a[36:39], a[204:207], v[64:67], a[36:39]
    ds_read_b64_tr_b16 a[196:197], v6 offset:8
    ds_read_b64_tr_b16 a[198:199], v7 offset:8
    v_exp_f16 v33, v32
    v_mfma_f32_16x16x32_bf16 a[84:87], a[204:207], v[68:71], a[84:87]
    v_exp_f16 v35, v34
    v_exp_f16_sdwa v33, v32 dst_sel:WORD_1 dst_unused:UNUSED_PRESERVE src0_sel:WORD_1
    v_mfma_f32_16x16x32_bf16 a[132:135], a[204:207], v[72:75], a[132:135]
    s_waitcnt lgkmcnt(6)
    v_exp_f16_sdwa v35, v34 dst_sel:WORD_1 dst_unused:UNUSED_PRESERVE src0_sel:WORD_1
    v_pk_add_f16 v32, v33, 1.0 op_sel_hi:[1,0]
    v_mfma_f32_16x16x32_bf16 a[40:43], a[208:211], v[64:67], a[40:43]
    ds_read_b64_tr_b16 a[200:201], v6 offset:512
    ds_read_b64_tr_b16 a[202:203], v7 offset:512
    v_pk_add_f16 v34, v35, 1.0 op_sel_hi:[1,0]
    v_mfma_f32_16x16x32_bf16 a[88:91], a[208:211], v[68:71], a[88:91]
    v_rcp_f16 v33, v32
    v_mfma_f32_16x16x32_bf16 a[136:139], a[208:211], v[72:75], a[136:139]
    s_waitcnt lgkmcnt(6)
    v_rcp_f16 v35, v34
    v_rcp_f16_sdwa v33, v32 dst_sel:WORD_1 dst_unused:UNUSED_PRESERVE src0_sel:WORD_1
    v_mfma_f32_16x16x32_bf16 a[44:47], a[212:215], v[64:67], a[44:47]
    ds_read_b64_tr_b16 a[204:205], v6 offset:520
    ds_read_b64_tr_b16 a[206:207], v7 offset:520
    v_rcp_f16_sdwa v35, v34 dst_sel:WORD_1 dst_unused:UNUSED_PRESERVE src0_sel:WORD_1
    v_mfma_f32_16x16x32_bf16 a[92:95], a[212:215], v[68:71], a[92:95]
    s_mov_b32 s33, s38
    v_fma_mix_f32 v32, v96, v33, 0 op_sel_hi:[0,1,0]
    v_fma_mix_f32 v34, v98, v35, 0 op_sel_hi:[0,1,0]
    v_fma_mix_f32 v33, v97, v33, 0 op_sel:[0,1,0] op_sel_hi:[0,1,0]
    v_mfma_f32_16x16x32_bf16 a[140:143], a[212:215], v[72:75], a[140:143]
    s_waitcnt lgkmcnt(6)
    v_fma_mix_f32 v35, v99, v35, 0 op_sel:[0,1,0] op_sel_hi:[0,1,0]
    v_cvt_pk_bf16_f32 v62, v32, v33
    v_cvt_pk_bf16_f32 v63, v34, v35
    s_mul_i32 s39, s28, 258048
    s_add_u32 s39, s39, s29
    s_mul_i32 s40, s28, 12288
    s_add_u32 s41, s40, 49408
    s_add_u32 s40, s40, 49408
    v_mfma_f32_16x16x32_bf16 a[0:3], a[192:195], v[52:55], a[0:3]
    ds_read_b64_tr_b16 a[208:209], v6 offset:1024
    ds_read_b64_tr_b16 a[210:211], v7 offset:1024
    v_cvt_pk_f16_f32 v28, v100, v101
    v_cvt_pk_f16_f32 v30, v102, v103
    v_mfma_f32_16x16x32_bf16 a[48:51], a[192:195], v[56:59], a[48:51]
    v_pk_fma_f16 v29, v28, v28, s32
    v_pk_fma_f16 v31, v30, v30, s32
    v_pk_mul_f16 v28, v28, v29 neg_lo:[1,0] neg_hi:[1,0]
    v_mfma_f32_16x16x32_bf16 a[96:99], a[192:195], v[60:63], a[96:99]
    s_waitcnt lgkmcnt(6)
    ds_read_b128 v[76:79], v17 offset:1024
    v_pk_mul_f16 v30, v30, v31 neg_lo:[1,0] neg_hi:[1,0]
    v_exp_f16 v29, v28
    v_mfma_f32_16x16x32_bf16 a[4:7], a[196:199], v[52:55], a[4:7]
    ds_read_b64_tr_b16 a[212:213], v6 offset:1032
    ds_read_b64_tr_b16 a[214:215], v7 offset:1032
    v_exp_f16 v31, v30
    v_mfma_f32_16x16x32_bf16 a[52:55], a[196:199], v[56:59], a[52:55]
    v_exp_f16_sdwa v29, v28 dst_sel:WORD_1 dst_unused:UNUSED_PRESERVE src0_sel:WORD_1
    v_mfma_f32_16x16x32_bf16 a[100:103], a[196:199], v[60:63], a[100:103]
    s_waitcnt lgkmcnt(7)
    ds_read_b128 v[80:83], v17 offset:1040
    v_exp_f16_sdwa v31, v30 dst_sel:WORD_1 dst_unused:UNUSED_PRESERVE src0_sel:WORD_1
    v_pk_add_f16 v28, v29, 1.0 op_sel_hi:[1,0]
    v_pk_add_f16 v30, v31, 1.0 op_sel_hi:[1,0]
    v_mfma_f32_16x16x32_bf16 a[8:11], a[200:203], v[52:55], a[8:11]
    ds_read_b64_tr_b16 a[192:193], v6 offset:1536
    ds_read_b64_tr_b16 a[194:195], v7 offset:1536
    v_rcp_f16 v29, v28
    v_mfma_f32_16x16x32_bf16 a[56:59], a[200:203], v[56:59], a[56:59]
    v_rcp_f16 v31, v30
    v_rcp_f16_sdwa v29, v28 dst_sel:WORD_1 dst_unused:UNUSED_PRESERVE src0_sel:WORD_1
    v_mfma_f32_16x16x32_bf16 a[104:107], a[200:203], v[60:63], a[104:107]
    s_waitcnt lgkmcnt(8)
    ds_read_b128 v[84:87], v17 offset:1152
    v_rcp_f16_sdwa v31, v30 dst_sel:WORD_1 dst_unused:UNUSED_PRESERVE src0_sel:WORD_1
    v_mfma_f32_16x16x32_bf16 a[12:15], a[204:207], v[52:55], a[12:15]
    ds_read_b64_tr_b16 a[196:197], v6 offset:1544
    ds_read_b64_tr_b16 a[198:199], v7 offset:1544
    v_fma_mix_f32 v28, v100, v29, 0 op_sel_hi:[0,1,0]
    v_fma_mix_f32 v30, v102, v31, 0 op_sel_hi:[0,1,0]
    v_mfma_f32_16x16x32_bf16 a[60:63], a[204:207], v[56:59], a[60:63]
    v_fma_mix_f32 v29, v101, v29, 0 op_sel:[0,1,0] op_sel_hi:[0,1,0]
    v_fma_mix_f32 v31, v103, v31, 0 op_sel:[0,1,0] op_sel_hi:[0,1,0]
    v_cvt_pk_bf16_f32 v64, v28, v29
    v_cvt_pk_bf16_f32 v65, v30, v31
    v_mfma_f32_16x16x32_bf16 a[108:111], a[204:207], v[60:63], a[108:111]
    s_waitcnt lgkmcnt(9)
    ds_read_b128 v[88:91], v17 offset:1168
    v_cvt_pk_f16_f32 v32, v104, v105
    v_cvt_pk_f16_f32 v34, v106, v107
    v_mfma_f32_16x16x32_bf16 a[16:19], a[208:211], v[52:55], a[16:19]
    ds_read_b64_tr_b16 a[200:201], v6 offset:2048
    ds_read_b64_tr_b16 a[202:203], v7 offset:2048
    v_pk_fma_f16 v33, v32, v32, s32
    v_pk_fma_f16 v35, v34, v34, s32
    v_mfma_f32_16x16x32_bf16 a[64:67], a[208:211], v[56:59], a[64:67]
    v_pk_mul_f16 v32, v32, v33 neg_lo:[1,0] neg_hi:[1,0]
    v_pk_mul_f16 v34, v34, v35 neg_lo:[1,0] neg_hi:[1,0]
    v_exp_f16 v33, v32
    v_mfma_f32_16x16x32_bf16 a[112:115], a[208:211], v[60:63], a[112:115]
    s_waitcnt lgkmcnt(9)
    ds_read_b128 v[92:95], v17 offset:1280
    v_exp_f16 v35, v34
    v_mfma_f32_16x16x32_bf16 a[20:23], a[212:215], v[52:55], a[20:23]
    ds_read_b64_tr_b16 a[204:205], v6 offset:2056
    ds_read_b64_tr_b16 a[206:207], v7 offset:2056
    v_exp_f16_sdwa v33, v32 dst_sel:WORD_1 dst_unused:UNUSED_PRESERVE src0_sel:WORD_1
    v_mfma_f32_16x16x32_bf16 a[68:71], a[212:215], v[56:59], a[68:71]
    v_exp_f16_sdwa v35, v34 dst_sel:WORD_1 dst_unused:UNUSED_PRESERVE src0_sel:WORD_1
    v_pk_add_f16 v32, v33, 1.0 op_sel_hi:[1,0]
    v_pk_add_f16 v34, v35, 1.0 op_sel_hi:[1,0]
    v_mfma_f32_16x16x32_bf16 a[116:119], a[212:215], v[60:63], a[116:119]
    s_waitcnt lgkmcnt(9)
    ds_read_b128 v[96:99], v17 offset:1296
    v_rcp_f16 v33, v32
    v_mfma_f32_16x16x32_bf16 a[24:27], a[192:195], v[52:55], a[24:27]
    ds_read_b64_tr_b16 a[208:209], v6 offset:2560
    ds_read_b64_tr_b16 a[210:211], v7 offset:2560
    v_rcp_f16 v35, v34
    v_mfma_f32_16x16x32_bf16 a[72:75], a[192:195], v[56:59], a[72:75]
    v_rcp_f16_sdwa v33, v32 dst_sel:WORD_1 dst_unused:UNUSED_PRESERVE src0_sel:WORD_1
    v_rcp_f16_sdwa v35, v34 dst_sel:WORD_1 dst_unused:UNUSED_PRESERVE src0_sel:WORD_1
    v_mfma_f32_16x16x32_bf16 a[120:123], a[192:195], v[60:63], a[120:123]
    s_waitcnt lgkmcnt(9)
    ds_read_b128 v[232:235], v17 offset:1408
    v_fma_mix_f32 v32, v104, v33, 0 op_sel_hi:[0,1,0]
    v_fma_mix_f32 v34, v106, v35, 0 op_sel_hi:[0,1,0]
    v_fma_mix_f32 v33, v105, v33, 0 op_sel:[0,1,0] op_sel_hi:[0,1,0]
    v_mfma_f32_16x16x32_bf16 a[28:31], a[196:199], v[52:55], a[28:31]
    ds_read_b64_tr_b16 a[212:213], v6 offset:2568
    ds_read_b64_tr_b16 a[214:215], v7 offset:2568
    v_fma_mix_f32 v35, v107, v35, 0 op_sel:[0,1,0] op_sel_hi:[0,1,0]
    v_mfma_f32_16x16x32_bf16 a[76:79], a[196:199], v[56:59], a[76:79]
    v_cvt_pk_bf16_f32 v66, v32, v33
    v_cvt_pk_bf16_f32 v67, v34, v35
    v_and_b32 v12, 15, v1
    v_lshrrev_b32 v13, 4, v1
    v_mfma_f32_16x16x32_bf16 a[124:127], a[196:199], v[60:63], a[124:127]
    s_waitcnt lgkmcnt(9)
    ds_read_b128 v[236:239], v17 offset:1424
    v_lshl_add_u32 v2, v12, 7, s40
    v_and_b32 v12, 7, v12
    v_xor_b32 v13, v12, v13
    v_mfma_f32_16x16x32_bf16 a[32:35], a[200:203], v[52:55], a[32:35]
    ds_read_b64_tr_b16 a[192:193], v8 offset:0
    ds_read_b64_tr_b16 a[194:195], v9 offset:0
    v_lshl_add_u32 v2, v13, 4, v2
    v_mfma_f32_16x16x32_bf16 a[80:83], a[200:203], v[56:59], a[80:83]
    v_xor_b32 v3, 64, v2
    v_lshrrev_b32 v13, 3, v1
    v_xor_b32 v4, v13, v1
    v_lshl_add_u32 v4, v4, 4, s40
    v_mfma_f32_16x16x32_bf16 a[128:131], a[200:203], v[60:63], a[128:131]
    s_waitcnt lgkmcnt(9)
    ds_read_b128 v[240:243], v17 offset:1536
    v_mul_u32_u24 v13, 384, v13
    v_lshl_add_u32 v5, v12, 4, v13
    v_add_u32 v5, s39, v5
    v_mfma_f32_16x16x32_bf16 a[36:39], a[204:207], v[52:55], a[36:39]
    ds_read_b64_tr_b16 a[196:197], v8 offset:8
    ds_read_b64_tr_b16 a[198:199], v9 offset:8
    v_lshlrev_b32 v208, 16, v148
    v_mfma_f32_16x16x32_bf16 a[84:87], a[204:207], v[56:59], a[84:87]
    v_and_b32 v209, 0xffff0000, v148
    v_lshlrev_b32 v210, 16, v149
    v_and_b32 v211, 0xffff0000, v149
    v_lshlrev_b32 v212, 16, v150
    v_mfma_f32_16x16x32_bf16 a[132:135], a[204:207], v[60:63], a[132:135]
    s_waitcnt lgkmcnt(9)
    ds_read_b128 v[244:247], v17 offset:1552
    v_and_b32 v213, 0xffff0000, v150
    v_lshlrev_b32 v214, 16, v151
    v_and_b32 v215, 0xffff0000, v151
    v_mfma_f32_16x16x32_bf16 a[40:43], a[208:211], v[52:55], a[40:43]
    ds_read_b64_tr_b16 a[200:201], v8 offset:512
    ds_read_b64_tr_b16 a[202:203], v9 offset:512
    v_lshlrev_b32 v216, 16, v152
    v_and_b32 v217, 0xffff0000, v152
    v_mfma_f32_16x16x32_bf16 a[88:91], a[208:211], v[56:59], a[88:91]
    v_lshlrev_b32 v218, 16, v153
    v_and_b32 v219, 0xffff0000, v153
    v_lshlrev_b32 v220, 16, v154
    v_mfma_f32_16x16x32_bf16 a[136:139], a[208:211], v[60:63], a[136:139]
    s_waitcnt lgkmcnt(9)
    ds_read_b128 v[248:251], v17 offset:1664
    v_and_b32 v221, 0xffff0000, v154
    v_lshlrev_b32 v222, 16, v155
    v_and_b32 v223, 0xffff0000, v155
    v_mfma_f32_16x16x32_bf16 a[44:47], a[212:215], v[52:55], a[44:47]
    ds_read_b64_tr_b16 a[204:205], v8 offset:520
    ds_read_b64_tr_b16 a[206:207], v9 offset:520
    v_lshlrev_b32 v224, 16, v124
    v_and_b32 v225, 0xffff0000, v124
    v_mfma_f32_16x16x32_bf16 a[92:95], a[212:215], v[56:59], a[92:95]
    v_lshlrev_b32 v226, 16, v125
    v_and_b32 v227, 0xffff0000, v125
    v_lshlrev_b32 v228, 16, v126
    v_mfma_f32_16x16x32_bf16 a[140:143], a[212:215], v[60:63], a[140:143]
    s_waitcnt lgkmcnt(9)
    ds_read_b128 v[252:255], v17 offset:1680
    v_and_b32 v229, 0xffff0000, v126
    v_lshlrev_b32 v230, 16, v127
    v_and_b32 v231, 0xffff0000, v127
    v_mfma_f32_16x16x32_bf16 a[0:3], a[192:195], v[64:67], a[0:3]
    s_waitcnt lgkmcnt(7)
    ds_read_b64_tr_b16 a[208:209], v8 offset:1024
    ds_read_b64_tr_b16 a[210:211], v9 offset:1024
    v_cvt_pk_f16_f32 v28, v108, v109
    v_cvt_pk_f16_f32 v30, v110, v111
    v_pk_fma_f16 v29, v28, v28, s32
    v_pk_fma_f16 v31, v30, v30, s32
    v_pk_mul_f16 v28, v28, v29 neg_lo:[1,0] neg_hi:[1,0]
    v_mfma_f32_16x16x32_bf16 a[4:7], a[196:199], v[64:67], a[4:7]
    s_waitcnt lgkmcnt(6)
    ds_read_b64_tr_b16 a[212:213], v8 offset:1032
    ds_read_b64_tr_b16 a[214:215], v9 offset:1032
    v_pk_mul_f16 v30, v30, v31 neg_lo:[1,0] neg_hi:[1,0]
    v_exp_f16 v29, v28
    v_exp_f16 v31, v30
    v_mfma_f32_16x16x32_bf16 a[8:11], a[200:203], v[64:67], a[8:11]
    s_waitcnt lgkmcnt(5)
    ds_read_b64_tr_b16 a[192:193], v8 offset:1536
    ds_read_b64_tr_b16 a[194:195], v9 offset:1536
    v_exp_f16_sdwa v29, v28 dst_sel:WORD_1 dst_unused:UNUSED_PRESERVE src0_sel:WORD_1
    v_exp_f16_sdwa v31, v30 dst_sel:WORD_1 dst_unused:UNUSED_PRESERVE src0_sel:WORD_1
    v_pk_add_f16 v28, v29, 1.0 op_sel_hi:[1,0]
    v_mfma_f32_16x16x32_bf16 a[12:15], a[204:207], v[64:67], a[12:15]
    s_waitcnt lgkmcnt(4)
    ds_read_b64_tr_b16 a[196:197], v8 offset:1544
    ds_read_b64_tr_b16 a[198:199], v9 offset:1544
    v_pk_add_f16 v30, v31, 1.0 op_sel_hi:[1,0]
    v_rcp_f16 v29, v28
    v_rcp_f16 v31, v30
    v_mfma_f32_16x16x32_bf16 a[16:19], a[208:211], v[64:67], a[16:19]
    s_waitcnt lgkmcnt(4)
    ds_read_b64_tr_b16 a[200:201], v8 offset:2048
    ds_read_b64_tr_b16 a[202:203], v9 offset:2048
    v_rcp_f16_sdwa v29, v28 dst_sel:WORD_1 dst_unused:UNUSED_PRESERVE src0_sel:WORD_1
    v_rcp_f16_sdwa v31, v30 dst_sel:WORD_1 dst_unused:UNUSED_PRESERVE src0_sel:WORD_1
    v_fma_mix_f32 v28, v108, v29, 0 op_sel_hi:[0,1,0]
    v_mfma_f32_16x16x32_bf16 a[20:23], a[212:215], v[64:67], a[20:23]
    s_waitcnt lgkmcnt(4)
    ds_read_b64_tr_b16 a[204:205], v8 offset:2056
    ds_read_b64_tr_b16 a[206:207], v9 offset:2056
    v_fma_mix_f32 v30, v110, v31, 0 op_sel_hi:[0,1,0]
    v_fma_mix_f32 v29, v109, v29, 0 op_sel:[0,1,0] op_sel_hi:[0,1,0]
    v_fma_mix_f32 v31, v111, v31, 0 op_sel:[0,1,0] op_sel_hi:[0,1,0]
    v_cvt_pk_bf16_f32 v68, v28, v29
    v_cvt_pk_bf16_f32 v69, v30, v31
    v_mfma_f32_16x16x32_bf16 a[24:27], a[192:195], v[64:67], a[24:27]
    s_waitcnt lgkmcnt(4)
    ds_read_b64_tr_b16 a[208:209], v8 offset:2560
    ds_read_b64_tr_b16 a[210:211], v9 offset:2560
    v_cvt_pk_f16_f32 v32, v112, v113
    v_cvt_pk_f16_f32 v34, v114, v115
    v_pk_fma_f16 v33, v32, v32, s32
    v_pk_fma_f16 v35, v34, v34, s32
    v_pk_mul_f16 v32, v32, v33 neg_lo:[1,0] neg_hi:[1,0]
    v_mfma_f32_16x16x32_bf16 a[28:31], a[196:199], v[64:67], a[28:31]
    s_waitcnt lgkmcnt(4)
    ds_read_b64_tr_b16 a[212:213], v8 offset:2568
    ds_read_b64_tr_b16 a[214:215], v9 offset:2568
    v_pk_mul_f16 v34, v34, v35 neg_lo:[1,0] neg_hi:[1,0]
    v_exp_f16 v33, v32
    v_exp_f16 v35, v34
    v_mfma_f32_16x16x32_bf16 a[32:35], a[200:203], v[64:67], a[32:35]
    s_waitcnt lgkmcnt(4)
    ds_read_b64_tr_b16 a[192:193], v8 offset:0
    ds_read_b64_tr_b16 a[194:195], v9 offset:0
    v_exp_f16_sdwa v33, v32 dst_sel:WORD_1 dst_unused:UNUSED_PRESERVE src0_sel:WORD_1
    v_exp_f16_sdwa v35, v34 dst_sel:WORD_1 dst_unused:UNUSED_PRESERVE src0_sel:WORD_1
    v_pk_add_f16 v32, v33, 1.0 op_sel_hi:[1,0]
    v_mfma_f32_16x16x32_bf16 a[36:39], a[204:207], v[64:67], a[36:39]
    s_waitcnt lgkmcnt(4)
    ds_read_b64_tr_b16 a[196:197], v8 offset:8
    ds_read_b64_tr_b16 a[198:199], v9 offset:8
    v_pk_add_f16 v34, v35, 1.0 op_sel_hi:[1,0]
    v_rcp_f16 v33, v32
    v_rcp_f16 v35, v34
    v_mfma_f32_16x16x32_bf16 a[40:43], a[208:211], v[64:67], a[40:43]
    s_waitcnt lgkmcnt(4)
    ds_read_b64_tr_b16 a[200:201], v8 offset:512
    ds_read_b64_tr_b16 a[202:203], v9 offset:512
    v_rcp_f16_sdwa v33, v32 dst_sel:WORD_1 dst_unused:UNUSED_PRESERVE src0_sel:WORD_1
    v_rcp_f16_sdwa v35, v34 dst_sel:WORD_1 dst_unused:UNUSED_PRESERVE src0_sel:WORD_1
    v_fma_mix_f32 v32, v112, v33, 0 op_sel_hi:[0,1,0]
    v_mfma_f32_16x16x32_bf16 a[44:47], a[212:215], v[64:67], a[44:47]
    s_waitcnt lgkmcnt(4)
    ds_read_b64_tr_b16 a[204:205], v8 offset:520
    ds_read_b64_tr_b16 a[206:207], v9 offset:520
    v_fma_mix_f32 v34, v114, v35, 0 op_sel_hi:[0,1,0]
    v_fma_mix_f32 v33, v113, v33, 0 op_sel:[0,1,0] op_sel_hi:[0,1,0]
    v_fma_mix_f32 v35, v115, v35, 0 op_sel:[0,1,0] op_sel_hi:[0,1,0]
    v_cvt_pk_bf16_f32 v70, v32, v33
    v_cvt_pk_bf16_f32 v71, v34, v35
    s_mov_b32 s38, 86016
    s_mov_b32 s47, 172032
    s_sub_u32 s41, s31, s28
    s_cmp_eq_u32 s41, 8
    s_cselect_b32 s47, 0x40000000, s47
    v_accvgpr_read_b32 v160, a0
    v_accvgpr_read_b32 v161, a1
    v_accvgpr_read_b32 v162, a2
    v_accvgpr_read_b32 v163, a3
    v_accvgpr_read_b32 v164, a4
    v_accvgpr_read_b32 v165, a5
    v_accvgpr_read_b32 v166, a6
    v_accvgpr_read_b32 v167, a7
    v_accvgpr_read_b32 v192, a216
    v_accvgpr_read_b32 v193, a217
    v_accvgpr_read_b32 v194, a218
    v_accvgpr_read_b32 v195, a219
    v_lshlrev_b32 v176, 16, v192
    v_and_b32 v177, 0xffff0000, v192
    v_lshlrev_b32 v178, 16, v193
    v_and_b32 v179, 0xffff0000, v193
    v_lshlrev_b32 v180, 16, v194
    v_and_b32 v181, 0xffff0000, v194
    v_lshlrev_b32 v182, 16, v195
    v_and_b32 v183, 0xffff0000, v195
    v_pk_fma_f32 v[176:177], v[160:161], v[76:77], v[176:177]
    v_pk_fma_f32 v[178:179], v[162:163], v[78:79], v[178:179]
    v_pk_fma_f32 v[180:181], v[164:165], v[80:81], v[180:181]
    v_pk_fma_f32 v[182:183], v[166:167], v[82:83], v[182:183]
    v_cvt_pk_bf16_f32 v200, v176, v177
    v_cvt_pk_bf16_f32 v201, v178, v179
    v_cvt_pk_bf16_f32 v202, v180, v181
    v_cvt_pk_bf16_f32 v203, v182, v183
    ds_write_b128 v2, v[200:203] offset:0
    v_accvgpr_read_b32 v168, a8
    v_accvgpr_read_b32 v169, a9
    v_accvgpr_read_b32 v170, a10
    v_accvgpr_read_b32 v171, a11
    v_accvgpr_read_b32 v172, a12
    v_accvgpr_read_b32 v173, a13
    v_accvgpr_read_b32 v174, a14
    v_accvgpr_read_b32 v175, a15
    v_accvgpr_read_b32 v196, a220
    v_accvgpr_read_b32 v197, a221
    v_accvgpr_read_b32 v198, a222
    v_accvgpr_read_b32 v199, a223
    v_lshlrev_b32 v184, 16, v196
    v_and_b32 v185, 0xffff0000, v196
    v_lshlrev_b32 v186, 16, v197
    v_and_b32 v187, 0xffff0000, v197
    v_lshlrev_b32 v188, 16, v198
    v_and_b32 v189, 0xffff0000, v198
    v_lshlrev_b32 v190, 16, v199
    v_and_b32 v191, 0xffff0000, v199
    v_pk_fma_f32 v[184:185], v[168:169], v[84:85], v[184:185]
    v_pk_fma_f32 v[186:187], v[170:171], v[86:87], v[186:187]
    v_pk_fma_f32 v[188:189], v[172:173], v[88:89], v[188:189]
    v_pk_fma_f32 v[190:191], v[174:175], v[90:91], v[190:191]
    v_cvt_pk_bf16_f32 v204, v184, v185
    v_cvt_pk_bf16_f32 v205, v186, v187
    v_cvt_pk_bf16_f32 v206, v188, v189
    v_cvt_pk_bf16_f32 v207, v190, v191
    ds_write_b128 v3, v[204:207] offset:0
    ds_read_b128 v[36:39], v4 offset:0
    ds_read_b128 v[40:43], v4 offset:1024
    v_accvgpr_read_b32 v160, a16
    v_accvgpr_read_b32 v161, a17
    v_accvgpr_read_b32 v162, a18
    v_accvgpr_read_b32 v163, a19
    v_accvgpr_read_b32 v164, a20
    v_accvgpr_read_b32 v165, a21
    v_accvgpr_read_b32 v166, a22
    v_accvgpr_read_b32 v167, a23
    v_pk_fma_f32 v[208:209], v[160:161], v[92:93], v[208:209]
    v_pk_fma_f32 v[210:211], v[162:163], v[94:95], v[210:211]
    v_pk_fma_f32 v[212:213], v[164:165], v[96:97], v[212:213]
    v_pk_fma_f32 v[214:215], v[166:167], v[98:99], v[214:215]
    v_cvt_pk_bf16_f32 v200, v208, v209
    v_cvt_pk_bf16_f32 v201, v210, v211
    v_cvt_pk_bf16_f32 v202, v212, v213
    v_cvt_pk_bf16_f32 v203, v214, v215
    s_waitcnt lgkmcnt(0)
    buffer_store_dwordx4 v[36:39], v5, s[20:23], 0 offen offset:0 sc1
    ds_write_b128 v2, v[200:203] offset:2048
    v_accvgpr_read_b32 v168, a24
    v_accvgpr_read_b32 v169, a25
    v_accvgpr_read_b32 v170, a26
    v_accvgpr_read_b32 v171, a27
    v_accvgpr_read_b32 v172, a28
    v_accvgpr_read_b32 v173, a29
    v_accvgpr_read_b32 v174, a30
    v_accvgpr_read_b32 v175, a31
    v_pk_fma_f32 v[216:217], v[168:169], v[232:233], v[216:217]
    v_pk_fma_f32 v[218:219], v[170:171], v[234:235], v[218:219]
    v_pk_fma_f32 v[220:221], v[172:173], v[236:237], v[220:221]
    v_pk_fma_f32 v[222:223], v[174:175], v[238:239], v[222:223]
    v_cvt_pk_bf16_f32 v204, v216, v217
    v_cvt_pk_bf16_f32 v205, v218, v219
    v_cvt_pk_bf16_f32 v206, v220, v221
    v_cvt_pk_bf16_f32 v207, v222, v223
    buffer_store_dwordx4 v[40:43], v5, s[20:23], 0 offen offset:3072 sc1
    ds_write_b128 v3, v[204:207] offset:2048
    ds_read_b128 v[44:47], v4 offset:2048
    ds_read_b128 v[48:51], v4 offset:3072
    v_accvgpr_read_b32 v160, a32
    v_accvgpr_read_b32 v161, a33
    v_accvgpr_read_b32 v162, a34
    v_accvgpr_read_b32 v163, a35
    v_accvgpr_read_b32 v164, a36
    v_accvgpr_read_b32 v165, a37
    v_accvgpr_read_b32 v166, a38
    v_accvgpr_read_b32 v167, a39
    v_pk_fma_f32 v[224:225], v[160:161], v[240:241], v[224:225]
    v_pk_fma_f32 v[226:227], v[162:163], v[242:243], v[226:227]
    v_pk_fma_f32 v[228:229], v[164:165], v[244:245], v[228:229]
    v_pk_fma_f32 v[230:231], v[166:167], v[246:247], v[230:231]
    v_cvt_pk_bf16_f32 v200, v224, v225
    v_cvt_pk_bf16_f32 v201, v226, v227
    v_cvt_pk_bf16_f32 v202, v228, v229
    v_cvt_pk_bf16_f32 v203, v230, v231
    s_waitcnt lgkmcnt(0)
    buffer_store_dwordx4 v[44:47], v5, s[20:23], 0 offen offset:128 sc1
    ds_write_b128 v2, v[200:203] offset:4096
    v_accvgpr_read_b32 v168, a40
    v_accvgpr_read_b32 v169, a41
    v_accvgpr_read_b32 v170, a42
    v_accvgpr_read_b32 v171, a43
    v_accvgpr_read_b32 v172, a44
    v_accvgpr_read_b32 v173, a45
    v_accvgpr_read_b32 v174, a46
    v_accvgpr_read_b32 v175, a47
    v_lshlrev_b32 v184, 16, v128
    v_and_b32 v185, 0xffff0000, v128
    v_lshlrev_b32 v186, 16, v129
    v_and_b32 v187, 0xffff0000, v129
    v_lshlrev_b32 v188, 16, v130
    v_and_b32 v189, 0xffff0000, v130
    v_lshlrev_b32 v190, 16, v131
    v_and_b32 v191, 0xffff0000, v131
    v_pk_fma_f32 v[184:185], v[168:169], v[248:249], v[184:185]
    v_pk_fma_f32 v[186:187], v[170:171], v[250:251], v[186:187]
    v_pk_fma_f32 v[188:189], v[172:173], v[252:253], v[188:189]
    v_pk_fma_f32 v[190:191], v[174:175], v[254:255], v[190:191]
    v_cvt_pk_bf16_f32 v204, v184, v185
    v_cvt_pk_bf16_f32 v205, v186, v187
    v_cvt_pk_bf16_f32 v206, v188, v189
    v_cvt_pk_bf16_f32 v207, v190, v191
    buffer_store_dwordx4 v[48:51], v5, s[20:23], 0 offen offset:3200 sc1
    ds_write_b128 v3, v[204:207] offset:4096
    ds_read_b128 v[36:39], v4 offset:4096
    ds_read_b128 v[40:43], v4 offset:5120
    v_mfma_f32_16x16x32_bf16 a[48:51], a[192:195], v[68:71], a[48:51]
    s_waitcnt lgkmcnt(4)
    ds_read_b64_tr_b16 a[208:209], v8 offset:1024
    ds_read_b64_tr_b16 a[210:211], v9 offset:1024
    v_cvt_pk_f16_f32 v28, v116, v117
    v_cvt_pk_f16_f32 v30, v118, v119
    v_pk_fma_f16 v29, v28, v28, s32
    v_pk_fma_f16 v31, v30, v30, s32
    v_pk_mul_f16 v28, v28, v29 neg_lo:[1,0] neg_hi:[1,0]
    v_mfma_f32_16x16x32_bf16 a[52:55], a[196:199], v[68:71], a[52:55]
    s_waitcnt lgkmcnt(4)
    ds_read_b64_tr_b16 a[212:213], v8 offset:1032
    ds_read_b64_tr_b16 a[214:215], v9 offset:1032
    v_pk_mul_f16 v30, v30, v31 neg_lo:[1,0] neg_hi:[1,0]
    v_exp_f16 v29, v28
    v_exp_f16 v31, v30
    v_mfma_f32_16x16x32_bf16 a[56:59], a[200:203], v[68:71], a[56:59]
    s_waitcnt lgkmcnt(4)
    ds_read_b64_tr_b16 a[192:193], v8 offset:1536
    ds_read_b64_tr_b16 a[194:195], v9 offset:1536
    v_exp_f16_sdwa v29, v28 dst_sel:WORD_1 dst_unused:UNUSED_PRESERVE src0_sel:WORD_1
    v_exp_f16_sdwa v31, v30 dst_sel:WORD_1 dst_unused:UNUSED_PRESERVE src0_sel:WORD_1
    v_pk_add_f16 v28, v29, 1.0 op_sel_hi:[1,0]
    v_mfma_f32_16x16x32_bf16 a[60:63], a[204:207], v[68:71], a[60:63]
    s_waitcnt lgkmcnt(4)
    ds_read_b64_tr_b16 a[196:197], v8 offset:1544
    ds_read_b64_tr_b16 a[198:199], v9 offset:1544
    v_pk_add_f16 v30, v31, 1.0 op_sel_hi:[1,0]
    v_rcp_f16 v29, v28
    v_rcp_f16 v31, v30
    v_mfma_f32_16x16x32_bf16 a[64:67], a[208:211], v[68:71], a[64:67]
    s_waitcnt lgkmcnt(4)
    buffer_store_dwordx4 v[36:39], v5, s[20:23], 0 offen offset:256 sc1
    buffer_store_dwordx4 v[40:43], v5, s[20:23], 0 offen offset:3328 sc1
    ds_read_b64_tr_b16 a[200:201], v8 offset:2048
    ds_read_b64_tr_b16 a[202:203], v9 offset:2048
    v_rcp_f16_sdwa v29, v28 dst_sel:WORD_1 dst_unused:UNUSED_PRESERVE src0_sel:WORD_1
    v_rcp_f16_sdwa v31, v30 dst_sel:WORD_1 dst_unused:UNUSED_PRESERVE src0_sel:WORD_1
    v_fma_mix_f32 v28, v116, v29, 0 op_sel_hi:[0,1,0]
    v_mfma_f32_16x16x32_bf16 a[68:71], a[212:215], v[68:71], a[68:71]
    s_waitcnt lgkmcnt(4)
    ds_read_b64_tr_b16 a[204:205], v8 offset:2056
    ds_read_b64_tr_b16 a[206:207], v9 offset:2056
    v_fma_mix_f32 v30, v118, v31, 0 op_sel_hi:[0,1,0]
    v_fma_mix_f32 v29, v117, v29, 0 op_sel:[0,1,0] op_sel_hi:[0,1,0]
    v_fma_mix_f32 v31, v119, v31, 0 op_sel:[0,1,0] op_sel_hi:[0,1,0]
    v_cvt_pk_bf16_f32 v72, v28, v29
    v_cvt_pk_bf16_f32 v73, v30, v31
    v_mfma_f32_16x16x32_bf16 a[72:75], a[192:195], v[68:71], a[72:75]
    s_waitcnt lgkmcnt(4)
    ds_read_b64_tr_b16 a[208:209], v8 offset:2560
    ds_read_b64_tr_b16 a[210:211], v9 offset:2560
    v_cvt_pk_f16_f32 v32, v120, v121
    v_cvt_pk_f16_f32 v34, v122, v123
    v_pk_fma_f16 v33, v32, v32, s32
    v_pk_fma_f16 v35, v34, v34, s32
    v_pk_mul_f16 v32, v32, v33 neg_lo:[1,0] neg_hi:[1,0]
    v_mfma_f32_16x16x32_bf16 a[76:79], a[196:199], v[68:71], a[76:79]
    s_waitcnt lgkmcnt(4)
    ds_read_b64_tr_b16 a[212:213], v8 offset:2568
    ds_read_b64_tr_b16 a[214:215], v9 offset:2568
    v_pk_mul_f16 v34, v34, v35 neg_lo:[1,0] neg_hi:[1,0]
    v_exp_f16 v33, v32
    v_exp_f16 v35, v34
    v_mfma_f32_16x16x32_bf16 a[80:83], a[200:203], v[68:71], a[80:83]
    s_waitcnt lgkmcnt(4)
    ds_read_b64_tr_b16 a[192:193], v8 offset:0
    ds_read_b64_tr_b16 a[194:195], v9 offset:0
    v_exp_f16_sdwa v33, v32 dst_sel:WORD_1 dst_unused:UNUSED_PRESERVE src0_sel:WORD_1
    v_exp_f16_sdwa v35, v34 dst_sel:WORD_1 dst_unused:UNUSED_PRESERVE src0_sel:WORD_1
    v_pk_add_f16 v32, v33, 1.0 op_sel_hi:[1,0]
    v_mfma_f32_16x16x32_bf16 a[84:87], a[204:207], v[68:71], a[84:87]
    s_waitcnt lgkmcnt(4)
    ds_read_b64_tr_b16 a[196:197], v8 offset:8
    ds_read_b64_tr_b16 a[198:199], v9 offset:8
    v_pk_add_f16 v34, v35, 1.0 op_sel_hi:[1,0]
    v_rcp_f16 v33, v32
    v_rcp_f16 v35, v34
    v_mfma_f32_16x16x32_bf16 a[88:91], a[208:211], v[68:71], a[88:91]
    s_waitcnt lgkmcnt(4)
    ds_read_b64_tr_b16 a[200:201], v8 offset:512
    ds_read_b64_tr_b16 a[202:203], v9 offset:512
    v_rcp_f16_sdwa v33, v32 dst_sel:WORD_1 dst_unused:UNUSED_PRESERVE src0_sel:WORD_1
    v_rcp_f16_sdwa v35, v34 dst_sel:WORD_1 dst_unused:UNUSED_PRESERVE src0_sel:WORD_1
    v_fma_mix_f32 v32, v120, v33, 0 op_sel_hi:[0,1,0]
    v_mfma_f32_16x16x32_bf16 a[92:95], a[212:215], v[68:71], a[92:95]
    s_waitcnt lgkmcnt(4)
    ds_read_b64_tr_b16 a[204:205], v8 offset:520
    ds_read_b64_tr_b16 a[206:207], v9 offset:520
    v_fma_mix_f32 v34, v122, v35, 0 op_sel_hi:[0,1,0]
    v_fma_mix_f32 v33, v121, v33, 0 op_sel:[0,1,0] op_sel_hi:[0,1,0]
    v_fma_mix_f32 v35, v123, v35, 0 op_sel:[0,1,0] op_sel_hi:[0,1,0]
    v_cvt_pk_bf16_f32 v74, v32, v33
    v_cvt_pk_bf16_f32 v75, v34, v35
    v_accvgpr_read_b32 v160, a48
    v_accvgpr_read_b32 v161, a49
    v_accvgpr_read_b32 v162, a50
    v_accvgpr_read_b32 v163, a51
    v_accvgpr_read_b32 v164, a52
    v_accvgpr_read_b32 v165, a53
    v_accvgpr_read_b32 v166, a54
    v_accvgpr_read_b32 v167, a55
    v_accvgpr_read_b32 v192, a224
    v_accvgpr_read_b32 v193, a225
    v_accvgpr_read_b32 v194, a226
    v_accvgpr_read_b32 v195, a227
    v_lshlrev_b32 v176, 16, v192
    v_and_b32 v177, 0xffff0000, v192
    v_lshlrev_b32 v178, 16, v193
    v_and_b32 v179, 0xffff0000, v193
    v_lshlrev_b32 v180, 16, v194
    v_and_b32 v181, 0xffff0000, v194
    v_lshlrev_b32 v182, 16, v195
    v_and_b32 v183, 0xffff0000, v195
    v_pk_fma_f32 v[176:177], v[160:161], v[76:77], v[176:177]
    v_pk_fma_f32 v[178:179], v[162:163], v[78:79], v[178:179]
    v_pk_fma_f32 v[180:181], v[164:165], v[80:81], v[180:181]
    v_pk_fma_f32 v[182:183], v[166:167], v[82:83], v[182:183]
    v_cvt_pk_bf16_f32 v200, v176, v177
    v_cvt_pk_bf16_f32 v201, v178, v179
    v_cvt_pk_bf16_f32 v202, v180, v181
    v_cvt_pk_bf16_f32 v203, v182, v183
    ds_write_b128 v2, v[200:203] offset:6144
    v_accvgpr_read_b32 v168, a56
    v_accvgpr_read_b32 v169, a57
    v_accvgpr_read_b32 v170, a58
    v_accvgpr_read_b32 v171, a59
    v_accvgpr_read_b32 v172, a60
    v_accvgpr_read_b32 v173, a61
    v_accvgpr_read_b32 v174, a62
    v_accvgpr_read_b32 v175, a63
    v_accvgpr_read_b32 v196, a228
    v_accvgpr_read_b32 v197, a229
    v_accvgpr_read_b32 v198, a230
    v_accvgpr_read_b32 v199, a231
    v_lshlrev_b32 v184, 16, v196
    v_and_b32 v185, 0xffff0000, v196
    v_lshlrev_b32 v186, 16, v197
    v_and_b32 v187, 0xffff0000, v197
    v_lshlrev_b32 v188, 16, v198
    v_and_b32 v189, 0xffff0000, v198
    v_lshlrev_b32 v190, 16, v199
    v_and_b32 v191, 0xffff0000, v199
    v_pk_fma_f32 v[184:185], v[168:169], v[84:85], v[184:185]
    v_pk_fma_f32 v[186:187], v[170:171], v[86:87], v[186:187]
    v_pk_fma_f32 v[188:189], v[172:173], v[88:89], v[188:189]
    v_pk_fma_f32 v[190:191], v[174:175], v[90:91], v[190:191]
    v_cvt_pk_bf16_f32 v204, v184, v185
    v_cvt_pk_bf16_f32 v205, v186, v187
    v_cvt_pk_bf16_f32 v206, v188, v189
    v_cvt_pk_bf16_f32 v207, v190, v191
    ds_write_b128 v3, v[204:207] offset:6144
    ds_read_b128 v[44:47], v4 offset:6144
    ds_read_b128 v[48:51], v4 offset:7168
    v_accvgpr_read_b32 v160, a64
    v_accvgpr_read_b32 v161, a65
    v_accvgpr_read_b32 v162, a66
    v_accvgpr_read_b32 v163, a67
    v_accvgpr_read_b32 v164, a68
    v_accvgpr_read_b32 v165, a69
    v_accvgpr_read_b32 v166, a70
    v_accvgpr_read_b32 v167, a71
    v_accvgpr_read_b32 v192, a232
    v_accvgpr_read_b32 v193, a233
    v_accvgpr_read_b32 v194, a234
    v_accvgpr_read_b32 v195, a235
    v_lshlrev_b32 v176, 16, v192
    v_and_b32 v177, 0xffff0000, v192
    v_lshlrev_b32 v178, 16, v193
    v_and_b32 v179, 0xffff0000, v193
    v_lshlrev_b32 v180, 16, v194
    v_and_b32 v181, 0xffff0000, v194
    v_lshlrev_b32 v182, 16, v195
    v_and_b32 v183, 0xffff0000, v195
    v_pk_fma_f32 v[176:177], v[160:161], v[92:93], v[176:177]
    v_pk_fma_f32 v[178:179], v[162:163], v[94:95], v[178:179]
    v_pk_fma_f32 v[180:181], v[164:165], v[96:97], v[180:181]
    v_pk_fma_f32 v[182:183], v[166:167], v[98:99], v[182:183]
    v_cvt_pk_bf16_f32 v200, v176, v177
    v_cvt_pk_bf16_f32 v201, v178, v179
    v_cvt_pk_bf16_f32 v202, v180, v181
    v_cvt_pk_bf16_f32 v203, v182, v183
    s_waitcnt lgkmcnt(0)
    buffer_store_dwordx4 v[44:47], v5, s[20:23], s38 offen offset:0 sc1
    ds_write_b128 v2, v[200:203] offset:0
    v_accvgpr_read_b32 v168, a72
    v_accvgpr_read_b32 v169, a73
    v_accvgpr_read_b32 v170, a74
    v_accvgpr_read_b32 v171, a75
    v_accvgpr_read_b32 v172, a76
    v_accvgpr_read_b32 v173, a77
    v_accvgpr_read_b32 v174, a78
    v_accvgpr_read_b32 v175, a79
    v_accvgpr_read_b32 v196, a236
    v_accvgpr_read_b32 v197, a237
    v_accvgpr_read_b32 v198, a238
    v_accvgpr_read_b32 v199, a239
    v_lshlrev_b32 v184, 16, v196
    v_and_b32 v185, 0xffff0000, v196
    v_lshlrev_b32 v186, 16, v197
    v_and_b32 v187, 0xffff0000, v197
    v_lshlrev_b32 v188, 16, v198
    v_and_b32 v189, 0xffff0000, v198
    v_lshlrev_b32 v190, 16, v199
    v_and_b32 v191, 0xffff0000, v199
    v_pk_fma_f32 v[184:185], v[168:169], v[232:233], v[184:185]
    v_pk_fma_f32 v[186:187], v[170:171], v[234:235], v[186:187]
    v_pk_fma_f32 v[188:189], v[172:173], v[236:237], v[188:189]
    v_pk_fma_f32 v[190:191], v[174:175], v[238:239], v[190:191]
    v_cvt_pk_bf16_f32 v204, v184, v185
    v_cvt_pk_bf16_f32 v205, v186, v187
    v_cvt_pk_bf16_f32 v206, v188, v189
    v_cvt_pk_bf16_f32 v207, v190, v191
    buffer_store_dwordx4 v[48:51], v5, s[20:23], s38 offen offset:3072 sc1
    ds_write_b128 v3, v[204:207] offset:0
    ds_read_b128 v[36:39], v4 offset:0
    ds_read_b128 v[40:43], v4 offset:1024
    v_accvgpr_read_b32 v160, a80
    v_accvgpr_read_b32 v161, a81
    v_accvgpr_read_b32 v162, a82
    v_accvgpr_read_b32 v163, a83
    v_accvgpr_read_b32 v164, a84
    v_accvgpr_read_b32 v165, a85
    v_accvgpr_read_b32 v166, a86
    v_accvgpr_read_b32 v167, a87
    v_lshlrev_b32 v176, 16, v132
    v_and_b32 v177, 0xffff0000, v132
    v_lshlrev_b32 v178, 16, v133
    v_and_b32 v179, 0xffff0000, v133
    v_lshlrev_b32 v180, 16, v134
    v_and_b32 v181, 0xffff0000, v134
    v_lshlrev_b32 v182, 16, v135
    v_and_b32 v183, 0xffff0000, v135
    v_pk_fma_f32 v[176:177], v[160:161], v[240:241], v[176:177]
    v_pk_fma_f32 v[178:179], v[162:163], v[242:243], v[178:179]
    v_pk_fma_f32 v[180:181], v[164:165], v[244:245], v[180:181]
    v_pk_fma_f32 v[182:183], v[166:167], v[246:247], v[182:183]
    v_cvt_pk_bf16_f32 v200, v176, v177
    v_cvt_pk_bf16_f32 v201, v178, v179
    v_cvt_pk_bf16_f32 v202, v180, v181
    v_cvt_pk_bf16_f32 v203, v182, v183
    s_waitcnt lgkmcnt(0)
    buffer_store_dwordx4 v[36:39], v5, s[20:23], s38 offen offset:128 sc1
    ds_write_b128 v2, v[200:203] offset:2048
    v_accvgpr_read_b32 v168, a88
    v_accvgpr_read_b32 v169, a89
    v_accvgpr_read_b32 v170, a90
    v_accvgpr_read_b32 v171, a91
    v_accvgpr_read_b32 v172, a92
    v_accvgpr_read_b32 v173, a93
    v_accvgpr_read_b32 v174, a94
    v_accvgpr_read_b32 v175, a95
    v_lshlrev_b32 v184, 16, v136
    v_and_b32 v185, 0xffff0000, v136
    v_lshlrev_b32 v186, 16, v137
    v_and_b32 v187, 0xffff0000, v137
    v_lshlrev_b32 v188, 16, v138
    v_and_b32 v189, 0xffff0000, v138
    v_lshlrev_b32 v190, 16, v139
    v_and_b32 v191, 0xffff0000, v139
    v_pk_fma_f32 v[184:185], v[168:169], v[248:249], v[184:185]
    v_pk_fma_f32 v[186:187], v[170:171], v[250:251], v[186:187]
    v_pk_fma_f32 v[188:189], v[172:173], v[252:253], v[188:189]
    v_pk_fma_f32 v[190:191], v[174:175], v[254:255], v[190:191]
    v_cvt_pk_bf16_f32 v204, v184, v185
    v_cvt_pk_bf16_f32 v205, v186, v187
    v_cvt_pk_bf16_f32 v206, v188, v189
    v_cvt_pk_bf16_f32 v207, v190, v191
    buffer_store_dwordx4 v[40:43], v5, s[20:23], s38 offen offset:3200 sc1
    ds_write_b128 v3, v[204:207] offset:2048
    ds_read_b128 v[44:47], v4 offset:2048
    ds_read_b128 v[48:51], v4 offset:3072
    v_mfma_f32_16x16x32_bf16 a[96:99], a[192:195], v[72:75], a[96:99]
    s_waitcnt lgkmcnt(4)
    ds_read_b64_tr_b16 a[208:209], v8 offset:1024
    ds_read_b64_tr_b16 a[210:211], v9 offset:1024
    v_accvgpr_read_b32 v209, a240
    v_accvgpr_read_b32 v211, a241
    v_accvgpr_read_b32 v213, a242
    v_accvgpr_read_b32 v215, a243
    v_lshlrev_b32 v208, 16, v209
    v_mfma_f32_16x16x32_bf16 a[100:103], a[196:199], v[72:75], a[100:103]
    s_waitcnt lgkmcnt(4)
    ds_read_b64_tr_b16 a[212:213], v8 offset:1032
    ds_read_b64_tr_b16 a[214:215], v9 offset:1032
    v_and_b32 v209, 0xffff0000, v209
    v_lshlrev_b32 v210, 16, v211
    v_and_b32 v211, 0xffff0000, v211
    v_lshlrev_b32 v212, 16, v213
    v_mfma_f32_16x16x32_bf16 a[104:107], a[200:203], v[72:75], a[104:107]
    s_waitcnt lgkmcnt(4)
    ds_read_b64_tr_b16 a[192:193], v8 offset:1536
    ds_read_b64_tr_b16 a[194:195], v9 offset:1536
    v_and_b32 v213, 0xffff0000, v213
    v_lshlrev_b32 v214, 16, v215
    v_and_b32 v215, 0xffff0000, v215
    v_accvgpr_read_b32 v217, a244
    v_accvgpr_read_b32 v219, a245
    v_mfma_f32_16x16x32_bf16 a[108:111], a[204:207], v[72:75], a[108:111]
    s_waitcnt lgkmcnt(4)
    ds_read_b64_tr_b16 a[196:197], v8 offset:1544
    ds_read_b64_tr_b16 a[198:199], v9 offset:1544
    v_accvgpr_read_b32 v221, a246
    v_accvgpr_read_b32 v223, a247
    v_lshlrev_b32 v216, 16, v217
    v_and_b32 v217, 0xffff0000, v217
    v_lshlrev_b32 v218, 16, v219
    v_mfma_f32_16x16x32_bf16 a[112:115], a[208:211], v[72:75], a[112:115]
    s_waitcnt lgkmcnt(4)
    buffer_store_dwordx4 v[44:47], v5, s[20:23], s38 offen offset:256 sc1
    buffer_store_dwordx4 v[48:51], v5, s[20:23], s38 offen offset:3328 sc1
    ds_read_b64_tr_b16 a[200:201], v8 offset:2048
    ds_read_b64_tr_b16 a[202:203], v9 offset:2048
    v_and_b32 v219, 0xffff0000, v219
    v_lshlrev_b32 v220, 16, v221
    v_and_b32 v221, 0xffff0000, v221
    v_lshlrev_b32 v222, 16, v223
    v_mfma_f32_16x16x32_bf16 a[116:119], a[212:215], v[72:75], a[116:119]
    s_waitcnt lgkmcnt(4)
    ds_read_b64_tr_b16 a[204:205], v8 offset:2056
    ds_read_b64_tr_b16 a[206:207], v9 offset:2056
    v_and_b32 v223, 0xffff0000, v223
    v_accvgpr_read_b32 v225, a248
    v_accvgpr_read_b32 v227, a249
    v_accvgpr_read_b32 v229, a250
    v_accvgpr_read_b32 v231, a251
    v_mfma_f32_16x16x32_bf16 a[120:123], a[192:195], v[72:75], a[120:123]
    s_waitcnt lgkmcnt(4)
    ds_read_b64_tr_b16 a[208:209], v8 offset:2560
    ds_read_b64_tr_b16 a[210:211], v9 offset:2560
    v_lshlrev_b32 v224, 16, v225
    v_and_b32 v225, 0xffff0000, v225
    v_lshlrev_b32 v226, 16, v227
    v_and_b32 v227, 0xffff0000, v227
    v_lshlrev_b32 v228, 16, v229
    v_mfma_f32_16x16x32_bf16 a[124:127], a[196:199], v[72:75], a[124:127]
    s_waitcnt lgkmcnt(4)
    ds_read_b64_tr_b16 a[212:213], v8 offset:2568
    ds_read_b64_tr_b16 a[214:215], v9 offset:2568
    v_and_b32 v229, 0xffff0000, v229
    v_lshlrev_b32 v230, 16, v231
    v_and_b32 v231, 0xffff0000, v231
    v_accvgpr_read_b32 v101, a252
    v_mfma_f32_16x16x32_bf16 a[128:131], a[200:203], v[72:75], a[128:131]
    s_waitcnt lgkmcnt(4)
    v_accvgpr_read_b32 v103, a253
    v_accvgpr_read_b32 v105, a254
    v_accvgpr_read_b32 v107, a255
    v_lshlrev_b32 v100, 16, v101
    v_and_b32 v101, 0xffff0000, v101
    v_lshlrev_b32 v102, 16, v103
    v_and_b32 v103, 0xffff0000, v103
    v_mfma_f32_16x16x32_bf16 a[132:135], a[204:207], v[72:75], a[132:135]
    s_waitcnt lgkmcnt(2)
    v_lshlrev_b32 v104, 16, v105
    v_and_b32 v105, 0xffff0000, v105
    v_lshlrev_b32 v106, 16, v107
    v_and_b32 v107, 0xffff0000, v107
    v_lshlrev_b32 v108, 16, v140
    v_and_b32 v109, 0xffff0000, v140
    v_lshlrev_b32 v110, 16, v141
    v_mfma_f32_16x16x32_bf16 a[136:139], a[208:211], v[72:75], a[136:139]
    s_waitcnt lgkmcnt(0)
    v_and_b32 v111, 0xffff0000, v141
    v_lshlrev_b32 v112, 16, v142
    v_and_b32 v113, 0xffff0000, v142
    v_lshlrev_b32 v114, 16, v143
    v_and_b32 v115, 0xffff0000, v143
    v_lshlrev_b32 v116, 16, v144
    v_mfma_f32_16x16x32_bf16 a[140:143], a[212:215], v[72:75], a[140:143]
    v_and_b32 v117, 0xffff0000, v144
    v_lshlrev_b32 v118, 16, v145
    v_and_b32 v119, 0xffff0000, v145
    v_lshlrev_b32 v120, 16, v146
    v_and_b32 v121, 0xffff0000, v146
    v_lshlrev_b32 v122, 16, v147
    v_and_b32 v123, 0xffff0000, v147
    v_accvgpr_read_b32 v160, a96
    v_accvgpr_read_b32 v161, a97
    v_accvgpr_read_b32 v162, a98
    v_accvgpr_read_b32 v163, a99
    v_accvgpr_read_b32 v164, a100
    v_accvgpr_read_b32 v165, a101
    v_accvgpr_read_b32 v166, a102
    v_accvgpr_read_b32 v167, a103
    v_pk_fma_f32 v[208:209], v[160:161], v[76:77], v[208:209]
    v_pk_fma_f32 v[210:211], v[162:163], v[78:79], v[210:211]
    v_pk_fma_f32 v[212:213], v[164:165], v[80:81], v[212:213]
    v_pk_fma_f32 v[214:215], v[166:167], v[82:83], v[214:215]
    v_cvt_pk_bf16_f32 v200, v208, v209
    v_cvt_pk_bf16_f32 v201, v210, v211
    v_cvt_pk_bf16_f32 v202, v212, v213
    v_cvt_pk_bf16_f32 v203, v214, v215
    ds_write_b128 v2, v[200:203] offset:4096
    v_accvgpr_read_b32 v168, a104
    v_accvgpr_read_b32 v169, a105
    v_accvgpr_read_b32 v170, a106
    v_accvgpr_read_b32 v171, a107
    v_accvgpr_read_b32 v172, a108
    v_accvgpr_read_b32 v173, a109
    v_accvgpr_read_b32 v174, a110
    v_accvgpr_read_b32 v175, a111
    v_pk_fma_f32 v[216:217], v[168:169], v[84:85], v[216:217]
    v_pk_fma_f32 v[218:219], v[170:171], v[86:87], v[218:219]
    v_pk_fma_f32 v[220:221], v[172:173], v[88:89], v[220:221]
    v_pk_fma_f32 v[222:223], v[174:175], v[90:91], v[222:223]
    v_cvt_pk_bf16_f32 v204, v216, v217
    v_cvt_pk_bf16_f32 v205, v218, v219
    v_cvt_pk_bf16_f32 v206, v220, v221
    v_cvt_pk_bf16_f32 v207, v222, v223
    ds_write_b128 v3, v[204:207] offset:4096
    ds_read_b128 v[36:39], v4 offset:4096
    ds_read_b128 v[40:43], v4 offset:5120
    v_accvgpr_read_b32 v160, a112
    v_accvgpr_read_b32 v161, a113
    v_accvgpr_read_b32 v162, a114
    v_accvgpr_read_b32 v163, a115
    v_accvgpr_read_b32 v164, a116
    v_accvgpr_read_b32 v165, a117
    v_accvgpr_read_b32 v166, a118
    v_accvgpr_read_b32 v167, a119
    v_pk_fma_f32 v[224:225], v[160:161], v[92:93], v[224:225]
    v_pk_fma_f32 v[226:227], v[162:163], v[94:95], v[226:227]
    v_pk_fma_f32 v[228:229], v[164:165], v[96:97], v[228:229]
    v_pk_fma_f32 v[230:231], v[166:167], v[98:99], v[230:231]
    v_cvt_pk_bf16_f32 v200, v224, v225
    v_cvt_pk_bf16_f32 v201, v226, v227
    v_cvt_pk_bf16_f32 v202, v228, v229
    v_cvt_pk_bf16_f32 v203, v230, v231
    s_waitcnt lgkmcnt(0)
    buffer_store_dwordx4 v[36:39], v5, s[20:23], s47 offen offset:0 sc1
    ds_write_b128 v2, v[200:203] offset:6144
    v_accvgpr_read_b32 v168, a120
    v_accvgpr_read_b32 v169, a121
    v_accvgpr_read_b32 v170, a122
    v_accvgpr_read_b32 v171, a123
    v_accvgpr_read_b32 v172, a124
    v_accvgpr_read_b32 v173, a125
    v_accvgpr_read_b32 v174, a126
    v_accvgpr_read_b32 v175, a127
    v_pk_fma_f32 v[100:101], v[168:169], v[232:233], v[100:101]
    v_pk_fma_f32 v[102:103], v[170:171], v[234:235], v[102:103]
    v_pk_fma_f32 v[104:105], v[172:173], v[236:237], v[104:105]
    v_pk_fma_f32 v[106:107], v[174:175], v[238:239], v[106:107]
    v_cvt_pk_bf16_f32 v204, v100, v101
    v_cvt_pk_bf16_f32 v205, v102, v103
    v_cvt_pk_bf16_f32 v206, v104, v105
    v_cvt_pk_bf16_f32 v207, v106, v107
    buffer_store_dwordx4 v[40:43], v5, s[20:23], s47 offen offset:3072 sc1
    ds_write_b128 v3, v[204:207] offset:6144
    ds_read_b128 v[44:47], v4 offset:6144
    ds_read_b128 v[48:51], v4 offset:7168
    v_accvgpr_read_b32 v160, a128
    v_accvgpr_read_b32 v161, a129
    v_accvgpr_read_b32 v162, a130
    v_accvgpr_read_b32 v163, a131
    v_accvgpr_read_b32 v164, a132
    v_accvgpr_read_b32 v165, a133
    v_accvgpr_read_b32 v166, a134
    v_accvgpr_read_b32 v167, a135
    v_pk_fma_f32 v[108:109], v[160:161], v[240:241], v[108:109]
    v_pk_fma_f32 v[110:111], v[162:163], v[242:243], v[110:111]
    v_pk_fma_f32 v[112:113], v[164:165], v[244:245], v[112:113]
    v_pk_fma_f32 v[114:115], v[166:167], v[246:247], v[114:115]
    v_cvt_pk_bf16_f32 v200, v108, v109
    v_cvt_pk_bf16_f32 v201, v110, v111
    v_cvt_pk_bf16_f32 v202, v112, v113
    v_cvt_pk_bf16_f32 v203, v114, v115
    s_waitcnt lgkmcnt(0)
    buffer_store_dwordx4 v[44:47], v5, s[20:23], s47 offen offset:128 sc1
    ds_write_b128 v2, v[200:203] offset:0
    v_accvgpr_read_b32 v168, a136
    v_accvgpr_read_b32 v169, a137
    v_accvgpr_read_b32 v170, a138
    v_accvgpr_read_b32 v171, a139
    v_accvgpr_read_b32 v172, a140
    v_accvgpr_read_b32 v173, a141
    v_accvgpr_read_b32 v174, a142
    v_accvgpr_read_b32 v175, a143
    v_pk_fma_f32 v[116:117], v[168:169], v[248:249], v[116:117]
    v_pk_fma_f32 v[118:119], v[170:171], v[250:251], v[118:119]
    v_pk_fma_f32 v[120:121], v[172:173], v[252:253], v[120:121]
    v_pk_fma_f32 v[122:123], v[174:175], v[254:255], v[122:123]
    v_cvt_pk_bf16_f32 v204, v116, v117
    v_cvt_pk_bf16_f32 v205, v118, v119
    v_cvt_pk_bf16_f32 v206, v120, v121
    v_cvt_pk_bf16_f32 v207, v122, v123
    buffer_store_dwordx4 v[48:51], v5, s[20:23], s47 offen offset:3200 sc1
    ds_write_b128 v3, v[204:207] offset:0
    ds_read_b128 v[36:39], v4 offset:0
    ds_read_b128 v[40:43], v4 offset:1024
    s_waitcnt lgkmcnt(0)
    buffer_store_dwordx4 v[36:39], v5, s[20:23], s47 offen offset:256 sc1
    buffer_store_dwordx4 v[40:43], v5, s[20:23], s47 offen offset:3328 sc1
    s_endpgm
L_exit:
    s_endpgm
.p2align 3
.type L_wgtab,@object
L_wgtab:
    .long 0xfffeae80, 0x000d1101
    .long 0xffff9e80, 0x010c1200
    .long 0xffff2680, 0x000d1200
    .long 0x007c4e80, 0x010b1200
    .long 0x0062b680, 0x010c1200
    .long 0x00f7ae80, 0x010c1200
    .long 0x00632e80, 0x010c1200
    .long 0x00d66680, 0x010c1200
    .long 0xfffec680, 0x000d1200
    .long 0xffffb680, 0x010c1200
    .long 0xffff3e80, 0x000d1200
    .long 0x007c6680, 0x010b1200
    .long 0x0062ce80, 0x010c1200
    .long 0x00f7c680, 0x010c1200
    .long 0x00634680, 0x010c1200
    .long 0x00e62680, 0x010c1200
    .long 0xfffede80, 0x000d1200
    .long 0xffffce80, 0x000c1200
    .long 0xffff5680, 0x000d1200
    .long 0x007c7e80, 0x000b1200
    .long 0x00722e80, 0x000d1101
    .long 0x00f7de80, 0x000c1200
    .long 0x0072a680, 0x000d1200
    .long 0x00f5e680, 0x000c1200
    .long 0xfffef680, 0x000d1200
    .long 0xffffe680, 0x000c1100
    .long 0xffff6e80, 0x000d1200
    .long 0x007c9680, 0x000b1100
    .long 0x00724680, 0x000d1200
    .long 0x00f7f680, 0x000c1100
    .long 0x0072be80, 0x000d1200
    .long 0x0105a680, 0x000c1200
    .long 0xffff0e80, 0x000d1200
    .long 0x000f5e80, 0x010c1200
    .long 0xffff8680, 0x000d1200
    .long 0x008abe80, 0x010c1200
    .long 0x00725e80, 0x000d1200
    .long 0x01076e80, 0x010c1200
    .long 0x0072d680, 0x000d1200
    .long 0x01156680, 0x010c1200
    .long 0x000fbe80, 0x000d1101
    .long 0x000f7680, 0x010c1200
    .long 0x00103680, 0x000d1200
    .long 0x008ad680, 0x010c1200
    .long 0x00727680, 0x000d1200
    .long 0x01078680, 0x010c1200
    .long 0x0072ee80, 0x000d1200
    .long 0x00d64e80, 0x010c1200
    .long 0x000fd680, 0x000d1200
    .long 0x000f8e80, 0x000c1200
    .long 0x00104e80, 0x000d1200
    .long 0x008aee80, 0x000c1200
    .long 0x00728e80, 0x000d1200
    .long 0x01079e80, 0x000c1200
    .long 0x00730680, 0x000d1200
    .long 0x00e60e80, 0x000c1200
    .long 0x000fee80, 0x000d1200
    .long 0x000fa680, 0x000c1100
    .long 0x00106680, 0x000d1200
    .long 0x008b0680, 0x000c1100
    .long 0x00833e80, 0x010c1101
    .long 0x0107b680, 0x000c1100
    .long 0x0083b680, 0x010c1200
    .long 0x00f5ce80, 0x000c1200
    .long 0x00100680, 0x000d1200
    .long 0x001f1e80, 0x010c1200
    .long 0x00107e80, 0x000d1200
    .long 0x009a7e80, 0x010c1200
    .long 0x00835680, 0x010c1200
    .long 0x01172e80, 0x010b1200
    .long 0x0083ce80, 0x010c1200
    .long 0x01058e80, 0x010c1200
    .long 0x00101e80, 0x000d1200
    .long 0x001f3680, 0x010c1200
    .long 0x00109680, 0x000d1200
    .long 0x009a9680, 0x010c1200
    .long 0x00836e80, 0x010c1200
    .long 0x01174680, 0x010b1200
    .long 0x0083e680, 0x010c1200
    .long 0x01154e80, 0x010c1200
    .long 0x0020ce80, 0x010c1101
    .long 0x001f4e80, 0x000c1200
    .long 0x00214680, 0x010c1200
    .long 0x009aae80, 0x000c1200
    .long 0x00838680, 0x010c1200
    .long 0x01175e80, 0x000b1200
    .long 0x0083fe80, 0x010c1200
    .long 0x00d63680, 0x000c1200
    .long 0x0020e680, 0x010c1200
    .long 0x001f6680, 0x000c1100
    .long 0x00215e80, 0x010c1200
    .long 0x009ac680, 0x000c1100
    .long 0x00839e80, 0x010c1200
    .long 0x01177680, 0x000b1100
    .long 0x00841680, 0x010c1200
    .long 0x00e5f680, 0x000c1200
    .long 0x0020fe80, 0x010c1200
    .long 0x002ede80, 0x010b1200
    .long 0x00217680, 0x010c1200
    .long 0x00aa3e80, 0x010c1200
    .long 0x0092fe80, 0x000d1101
    .long 0x00d6c680, 0x010c1200
    .long 0x00937680, 0x000d1200
    .long 0x00f5b680, 0x010c1200
    .long 0x00211680, 0x010c1200
    .long 0x002ef680, 0x010b1200
    .long 0x00218e80, 0x010c1200
    .long 0x00aa5680, 0x010c1200
    .long 0x00931680, 0x000d1200
    .long 0x00e68680, 0x010c1200
    .long 0x00938e80, 0x000d1200
    .long 0x01057680, 0x010c1200
    .long 0x00212e80, 0x010c1200
    .long 0x002f0e80, 0x000b1200
    .long 0x0021a680, 0x010c1200
    .long 0x00aa6e80, 0x000c1200
    .long 0x00932e80, 0x000d1200
    .long 0x00f64680, 0x000c1200
    .long 0x0093a680, 0x000d1200
    .long 0x01153680, 0x000c1200
    .long 0x00308e80, 0x000d1101
    .long 0x002f2680, 0x000b1100
    .long 0x00310680, 0x000d1200
    .long 0x00aa8680, 0x000c1100
    .long 0x00934680, 0x000d1200
    .long 0x01060680, 0x000c1200
    .long 0x0093be80, 0x000d1200
    .long 0x00d61e80, 0x000c1200
    .long 0x0030a680, 0x000d1200
    .long 0x003d4e80, 0x010c1200
    .long 0x00311e80, 0x000d1200
    .long 0x00b9fe80, 0x010c1200
    .long 0x00935e80, 0x000d1200
    .long 0x0115c680, 0x010c1200
    .long 0x0093d680, 0x000d1200
    .long 0x00e5de80, 0x010c1200
    .long 0x0030be80, 0x000d1200
    .long 0x003d6680, 0x010c1200
    .long 0x00313680, 0x000d1200
    .long 0x00ba1680, 0x010c1200
    .long 0x00a40e80, 0x000d1101
    .long 0x00d6ae80, 0x010c1200
    .long 0x00a48680, 0x000d1200
    .long 0x00f59e80, 0x010c1200
    .long 0x0030d680, 0x000d1200
    .long 0x003d7e80, 0x000c1200
    .long 0x00314e80, 0x000d1200
    .long 0x00ba2e80, 0x000c1200
    .long 0x00a42680, 0x000d1200
    .long 0x00e66e80, 0x000c1200
    .long 0x00a49e80, 0x000d1200
    .long 0x01055e80, 0x000c1200
    .long 0x0030ee80, 0x000d1200
    .long 0x003d9680, 0x000c1100
    .long 0x00316680, 0x000d1200
    .long 0x00ba4680, 0x000c1100
    .long 0x00a43e80, 0x000d1200
    .long 0x00f62e80, 0x000c1200
    .long 0x00a4b680, 0x000d1200
    .long 0x01151e80, 0x000c1200
    .long 0x00419e80, 0x010c1101
    .long 0x004d0e80, 0x010c1200
    .long 0x00421680, 0x010c1200
    .long 0x00c9be80, 0x010b1200
    .long 0x00a45680, 0x000d1200
    .long 0x0105ee80, 0x010c1200
    .long 0x00a4ce80, 0x000d1200
    .long 0x00d60680, 0x010c1200
    .long 0x0041b680, 0x010c1200
    .long 0x004d2680, 0x010c1200
    .long 0x00422e80, 0x010c1200
    .long 0x00c9d680, 0x010b1200
    .long 0x00a46e80, 0x000d1200
    .long 0x0115ae80, 0x010c1200
    .long 0x00a4e680, 0x000d1200
    .long 0x00e5c680, 0x010c1200
    .long 0x0041ce80, 0x010c1200
    .long 0x004d3e80, 0x000c1200
    .long 0x00424680, 0x010c1200
    .long 0x00c9ee80, 0x000b1200
    .long 0x00b51e80, 0x010c1101
    .long 0x00d69680, 0x000c1200
    .long 0x00b59680, 0x010c1200
    .long 0x00f58680, 0x000c1200
    .long 0x0041e680, 0x010c1200
    .long 0x004d5680, 0x000c1100
    .long 0x00425e80, 0x010c1200
    .long 0x00ca0680, 0x000b1100
    .long 0x00b53680, 0x010c1200
    .long 0x00e65680, 0x000c1200
    .long 0x00b5ae80, 0x010c1200
    .long 0x01054680, 0x000c1200
    .long 0x0041fe80, 0x010c1200
    .long 0x005cce80, 0x010c1200
    .long 0x00427680, 0x010c1200
    .long 0x00d82e80, 0x010c1200
    .long 0x00b54e80, 0x010c1200
    .long 0x00f61680, 0x010c1200
    .long 0x00b5c680, 0x010c1200
    .long 0x01150680, 0x010c1200
    .long 0x00515e80, 0x000d1101
    .long 0x005ce680, 0x010c1200
    .long 0x0051d680, 0x000d1200
    .long 0x00d84680, 0x010c1200
    .long 0x00b56680, 0x010c1200
    .long 0x0105d680, 0x010c1200
    .long 0x00b5de80, 0x010c1200
    .long 0x00d5ee80, 0x010c1101
    .long 0x00517680, 0x000d1200
    .long 0x005cfe80, 0x000c1200
    .long 0x0051ee80, 0x000d1200
    .long 0x00d85e80, 0x000c1200
    .long 0x00b57e80, 0x010c1200
    .long 0x01159680, 0x000c1200
    .long 0x00b5f680, 0x010c1200
    .long 0x00e5ae80, 0x000c1101
    .long 0x00518e80, 0x000d1200
    .long 0x005d1680, 0x000c1100
    .long 0x00520680, 0x000d1200
    .long 0x00d87680, 0x000c1100
    .long 0x00c4de80, 0x000d1101
    .long 0x00d67e80, 0x000c1200
    .long 0x00c55680, 0x000d1200
    .long 0x00f56e80, 0x000c1101
    .long 0x0051a680, 0x000d1200
    .long 0x006c8e80, 0x010c1200
    .long 0x00521e80, 0x000d1200
    .long 0x00e7ee80, 0x010c1200
    .long 0x00c4f680, 0x000d1200
    .long 0x00e63e80, 0x010c1200
    .long 0x00c56e80, 0x000d1200
    .long 0x01052e80, 0x010c1101
    .long 0x0051be80, 0x000d1200
    .long 0x006ca680, 0x010c1200
    .long 0x00523680, 0x000d1200
    .long 0x00e80680, 0x010c1200
    .long 0x00c50e80, 0x000d1200
    .long 0x00f5fe80, 0x010c1200
    .long 0x00c58680, 0x000d1200
    .long 0x0114ee80, 0x010c1101
    .long 0x00626e80, 0x010c1101
    .long 0x006cbe80, 0x000c1200
    .long 0x0062e680, 0x010c1200
    .long 0x00e81e80, 0x000c1200
    .long 0x00c52680, 0x000d1200
    .long 0x0105be80, 0x000c1200
    .long 0x00c59e80, 0x000d1200
    .long 0x00629e80, 0x000c1200
    .long 0x00628680, 0x010c1200
    .long 0x006cd680, 0x000c1100
    .long 0x0062fe80, 0x010c1200
    .long 0x00e83680, 0x000c1100
    .long 0x00c53e80, 0x000d1200
    .long 0x01157e80, 0x000c1200
    .long 0x00c5b680, 0x000d1200
    .long 0x00631680, 0x000c1200
.size L_wgtab, 2048
.section .rodata,"a"
.p2align 6
.amdhsa_kernel standalone__modern_conv_block_convnext__vision_kernel
  .amdhsa_next_free_vgpr 512
  .amdhsa_next_free_sgpr 102
  .amdhsa_accum_offset 256
  .amdhsa_group_segment_fixed_size 0
  .amdhsa_kernarg_size 80
  .amdhsa_user_sgpr_count 2
  .amdhsa_user_sgpr_kernarg_segment_ptr 1
  .amdhsa_system_sgpr_workgroup_id_x 1
.end_amdhsa_kernel
```
